```python
import torch

def _softmax(x, axis=-1):
    return torch.softmax(x, dim=axis)
def _gelu(x):
    return torch.nn.functional.gelu(x, approximate="tanh")
def _silu(x):
    return torch.nn.functional.silu(x)
def _sigmoid(x):
    return torch.sigmoid(x)
def _layernorm(x, axis=-1, eps=1e-5):
    m = x.mean(dim=axis, keepdim=True)
    v = x.var(dim=axis, keepdim=True, unbiased=False)
    return (x - m) / torch.sqrt(v + eps)
def _scatter_add(tgt, idx, src, axis=0):
    return tgt.clone().index_add_(axis, idx, src)
def _segment_sum(src, seg, n):
    out = torch.zeros((n,) + src.shape[1:], dtype=src.dtype)
    return out.index_add_(0, seg, src)
def _pad(x, pw):
    flat = tuple(v for pair in reversed(pw) for v in pair)
    return torch.nn.functional.pad(x, flat)

kernel_name = 'sequential_preLN__grouped_kv_mqa__dense_activation_silu__prompt'

def setup_inputs():

    _w = (lambda a: (lambda t: t.to(torch.bfloat16) if t.is_floating_point() else t)(torch.as_tensor(a)))
    def _A_setup():
        B, S, D, H = 1, 2048, 576, 32
        Dh = D // H
        return {
            "x": _w((lambda *s: torch.randn(*s, dtype=torch.bfloat16) * 0.05)(B, S, D)),
            "wq": _w((lambda *s: torch.randn(*s, dtype=torch.bfloat16) * 0.05)(D, H * Dh)),
            "wk": _w((lambda *s: torch.randn(*s, dtype=torch.bfloat16) * 0.05)(D, Dh)),
            "wv": _w((lambda *s: torch.randn(*s, dtype=torch.bfloat16) * 0.05)(D, Dh)),
            "wo": _w((lambda *s: torch.randn(*s, dtype=torch.bfloat16) * 0.05)(H * Dh, D)),
        }
    _A_in = _A_setup()

    def _B_setup():
        B, S, D, F = 1, 2048, 576, 4608
        return {
            "x": _w((lambda *s: torch.randn(*s, dtype=torch.bfloat16) * 0.05)(B, S, D)),
            "w1": _w((lambda *s: torch.randn(*s, dtype=torch.bfloat16) * 1.6)(D, F) * (D ** -0.5)),
            "w2": _w((lambda *s: torch.randn(*s, dtype=torch.bfloat16) * 0.2)(F, D) * (F ** -0.5)),
        }
    _B_in = _B_setup()

    return {
        "A_x": _A_in["x"],
        "A_wq": _A_in["wq"],
        "A_wk": _A_in["wk"],
        "A_wv": _A_in["wv"],
        "A_wo": _A_in["wo"],
        "B_x": _B_in["x"],
        "B_w1": _B_in["w1"],
        "B_w2": _B_in["w2"],
    }

def reference(A_x, A_wq, A_wk, A_wv, A_wo, B_x, B_w1, B_w2):
    def _A_ref(x, wq, wk, wv, wo):
        B, S, D = x.shape
        H = 32
        Dh = D // H
        q = (lambda x, *d: x.permute(*d))((x @ wq).reshape(B, S, H, Dh), 0, 2, 1, 3)
        k = x @ wk
        v = x @ wv
        scores = torch.einsum("bhqd,bkd->bhqk", q, k) * (Dh ** -0.5)
        p = _softmax(scores, axis=-1)
        o = torch.einsum("bhqk,bkd->bhqd", p, v)
        return (lambda x, *d: x.permute(*d))(o, 0, 2, 1, 3).reshape(B, S, H * Dh) @ wo

    def _B_ref(x, w1, w2):
        h = torch.einsum("bsd,df->bsf", x, w1)
        h = _silu(h)
        out = torch.einsum("bsf,fd->bsd", h, w2)
        return out

    x = A_x
    h = x + _A_ref(_layernorm(x, axis=-1), A_wq, A_wk, A_wv, A_wo)
    h2 = h + _B_ref(_layernorm(h, axis=-1), B_w1, B_w2)
    return h2
```

```asm
; @launch grid=(256,1,1) block=(256,1,1) lds=163840
.amdgcn_target "amdgcn-amd-amdhsa--gfx950"
.text
.globl sequential_preLN__grouped_kv_mqa__dense_activation_silu__prompt_kernel
.p2align 12
.type sequential_preLN__grouped_kv_mqa__dense_activation_silu__prompt_kernel,@function
sequential_preLN__grouped_kv_mqa__dense_activation_silu__prompt_kernel:
    s_cmp_ge_u32 s2, 256
    s_cbranch_scc1 sequential_preLN__grouped_kv_mqa__dense_activation_silu__prompt_kernel_end
    s_load_dwordx16 s[64:79], s[0:1], 0
    s_load_dwordx4 s[8:11], s[0:1], 72
    s_load_dwordx2 s[12:13], s[0:1], 64
    s_getpc_b64 s[24:25]
    s_lshr_b32 s17, s2, 3
    s_and_b32 s24, s24, 0xffffff00
    s_mov_b32 s26, sequential_preLN__grouped_kv_mqa__dense_activation_silu__prompt_kernel_end-sequential_preLN__grouped_kv_mqa__dense_activation_silu__prompt_kernel
    s_mov_b32 s27, 0x00020000
    s_and_b32 s17, s17, 7
    s_lshl_b32 s17, s17, 14
    v_lshlrev_b32 v1, 6, v0
    buffer_load_dword a0, v1, s[24:27], s17 offen
    s_and_b32 s15, s2, 1
    s_lshl_b32 s15, s15, 2
    s_lshr_b32 s14, s2, 3
    s_and_b32 s17, s14, 3
    s_or_b32 s15, s15, s17
    s_lshr_b32 s14, s14, 2
    s_and_b32 s17, s14, 1
    s_lshr_b32 s14, s14, 1
    s_lshl_b32 s14, s14, 3
    s_or_b32 s14, s14, s17
    s_and_b32 s17, s2, 6
    s_or_b32 s14, s14, s17
    v_lshrrev_b32 v2, 6, v0
    v_and_b32 v1, 63, v0
    s_mov_b32 s42, 0x3f803f80
    v_readfirstlane_b32 s16, v2
    v_lshrrev_b32 v3, 3, v1
    v_and_b32 v4, 7, v1
    v_lshrrev_b32 v5, 4, v1
    v_mul_u32_u24 v6, 1152, v3
    s_and_b32 s17, s16, 1
    s_lshl_b32 s17, s17, 2
    v_or_b32 v5, s17, v5
    v_xor_b32 v5, v5, v4
    v_lshl_add_u32 v240, v5, 4, v6
    v_lshl_add_u32 v6, v4, 7, v6
    v_mul_u32_u24 v7, 43, v1
    v_lshrrev_b32 v7, 7, v7
    v_mul_u32_u24 v8, 12, v7
    v_lshlrev_b32 v2, 4, v1
    v_sub_u32 v242, v2, v8
    s_lshl_b32 s17, s14, 3
    s_and_b32 s18, s15, 1
    s_lshl_b32 s18, s18, 2
    s_add_u32 s17, s17, s16
    s_add_u32 s17, s17, s18
    s_mul_i32 s98, s17, 9216
    s_xor_b32 s17, s17, 4
    s_mul_i32 s99, s17, 9216
    s_mul_i32 s100, s16, 9216
    s_mul_i32 s101, s16, 768
    s_mul_i32 s40, s16, 576
    s_lshr_b32 s19, s2, 3
    s_lshl_b32 s19, s19, 2
    s_add_u32 s19, s19, s16
    s_mul_i32 s19, s19, 5760
    s_lshr_b32 s17, s15, 2
    s_lshl_b32 s17, s17, 9
    s_add_u32 s19, s19, s17
    s_mov_b32 s34, 2359296
    s_mov_b32 s35, 0x00020000
    s_mov_b32 s58, 663552
    s_mov_b32 s59, 0x00020000
    s_mov_b32 s38, 268435456
    s_mov_b32 s39, 0x00020000
    s_lshl_b32 s17, s2, 2
    s_add_u32 s18, s17, s16
    s_add_u32 m0, s100, 0
    s_cmp_lt_u32 s15, 4
    s_cselect_b32 s6, 20736, 0
    s_mov_b32 s7, 0x00020000
    s_cmp_lt_u32 s15, 2
    s_waitcnt lgkmcnt(0)
    s_mov_b64 s[32:33], s[64:65]
    s_cselect_b32 s4, s68, s70
    s_cselect_b32 s5, s69, s71
    s_mov_b64 s[56:57], s[66:67]
    s_mov_b64 s[36:37], s[10:11]
    s_cmp_eq_u32 s18, 5
    s_cbranch_scc0 p1_noclr
    v_mov_b32 v10, 0
    v_mov_b32 v11, 0
    v_mov_b32 v12, 0
    v_mov_b32 v13, 0
    v_lshlrev_b32 v9, 6, v1
    s_mov_b32 s17, 3375104
    buffer_store_dwordx2 v[10:11], v9, s[36:39], s17 offen sc1
    buffer_store_dwordx4 v[10:13], v9, s[36:39], s17 offen offset:16 sc1
    buffer_store_dwordx4 v[10:13], v9, s[36:39], s17 offen offset:32 sc1
p1_noclr:
    s_add_u32 s17, s40, 0
    buffer_load_dwordx4 v240, s[32:35], s98 offen offset:0 lds
    s_add_u32 m0, s101, 132096
    s_mov_b32 exec_hi, 0xffff
    buffer_load_dwordx4 v242, s[4:7], s17 offen lds
    s_mov_b32 exec_lo, 0x1f1f1f1f
    s_mov_b32 exec_hi, 0x1f
    buffer_load_dword a1, v6, s[56:59], s19 offen
    s_mov_b32 exec_lo, -1
    s_mov_b32 exec_hi, -1
    s_add_u32 m0, s100, 896
    s_add_u32 s17, s40, 2304
    buffer_load_dwordx4 v240, s[32:35], s98 offen offset:128 lds
    s_add_u32 m0, s101, 135168
    s_mov_b32 exec_hi, 0xffff
    buffer_load_dwordx4 v242, s[4:7], s17 offen lds
    s_mov_b32 exec_hi, -1
    s_add_u32 m0, s100, 1792
    s_add_u32 s17, s40, 4608
    buffer_load_dwordx4 v240, s[32:35], s98 offen offset:256 lds
    s_add_u32 m0, s101, 138240
    s_mov_b32 exec_hi, 0xffff
    buffer_load_dwordx4 v242, s[4:7], s17 offen lds
    s_mov_b32 exec_hi, -1
    s_add_u32 m0, s100, 2688
    s_add_u32 s17, s40, 6912
    buffer_load_dwordx4 v240, s[32:35], s98 offen offset:384 lds
    s_add_u32 m0, s101, 141312
    s_mov_b32 exec_hi, 0xffff
    buffer_load_dwordx4 v242, s[4:7], s17 offen lds
    s_mov_b32 exec_hi, -1
    s_add_u32 m0, s100, 3584
    s_add_u32 s17, s40, 9216
    buffer_load_dwordx4 v240, s[32:35], s98 offen offset:512 lds
    s_add_u32 m0, s101, 144384
    s_mov_b32 exec_hi, 0xffff
    buffer_load_dwordx4 v242, s[4:7], s17 offen lds
    s_mov_b32 exec_hi, -1
    s_mov_b32 s64, s8
    s_mov_b32 s65, s9
    s_mov_b32 s66, 256
    s_mov_b32 s67, 0x00020000
    s_mov_b32 s8, s12
    s_mov_b32 s9, s13
    s_mov_b32 s10, 2359296
    s_mov_b32 s11, 0x00020000
    v_and_b32 v6, 31, v1
    v_mov_b32 v7, 18
    v_cmp_eq_u32 vcc, 22, v6
    v_lshrrev_b32 v8, 5, v1
    v_mul_u32_u24 v8, 320, v8
    v_cndmask_b32 v6, v6, v7, vcc
    v_mov_b32 v7, 0x7ffffff0
    v_cmp_gt_u32 vcc, 19, v6
    v_lshl_add_u32 v3, v6, 4, v8
    s_nop 0
    v_cndmask_b32 v3, v7, v3, vcc
    s_mul_i32 s43, s16, 36864
    s_add_u32 s43, s43, 3145728
    s_lshl_b32 s21, s16, 12
    s_add_u32 s21, s21, 3342336
    v_lshrrev_b32 v4, 2, v1
    v_and_b32 v5, 3, v1
    s_lshl_b32 s54, s2, 2
    s_add_u32 s54, s54, s16
    s_mul_i32 s61, s16, 9216
    s_add_u32 s61, s61, 36864
    s_cmp_ge_u32 s54, 576
    s_cselect_b32 s49, 1, 0
    s_cselect_b32 s24, s78, s76
    s_cselect_b32 s25, s79, s77
    s_mov_b32 s26, 5308416
    s_mov_b32 s27, 0x00020000
    s_mov_b32 s50, 9216
    s_cmov_b32 s50, 1152
    s_mov_b32 s52, 1152
    s_cmov_b32 s52, 663552
    s_cselect_b32 s46, 576, 0
    s_sub_u32 s46, s54, s46
    s_mul_i32 s47, s46, 911
    s_lshr_b32 s47, s47, 16
    s_mul_i32 s48, s47, 72
    s_sub_u32 s48, s46, s48
    s_and_b32 s46, s48, 1
    s_lshr_b32 s48, s48, 1
    s_mul_i32 s51, s48, s50
    s_lshl_b32 s51, s51, 4
    s_mul_i32 s52, s52, s47
    s_add_u32 s51, s51, s52
    s_mul_i32 s52, s46, 576
    s_add_u32 s44, s51, s52
    v_mul_lo_u32 v7, v4, s50
    v_lshl_add_u32 v252, v5, 4, v7
    s_lshr_b32 s51, s48, 3
    s_add_u32 s51, s51, s48
    s_mul_i32 s52, s48, 9
    s_sub_u32 s52, s52, 280
    s_cmp_ge_u32 s48, 32
    s_cselect_b32 s51, s52, s51
    s_cmp_eq_u32 s49, 1
    s_cselect_b32 s48, s51, s48
    s_mul_i32 s46, s46, 9
    v_add_u32 v7, s46, v1
    v_and_b32 v8, 1, v7
    v_lshrrev_b32 v9, 1, v7
    v_subrev_u32 v9, s47, v9
    v_and_b32 v9, 7, v9
    v_cmp_gt_u32 vcc, 16, v7
    v_cmp_eq_u32 s[52:53], 0, v9
    v_lshrrev_b32 v10, 2, v7
    v_and_b32 v11, 3, v7
    v_cndmask_b32 v9, 0, v9, vcc
    s_and_b64 s[52:53], s[52:53], vcc
    s_not_b64 vcc, vcc
    s_cmp_eq_u32 s49, 1
    s_cselect_b64 s[52:53], s[52:53], vcc
    s_cselect_b64 vcc, -1, 0
    v_and_b32 v12, 1, v9
    v_lshl_add_u32 v12, v12, 1, v8
    v_lshrrev_b32 v13, 1, v9
    v_cndmask_b32 v10, v10, v12, vcc
    v_cndmask_b32 v11, v11, v13, vcc
    s_mul_i32 s51, s48, 57
    s_lshr_b32 s51, s51, 9
    s_mul_i32 s50, s51, 9
    s_sub_u32 s48, s48, s50
    s_and_b32 s50, s51, 1
    v_lshl_add_u32 v8, v8, 1, s50
    v_cndmask_b32 v10, v10, v8, s[52:53]
    s_lshl2_add_u32 s46, s49, 1
    v_add_u32 v11, s46, v11
    v_mul_u32_u24 v11, 288, v11
    v_mov_b32 v12, s50
    v_mov_b32 v13, s49
    v_cndmask_b32 v11, v11, v12, s[52:53]
    v_cndmask_b32 v13, 0, v13, s[52:53]
    v_sub_u32 v12, s51, v10
    v_add_u32 v12, v12, v13
    v_and_b32 v12, 3, v12
    s_lshr_b32 s50, s48, 1
    s_and_b32 s46, s48, 1
    s_lshl2_add_u32 s50, s50, s46
    v_lshl_add_u32 v13, v12, 4, s50
    v_and_b32 v8, 1, v12
    v_lshrrev_b32 v12, 1, v12
    v_lshl_add_u32 v12, v8, 2, v12
    v_add_u32 v12, 64, v12
    s_cmp_eq_u32 s48, 8
    s_cselect_b64 vcc, -1, 0
    v_mul_u32_u24 v10, 2592, v10
    v_cndmask_b32 v12, v13, v12, vcc
    s_mul_i32 s51, s47, 10368
    s_add_u32 s51, s51, 32768
    v_lshl_add_u32 v12, v12, 2, v11
    v_add_u32 v12, v12, v10
    v_add_lshl_u32 v12, v12, s51, 7
    s_nop 0
    v_readlane_b32 s80, v12, 0
    v_readlane_b32 s81, v12, 1
    v_readlane_b32 s82, v12, 2
    v_readlane_b32 s83, v12, 3
    v_readlane_b32 s84, v12, 4
    v_readlane_b32 s85, v12, 5
    v_readlane_b32 s86, v12, 6
    v_readlane_b32 s87, v12, 7
    v_readlane_b32 s88, v12, 8
    v_and_b32 v7, 1, v1
    v_bfe_u32 v8, v1, 1, 1
    v_lshlrev_b32 v7, 4, v7
    v_lshl_add_u32 v7, v8, 3, v7
    v_bfe_u32 v8, v1, 4, 1
    v_lshl_add_u32 v7, v8, 5, v7
    v_bfe_u32 v8, v1, 2, 2
    v_lshl_add_u32 v7, v8, 6, v7
    v_lshrrev_b32 v8, 5, v1
    v_lshl_add_u32 v7, v8, 9, v7
    v_add_u32 v244, s61, v7
    s_lshl_b32 s60, s16, 11
    s_add_u32 s60, s60, 147456
    v_add_u32 v245, s60, v7
    s_lshr_b32 s18, s2, 1
    s_add_u32 s18, s18, 1024
    s_cmp_ge_u32 s18, 576
    s_cselect_b32 s49, 1, 0
    s_cselect_b32 s28, s78, s76
    s_cselect_b32 s29, s79, s77
    s_mov_b32 s30, 5308416
    s_mov_b32 s31, 0x00020000
    s_mov_b32 s50, 9216
    s_cmov_b32 s50, 1152
    s_mov_b32 s52, 1152
    s_cmov_b32 s52, 663552
    s_cselect_b32 s46, 576, 0
    s_sub_u32 s46, s18, s46
    s_mul_i32 s47, s46, 911
    s_lshr_b32 s47, s47, 16
    s_mul_i32 s48, s47, 72
    s_sub_u32 s48, s46, s48
    s_and_b32 s46, s48, 1
    s_lshr_b32 s48, s48, 1
    s_mul_i32 s51, s48, s50
    s_lshl_b32 s51, s51, 4
    s_mul_i32 s52, s52, s47
    s_add_u32 s51, s51, s52
    s_mul_i32 s52, s46, 576
    s_add_u32 s45, s51, s52
    v_mul_lo_u32 v7, v4, s50
    v_lshl_add_u32 v253, v5, 4, v7
    s_lshr_b32 s51, s48, 3
    s_add_u32 s51, s51, s48
    s_mul_i32 s52, s48, 9
    s_sub_u32 s52, s52, 280
    s_cmp_ge_u32 s48, 32
    s_cselect_b32 s51, s52, s51
    s_cmp_eq_u32 s49, 1
    s_cselect_b32 s48, s51, s48
    s_mul_i32 s46, s46, 9
    v_add_u32 v7, s46, v1
    v_and_b32 v8, 1, v7
    v_lshrrev_b32 v9, 1, v7
    v_subrev_u32 v9, s47, v9
    v_and_b32 v9, 7, v9
    v_cmp_gt_u32 vcc, 16, v7
    v_cmp_eq_u32 s[52:53], 0, v9
    v_lshrrev_b32 v10, 2, v7
    v_and_b32 v11, 3, v7
    v_cndmask_b32 v9, 0, v9, vcc
    s_and_b64 s[52:53], s[52:53], vcc
    s_not_b64 vcc, vcc
    s_cmp_eq_u32 s49, 1
    s_cselect_b64 s[52:53], s[52:53], vcc
    s_cselect_b64 vcc, -1, 0
    v_and_b32 v12, 1, v9
    v_lshl_add_u32 v12, v12, 1, v8
    v_lshrrev_b32 v13, 1, v9
    v_cndmask_b32 v10, v10, v12, vcc
    v_cndmask_b32 v11, v11, v13, vcc
    s_mul_i32 s51, s48, 57
    s_lshr_b32 s51, s51, 9
    s_mul_i32 s50, s51, 9
    s_sub_u32 s48, s48, s50
    s_and_b32 s50, s51, 1
    v_lshl_add_u32 v8, v8, 1, s50
    v_cndmask_b32 v10, v10, v8, s[52:53]
    s_lshl2_add_u32 s46, s49, 1
    v_add_u32 v11, s46, v11
    v_mul_u32_u24 v11, 288, v11
    v_mov_b32 v12, s50
    v_mov_b32 v13, s49
    v_cndmask_b32 v11, v11, v12, s[52:53]
    v_cndmask_b32 v13, 0, v13, s[52:53]
    v_sub_u32 v12, s51, v10
    v_add_u32 v12, v12, v13
    v_and_b32 v12, 3, v12
    s_lshr_b32 s50, s48, 1
    s_and_b32 s46, s48, 1
    s_lshl2_add_u32 s50, s50, s46
    v_lshl_add_u32 v13, v12, 4, s50
    v_and_b32 v8, 1, v12
    v_lshrrev_b32 v12, 1, v12
    v_lshl_add_u32 v12, v8, 2, v12
    v_add_u32 v12, 64, v12
    s_cmp_eq_u32 s48, 8
    s_cselect_b64 vcc, -1, 0
    v_mul_u32_u24 v10, 2592, v10
    v_cndmask_b32 v12, v13, v12, vcc
    s_mul_i32 s51, s47, 10368
    s_add_u32 s51, s51, 32768
    v_lshl_add_u32 v12, v12, 2, v11
    v_add_u32 v12, v12, v10
    v_add_lshl_u32 v12, v12, s51, 7
    s_and_b32 s46, s2, 1
    s_lshl2_add_u32 s46, s46, s16
    s_lshl_b32 s47, s46, 6
    s_add_u32 s91, s45, s47
    v_readlane_b32 s89, v12, s46
    v_readlane_b32 s90, v12, 8
    s_add_u32 m0, s100, 4480
    s_add_u32 s17, s40, 11520
    buffer_load_dwordx4 v240, s[32:35], s98 offen offset:640 lds
    s_add_u32 m0, s101, 147456
    s_mov_b32 exec_hi, 0xffff
    buffer_load_dwordx4 v242, s[4:7], s17 offen lds
    s_mov_b32 exec_hi, -1
    s_add_u32 m0, s100, 5376
    s_add_u32 s17, s40, 13824
    buffer_load_dwordx4 v240, s[32:35], s98 offen offset:768 lds
    s_add_u32 m0, s101, 150528
    s_mov_b32 exec_hi, 0xffff
    buffer_load_dwordx4 v242, s[4:7], s17 offen lds
    s_mov_b32 exec_hi, -1
    s_add_u32 m0, s100, 6272
    s_add_u32 s17, s40, 16128
    buffer_load_dwordx4 v240, s[32:35], s98 offen offset:896 lds
    s_add_u32 m0, s101, 153600
    s_mov_b32 exec_hi, 0xffff
    buffer_load_dwordx4 v242, s[4:7], s17 offen lds
    s_mov_b32 exec_hi, -1
    s_add_u32 m0, s100, 7168
    s_add_u32 s17, s40, 18432
    buffer_load_dwordx4 v240, s[32:35], s98 offen offset:1024 lds
    s_add_u32 m0, s101, 156672
    s_mov_b32 exec_hi, 0xffff
    buffer_load_dwordx4 v242, s[4:7], s17 offen lds
    s_mov_b32 exec_hi, -1
    s_mov_b32 s4, s72
    s_mov_b32 s5, s73
    s_mov_b32 s6, 663552
    s_mov_b32 s7, 0x00020000
    v_lshrrev_b32 v8, 2, v1
    v_and_b32 v9, 4, v8
    v_and_b32 v4, 7, v1
    v_xor_b32 v9, v9, v4
    v_lshlrev_b32 v9, 4, v9
    v_lshrrev_b32 v6, 3, v1
    v_mul_u32_u24 v7, 1152, v6
    v_add_u32 v7, v7, v9
    v_accvgpr_write_b32 a248, v7
    v_lshrrev_b32 v10, 4, v1
    v_mul_u32_u24 v10, 20736, v10
    v_and_b32 v6, 1, v6
    v_mul_u32_u24 v6, 1152, v6
    v_add3_u32 v7, v10, v6, v9
    v_accvgpr_write_b32 a249, v7
    v_and_b32 v6, 15, v1
    v_mul_u32_u24 v6, 1152, v6
    v_add_u32 v7, v10, v6
    v_accvgpr_write_b32 a250, v7
    v_lshrrev_b32 v6, 1, v1
    v_mul_u32_u24 v6, 18, v6
    v_and_b32 v7, 1, v1
    v_add_u32 v6, v6, v7
    v_mul_u32_u24 v6, 1152, v6
    v_accvgpr_write_b32 a251, v6
    s_and_b32 s17, s16, 1
    v_lshrrev_b32 v5, 5, v1
    v_bfe_u32 v6, v1, 2, 2
    v_bfe_u32 v8, v1, 1, 1
    v_bfe_u32 v9, v1, 4, 1
    v_lshl_add_u32 v10, v5, 3, v6
    v_bfe_u32 v11, v1, 3, 1
    v_xor_b32 v11, s17, v11
    v_lshlrev_b32 v11, 6, v11
    v_lshl_add_u32 v11, v9, 5, v11
    v_lshl_add_u32 v11, v7, 4, v11
    v_lshl_add_u32 v11, v8, 3, v11
    v_lshl_add_u32 v11, v10, 7, v11
    s_lshl_b32 s18, s17, 15
    s_add_u32 s18, s18, 73728
    v_add_u32 v11, s18, v11
    v_accvgpr_write_b32 a252, v11
    v_lshlrev_b32 v10, 4, v10
    v_lshl_add_u32 v10, v8, 3, v10
    s_lshl_b32 s18, s17, 12
    s_add_u32 s18, s18, 147456
    v_add_u32 v10, s18, v10
    v_lshlrev_b32 v11, 3, v6
    v_lshl_add_u32 v11, v5, 5, v11
    s_lshl_b32 s18, s17, 11
    s_add_u32 s18, s18, 156672
    v_add_u32 v11, s18, v11
    v_cmp_eq_u32 vcc, 0, v9
    v_mov_b32 v12, 256
    s_nop 0
    v_cndmask_b32 v10, v11, v10, vcc
    v_lshrrev_b32 v12, v9, v12
    v_accvgpr_write_b32 a253, v10
    v_accvgpr_write_b32 a254, v12
    v_and_b32 v6, 31, v1
    v_mul_u32_u24 v6, 1152, v6
    v_lshl_add_u32 v6, v5, 4, v6
    v_accvgpr_write_b32 a255, v6
    s_lshl_b32 s62, s2, 2
    s_add_u32 s62, s62, s16
    s_mul_i32 s20, s62, 5120
    s_add_u32 s20, s20, 17829888
    s_mul_i32 s62, s62, 18432
    s_add_u32 s62, s62, 23072768
    v_mov_b32 v236, -1
    v_mov_b32 v237, -1
    v_mov_b32 v238, -1
    v_mov_b32 v239, -1
    s_sub_u32 s17, s16, 0
    s_and_b32 s17, s17, 3
    s_mul_i32 s17, s17, 3072
    v_add_u32 v246, s17, v2
    s_sub_u32 s17, s16, 1
    s_and_b32 s17, s17, 3
    s_mul_i32 s17, s17, 3072
    v_add_u32 v247, s17, v2
    s_sub_u32 s17, s16, 2
    s_and_b32 s17, s17, 3
    s_mul_i32 s17, s17, 3072
    v_add_u32 v248, s17, v2
    s_sub_u32 s17, s16, 3
    s_and_b32 s17, s17, 3
    s_mul_i32 s17, s17, 3072
    v_add_u32 v249, s17, v2
    s_add_u32 m0, s100, 36864
    s_nop 0
    buffer_load_dwordx4 v240, s[32:35], s99 offen offset:0 lds
    s_add_u32 m0, s100, 37760
    s_nop 0
    buffer_load_dwordx4 v240, s[32:35], s99 offen offset:128 lds
    s_add_u32 m0, s100, 38656
    s_nop 0
    buffer_load_dwordx4 v240, s[32:35], s99 offen offset:256 lds
    s_add_u32 m0, s100, 39552
    s_nop 0
    buffer_load_dwordx4 v240, s[32:35], s99 offen offset:384 lds
    s_add_u32 m0, s100, 40448
    s_nop 0
    buffer_load_dwordx4 v240, s[32:35], s99 offen offset:512 lds
    s_add_u32 m0, s100, 41344
    s_nop 0
    buffer_load_dwordx4 v240, s[32:35], s99 offen offset:640 lds
    s_add_u32 m0, s100, 42240
    s_nop 0
    buffer_load_dwordx4 v240, s[32:35], s99 offen offset:768 lds
    s_add_u32 m0, s100, 43136
    s_nop 0
    buffer_load_dwordx4 v240, s[32:35], s99 offen offset:896 lds
    s_add_u32 m0, s100, 44032
    s_nop 0
    buffer_load_dwordx4 v240, s[32:35], s99 offen offset:1024 lds
    v_lshrrev_b32 v8, 2, v1
    v_and_b32 v9, 4, v8
    v_and_b32 v4, 7, v1
    v_xor_b32 v9, v9, v4
    v_lshrrev_b32 v10, 1, v9
    v_and_b32 v9, 1, v9
    v_lshrrev_b32 v6, 3, v1
    v_mul_u32_u24 v6, 1152, v6
    v_mad_u32_u24 v6, v10, 36, v6
    v_lshl_add_u32 v232, v9, 4, v6
    v_and_b32 v9, 3, v1
    v_mul_u32_u24 v8, 1152, v8
    v_mad_u32_u24 v13, v9, 36, v8
    s_sub_u32 s17, s16, 1
    s_mul_i32 s18, s15, 144
    s_mul_i32 s40, s17, 9216
    s_add_u32 s40, s40, s18
    s_lshl_b32 s41, s17, 10
    s_mul_i32 s98, s17, 18432
    s_add_u32 s98, s98, s18
    s_add_u32 s98, s98, 32
    s_lshl_b32 s99, s17, 8
    v_and_b32 v4, 31, v1
    v_lshrrev_b32 v5, 5, v1
    v_bfe_u32 v6, v1, 2, 2
    v_lshl_add_u32 v6, v5, 3, v6
    v_and_b32 v7, 3, v1
    v_bfe_u32 v8, v1, 4, 1
    v_lshrrev_b32 v9, 3, v4
    v_mul_u32_u24 v9, 9216, v9
    v_and_b32 v10, 7, v4
    v_lshl_add_u32 v9, v10, 7, v9
    v_bfe_u32 v10, v4, 1, 3
    v_xor_b32 v10, v10, v5
    v_xor_b32 v11, 0, v10
    v_lshl_add_u32 v220, v11, 4, v9
    v_xor_b32 v11, 2, v10
    v_lshl_add_u32 v221, v11, 4, v9
    v_xor_b32 v11, 4, v10
    v_lshl_add_u32 v222, v11, 4, v9
    v_xor_b32 v11, 6, v10
    v_lshl_add_u32 v223, v11, 4, v9
    s_lshr_b32 s17, s16, 1
    v_bfe_u32 v9, v1, 3, 1
    v_xor_b32 v9, s17, v9
    v_lshlrev_b32 v9, 6, v9
    v_lshl_add_u32 v9, v8, 5, v9
    v_lshl_add_u32 v9, v7, 3, v9
    v_lshl_add_u32 v14, v6, 7, v9
    v_add_u32 v233, 73728, v14
    s_lshl_b32 s17, s17, 3
    s_add_u32 s17, s17, 122880
    v_lshl_add_u32 v9, v6, 4, s17
    v_and_b32 v10, 1, v7
    v_cmp_eq_u32 vcc, v10, v8
    v_mov_b32 v11, 162560
    v_mov_b32 v12, 256
    v_cndmask_b32 v234, v11, v9, vcc
    v_cndmask_b32 v235, 0, v12, vcc
    v_bfe_u32 v9, v1, 2, 1
    v_cmp_eq_u32 vcc, v9, v8
    v_mov_b32 v228, s42
    v_mov_b32 v229, s42
    v_mov_b32 v230, s42
    v_mov_b32 v231, s42
    v_cndmask_b32 v224, 0, v228, vcc
    v_cndmask_b32 v225, 0, v228, vcc
    v_cndmask_b32 v226, 0, v228, vcc
    v_cndmask_b32 v227, 0, v228, vcc
    v_lshrrev_b32 v9, 1, v7
    v_lshl_add_u32 v9, v10, 1, v9
    s_cmp_lt_u32 s15, 2
    s_cselect_b64 vcc, -1, 0
    v_cndmask_b32 v9, v9, v7, vcc
    v_cmp_eq_u32 vcc, 0, v8
    s_nop 1
    v_cndmask_b32 v9, 4, v9, vcc
    v_mul_u32_u24 v15, 48, v6
    v_lshl_add_u32 v15, v9, 3, v15
    v_add_u32 v15, 132096, v15
    v_mov_b32 v9, 0
    s_mov_b32 s17, 0x20000
    v_lshl_add_u32 v12, v4, 2, s17
    v_lshl_add_u32 v8, v4, 3, s17
    v_add_u32 v7, s17, v2
    ds_write_b32 v12, v9 offset:31488
    s_lshr_b32 s17, s15, 1
    s_add_u32 s55, s17, 1
    s_cmp_lt_u32 s15, 4
    s_cselect_b32 s55, s55, 0
    s_cmp_eq_u32 s16, 0
    s_cselect_b32 s54, s55, 0
    s_lshl_b32 s22, s14, 1
    s_and_b32 s17, s15, 1
    s_add_u32 s22, s22, s17
    s_mul_i32 s23, s22, 2304
    s_add_u32 s23, s23, 3145728
    s_mov_b32 s63, 0x40000
    s_and_b32 s17, s16, 1
    s_lshr_b32 s18, s16, 1
    v_bfe_u32 v9, v1, 3, 1
    v_mul_u32_u24 v9, 9216, v9
    v_and_b32 v10, 7, v1
    v_lshl_add_u32 v9, v10, 7, v9
    v_bfe_u32 v10, v1, 1, 3
    v_lshrrev_b32 v11, 4, v1
    v_lshl_add_u32 v11, s18, 2, v11
    v_xor_b32 v10, v10, v11
    s_mul_i32 s19, s17, 18432
    v_lshl_add_u32 v9, v10, 4, v9
    v_add_u32 v250, s19, v9
    s_lshl1_add_u32 s17, s18, s17
    s_lshl_b32 s17, s17, 7
    s_add_u32 s17, s17, 0x20000
    v_and_b32 v10, 15, v1
    v_lshl_add_u32 v251, v10, 3, s17
    s_mov_b64 exec, 0
    s_cmp_eq_u32 s16, 0
    s_cbranch_scc1 wb_pad0
    s_cmp_eq_u32 s16, 1
    s_cbranch_scc1 wb_pad1
    s_cmp_eq_u32 s16, 2
    s_cbranch_scc1 wb_pad2
    s_branch wb_pad3
wb_ret:
    s_mov_b64 exec, -1
    s_cmp_lg_u32 s16, 0
    s_cbranch_scc1 p1_r123
    s_cmp_eq_u32 s55, 1
    s_cbranch_scc1 p1_rk
    s_cmp_eq_u32 s55, 2
    s_cbranch_scc1 p1_rv
    s_waitcnt vmcnt(21)
    s_barrier
    ds_read_b128 v[16:19], v220 offset:0
    ds_read_b128 v[20:23], v221 offset:0
    ds_read_b128 v[24:27], v222 offset:0
    ds_read_b128 v[28:31], v223 offset:0
    ds_read_b128 v[32:35], v220 offset:1024
    ds_read_b128 v[40:43], v222 offset:1024
    ds_read_b128 v[36:39], v221 offset:1024
    ds_read_b128 v[44:47], v223 offset:1024
    s_waitcnt vmcnt(15)
    s_barrier
    ds_read_b128 v[64:67], v220 offset:3072
    ds_read_b128 v[48:51], v220 offset:2048
    ds_read_b128 v[68:71], v221 offset:3072
    ds_read_b128 v[52:55], v221 offset:2048
    ds_read_b128 v[72:75], v222 offset:3072
    ds_read_b128 v[56:59], v222 offset:2048
    ds_read_b128 v[76:79], v223 offset:3072
    ds_read_b128 v[60:63], v223 offset:2048
    ds_read_b128 v[80:83], v220 offset:4096
    ds_read_b128 v[88:91], v222 offset:4096
    ds_read_b128 v[84:87], v221 offset:4096
    ds_read_b128 v[92:95], v223 offset:4096
    s_waitcnt vmcnt(9)
    s_barrier
    ds_read_b128 v[112:115], v220 offset:6144
    ds_read_b128 v[96:99], v220 offset:5120
    ds_read_b128 v[116:119], v221 offset:6144
    ds_read_b128 v[100:103], v221 offset:5120
    ds_read_b128 v[120:123], v222 offset:6144
    ds_read_b128 v[104:107], v222 offset:5120
    ds_read_b128 v[124:127], v223 offset:6144
    ds_read_b128 v[108:111], v223 offset:5120
    ds_read_b128 v[128:131], v220 offset:7168
    ds_read_b128 v[136:139], v222 offset:7168
    ds_read_b128 v[132:135], v221 offset:7168
    ds_read_b128 v[140:143], v223 offset:7168
    ds_read_b128 v[144:147], v220 offset:8192
    ds_read_b128 v[148:151], v221 offset:8192
    ds_read_b128 v[152:155], v222 offset:8192
    ds_read_b128 v[156:159], v223 offset:8192
    buffer_load_dword v255, off, s[64:67], 0 sc1
    s_waitcnt vmcnt(1)
    s_waitcnt lgkmcnt(0)
    s_barrier
    ds_read_b64 v[160:161], v8 offset:31744
    ds_read_b64 v[162:163], v8 offset:32000
    s_waitcnt lgkmcnt(0)
    v_add_f32 v10, v160, v162
    v_add_f32 v11, v161, v163
    v_mul_f32 v10, 0xbae38e39, v10
    v_mul_f32 v11, 0x3ae38e39, v11
    v_fma_f32 v11, -v10, v10, v11
    v_add_f32 v11, 0x3727c5ac, v11
    v_rsq_f32 v11, v11
    s_branch p1_qe
p1_rk:
    s_setprio 2
    s_waitcnt vmcnt(21)
    s_barrier
    ds_read_b64_tr_b16 v[160:161], v15 offset:0
    ds_read_b64_tr_b16 v[162:163], v15 offset:192
    ds_read_b128 v[16:19], v220 offset:0
    ds_read_b64_tr_b16 v[164:165], v15 offset:768
    ds_read_b64_tr_b16 v[166:167], v15 offset:960
    ds_read_b128 v[20:23], v221 offset:0
    ds_read_b64_tr_b16 v[168:169], v15 offset:1536
    ds_read_b64_tr_b16 v[170:171], v15 offset:1728
    ds_read_b128 v[24:27], v222 offset:0
    s_waitcnt lgkmcnt(6)
    v_mfma_f32_32x32x16_bf16 v[192:207], v[160:163], v[16:19], 0
    ds_read_b64_tr_b16 v[172:173], v15 offset:2304
    ds_read_b64_tr_b16 v[174:175], v15 offset:2496
    ds_read_b128 v[28:31], v223 offset:0
    v_mfma_f32_16x16x32_bf16 v[212:215], v[224:227], v[160:163], 0
    ds_read_b128 v[40:43], v222 offset:1024
    s_waitcnt lgkmcnt(7)
    v_mfma_f32_32x32x16_bf16 v[192:207], v[164:167], v[20:23], v[192:207]
    ds_read_b64_tr_b16 v[160:161], v15 offset:3072
    ds_read_b64_tr_b16 v[162:163], v15 offset:3264
    ds_read_b128 v[32:35], v220 offset:1024
    v_mfma_f32_16x16x32_bf16 v[212:215], v[224:227], v[164:167], v[212:215]
    ds_read_b128 v[44:47], v223 offset:1024
    s_waitcnt lgkmcnt(8)
    v_mfma_f32_32x32x16_bf16 v[192:207], v[168:171], v[24:27], v[192:207]
    ds_read_b64_tr_b16 v[164:165], v15 offset:3840
    ds_read_b64_tr_b16 v[166:167], v15 offset:4032
    ds_read_b128 v[36:39], v221 offset:1024
    v_mfma_f32_16x16x32_bf16 v[212:215], v[224:227], v[168:171], v[212:215]
    ds_read_b128 v[48:51], v220 offset:2048
    s_waitcnt lgkmcnt(9)
    v_mfma_f32_32x32x16_bf16 v[192:207], v[172:175], v[28:31], v[192:207]
    s_waitcnt vmcnt(15)
    s_barrier
    ds_read_b64_tr_b16 v[168:169], v15 offset:9216
    ds_read_b64_tr_b16 v[170:171], v15 offset:9408
    ds_read_b128 v[64:67], v220 offset:3072
    v_mfma_f32_16x16x32_bf16 v[212:215], v[224:227], v[172:175], v[212:215]
    ds_read_b128 v[52:55], v221 offset:2048
    s_waitcnt lgkmcnt(9)
    v_mfma_f32_32x32x16_bf16 v[192:207], v[160:163], v[32:35], v[192:207]
    ds_read_b64_tr_b16 v[172:173], v15 offset:9984
    ds_read_b64_tr_b16 v[174:175], v15 offset:10176
    ds_read_b128 v[68:71], v221 offset:3072
    v_mfma_f32_16x16x32_bf16 v[212:215], v[224:227], v[160:163], v[212:215]
    ds_read_b128 v[56:59], v222 offset:2048
    s_waitcnt lgkmcnt(9)
    v_mfma_f32_32x32x16_bf16 v[192:207], v[164:167], v[36:39], v[192:207]
    ds_read_b64_tr_b16 v[160:161], v15 offset:10752
    ds_read_b64_tr_b16 v[162:163], v15 offset:10944
    ds_read_b128 v[72:75], v222 offset:3072
    v_mfma_f32_16x16x32_bf16 v[212:215], v[224:227], v[164:167], v[212:215]
    ds_read_b128 v[60:63], v223 offset:2048
    s_waitcnt lgkmcnt(9)
    v_mfma_f32_32x32x16_bf16 v[192:207], v[168:171], v[64:67], v[192:207]
    ds_read_b64_tr_b16 v[164:165], v15 offset:11520
    ds_read_b64_tr_b16 v[166:167], v15 offset:11712
    ds_read_b128 v[76:79], v223 offset:3072
    v_mfma_f32_16x16x32_bf16 v[212:215], v[224:227], v[168:171], v[212:215]
    ds_read_b128 v[88:91], v222 offset:4096
    s_waitcnt lgkmcnt(9)
    v_mfma_f32_32x32x16_bf16 v[192:207], v[172:175], v[68:71], v[192:207]
    ds_read_b64_tr_b16 v[168:169], v15 offset:12288
    ds_read_b64_tr_b16 v[170:171], v15 offset:12480
    ds_read_b128 v[80:83], v220 offset:4096
    v_mfma_f32_16x16x32_bf16 v[212:215], v[224:227], v[172:175], v[212:215]
    ds_read_b128 v[92:95], v223 offset:4096
    s_waitcnt lgkmcnt(9)
    v_mfma_f32_32x32x16_bf16 v[192:207], v[160:163], v[72:75], v[192:207]
    ds_read_b64_tr_b16 v[172:173], v15 offset:13056
    ds_read_b64_tr_b16 v[174:175], v15 offset:13248
    ds_read_b128 v[84:87], v221 offset:4096
    v_mfma_f32_16x16x32_bf16 v[212:215], v[224:227], v[160:163], v[212:215]
    ds_read_b128 v[96:99], v220 offset:5120
    s_waitcnt lgkmcnt(9)
    v_mfma_f32_32x32x16_bf16 v[192:207], v[164:167], v[76:79], v[192:207]
    s_waitcnt vmcnt(9)
    s_barrier
    ds_read_b64_tr_b16 v[160:161], v15 offset:18432
    ds_read_b64_tr_b16 v[162:163], v15 offset:18624
    ds_read_b128 v[112:115], v220 offset:6144
    v_mfma_f32_16x16x32_bf16 v[212:215], v[224:227], v[164:167], v[212:215]
    ds_read_b128 v[100:103], v221 offset:5120
    s_waitcnt lgkmcnt(9)
    v_mfma_f32_32x32x16_bf16 v[192:207], v[168:171], v[80:83], v[192:207]
    ds_read_b64_tr_b16 v[164:165], v15 offset:19200
    ds_read_b64_tr_b16 v[166:167], v15 offset:19392
    ds_read_b128 v[116:119], v221 offset:6144
    v_mfma_f32_16x16x32_bf16 v[212:215], v[224:227], v[168:171], v[212:215]
    ds_read_b128 v[104:107], v222 offset:5120
    s_waitcnt lgkmcnt(9)
    v_mfma_f32_32x32x16_bf16 v[192:207], v[172:175], v[84:87], v[192:207]
    ds_read_b64_tr_b16 v[168:169], v15 offset:19968
    ds_read_b64_tr_b16 v[170:171], v15 offset:20160
    ds_read_b128 v[120:123], v222 offset:6144
    v_mfma_f32_16x16x32_bf16 v[212:215], v[224:227], v[172:175], v[212:215]
    ds_read_b128 v[108:111], v223 offset:5120
    s_waitcnt lgkmcnt(9)
    v_mfma_f32_32x32x16_bf16 v[192:207], v[160:163], v[112:115], v[192:207]
    ds_read_b64_tr_b16 v[172:173], v15 offset:20736
    ds_read_b64_tr_b16 v[174:175], v15 offset:20928
    ds_read_b128 v[124:127], v223 offset:6144
    v_mfma_f32_16x16x32_bf16 v[212:215], v[224:227], v[160:163], v[212:215]
    ds_read_b128 v[136:139], v222 offset:7168
    s_waitcnt lgkmcnt(9)
    v_mfma_f32_32x32x16_bf16 v[192:207], v[164:167], v[116:119], v[192:207]
    ds_read_b64_tr_b16 v[160:161], v15 offset:21504
    ds_read_b64_tr_b16 v[162:163], v15 offset:21696
    ds_read_b128 v[128:131], v220 offset:7168
    v_mfma_f32_16x16x32_bf16 v[212:215], v[224:227], v[164:167], v[212:215]
    ds_read_b128 v[140:143], v223 offset:7168
    s_waitcnt lgkmcnt(9)
    v_mfma_f32_32x32x16_bf16 v[192:207], v[168:171], v[120:123], v[192:207]
    ds_read_b64_tr_b16 v[164:165], v15 offset:22272
    ds_read_b64_tr_b16 v[166:167], v15 offset:22464
    ds_read_b128 v[132:135], v221 offset:7168
    v_mfma_f32_16x16x32_bf16 v[212:215], v[224:227], v[168:171], v[212:215]
    ds_read_b128 v[144:147], v220 offset:8192
    s_waitcnt lgkmcnt(9)
    v_mfma_f32_32x32x16_bf16 v[192:207], v[172:175], v[124:127], v[192:207]
    v_mfma_f32_16x16x32_bf16 v[212:215], v[224:227], v[172:175], v[212:215]
    ds_read_b128 v[148:151], v221 offset:8192
    s_waitcnt lgkmcnt(6)
    v_mfma_f32_32x32x16_bf16 v[192:207], v[160:163], v[128:131], v[192:207]
    v_mfma_f32_16x16x32_bf16 v[212:215], v[224:227], v[160:163], v[212:215]
    ds_read_b128 v[152:155], v222 offset:8192
    s_waitcnt lgkmcnt(3)
    v_mfma_f32_32x32x16_bf16 v[192:207], v[164:167], v[132:135], v[192:207]
    v_mfma_f32_16x16x32_bf16 v[212:215], v[224:227], v[164:167], v[212:215]
    ds_read_b128 v[156:159], v223 offset:8192
    buffer_load_dword v255, off, s[64:67], 0 sc1
    s_waitcnt vmcnt(1)
    s_waitcnt lgkmcnt(0)
    s_barrier
    ds_read_b64 v[164:165], v8 offset:31744
    ds_read_b64 v[166:167], v8 offset:32000
    ds_read_b32 v162, v12 offset:9728
    ds_read_b128 v[168:171], v7 offset:5632
    ds_read_b128 v[172:175], v7 offset:6656
    ds_read_b128 v[176:179], v7 offset:7680
    s_waitcnt lgkmcnt(4)
    v_add_f32 v10, v164, v166
    v_add_f32 v11, v165, v167
    v_mul_f32 v10, 0xbae38e39, v10
    v_mul_f32 v11, 0x3ae38e39, v11
    v_fma_f32 v11, -v10, v10, v11
    v_add_f32 v11, 0x3727c5ac, v11
    v_rsq_f32 v11, v11
    s_waitcnt lgkmcnt(3)
    v_add_f32 v212, v212, v162
    v_cvt_pk_bf16_f32 v160, v212, v212
    v_lshlrev_b32 v161, 16, v160
    v_sub_f32 v161, v212, v161
    v_cvt_pk_bf16_f32 v161, v161, v161
    v_cvt_pk_bf16_f32 v162, v10, v10
    v_cmp_gt_u32 vcc, 32, v1
    v_lshlrev_b32 v162, 16, v162
    v_sub_f32 v162, v10, v162
    v_cvt_pk_bf16_f32 v162, v10, v162
    v_cndmask_b32 v162, 0, v162, vcc
    v_mov_b32 v163, v162
    s_waitcnt lgkmcnt(0)
    v_add_f32 v192, v192, v168
    v_add_f32 v193, v193, v169
    v_add_f32 v194, v194, v170
    v_add_f32 v195, v195, v171
    v_add_f32 v196, v196, v172
    v_add_f32 v197, v197, v173
    v_add_f32 v198, v198, v174
    v_add_f32 v199, v199, v175
    v_add_f32 v200, v200, v176
    v_add_f32 v201, v201, v177
    s_nop 1
    v_mfma_f32_32x32x8bf16_1k v[192:207], v[160:161], v[162:163], v[192:207]
    s_lshr_b32 s17, s22, 2
    s_lshl_b32 s17, s17, 10
    s_and_b32 s18, s22, 3
    s_lshl_b32 s18, s18, 2
    s_add_u32 s17, s17, s18
    s_add_u32 s17, s17, 3342336
    s_lshl_b32 s22, s22, 6
    s_add_u32 s22, s22, 3375104
    s_nop 3
    v_mul_f32 v192, v192, v11
    v_mul_f32 v193, v193, v11
    v_mul_f32 v194, v194, v11
    v_mul_f32 v195, v195, v11
    v_mul_f32 v196, v196, v11
    v_mul_f32 v197, v197, v11
    v_mul_f32 v198, v198, v11
    v_mul_f32 v199, v199, v11
    v_mul_f32 v200, v200, v11
    v_mul_f32 v201, v201, v11
    v_cvt_pk_bf16_f32 v160, v192, v193
    v_cvt_pk_bf16_f32 v161, v194, v195
    v_cvt_pk_bf16_f32 v162, v196, v197
    v_cvt_pk_bf16_f32 v163, v198, v199
    v_cvt_pk_bf16_f32 v164, v200, v201
    buffer_store_dwordx4 v[160:163], v2, s[36:39], s23 offen sc1
    v_cndmask_b32 v164, v228, v164, vcc
    buffer_store_dword v164, v2, s[36:39], s17 offen sc1
    v_mul_f32 v13, v192, v192
    v_fmac_f32 v13, v193, v193
    v_fmac_f32 v13, v194, v194
    v_fmac_f32 v13, v195, v195
    v_fmac_f32 v13, v196, v196
    v_fmac_f32 v13, v197, v197
    v_fmac_f32 v13, v198, v198
    v_fmac_f32 v13, v199, v199
    v_mov_b32 v9, v13
    s_nop 1
    v_permlane32_swap_b32 v9, v13
    v_add_f32 v13, v13, v9
    v_fmac_f32 v13, v200, v200
    v_fmac_f32 v13, v201, v201
    v_mov_b32 v9, v13
    s_nop 1
    v_permlane16_swap_b32 v9, v13
    v_max_u32 v13, v13, v9
    s_nop 1
    v_max_u32_dpp v13, v13, v13 row_ror:8 row_mask:0xf bank_mask:0xf
    s_nop 1
    v_max_u32_dpp v13, v13, v13 row_ror:4 row_mask:0xf bank_mask:0xf
    s_nop 1
    v_max_u32_dpp v13, v13, v13 row_ror:2 row_mask:0xf bank_mask:0xf
    s_nop 1
    v_max_u32_dpp v13, v13, v13 row_ror:1 row_mask:0xf bank_mask:0xf
    v_or_b32 v13, 1, v13
    s_setprio 0
    s_branch p1_qe
p1_rv:
    s_setprio 2
    s_waitcnt vmcnt(21)
    s_barrier
    ds_read_b64_tr_b16 v[160:161], v15 offset:0
    ds_read_b64_tr_b16 v[162:163], v15 offset:192
    ds_read_b128 v[16:19], v220 offset:0
    ds_read_b64_tr_b16 v[164:165], v15 offset:768
    ds_read_b64_tr_b16 v[166:167], v15 offset:960
    ds_read_b128 v[20:23], v221 offset:0
    ds_read_b64_tr_b16 v[168:169], v15 offset:1536
    ds_read_b64_tr_b16 v[170:171], v15 offset:1728
    ds_read_b128 v[24:27], v222 offset:0
    s_waitcnt lgkmcnt(6)
    v_mfma_f32_32x32x16_bf16 v[192:207], v[16:19], v[160:163], 0
    ds_read_b64_tr_b16 v[172:173], v15 offset:2304
    ds_read_b64_tr_b16 v[174:175], v15 offset:2496
    ds_read_b128 v[28:31], v223 offset:0
    v_mfma_f32_16x16x32_bf16 v[212:215], v[224:227], v[160:163], 0
    ds_read_b128 v[40:43], v222 offset:1024
    s_waitcnt lgkmcnt(7)
    v_mfma_f32_32x32x16_bf16 v[192:207], v[20:23], v[164:167], v[192:207]
    ds_read_b64_tr_b16 v[160:161], v15 offset:3072
    ds_read_b64_tr_b16 v[162:163], v15 offset:3264
    ds_read_b128 v[32:35], v220 offset:1024
    v_mfma_f32_16x16x32_bf16 v[212:215], v[224:227], v[164:167], v[212:215]
    ds_read_b128 v[44:47], v223 offset:1024
    s_waitcnt lgkmcnt(8)
    v_mfma_f32_32x32x16_bf16 v[192:207], v[24:27], v[168:171], v[192:207]
    ds_read_b64_tr_b16 v[164:165], v15 offset:3840
    ds_read_b64_tr_b16 v[166:167], v15 offset:4032
    ds_read_b128 v[36:39], v221 offset:1024
    v_mfma_f32_16x16x32_bf16 v[212:215], v[224:227], v[168:171], v[212:215]
    ds_read_b128 v[48:51], v220 offset:2048
    s_waitcnt lgkmcnt(9)
    v_mfma_f32_32x32x16_bf16 v[192:207], v[28:31], v[172:175], v[192:207]
    s_waitcnt vmcnt(15)
    s_barrier
    ds_read_b64_tr_b16 v[168:169], v15 offset:9216
    ds_read_b64_tr_b16 v[170:171], v15 offset:9408
    ds_read_b128 v[64:67], v220 offset:3072
    v_mfma_f32_16x16x32_bf16 v[212:215], v[224:227], v[172:175], v[212:215]
    ds_read_b128 v[52:55], v221 offset:2048
    s_waitcnt lgkmcnt(9)
    v_mfma_f32_32x32x16_bf16 v[192:207], v[32:35], v[160:163], v[192:207]
    ds_read_b64_tr_b16 v[172:173], v15 offset:9984
    ds_read_b64_tr_b16 v[174:175], v15 offset:10176
    ds_read_b128 v[68:71], v221 offset:3072
    v_mfma_f32_16x16x32_bf16 v[212:215], v[224:227], v[160:163], v[212:215]
    ds_read_b128 v[56:59], v222 offset:2048
    s_waitcnt lgkmcnt(9)
    v_mfma_f32_32x32x16_bf16 v[192:207], v[36:39], v[164:167], v[192:207]
    ds_read_b64_tr_b16 v[160:161], v15 offset:10752
    ds_read_b64_tr_b16 v[162:163], v15 offset:10944
    ds_read_b128 v[72:75], v222 offset:3072
    v_mfma_f32_16x16x32_bf16 v[212:215], v[224:227], v[164:167], v[212:215]
    ds_read_b128 v[60:63], v223 offset:2048
    s_waitcnt lgkmcnt(9)
    v_mfma_f32_32x32x16_bf16 v[192:207], v[64:67], v[168:171], v[192:207]
    ds_read_b64_tr_b16 v[164:165], v15 offset:11520
    ds_read_b64_tr_b16 v[166:167], v15 offset:11712
    ds_read_b128 v[76:79], v223 offset:3072
    v_mfma_f32_16x16x32_bf16 v[212:215], v[224:227], v[168:171], v[212:215]
    ds_read_b128 v[88:91], v222 offset:4096
    s_waitcnt lgkmcnt(9)
    v_mfma_f32_32x32x16_bf16 v[192:207], v[68:71], v[172:175], v[192:207]
    ds_read_b64_tr_b16 v[168:169], v15 offset:12288
    ds_read_b64_tr_b16 v[170:171], v15 offset:12480
    ds_read_b128 v[80:83], v220 offset:4096
    v_mfma_f32_16x16x32_bf16 v[212:215], v[224:227], v[172:175], v[212:215]
    ds_read_b128 v[92:95], v223 offset:4096
    s_waitcnt lgkmcnt(9)
    v_mfma_f32_32x32x16_bf16 v[192:207], v[72:75], v[160:163], v[192:207]
    ds_read_b64_tr_b16 v[172:173], v15 offset:13056
    ds_read_b64_tr_b16 v[174:175], v15 offset:13248
    ds_read_b128 v[84:87], v221 offset:4096
    v_mfma_f32_16x16x32_bf16 v[212:215], v[224:227], v[160:163], v[212:215]
    ds_read_b128 v[96:99], v220 offset:5120
    s_waitcnt lgkmcnt(9)
    v_mfma_f32_32x32x16_bf16 v[192:207], v[76:79], v[164:167], v[192:207]
    s_waitcnt vmcnt(9)
    s_barrier
    ds_read_b64_tr_b16 v[160:161], v15 offset:18432
    ds_read_b64_tr_b16 v[162:163], v15 offset:18624
    ds_read_b128 v[112:115], v220 offset:6144
    v_mfma_f32_16x16x32_bf16 v[212:215], v[224:227], v[164:167], v[212:215]
    ds_read_b128 v[100:103], v221 offset:5120
    s_waitcnt lgkmcnt(9)
    v_mfma_f32_32x32x16_bf16 v[192:207], v[80:83], v[168:171], v[192:207]
    ds_read_b64_tr_b16 v[164:165], v15 offset:19200
    ds_read_b64_tr_b16 v[166:167], v15 offset:19392
    ds_read_b128 v[116:119], v221 offset:6144
    v_mfma_f32_16x16x32_bf16 v[212:215], v[224:227], v[168:171], v[212:215]
    ds_read_b128 v[104:107], v222 offset:5120
    s_waitcnt lgkmcnt(9)
    v_mfma_f32_32x32x16_bf16 v[192:207], v[84:87], v[172:175], v[192:207]
    ds_read_b64_tr_b16 v[168:169], v15 offset:19968
    ds_read_b64_tr_b16 v[170:171], v15 offset:20160
    ds_read_b128 v[120:123], v222 offset:6144
    v_mfma_f32_16x16x32_bf16 v[212:215], v[224:227], v[172:175], v[212:215]
    ds_read_b128 v[108:111], v223 offset:5120
    s_waitcnt lgkmcnt(9)
    v_mfma_f32_32x32x16_bf16 v[192:207], v[112:115], v[160:163], v[192:207]
    ds_read_b64_tr_b16 v[172:173], v15 offset:20736
    ds_read_b64_tr_b16 v[174:175], v15 offset:20928
    ds_read_b128 v[124:127], v223 offset:6144
    v_mfma_f32_16x16x32_bf16 v[212:215], v[224:227], v[160:163], v[212:215]
    ds_read_b128 v[136:139], v222 offset:7168
    s_waitcnt lgkmcnt(9)
    v_mfma_f32_32x32x16_bf16 v[192:207], v[116:119], v[164:167], v[192:207]
    ds_read_b64_tr_b16 v[160:161], v15 offset:21504
    ds_read_b64_tr_b16 v[162:163], v15 offset:21696
    ds_read_b128 v[128:131], v220 offset:7168
    v_mfma_f32_16x16x32_bf16 v[212:215], v[224:227], v[164:167], v[212:215]
    ds_read_b128 v[140:143], v223 offset:7168
    s_waitcnt lgkmcnt(9)
    v_mfma_f32_32x32x16_bf16 v[192:207], v[120:123], v[168:171], v[192:207]
    ds_read_b64_tr_b16 v[164:165], v15 offset:22272
    ds_read_b64_tr_b16 v[166:167], v15 offset:22464
    ds_read_b128 v[132:135], v221 offset:7168
    v_mfma_f32_16x16x32_bf16 v[212:215], v[224:227], v[168:171], v[212:215]
    ds_read_b128 v[144:147], v220 offset:8192
    s_waitcnt lgkmcnt(9)
    v_mfma_f32_32x32x16_bf16 v[192:207], v[124:127], v[172:175], v[192:207]
    v_mfma_f32_16x16x32_bf16 v[212:215], v[224:227], v[172:175], v[212:215]
    ds_read_b128 v[148:151], v221 offset:8192
    s_waitcnt lgkmcnt(6)
    v_mfma_f32_32x32x16_bf16 v[192:207], v[128:131], v[160:163], v[192:207]
    v_mfma_f32_16x16x32_bf16 v[212:215], v[224:227], v[160:163], v[212:215]
    ds_read_b128 v[152:155], v222 offset:8192
    s_waitcnt lgkmcnt(3)
    v_mfma_f32_32x32x16_bf16 v[192:207], v[132:135], v[164:167], v[192:207]
    v_mfma_f32_16x16x32_bf16 v[212:215], v[224:227], v[164:167], v[212:215]
    ds_read_b128 v[156:159], v223 offset:8192
    buffer_load_dword v255, off, s[64:67], 0 sc1
    s_waitcnt vmcnt(1)
    s_waitcnt lgkmcnt(0)
    s_barrier
    ds_read_b64 v[164:165], v8 offset:31744
    ds_read_b64 v[166:167], v8 offset:32000
    ds_read_b32 v162, v12 offset:9728
    ds_read_b128 v[168:171], v7 offset:5632
    ds_read_b128 v[172:175], v7 offset:6656
    ds_read_b128 v[176:179], v7 offset:7680
    ds_read_b128 v[180:183], v7 offset:8704
    s_waitcnt lgkmcnt(5)
    v_add_f32 v10, v164, v166
    v_add_f32 v11, v165, v167
    v_mul_f32 v10, 0xbae38e39, v10
    v_mul_f32 v11, 0x3ae38e39, v11
    v_fma_f32 v11, -v10, v10, v11
    v_add_f32 v11, 0x3727c5ac, v11
    v_rsq_f32 v11, v11
    ds_write_b32 v12, v11 offset:31616
    v_lshlrev_b32 v9, 4, v5
    v_add_u32 v9, 0x20000, v9
    s_waitcnt lgkmcnt(5)
    v_add_f32 v212, v212, v162
    v_cvt_pk_bf16_f32 v160, v212, v212
    v_lshlrev_b32 v161, 16, v160
    v_sub_f32 v161, v212, v161
    v_cvt_pk_bf16_f32 v161, v161, v161
    v_cvt_pk_bf16_f32 v162, v10, v10
    v_cmp_gt_u32 vcc, 32, v1
    v_lshlrev_b32 v162, 16, v162
    v_sub_f32 v162, v10, v162
    v_cvt_pk_bf16_f32 v162, v10, v162
    v_cndmask_b32 v162, 0, v162, vcc
    v_mov_b32 v163, v162
    s_waitcnt lgkmcnt(1)
    v_add_f32 v192, v192, v168
    v_add_f32 v193, v193, v169
    v_add_f32 v194, v194, v170
    v_add_f32 v195, v195, v171
    v_add_f32 v196, v196, v172
    v_add_f32 v197, v197, v173
    v_add_f32 v198, v198, v174
    v_add_f32 v199, v199, v175
    v_add_f32 v200, v200, v176
    v_add_f32 v201, v201, v177
    v_add_f32 v202, v202, v178
    v_add_f32 v203, v203, v179
    v_add_f32 v204, v204, v180
    v_add_f32 v205, v205, v181
    v_add_f32 v206, v206, v182
    v_add_f32 v207, v207, v183
    ds_read_b128 v[168:171], v9 offset:31616
    ds_read_b128 v[172:175], v9 offset:31648
    ds_read_b128 v[176:179], v9 offset:31680
    ds_read_b128 v[180:183], v9 offset:31712
    v_mfma_f32_32x32x8bf16_1k v[192:207], v[162:163], v[160:161], v[192:207]
    v_mul_u32_u24 v9, 320, v5
    v_lshl_add_u32 v9, v4, 4, v9
    v_cmp_lt_u32 vcc, 17, v4
    s_lshl_b32 s22, s22, 6
    s_add_u32 s22, s22, 3375108
    v_mov_b32 v13, 1
    s_waitcnt lgkmcnt(0)
    s_nop 4
    v_mul_f32 v192, v192, v168
    v_mul_f32 v193, v193, v169
    v_mul_f32 v194, v194, v170
    v_mul_f32 v195, v195, v171
    v_mul_f32 v196, v196, v172
    v_mul_f32 v197, v197, v173
    v_mul_f32 v198, v198, v174
    v_mul_f32 v199, v199, v175
    v_mul_f32 v200, v200, v176
    v_mul_f32 v201, v201, v177
    v_mul_f32 v202, v202, v178
    v_mul_f32 v203, v203, v179
    v_mul_f32 v204, v204, v180
    v_mul_f32 v205, v205, v181
    v_mul_f32 v206, v206, v182
    v_mul_f32 v207, v207, v183
    v_cvt_pk_bf16_f32 v160, v192, v193
    v_cvt_pk_bf16_f32 v161, v194, v195
    v_cvt_pk_bf16_f32 v162, v196, v197
    v_cvt_pk_bf16_f32 v163, v198, v199
    v_cvt_pk_bf16_f32 v164, v200, v201
    v_cvt_pk_bf16_f32 v165, v202, v203
    v_cvt_pk_bf16_f32 v166, v204, v205
    v_cvt_pk_bf16_f32 v167, v206, v207
    v_cndmask_b32 v160, v160, v228, vcc
    v_cndmask_b32 v161, v161, v228, vcc
    v_cndmask_b32 v162, v162, v228, vcc
    v_cndmask_b32 v163, v163, v228, vcc
    v_cndmask_b32 v164, v164, v228, vcc
    v_cndmask_b32 v165, v165, v228, vcc
    v_cndmask_b32 v166, v166, v228, vcc
    v_cndmask_b32 v167, v167, v228, vcc
    v_permlane32_swap_b32 v160, v162
    v_permlane32_swap_b32 v161, v163
    v_permlane32_swap_b32 v164, v166
    v_permlane32_swap_b32 v165, v167
    s_mov_b32 exec_lo, 0x000fffff
    s_mov_b32 exec_hi, 0x000fffff
    buffer_store_dwordx4 v[160:163], v9, s[36:39], s23 offen offset:1024 sc1
    buffer_store_dwordx4 v[164:167], v9, s[36:39], s23 offen offset:1664 sc1
    s_mov_b64 exec, -1
    s_setprio 0
    s_branch p1_qe
p1_r123:
    s_add_u32 m0, s41, 73728
    s_add_u32 s17, s40, 0
    buffer_load_dwordx4 v232, s[56:59], s17 offen lds
    s_add_u32 m0, s41, 76800
    s_add_u32 s17, s40, 27648
    buffer_load_dwordx4 v232, s[56:59], s17 offen lds
    s_add_u32 m0, s99, 122880
    s_add_u32 s17, s98, 0
    buffer_load_dword v13, s[56:59], s17 offen lds
    s_add_u32 m0, s41, 79872
    s_add_u32 s17, s40, 55296
    buffer_load_dwordx4 v232, s[56:59], s17 offen lds
    s_add_u32 m0, s41, 82944
    s_add_u32 s17, s40, 82944
    buffer_load_dwordx4 v232, s[56:59], s17 offen lds
    s_add_u32 m0, s99, 123648
    s_add_u32 s17, s98, 55296
    buffer_load_dword v13, s[56:59], s17 offen lds
    s_cmp_eq_u32 s16, 2
    s_cbranch_scc1 p1_r2
    s_cmp_eq_u32 s16, 3
    s_cbranch_scc1 p1_r3
    s_cmp_eq_u32 s55, 1
    s_cbranch_scc1 p1_r1k
    s_cmp_eq_u32 s55, 2
    s_cbranch_scc1 p1_r1v
    s_cmp_eq_u32 s2, 1
    s_cbranch_scc0 p1_nomark
    s_mov_b64 exec, 1
    v_mov_b32 v255, 1
    s_waitcnt vmcnt(34)
    buffer_store_dword v255, off, s[64:67], 0 sc1
    s_mov_b64 exec, -1
p1_nomark:
    s_lshl2_add_u32 s22, s14, s15
    s_sub_u32 s22, s22, 60
    s_cbranch_scc0 p1_r1b
    s_waitcnt vmcnt(27)
    s_barrier
    s_add_u32 m0, s41, 86016
    s_add_u32 s17, s40, 110592
    buffer_load_dwordx4 v232, s[56:59], s17 offen lds
    s_add_u32 m0, s41, 89088
    s_add_u32 s17, s40, 138240
    buffer_load_dwordx4 v232, s[56:59], s17 offen lds
    s_waitcnt vmcnt(23)
    s_barrier
    s_add_u32 m0, s99, 124416
    s_add_u32 s17, s98, 110592
    buffer_load_dword v13, s[56:59], s17 offen lds
    s_add_u32 m0, s41, 92160
    s_add_u32 s17, s40, 165888
    buffer_load_dwordx4 v232, s[56:59], s17 offen lds
    s_add_u32 m0, s41, 95232
    s_add_u32 s17, s40, 193536
    buffer_load_dwordx4 v232, s[56:59], s17 offen lds
    s_add_u32 m0, s99, 125184
    s_add_u32 s17, s98, 165888
    buffer_load_dword v13, s[56:59], s17 offen lds
    s_add_u32 m0, s41, 98304
    s_add_u32 s17, s40, 221184
    buffer_load_dwordx4 v232, s[56:59], s17 offen lds
    s_add_u32 m0, s41, 101376
    s_add_u32 s17, s40, 248832
    buffer_load_dwordx4 v232, s[56:59], s17 offen lds
    s_waitcnt vmcnt(23)
    s_barrier
    s_add_u32 m0, s99, 125952
    s_add_u32 s17, s98, 221184
    buffer_load_dword v13, s[56:59], s17 offen lds
    s_add_u32 m0, s41, 104448
    s_add_u32 s17, s40, 276480
    buffer_load_dwordx4 v232, s[56:59], s17 offen lds
    s_add_u32 m0, s41, 107520
    s_add_u32 s17, s40, 304128
    buffer_load_dwordx4 v232, s[56:59], s17 offen lds
    s_add_u32 m0, s99, 126720
    s_add_u32 s17, s98, 276480
    buffer_load_dword v13, s[56:59], s17 offen lds
    s_add_u32 m0, s41, 110592
    s_add_u32 s17, s40, 331776
    buffer_load_dwordx4 v232, s[56:59], s17 offen lds
    s_add_u32 m0, s41, 113664
    s_add_u32 s17, s40, 359424
    buffer_load_dwordx4 v232, s[56:59], s17 offen lds
    s_add_u32 m0, s99, 127488
    s_add_u32 s17, s98, 331776
    buffer_load_dword v13, s[56:59], s17 offen lds
    s_add_u32 m0, s41, 116736
    s_add_u32 s17, s40, 387072
    buffer_load_dwordx4 v232, s[56:59], s17 offen lds
    s_add_u32 m0, s41, 119808
    s_add_u32 s17, s40, 414720
    buffer_load_dwordx4 v232, s[56:59], s17 offen lds
    s_add_u32 m0, s99, 128256
    s_add_u32 s17, s98, 387072
    buffer_load_dword v13, s[56:59], s17 offen lds
    buffer_load_dword v255, off, s[64:67], 0 sc1
    s_branch p1_o
p1_r1b:
    s_lshr_b32 s18, s22, 1
    s_and_b32 s19, s22, 1
    s_mul_i32 s23, s18, 20736
    s_mul_i32 s17, s18, 165888
    s_sub_u32 s17, s17, 5289984
    s_cmp_ge_u32 s18, 32
    s_cselect_b32 s23, s17, s23
    s_mov_b32 s17, 2304
    s_cmov_b32 s17, 20736
    s_mul_i32 s52, s19, 576
    s_add_u32 s23, s23, s52
    v_lshrrev_b32 v16, 3, v1
    v_mul_lo_u32 v16, v16, s17
    v_bfe_u32 v17, v1, 2, 1
    v_mul_u32_u24 v17, 1152, v17
    v_and_b32 v18, 48, v2
    v_add3_u32 v16, v16, v17, v18
    buffer_load_dwordx4 v[24:27], v16, s[4:7], s23 offen offset:0
    buffer_load_dwordx4 v[28:31], v16, s[4:7], s23 offen offset:64
    buffer_load_dwordx4 v[32:35], v16, s[4:7], s23 offen offset:128
    buffer_load_dwordx4 v[36:39], v16, s[4:7], s23 offen offset:192
    buffer_load_dwordx4 v[40:43], v16, s[4:7], s23 offen offset:256
    buffer_load_dwordx4 v[44:47], v16, s[4:7], s23 offen offset:320
    buffer_load_dwordx4 v[48:51], v16, s[4:7], s23 offen offset:384
    buffer_load_dwordx4 v[52:55], v16, s[4:7], s23 offen offset:448
    buffer_load_dwordx4 v[56:59], v16, s[4:7], s23 offen offset:512
    s_lshl_b32 s18, s18, 7
    s_lshl2_add_u32 s22, s19, s18
    s_add_u32 s22, s22, 3379200
    v_bfe_u32 v17, v1, 2, 2
    v_lshlrev_b32 v17, 3, v17
    v_bfe_u32 v18, v1, 4, 1
    v_lshl_add_u32 v17, v18, 6, v17
    v_and_b32 v18, 32, v1
    v_add_u32 v17, v17, v18
    s_waitcnt vmcnt(36)
    s_barrier
    s_add_u32 m0, s41, 86016
    s_add_u32 s17, s40, 110592
    buffer_load_dwordx4 v232, s[56:59], s17 offen lds
    s_add_u32 m0, s41, 89088
    s_add_u32 s17, s40, 138240
    buffer_load_dwordx4 v232, s[56:59], s17 offen lds
    s_waitcnt vmcnt(32)
    s_barrier
    s_add_u32 m0, s99, 124416
    s_add_u32 s17, s98, 110592
    buffer_load_dword v13, s[56:59], s17 offen lds
    s_add_u32 m0, s41, 92160
    s_add_u32 s17, s40, 165888
    buffer_load_dwordx4 v232, s[56:59], s17 offen lds
    s_add_u32 m0, s41, 95232
    s_add_u32 s17, s40, 193536
    buffer_load_dwordx4 v232, s[56:59], s17 offen lds
    s_add_u32 m0, s99, 125184
    s_add_u32 s17, s98, 165888
    buffer_load_dword v13, s[56:59], s17 offen lds
    s_add_u32 m0, s41, 98304
    s_add_u32 s17, s40, 221184
    buffer_load_dwordx4 v232, s[56:59], s17 offen lds
    s_add_u32 m0, s41, 101376
    s_add_u32 s17, s40, 248832
    buffer_load_dwordx4 v232, s[56:59], s17 offen lds
    s_waitcnt vmcnt(32)
    s_barrier
    s_add_u32 m0, s99, 125952
    s_add_u32 s17, s98, 221184
    buffer_load_dword v13, s[56:59], s17 offen lds
    s_add_u32 m0, s41, 104448
    s_add_u32 s17, s40, 276480
    buffer_load_dwordx4 v232, s[56:59], s17 offen lds
    s_add_u32 m0, s41, 107520
    s_add_u32 s17, s40, 304128
    buffer_load_dwordx4 v232, s[56:59], s17 offen lds
    s_add_u32 m0, s99, 126720
    s_add_u32 s17, s98, 276480
    buffer_load_dword v13, s[56:59], s17 offen lds
    s_add_u32 m0, s41, 110592
    s_add_u32 s17, s40, 331776
    buffer_load_dwordx4 v232, s[56:59], s17 offen lds
    s_add_u32 m0, s41, 113664
    s_add_u32 s17, s40, 359424
    buffer_load_dwordx4 v232, s[56:59], s17 offen lds
    s_add_u32 m0, s99, 127488
    s_add_u32 s17, s98, 331776
    buffer_load_dword v13, s[56:59], s17 offen lds
    s_add_u32 m0, s41, 116736
    s_add_u32 s17, s40, 387072
    buffer_load_dwordx4 v232, s[56:59], s17 offen lds
    s_add_u32 m0, s41, 119808
    s_add_u32 s17, s40, 414720
    buffer_load_dwordx4 v232, s[56:59], s17 offen lds
    s_add_u32 m0, s99, 128256
    s_add_u32 s17, s98, 387072
    buffer_load_dword v13, s[56:59], s17 offen lds
    buffer_load_dword v255, off, s[64:67], 0 sc1
    s_waitcnt vmcnt(25)
    v_dot2_f32_bf16 v20, v24, s42, 0
    v_dot2_f32_bf16 v21, v25, s42, 0
    v_dot2_f32_bf16 v22, v26, s42, 0
    v_dot2_f32_bf16 v23, v27, s42, 0
    v_dot2_f32_bf16 v20, v28, s42, v20
    v_dot2_f32_bf16 v21, v29, s42, v21
    v_dot2_f32_bf16 v22, v30, s42, v22
    v_dot2_f32_bf16 v23, v31, s42, v23
    v_dot2_f32_bf16 v20, v32, s42, v20
    v_dot2_f32_bf16 v21, v33, s42, v21
    v_dot2_f32_bf16 v22, v34, s42, v22
    v_dot2_f32_bf16 v23, v35, s42, v23
    s_waitcnt vmcnt(22)
    v_dot2_f32_bf16 v20, v36, s42, v20
    v_dot2_f32_bf16 v21, v37, s42, v21
    v_dot2_f32_bf16 v22, v38, s42, v22
    v_dot2_f32_bf16 v23, v39, s42, v23
    v_dot2_f32_bf16 v20, v40, s42, v20
    v_dot2_f32_bf16 v21, v41, s42, v21
    v_dot2_f32_bf16 v22, v42, s42, v22
    v_dot2_f32_bf16 v23, v43, s42, v23
    v_dot2_f32_bf16 v20, v44, s42, v20
    v_dot2_f32_bf16 v21, v45, s42, v21
    v_dot2_f32_bf16 v22, v46, s42, v22
    v_dot2_f32_bf16 v23, v47, s42, v23
    s_waitcnt vmcnt(19)
    v_dot2_f32_bf16 v20, v48, s42, v20
    v_dot2_f32_bf16 v21, v49, s42, v21
    v_dot2_f32_bf16 v22, v50, s42, v22
    v_dot2_f32_bf16 v23, v51, s42, v23
    v_dot2_f32_bf16 v20, v52, s42, v20
    v_dot2_f32_bf16 v21, v53, s42, v21
    v_dot2_f32_bf16 v22, v54, s42, v22
    v_dot2_f32_bf16 v23, v55, s42, v23
    v_dot2_f32_bf16 v20, v56, s42, v20
    v_dot2_f32_bf16 v21, v57, s42, v21
    v_dot2_f32_bf16 v22, v58, s42, v22
    v_dot2_f32_bf16 v23, v59, s42, v23
    s_nop 0
    v_add_f32 v20, v20, v21
    s_nop 0
    v_add_f32 v22, v22, v23
    v_add_f32 v20, v20, v22
    s_nop 1
    v_add_f32_dpp v20, v20, v20 quad_perm:[1,0,3,2] row_mask:0xf bank_mask:0xf
    s_nop 1
    v_add_f32_dpp v20, v20, v20 quad_perm:[2,3,0,1] row_mask:0xf bank_mask:0xf
    v_mul_f32 v20, 0x3ae38e39, v20
    v_cvt_pk_bf16_f32 v21, v20, v20
    v_lshlrev_b32 v21, 16, v21
    v_sub_f32 v21, v20, v21
    v_cvt_pk_bf16_f32 v20, v20, v21
    s_mov_b32 exec_lo, 0x11111111
    s_mov_b32 exec_hi, 0x11111111
    buffer_store_dword v20, v17, s[36:39], s22 offen sc1
    s_mov_b64 exec, -1
    s_branch p1_o
p1_r1k:
    s_setprio 2
    s_waitcnt vmcnt(27)
    s_barrier
    ds_read_b64_tr_b16 v[160:161], v15 offset:4608
    ds_read_b64_tr_b16 v[162:163], v15 offset:4800
    ds_read_b128 v[40:43], v222 offset:1024
    ds_read_b64_tr_b16 v[164:165], v15 offset:5376
    ds_read_b64_tr_b16 v[166:167], v15 offset:5568
    ds_read_b128 v[44:47], v223 offset:1024
    ds_read_b64_tr_b16 v[168:169], v15 offset:6144
    ds_read_b64_tr_b16 v[170:171], v15 offset:6336
    ds_read_b128 v[48:51], v220 offset:2048
    s_waitcnt lgkmcnt(6)
    v_mfma_f32_32x32x16_bf16 v[192:207], v[160:163], v[40:43], 0
    ds_read_b64_tr_b16 v[172:173], v15 offset:6912
    ds_read_b64_tr_b16 v[174:175], v15 offset:7104
    ds_read_b128 v[52:55], v221 offset:2048
    v_mfma_f32_16x16x32_bf16 v[212:215], v[224:227], v[160:163], 0
    s_add_u32 m0, s41, 86016
    s_add_u32 s17, s40, 110592
    buffer_load_dwordx4 v232, s[56:59], s17 offen lds
    s_waitcnt lgkmcnt(6)
    v_mfma_f32_32x32x16_bf16 v[192:207], v[164:167], v[44:47], v[192:207]
    ds_read_b64_tr_b16 v[160:161], v15 offset:7680
    ds_read_b64_tr_b16 v[162:163], v15 offset:7872
    ds_read_b128 v[56:59], v222 offset:2048
    v_mfma_f32_16x16x32_bf16 v[212:215], v[224:227], v[164:167], v[212:215]
    s_add_u32 m0, s41, 89088
    s_add_u32 s17, s40, 138240
    buffer_load_dwordx4 v232, s[56:59], s17 offen lds
    s_waitcnt lgkmcnt(6)
    v_mfma_f32_32x32x16_bf16 v[192:207], v[168:171], v[48:51], v[192:207]
    ds_read_b64_tr_b16 v[164:165], v15 offset:8448
    ds_read_b64_tr_b16 v[166:167], v15 offset:8640
    ds_read_b128 v[60:63], v223 offset:2048
    v_mfma_f32_16x16x32_bf16 v[212:215], v[224:227], v[168:171], v[212:215]
    s_add_u32 m0, s99, 124416
    s_add_u32 s17, s98, 110592
    buffer_load_dword v13, s[56:59], s17 offen lds
    s_waitcnt lgkmcnt(6)
    v_mfma_f32_32x32x16_bf16 v[192:207], v[172:175], v[52:55], v[192:207]
    s_waitcnt vmcnt(24)
    s_barrier
    ds_read_b64_tr_b16 v[168:169], v15 offset:13824
    ds_read_b64_tr_b16 v[170:171], v15 offset:14016
    ds_read_b128 v[88:91], v222 offset:4096
    v_mfma_f32_16x16x32_bf16 v[212:215], v[224:227], v[172:175], v[212:215]
    s_add_u32 m0, s41, 92160
    s_add_u32 s17, s40, 165888
    buffer_load_dwordx4 v232, s[56:59], s17 offen lds
    s_waitcnt lgkmcnt(6)
    v_mfma_f32_32x32x16_bf16 v[192:207], v[160:163], v[56:59], v[192:207]
    ds_read_b64_tr_b16 v[172:173], v15 offset:14592
    ds_read_b64_tr_b16 v[174:175], v15 offset:14784
    ds_read_b128 v[92:95], v223 offset:4096
    v_mfma_f32_16x16x32_bf16 v[212:215], v[224:227], v[160:163], v[212:215]
    s_add_u32 m0, s41, 95232
    s_add_u32 s17, s40, 193536
    buffer_load_dwordx4 v232, s[56:59], s17 offen lds
    s_waitcnt lgkmcnt(6)
    v_mfma_f32_32x32x16_bf16 v[192:207], v[164:167], v[60:63], v[192:207]
    ds_read_b64_tr_b16 v[160:161], v15 offset:15360
    ds_read_b64_tr_b16 v[162:163], v15 offset:15552
    ds_read_b128 v[96:99], v220 offset:5120
    v_mfma_f32_16x16x32_bf16 v[212:215], v[224:227], v[164:167], v[212:215]
    s_add_u32 m0, s99, 125184
    s_add_u32 s17, s98, 165888
    buffer_load_dword v13, s[56:59], s17 offen lds
    s_waitcnt lgkmcnt(6)
    v_mfma_f32_32x32x16_bf16 v[192:207], v[168:171], v[88:91], v[192:207]
    ds_read_b64_tr_b16 v[164:165], v15 offset:16128
    ds_read_b64_tr_b16 v[166:167], v15 offset:16320
    ds_read_b128 v[100:103], v221 offset:5120
    v_mfma_f32_16x16x32_bf16 v[212:215], v[224:227], v[168:171], v[212:215]
    s_add_u32 m0, s41, 98304
    s_add_u32 s17, s40, 221184
    buffer_load_dwordx4 v232, s[56:59], s17 offen lds
    s_waitcnt lgkmcnt(6)
    v_mfma_f32_32x32x16_bf16 v[192:207], v[172:175], v[92:95], v[192:207]
    ds_read_b64_tr_b16 v[168:169], v15 offset:16896
    ds_read_b64_tr_b16 v[170:171], v15 offset:17088
    ds_read_b128 v[104:107], v222 offset:5120
    v_mfma_f32_16x16x32_bf16 v[212:215], v[224:227], v[172:175], v[212:215]
    s_add_u32 m0, s41, 101376
    s_add_u32 s17, s40, 248832
    buffer_load_dwordx4 v232, s[56:59], s17 offen lds
    s_waitcnt lgkmcnt(6)
    v_mfma_f32_32x32x16_bf16 v[192:207], v[160:163], v[96:99], v[192:207]
    ds_read_b64_tr_b16 v[172:173], v15 offset:17664
    ds_read_b64_tr_b16 v[174:175], v15 offset:17856
    ds_read_b128 v[108:111], v223 offset:5120
    v_mfma_f32_16x16x32_bf16 v[212:215], v[224:227], v[160:163], v[212:215]
    s_add_u32 m0, s99, 125952
    s_add_u32 s17, s98, 221184
    buffer_load_dword v13, s[56:59], s17 offen lds
    s_waitcnt lgkmcnt(6)
    v_mfma_f32_32x32x16_bf16 v[192:207], v[164:167], v[100:103], v[192:207]
    s_waitcnt vmcnt(24)
    s_barrier
    ds_read_b64_tr_b16 v[160:161], v15 offset:23040
    ds_read_b64_tr_b16 v[162:163], v15 offset:23232
    ds_read_b128 v[136:139], v222 offset:7168
    v_mfma_f32_16x16x32_bf16 v[212:215], v[224:227], v[164:167], v[212:215]
    s_add_u32 m0, s41, 104448
    s_add_u32 s17, s40, 276480
    buffer_load_dwordx4 v232, s[56:59], s17 offen lds
    s_waitcnt lgkmcnt(6)
    v_mfma_f32_32x32x16_bf16 v[192:207], v[168:171], v[104:107], v[192:207]
    ds_read_b64_tr_b16 v[164:165], v15 offset:23808
    ds_read_b64_tr_b16 v[166:167], v15 offset:24000
    ds_read_b128 v[140:143], v223 offset:7168
    v_mfma_f32_16x16x32_bf16 v[212:215], v[224:227], v[168:171], v[212:215]
    s_add_u32 m0, s41, 107520
    s_add_u32 s17, s40, 304128
    buffer_load_dwordx4 v232, s[56:59], s17 offen lds
    s_waitcnt lgkmcnt(6)
    v_mfma_f32_32x32x16_bf16 v[192:207], v[172:175], v[108:111], v[192:207]
    ds_read_b64_tr_b16 v[168:169], v15 offset:24576
    ds_read_b64_tr_b16 v[170:171], v15 offset:24768
    ds_read_b128 v[144:147], v220 offset:8192
    v_mfma_f32_16x16x32_bf16 v[212:215], v[224:227], v[172:175], v[212:215]
    s_add_u32 m0, s99, 126720
    s_add_u32 s17, s98, 276480
    buffer_load_dword v13, s[56:59], s17 offen lds
    s_waitcnt lgkmcnt(6)
    v_mfma_f32_32x32x16_bf16 v[192:207], v[160:163], v[136:139], v[192:207]
    ds_read_b64_tr_b16 v[172:173], v15 offset:25344
    ds_read_b64_tr_b16 v[174:175], v15 offset:25536
    ds_read_b128 v[148:151], v221 offset:8192
    v_mfma_f32_16x16x32_bf16 v[212:215], v[224:227], v[160:163], v[212:215]
    s_add_u32 m0, s41, 110592
    s_add_u32 s17, s40, 331776
    buffer_load_dwordx4 v232, s[56:59], s17 offen lds
    s_waitcnt lgkmcnt(6)
    v_mfma_f32_32x32x16_bf16 v[192:207], v[164:167], v[140:143], v[192:207]
    ds_read_b64_tr_b16 v[160:161], v15 offset:26112
    ds_read_b64_tr_b16 v[162:163], v15 offset:26304
    ds_read_b128 v[152:155], v222 offset:8192
    v_mfma_f32_16x16x32_bf16 v[212:215], v[224:227], v[164:167], v[212:215]
    s_add_u32 m0, s41, 113664
    s_add_u32 s17, s40, 359424
    buffer_load_dwordx4 v232, s[56:59], s17 offen lds
    s_waitcnt lgkmcnt(6)
    v_mfma_f32_32x32x16_bf16 v[192:207], v[168:171], v[144:147], v[192:207]
    ds_read_b64_tr_b16 v[164:165], v15 offset:26880
    ds_read_b64_tr_b16 v[166:167], v15 offset:27072
    ds_read_b128 v[156:159], v223 offset:8192
    v_mfma_f32_16x16x32_bf16 v[212:215], v[224:227], v[168:171], v[212:215]
    s_add_u32 m0, s99, 127488
    s_add_u32 s17, s98, 331776
    buffer_load_dword v13, s[56:59], s17 offen lds
    s_waitcnt lgkmcnt(6)
    v_mfma_f32_32x32x16_bf16 v[192:207], v[172:175], v[148:151], v[192:207]
    v_mfma_f32_16x16x32_bf16 v[212:215], v[224:227], v[172:175], v[212:215]
    s_add_u32 m0, s41, 116736
    s_add_u32 s17, s40, 387072
    buffer_load_dwordx4 v232, s[56:59], s17 offen lds
    s_waitcnt lgkmcnt(3)
    v_mfma_f32_32x32x16_bf16 v[192:207], v[160:163], v[152:155], v[192:207]
    v_mfma_f32_16x16x32_bf16 v[212:215], v[224:227], v[160:163], v[212:215]
    s_add_u32 m0, s41, 119808
    s_add_u32 s17, s40, 414720
    buffer_load_dwordx4 v232, s[56:59], s17 offen lds
    s_waitcnt lgkmcnt(0)
    v_mfma_f32_32x32x16_bf16 v[192:207], v[164:167], v[156:159], v[192:207]
    v_mfma_f32_16x16x32_bf16 v[212:215], v[224:227], v[164:167], v[212:215]
    s_add_u32 m0, s99, 128256
    s_add_u32 s17, s98, 387072
    buffer_load_dword v13, s[56:59], s17 offen lds
    buffer_load_dword v255, off, s[64:67], 0 sc1
    s_nop 3
    ds_write_b32 v12, v212 offset:9728
    ds_write_b128 v7, v[192:195] offset:5632
    ds_write_b128 v7, v[196:199] offset:6656
    ds_write_b128 v7, v[200:203] offset:7680
    s_setprio 0
    s_branch p1_o
p1_r1v:
    s_setprio 2
    s_waitcnt vmcnt(27)
    s_barrier
    ds_read_b64_tr_b16 v[160:161], v15 offset:4608
    ds_read_b64_tr_b16 v[162:163], v15 offset:4800
    ds_read_b128 v[40:43], v222 offset:1024
    ds_read_b64_tr_b16 v[164:165], v15 offset:5376
    ds_read_b64_tr_b16 v[166:167], v15 offset:5568
    ds_read_b128 v[44:47], v223 offset:1024
    ds_read_b64_tr_b16 v[168:169], v15 offset:6144
    ds_read_b64_tr_b16 v[170:171], v15 offset:6336
    ds_read_b128 v[48:51], v220 offset:2048
    s_waitcnt lgkmcnt(6)
    v_mfma_f32_32x32x16_bf16 v[192:207], v[40:43], v[160:163], 0
    ds_read_b64_tr_b16 v[172:173], v15 offset:6912
    ds_read_b64_tr_b16 v[174:175], v15 offset:7104
    ds_read_b128 v[52:55], v221 offset:2048
    v_mfma_f32_16x16x32_bf16 v[212:215], v[224:227], v[160:163], 0
    s_add_u32 m0, s41, 86016
    s_add_u32 s17, s40, 110592
    buffer_load_dwordx4 v232, s[56:59], s17 offen lds
    s_waitcnt lgkmcnt(6)
    v_mfma_f32_32x32x16_bf16 v[192:207], v[44:47], v[164:167], v[192:207]
    ds_read_b64_tr_b16 v[160:161], v15 offset:7680
    ds_read_b64_tr_b16 v[162:163], v15 offset:7872
    ds_read_b128 v[56:59], v222 offset:2048
    v_mfma_f32_16x16x32_bf16 v[212:215], v[224:227], v[164:167], v[212:215]
    s_add_u32 m0, s41, 89088
    s_add_u32 s17, s40, 138240
    buffer_load_dwordx4 v232, s[56:59], s17 offen lds
    s_waitcnt lgkmcnt(6)
    v_mfma_f32_32x32x16_bf16 v[192:207], v[48:51], v[168:171], v[192:207]
    ds_read_b64_tr_b16 v[164:165], v15 offset:8448
    ds_read_b64_tr_b16 v[166:167], v15 offset:8640
    ds_read_b128 v[60:63], v223 offset:2048
    v_mfma_f32_16x16x32_bf16 v[212:215], v[224:227], v[168:171], v[212:215]
    s_add_u32 m0, s99, 124416
    s_add_u32 s17, s98, 110592
    buffer_load_dword v13, s[56:59], s17 offen lds
    s_waitcnt lgkmcnt(6)
    v_mfma_f32_32x32x16_bf16 v[192:207], v[52:55], v[172:175], v[192:207]
    s_waitcnt vmcnt(24)
    s_barrier
    ds_read_b64_tr_b16 v[168:169], v15 offset:13824
    ds_read_b64_tr_b16 v[170:171], v15 offset:14016
    ds_read_b128 v[88:91], v222 offset:4096
    v_mfma_f32_16x16x32_bf16 v[212:215], v[224:227], v[172:175], v[212:215]
    s_add_u32 m0, s41, 92160
    s_add_u32 s17, s40, 165888
    buffer_load_dwordx4 v232, s[56:59], s17 offen lds
    s_waitcnt lgkmcnt(6)
    v_mfma_f32_32x32x16_bf16 v[192:207], v[56:59], v[160:163], v[192:207]
    ds_read_b64_tr_b16 v[172:173], v15 offset:14592
    ds_read_b64_tr_b16 v[174:175], v15 offset:14784
    ds_read_b128 v[92:95], v223 offset:4096
    v_mfma_f32_16x16x32_bf16 v[212:215], v[224:227], v[160:163], v[212:215]
    s_add_u32 m0, s41, 95232
    s_add_u32 s17, s40, 193536
    buffer_load_dwordx4 v232, s[56:59], s17 offen lds
    s_waitcnt lgkmcnt(6)
    v_mfma_f32_32x32x16_bf16 v[192:207], v[60:63], v[164:167], v[192:207]
    ds_read_b64_tr_b16 v[160:161], v15 offset:15360
    ds_read_b64_tr_b16 v[162:163], v15 offset:15552
    ds_read_b128 v[96:99], v220 offset:5120
    v_mfma_f32_16x16x32_bf16 v[212:215], v[224:227], v[164:167], v[212:215]
    s_add_u32 m0, s99, 125184
    s_add_u32 s17, s98, 165888
    buffer_load_dword v13, s[56:59], s17 offen lds
    s_waitcnt lgkmcnt(6)
    v_mfma_f32_32x32x16_bf16 v[192:207], v[88:91], v[168:171], v[192:207]
    ds_read_b64_tr_b16 v[164:165], v15 offset:16128
    ds_read_b64_tr_b16 v[166:167], v15 offset:16320
    ds_read_b128 v[100:103], v221 offset:5120
    v_mfma_f32_16x16x32_bf16 v[212:215], v[224:227], v[168:171], v[212:215]
    s_add_u32 m0, s41, 98304
    s_add_u32 s17, s40, 221184
    buffer_load_dwordx4 v232, s[56:59], s17 offen lds
    s_waitcnt lgkmcnt(6)
    v_mfma_f32_32x32x16_bf16 v[192:207], v[92:95], v[172:175], v[192:207]
    ds_read_b64_tr_b16 v[168:169], v15 offset:16896
    ds_read_b64_tr_b16 v[170:171], v15 offset:17088
    ds_read_b128 v[104:107], v222 offset:5120
    v_mfma_f32_16x16x32_bf16 v[212:215], v[224:227], v[172:175], v[212:215]
    s_add_u32 m0, s41, 101376
    s_add_u32 s17, s40, 248832
    buffer_load_dwordx4 v232, s[56:59], s17 offen lds
    s_waitcnt lgkmcnt(6)
    v_mfma_f32_32x32x16_bf16 v[192:207], v[96:99], v[160:163], v[192:207]
    ds_read_b64_tr_b16 v[172:173], v15 offset:17664
    ds_read_b64_tr_b16 v[174:175], v15 offset:17856
    ds_read_b128 v[108:111], v223 offset:5120
    v_mfma_f32_16x16x32_bf16 v[212:215], v[224:227], v[160:163], v[212:215]
    s_add_u32 m0, s99, 125952
    s_add_u32 s17, s98, 221184
    buffer_load_dword v13, s[56:59], s17 offen lds
    s_waitcnt lgkmcnt(6)
    v_mfma_f32_32x32x16_bf16 v[192:207], v[100:103], v[164:167], v[192:207]
    s_waitcnt vmcnt(24)
    s_barrier
    ds_read_b64_tr_b16 v[160:161], v15 offset:23040
    ds_read_b64_tr_b16 v[162:163], v15 offset:23232
    ds_read_b128 v[136:139], v222 offset:7168
    v_mfma_f32_16x16x32_bf16 v[212:215], v[224:227], v[164:167], v[212:215]
    s_add_u32 m0, s41, 104448
    s_add_u32 s17, s40, 276480
    buffer_load_dwordx4 v232, s[56:59], s17 offen lds
    s_waitcnt lgkmcnt(6)
    v_mfma_f32_32x32x16_bf16 v[192:207], v[104:107], v[168:171], v[192:207]
    ds_read_b64_tr_b16 v[164:165], v15 offset:23808
    ds_read_b64_tr_b16 v[166:167], v15 offset:24000
    ds_read_b128 v[140:143], v223 offset:7168
    v_mfma_f32_16x16x32_bf16 v[212:215], v[224:227], v[168:171], v[212:215]
    s_add_u32 m0, s41, 107520
    s_add_u32 s17, s40, 304128
    buffer_load_dwordx4 v232, s[56:59], s17 offen lds
    s_waitcnt lgkmcnt(6)
    v_mfma_f32_32x32x16_bf16 v[192:207], v[108:111], v[172:175], v[192:207]
    ds_read_b64_tr_b16 v[168:169], v15 offset:24576
    ds_read_b64_tr_b16 v[170:171], v15 offset:24768
    ds_read_b128 v[144:147], v220 offset:8192
    v_mfma_f32_16x16x32_bf16 v[212:215], v[224:227], v[172:175], v[212:215]
    s_add_u32 m0, s99, 126720
    s_add_u32 s17, s98, 276480
    buffer_load_dword v13, s[56:59], s17 offen lds
    s_waitcnt lgkmcnt(6)
    v_mfma_f32_32x32x16_bf16 v[192:207], v[136:139], v[160:163], v[192:207]
    ds_read_b64_tr_b16 v[172:173], v15 offset:25344
    ds_read_b64_tr_b16 v[174:175], v15 offset:25536
    ds_read_b128 v[148:151], v221 offset:8192
    v_mfma_f32_16x16x32_bf16 v[212:215], v[224:227], v[160:163], v[212:215]
    s_add_u32 m0, s41, 110592
    s_add_u32 s17, s40, 331776
    buffer_load_dwordx4 v232, s[56:59], s17 offen lds
    s_waitcnt lgkmcnt(6)
    v_mfma_f32_32x32x16_bf16 v[192:207], v[140:143], v[164:167], v[192:207]
    ds_read_b64_tr_b16 v[160:161], v15 offset:26112
    ds_read_b64_tr_b16 v[162:163], v15 offset:26304
    ds_read_b128 v[152:155], v222 offset:8192
    v_mfma_f32_16x16x32_bf16 v[212:215], v[224:227], v[164:167], v[212:215]
    s_add_u32 m0, s41, 113664
    s_add_u32 s17, s40, 359424
    buffer_load_dwordx4 v232, s[56:59], s17 offen lds
    s_waitcnt lgkmcnt(6)
    v_mfma_f32_32x32x16_bf16 v[192:207], v[144:147], v[168:171], v[192:207]
    ds_read_b64_tr_b16 v[164:165], v15 offset:26880
    ds_read_b64_tr_b16 v[166:167], v15 offset:27072
    ds_read_b128 v[156:159], v223 offset:8192
    v_mfma_f32_16x16x32_bf16 v[212:215], v[224:227], v[168:171], v[212:215]
    s_add_u32 m0, s99, 127488
    s_add_u32 s17, s98, 331776
    buffer_load_dword v13, s[56:59], s17 offen lds
    s_waitcnt lgkmcnt(6)
    v_mfma_f32_32x32x16_bf16 v[192:207], v[148:151], v[172:175], v[192:207]
    v_mfma_f32_16x16x32_bf16 v[212:215], v[224:227], v[172:175], v[212:215]
    s_add_u32 m0, s41, 116736
    s_add_u32 s17, s40, 387072
    buffer_load_dwordx4 v232, s[56:59], s17 offen lds
    s_waitcnt lgkmcnt(3)
    v_mfma_f32_32x32x16_bf16 v[192:207], v[152:155], v[160:163], v[192:207]
    v_mfma_f32_16x16x32_bf16 v[212:215], v[224:227], v[160:163], v[212:215]
    s_add_u32 m0, s41, 119808
    s_add_u32 s17, s40, 414720
    buffer_load_dwordx4 v232, s[56:59], s17 offen lds
    s_waitcnt lgkmcnt(0)
    v_mfma_f32_32x32x16_bf16 v[192:207], v[156:159], v[164:167], v[192:207]
    v_mfma_f32_16x16x32_bf16 v[212:215], v[224:227], v[164:167], v[212:215]
    s_add_u32 m0, s99, 128256
    s_add_u32 s17, s98, 387072
    buffer_load_dword v13, s[56:59], s17 offen lds
    buffer_load_dword v255, off, s[64:67], 0 sc1
    s_nop 3
    ds_write_b32 v12, v212 offset:9728
    ds_write_b128 v7, v[192:195] offset:5632
    ds_write_b128 v7, v[196:199] offset:6656
    ds_write_b128 v7, v[200:203] offset:7680
    ds_write_b128 v7, v[204:207] offset:8704
    s_setprio 0
    s_branch p1_o
p1_r3:
    s_waitcnt vmcnt(27)
    s_barrier
    ds_read_b128 v[40:43], v222 offset:1024
    ds_read_b128 v[44:47], v223 offset:1024
    ds_read_b128 v[48:51], v220 offset:2048
    ds_read_b128 v[52:55], v221 offset:2048
    s_waitcnt lgkmcnt(3)
    ds_read_b128 v[56:59], v222 offset:2048
    s_add_u32 m0, s41, 86016
    s_add_u32 s17, s40, 110592
    buffer_load_dwordx4 v232, s[56:59], s17 offen lds
    v_dot2_f32_bf16 v160, v40, s42, 0
    v_dot2_f32_bf16 v161, v40, v40, 0
    v_dot2_f32_bf16 v162, v41, s42, 0
    v_dot2_f32_bf16 v163, v41, v41, 0
    v_dot2_f32_bf16 v160, v42, s42, v160
    v_dot2_f32_bf16 v161, v42, v42, v161
    v_dot2_f32_bf16 v162, v43, s42, v162
    v_dot2_f32_bf16 v163, v43, v43, v163
    s_waitcnt lgkmcnt(3)
    ds_read_b128 v[60:63], v223 offset:2048
    s_add_u32 m0, s41, 89088
    s_add_u32 s17, s40, 138240
    buffer_load_dwordx4 v232, s[56:59], s17 offen lds
    v_dot2_f32_bf16 v160, v44, s42, v160
    v_dot2_f32_bf16 v161, v44, v44, v161
    v_dot2_f32_bf16 v162, v45, s42, v162
    v_dot2_f32_bf16 v163, v45, v45, v163
    v_dot2_f32_bf16 v160, v46, s42, v160
    v_dot2_f32_bf16 v161, v46, v46, v161
    v_dot2_f32_bf16 v162, v47, s42, v162
    v_dot2_f32_bf16 v163, v47, v47, v163
    s_waitcnt lgkmcnt(3)
    s_waitcnt vmcnt(23)
    s_barrier
    ds_read_b128 v[88:91], v222 offset:4096
    s_add_u32 m0, s99, 124416
    s_add_u32 s17, s98, 110592
    buffer_load_dword v13, s[56:59], s17 offen lds
    v_dot2_f32_bf16 v160, v48, s42, v160
    v_dot2_f32_bf16 v161, v48, v48, v161
    v_dot2_f32_bf16 v162, v49, s42, v162
    v_dot2_f32_bf16 v163, v49, v49, v163
    v_dot2_f32_bf16 v160, v50, s42, v160
    v_dot2_f32_bf16 v161, v50, v50, v161
    v_dot2_f32_bf16 v162, v51, s42, v162
    v_dot2_f32_bf16 v163, v51, v51, v163
    s_waitcnt lgkmcnt(3)
    ds_read_b128 v[92:95], v223 offset:4096
    s_add_u32 m0, s41, 92160
    s_add_u32 s17, s40, 165888
    buffer_load_dwordx4 v232, s[56:59], s17 offen lds
    v_dot2_f32_bf16 v160, v52, s42, v160
    v_dot2_f32_bf16 v161, v52, v52, v161
    v_dot2_f32_bf16 v162, v53, s42, v162
    v_dot2_f32_bf16 v163, v53, v53, v163
    v_dot2_f32_bf16 v160, v54, s42, v160
    v_dot2_f32_bf16 v161, v54, v54, v161
    v_dot2_f32_bf16 v162, v55, s42, v162
    v_dot2_f32_bf16 v163, v55, v55, v163
    s_waitcnt lgkmcnt(3)
    ds_read_b128 v[96:99], v220 offset:5120
    s_add_u32 m0, s41, 95232
    s_add_u32 s17, s40, 193536
    buffer_load_dwordx4 v232, s[56:59], s17 offen lds
    v_dot2_f32_bf16 v160, v56, s42, v160
    v_dot2_f32_bf16 v161, v56, v56, v161
    v_dot2_f32_bf16 v162, v57, s42, v162
    v_dot2_f32_bf16 v163, v57, v57, v163
    v_dot2_f32_bf16 v160, v58, s42, v160
    v_dot2_f32_bf16 v161, v58, v58, v161
    v_dot2_f32_bf16 v162, v59, s42, v162
    v_dot2_f32_bf16 v163, v59, v59, v163
    s_waitcnt lgkmcnt(3)
    ds_read_b128 v[100:103], v221 offset:5120
    s_add_u32 m0, s99, 125184
    s_add_u32 s17, s98, 165888
    buffer_load_dword v13, s[56:59], s17 offen lds
    v_dot2_f32_bf16 v160, v60, s42, v160
    v_dot2_f32_bf16 v161, v60, v60, v161
    v_dot2_f32_bf16 v162, v61, s42, v162
    v_dot2_f32_bf16 v163, v61, v61, v163
    v_dot2_f32_bf16 v160, v62, s42, v160
    v_dot2_f32_bf16 v161, v62, v62, v161
    v_dot2_f32_bf16 v162, v63, s42, v162
    v_dot2_f32_bf16 v163, v63, v63, v163
    s_waitcnt lgkmcnt(3)
    ds_read_b128 v[104:107], v222 offset:5120
    s_add_u32 m0, s41, 98304
    s_add_u32 s17, s40, 221184
    buffer_load_dwordx4 v232, s[56:59], s17 offen lds
    v_dot2_f32_bf16 v160, v88, s42, v160
    v_dot2_f32_bf16 v161, v88, v88, v161
    v_dot2_f32_bf16 v162, v89, s42, v162
    v_dot2_f32_bf16 v163, v89, v89, v163
    v_dot2_f32_bf16 v160, v90, s42, v160
    v_dot2_f32_bf16 v161, v90, v90, v161
    v_dot2_f32_bf16 v162, v91, s42, v162
    v_dot2_f32_bf16 v163, v91, v91, v163
    s_waitcnt lgkmcnt(3)
    ds_read_b128 v[108:111], v223 offset:5120
    s_add_u32 m0, s41, 101376
    s_add_u32 s17, s40, 248832
    buffer_load_dwordx4 v232, s[56:59], s17 offen lds
    v_dot2_f32_bf16 v160, v92, s42, v160
    v_dot2_f32_bf16 v161, v92, v92, v161
    v_dot2_f32_bf16 v162, v93, s42, v162
    v_dot2_f32_bf16 v163, v93, v93, v163
    v_dot2_f32_bf16 v160, v94, s42, v160
    v_dot2_f32_bf16 v161, v94, v94, v161
    v_dot2_f32_bf16 v162, v95, s42, v162
    v_dot2_f32_bf16 v163, v95, v95, v163
    s_waitcnt lgkmcnt(3)
    s_waitcnt vmcnt(23)
    s_barrier
    ds_read_b128 v[136:139], v222 offset:7168
    s_add_u32 m0, s99, 125952
    s_add_u32 s17, s98, 221184
    buffer_load_dword v13, s[56:59], s17 offen lds
    v_dot2_f32_bf16 v160, v96, s42, v160
    v_dot2_f32_bf16 v161, v96, v96, v161
    v_dot2_f32_bf16 v162, v97, s42, v162
    v_dot2_f32_bf16 v163, v97, v97, v163
    v_dot2_f32_bf16 v160, v98, s42, v160
    v_dot2_f32_bf16 v161, v98, v98, v161
    v_dot2_f32_bf16 v162, v99, s42, v162
    v_dot2_f32_bf16 v163, v99, v99, v163
    s_waitcnt lgkmcnt(3)
    ds_read_b128 v[140:143], v223 offset:7168
    s_add_u32 m0, s41, 104448
    s_add_u32 s17, s40, 276480
    buffer_load_dwordx4 v232, s[56:59], s17 offen lds
    v_dot2_f32_bf16 v160, v100, s42, v160
    v_dot2_f32_bf16 v161, v100, v100, v161
    v_dot2_f32_bf16 v162, v101, s42, v162
    v_dot2_f32_bf16 v163, v101, v101, v163
    v_dot2_f32_bf16 v160, v102, s42, v160
    v_dot2_f32_bf16 v161, v102, v102, v161
    v_dot2_f32_bf16 v162, v103, s42, v162
    v_dot2_f32_bf16 v163, v103, v103, v163
    s_waitcnt lgkmcnt(3)
    ds_read_b128 v[144:147], v220 offset:8192
    s_add_u32 m0, s41, 107520
    s_add_u32 s17, s40, 304128
    buffer_load_dwordx4 v232, s[56:59], s17 offen lds
    v_dot2_f32_bf16 v160, v104, s42, v160
    v_dot2_f32_bf16 v161, v104, v104, v161
    v_dot2_f32_bf16 v162, v105, s42, v162
    v_dot2_f32_bf16 v163, v105, v105, v163
    v_dot2_f32_bf16 v160, v106, s42, v160
    v_dot2_f32_bf16 v161, v106, v106, v161
    v_dot2_f32_bf16 v162, v107, s42, v162
    v_dot2_f32_bf16 v163, v107, v107, v163
    s_waitcnt lgkmcnt(3)
    ds_read_b128 v[148:151], v221 offset:8192
    s_add_u32 m0, s99, 126720
    s_add_u32 s17, s98, 276480
    buffer_load_dword v13, s[56:59], s17 offen lds
    v_dot2_f32_bf16 v160, v108, s42, v160
    v_dot2_f32_bf16 v161, v108, v108, v161
    v_dot2_f32_bf16 v162, v109, s42, v162
    v_dot2_f32_bf16 v163, v109, v109, v163
    v_dot2_f32_bf16 v160, v110, s42, v160
    v_dot2_f32_bf16 v161, v110, v110, v161
    v_dot2_f32_bf16 v162, v111, s42, v162
    v_dot2_f32_bf16 v163, v111, v111, v163
    s_waitcnt lgkmcnt(3)
    ds_read_b128 v[152:155], v222 offset:8192
    s_add_u32 m0, s41, 110592
    s_add_u32 s17, s40, 331776
    buffer_load_dwordx4 v232, s[56:59], s17 offen lds
    v_dot2_f32_bf16 v160, v136, s42, v160
    v_dot2_f32_bf16 v161, v136, v136, v161
    v_dot2_f32_bf16 v162, v137, s42, v162
    v_dot2_f32_bf16 v163, v137, v137, v163
    v_dot2_f32_bf16 v160, v138, s42, v160
    v_dot2_f32_bf16 v161, v138, v138, v161
    v_dot2_f32_bf16 v162, v139, s42, v162
    v_dot2_f32_bf16 v163, v139, v139, v163
    s_waitcnt lgkmcnt(3)
    ds_read_b128 v[156:159], v223 offset:8192
    s_add_u32 m0, s41, 113664
    s_add_u32 s17, s40, 359424
    buffer_load_dwordx4 v232, s[56:59], s17 offen lds
    v_dot2_f32_bf16 v160, v140, s42, v160
    v_dot2_f32_bf16 v161, v140, v140, v161
    v_dot2_f32_bf16 v162, v141, s42, v162
    v_dot2_f32_bf16 v163, v141, v141, v163
    v_dot2_f32_bf16 v160, v142, s42, v160
    v_dot2_f32_bf16 v161, v142, v142, v161
    v_dot2_f32_bf16 v162, v143, s42, v162
    v_dot2_f32_bf16 v163, v143, v143, v163
    s_waitcnt lgkmcnt(3)
    s_add_u32 m0, s99, 127488
    s_add_u32 s17, s98, 331776
    buffer_load_dword v13, s[56:59], s17 offen lds
    v_dot2_f32_bf16 v160, v144, s42, v160
    v_dot2_f32_bf16 v161, v144, v144, v161
    v_dot2_f32_bf16 v162, v145, s42, v162
    v_dot2_f32_bf16 v163, v145, v145, v163
    v_dot2_f32_bf16 v160, v146, s42, v160
    v_dot2_f32_bf16 v161, v146, v146, v161
    v_dot2_f32_bf16 v162, v147, s42, v162
    v_dot2_f32_bf16 v163, v147, v147, v163
    s_waitcnt lgkmcnt(2)
    s_add_u32 m0, s41, 116736
    s_add_u32 s17, s40, 387072
    buffer_load_dwordx4 v232, s[56:59], s17 offen lds
    v_dot2_f32_bf16 v160, v148, s42, v160
    v_dot2_f32_bf16 v161, v148, v148, v161
    v_dot2_f32_bf16 v162, v149, s42, v162
    v_dot2_f32_bf16 v163, v149, v149, v163
    v_dot2_f32_bf16 v160, v150, s42, v160
    v_dot2_f32_bf16 v161, v150, v150, v161
    v_dot2_f32_bf16 v162, v151, s42, v162
    v_dot2_f32_bf16 v163, v151, v151, v163
    s_waitcnt lgkmcnt(1)
    s_add_u32 m0, s41, 119808
    s_add_u32 s17, s40, 414720
    buffer_load_dwordx4 v232, s[56:59], s17 offen lds
    v_dot2_f32_bf16 v160, v152, s42, v160
    v_dot2_f32_bf16 v161, v152, v152, v161
    v_dot2_f32_bf16 v162, v153, s42, v162
    v_dot2_f32_bf16 v163, v153, v153, v163
    v_dot2_f32_bf16 v160, v154, s42, v160
    v_dot2_f32_bf16 v161, v154, v154, v161
    v_dot2_f32_bf16 v162, v155, s42, v162
    v_dot2_f32_bf16 v163, v155, v155, v163
    s_waitcnt lgkmcnt(0)
    s_add_u32 m0, s99, 128256
    s_add_u32 s17, s98, 387072
    buffer_load_dword v13, s[56:59], s17 offen lds
    v_dot2_f32_bf16 v160, v156, s42, v160
    v_dot2_f32_bf16 v161, v156, v156, v161
    v_dot2_f32_bf16 v162, v157, s42, v162
    v_dot2_f32_bf16 v163, v157, v157, v163
    v_dot2_f32_bf16 v160, v158, s42, v160
    v_dot2_f32_bf16 v161, v158, v158, v161
    v_dot2_f32_bf16 v162, v159, s42, v162
    v_dot2_f32_bf16 v163, v159, v159, v163
    buffer_load_dword v255, off, s[64:67], 0 sc1
    s_nop 0
    v_add_f32 v160, v160, v162
    v_add_f32 v161, v161, v163
    v_mov_b32 v162, v160
    v_mov_b32 v163, v161
    s_nop 0
    v_permlane32_swap_b32 v160, v162
    v_permlane32_swap_b32 v161, v163
    v_add_f32 v160, v160, v162
    v_add_f32 v161, v161, v163
    ds_write_b64 v8, v[160:161] offset:32000
p1_o:
    s_waitcnt vmcnt(13)
    s_waitcnt lgkmcnt(0)
    s_barrier
    ds_read_b64_tr_b16 v[160:161], v233 offset:0
    ds_read_b64_tr_b16 v[162:163], v233 offset:512
    ds_read_b64_tr_b16 v[164:165], v234
    ds_read_b64_tr_b16 v[166:167], v234 offset:64
    v_add_u32 v234, v234, v235
    ds_read_b128 v[16:19], v220 offset:36864
    ds_read_b64_tr_b16 v[168:169], v233 offset:2048
    ds_read_b64_tr_b16 v[170:171], v233 offset:2560
    ds_read_b64_tr_b16 v[172:173], v234
    ds_read_b64_tr_b16 v[174:175], v234 offset:64
    v_add_u32 v234, v234, v235
    ds_read_b128 v[20:23], v221 offset:36864
    ds_read_b64_tr_b16 v[176:177], v233 offset:4096
    ds_read_b64_tr_b16 v[178:179], v233 offset:4608
    ds_read_b64_tr_b16 v[180:181], v234
    ds_read_b64_tr_b16 v[182:183], v234 offset:64
    v_add_u32 v234, v234, v235
    ds_read_b128 v[24:27], v222 offset:36864
    s_add_u32 m0, s41, 0
    s_add_u32 s17, s40, 442368
    buffer_load_dwordx4 v232, s[56:59], s17 offen lds
    s_add_u32 m0, s41, 3072
    s_add_u32 s17, s40, 470016
    buffer_load_dwordx4 v232, s[56:59], s17 offen lds
    s_waitcnt lgkmcnt(10)
    v_mfma_f32_32x32x16_bf16 v[192:207], v[160:163], v[16:19], 0
    ds_read_b64_tr_b16 v[184:185], v233 offset:6144
    ds_read_b64_tr_b16 v[186:187], v233 offset:6656
    ds_read_b64_tr_b16 v[188:189], v234
    ds_read_b64_tr_b16 v[190:191], v234 offset:64
    ds_read_b128 v[28:31], v223 offset:36864
    v_mfma_f32_16x16x32_bf16 v[208:211], v[164:167], v[16:19], 0
    v_add_u32 v234, v234, v235
    v_mfma_f32_16x16x32_bf16 v[212:215], v[224:227], v[160:163], 0
    v_mfma_f32_16x16x32_bf16 v[216:219], v[164:167], v[228:231], 0
    s_add_u32 m0, s99, 129024
    s_add_u32 s17, s98, 442368
    buffer_load_dword v13, s[56:59], s17 offen lds
    s_waitcnt lgkmcnt(10)
    v_mfma_f32_32x32x16_bf16 v[192:207], v[168:171], v[20:23], v[192:207]
    ds_read_b64_tr_b16 v[160:161], v233 offset:8192
    ds_read_b64_tr_b16 v[162:163], v233 offset:8704
    ds_read_b64_tr_b16 v[164:165], v234
    ds_read_b64_tr_b16 v[166:167], v234 offset:64
    ds_read_b128 v[32:35], v220 offset:37888
    v_mfma_f32_16x16x32_bf16 v[208:211], v[172:175], v[20:23], v[208:211]
    v_add_u32 v234, v234, v235
    v_mfma_f32_16x16x32_bf16 v[212:215], v[224:227], v[168:171], v[212:215]
    v_mfma_f32_16x16x32_bf16 v[216:219], v[172:175], v[228:231], v[216:219]
    s_add_u32 m0, s41, 6144
    s_add_u32 s17, s40, 497664
    buffer_load_dwordx4 v232, s[56:59], s17 offen lds
    s_waitcnt lgkmcnt(10)
    v_mfma_f32_32x32x16_bf16 v[192:207], v[176:179], v[24:27], v[192:207]
    ds_read_b64_tr_b16 v[168:169], v233 offset:10240
    ds_read_b64_tr_b16 v[170:171], v233 offset:10752
    ds_read_b64_tr_b16 v[172:173], v234
    ds_read_b64_tr_b16 v[174:175], v234 offset:64
    ds_read_b128 v[36:39], v221 offset:37888
    v_mfma_f32_16x16x32_bf16 v[208:211], v[180:183], v[24:27], v[208:211]
    v_add_u32 v234, v234, v235
    v_mfma_f32_16x16x32_bf16 v[212:215], v[224:227], v[176:179], v[212:215]
    v_mfma_f32_16x16x32_bf16 v[216:219], v[180:183], v[228:231], v[216:219]
    s_add_u32 m0, s41, 9216
    s_add_u32 s17, s40, 525312
    buffer_load_dwordx4 v232, s[56:59], s17 offen lds
    s_waitcnt lgkmcnt(10)
    v_mfma_f32_32x32x16_bf16 v[192:207], v[184:187], v[28:31], v[192:207]
    ds_read_b64_tr_b16 v[176:177], v233 offset:12288
    ds_read_b64_tr_b16 v[178:179], v233 offset:12800
    ds_read_b64_tr_b16 v[180:181], v234
    ds_read_b64_tr_b16 v[182:183], v234 offset:64
    ds_read_b128 v[40:43], v222 offset:37888
    v_mfma_f32_16x16x32_bf16 v[208:211], v[188:191], v[28:31], v[208:211]
    v_add_u32 v234, v234, v235
    v_mfma_f32_16x16x32_bf16 v[212:215], v[224:227], v[184:187], v[212:215]
    v_mfma_f32_16x16x32_bf16 v[216:219], v[188:191], v[228:231], v[216:219]
    s_add_u32 m0, s99, 129792
    s_add_u32 s17, s98, 497664
    buffer_load_dword v13, s[56:59], s17 offen lds
    s_waitcnt lgkmcnt(10)
    v_mfma_f32_32x32x16_bf16 v[192:207], v[160:163], v[32:35], v[192:207]
    ds_read_b64_tr_b16 v[184:185], v233 offset:14336
    ds_read_b64_tr_b16 v[186:187], v233 offset:14848
    ds_read_b64_tr_b16 v[188:189], v234
    ds_read_b64_tr_b16 v[190:191], v234 offset:64
    ds_read_b128 v[44:47], v223 offset:37888
    v_mfma_f32_16x16x32_bf16 v[208:211], v[164:167], v[32:35], v[208:211]
    v_add_u32 v234, v234, v235
    v_mfma_f32_16x16x32_bf16 v[212:215], v[224:227], v[160:163], v[212:215]
    v_mfma_f32_16x16x32_bf16 v[216:219], v[164:167], v[228:231], v[216:219]
    s_add_u32 m0, s41, 12288
    s_add_u32 s17, s40, 552960
    buffer_load_dwordx4 v232, s[56:59], s17 offen lds
    s_waitcnt lgkmcnt(10)
    v_mfma_f32_32x32x16_bf16 v[192:207], v[168:171], v[36:39], v[192:207]
    ds_read_b64_tr_b16 v[160:161], v233 offset:16384
    ds_read_b64_tr_b16 v[162:163], v233 offset:16896
    ds_read_b64_tr_b16 v[164:165], v234
    ds_read_b64_tr_b16 v[166:167], v234 offset:64
    ds_read_b128 v[48:51], v220 offset:38912
    v_mfma_f32_16x16x32_bf16 v[208:211], v[172:175], v[36:39], v[208:211]
    ds_read_b128 a[16:19], v250 offset:36864
    v_add_u32 v234, v234, v235
    v_mfma_f32_16x16x32_bf16 v[212:215], v[224:227], v[168:171], v[212:215]
    v_mfma_f32_16x16x32_bf16 v[216:219], v[172:175], v[228:231], v[216:219]
    s_add_u32 m0, s41, 15360
    s_add_u32 s17, s40, 580608
    buffer_load_dwordx4 v232, s[56:59], s17 offen lds
    s_waitcnt lgkmcnt(11)
    v_mfma_f32_32x32x16_bf16 v[192:207], v[176:179], v[40:43], v[192:207]
    ds_read_b64_tr_b16 v[168:169], v233 offset:18432
    ds_read_b64_tr_b16 v[170:171], v233 offset:18944
    ds_read_b64_tr_b16 v[172:173], v234
    ds_read_b64_tr_b16 v[174:175], v234 offset:64
    ds_read_b128 v[52:55], v221 offset:38912
    v_mfma_f32_16x16x32_bf16 v[208:211], v[180:183], v[40:43], v[208:211]
    ds_read_b128 a[20:23], v250 offset:37888
    v_add_u32 v234, v234, v235
    v_mfma_f32_16x16x32_bf16 v[212:215], v[224:227], v[176:179], v[212:215]
    v_mfma_f32_16x16x32_bf16 v[216:219], v[180:183], v[228:231], v[216:219]
    s_add_u32 m0, s99, 130560
    s_add_u32 s17, s98, 552960
    buffer_load_dword v13, s[56:59], s17 offen lds
    s_waitcnt lgkmcnt(12)
    v_mfma_f32_32x32x16_bf16 v[192:207], v[184:187], v[44:47], v[192:207]
    ds_read_b64_tr_b16 v[176:177], v233 offset:20480
    ds_read_b64_tr_b16 v[178:179], v233 offset:20992
    ds_read_b64_tr_b16 v[180:181], v234
    ds_read_b64_tr_b16 v[182:183], v234 offset:64
    ds_read_b128 v[56:59], v222 offset:38912
    v_mfma_f32_16x16x32_bf16 v[208:211], v[188:191], v[44:47], v[208:211]
    ds_read_b128 a[24:27], v250 offset:38912
    v_add_u32 v234, v234, v235
    v_mfma_f32_16x16x32_bf16 v[212:215], v[224:227], v[184:187], v[212:215]
    v_mfma_f32_16x16x32_bf16 v[216:219], v[188:191], v[228:231], v[216:219]
    s_add_u32 m0, s41, 18432
    s_add_u32 s17, s40, 608256
    buffer_load_dwordx4 v232, s[56:59], s17 offen lds
    s_waitcnt lgkmcnt(12)
    v_mfma_f32_32x32x16_bf16 v[192:207], v[160:163], v[48:51], v[192:207]
    ds_read_b64_tr_b16 v[184:185], v233 offset:22528
    ds_read_b64_tr_b16 v[186:187], v233 offset:23040
    ds_read_b64_tr_b16 v[188:189], v234
    ds_read_b64_tr_b16 v[190:191], v234 offset:64
    ds_read_b128 v[60:63], v223 offset:38912
    v_mfma_f32_16x16x32_bf16 v[208:211], v[164:167], v[48:51], v[208:211]
    ds_read_b128 a[28:31], v250 offset:39936
    v_add_u32 v234, v234, v235
    v_mfma_f32_16x16x32_bf16 v[212:215], v[224:227], v[160:163], v[212:215]
    v_mfma_f32_16x16x32_bf16 v[216:219], v[164:167], v[228:231], v[216:219]
    v_mfma_f32_16x16x32_bf16 v[240:243], a[16:19], a[16:19], 0
    v_mfma_f32_16x16x32_bf16 a[12:15], v[228:231], a[16:19], 0
    s_add_u32 m0, s41, 21504
    s_add_u32 s17, s40, 635904
    buffer_load_dwordx4 v232, s[56:59], s17 offen lds
    s_waitcnt lgkmcnt(12)
    v_mfma_f32_32x32x16_bf16 v[192:207], v[168:171], v[52:55], v[192:207]
    s_waitcnt vmcnt(12)
    s_barrier
    ds_read_b64_tr_b16 v[160:161], v233 offset:24576
    ds_read_b64_tr_b16 v[162:163], v233 offset:25088
    ds_read_b64_tr_b16 v[164:165], v234
    ds_read_b64_tr_b16 v[166:167], v234 offset:64
    ds_read_b128 v[64:67], v220 offset:39936
    v_mfma_f32_16x16x32_bf16 v[208:211], v[172:175], v[52:55], v[208:211]
    ds_read_b128 a[32:35], v250 offset:40960
    v_add_u32 v234, v234, v235
    v_mfma_f32_16x16x32_bf16 v[212:215], v[224:227], v[168:171], v[212:215]
    v_mfma_f32_16x16x32_bf16 v[216:219], v[172:175], v[228:231], v[216:219]
    v_mfma_f32_16x16x32_bf16 v[240:243], a[20:23], a[20:23], v[240:243]
    v_mfma_f32_16x16x32_bf16 a[12:15], v[228:231], a[20:23], a[12:15]
    s_add_u32 m0, s99, 131328
    s_add_u32 s17, s98, 608256
    buffer_load_dword v13, s[56:59], s17 offen lds
    s_waitcnt lgkmcnt(12)
    v_mfma_f32_32x32x16_bf16 v[192:207], v[176:179], v[56:59], v[192:207]
    ds_read_b64_tr_b16 v[168:169], v233 offset:26624
    ds_read_b64_tr_b16 v[170:171], v233 offset:27136
    ds_read_b64_tr_b16 v[172:173], v234
    ds_read_b64_tr_b16 v[174:175], v234 offset:64
    ds_read_b128 v[68:71], v221 offset:39936
    v_mfma_f32_16x16x32_bf16 v[208:211], v[180:183], v[56:59], v[208:211]
    ds_read_b128 a[36:39], v250 offset:41984
    v_add_u32 v234, v234, v235
    v_mfma_f32_16x16x32_bf16 v[240:243], a[24:27], a[24:27], v[240:243]
    v_mfma_f32_16x16x32_bf16 a[12:15], v[228:231], a[24:27], a[12:15]
    s_waitcnt lgkmcnt(12)
    v_mfma_f32_32x32x16_bf16 v[192:207], v[184:187], v[60:63], v[192:207]
    ds_read_b64_tr_b16 v[176:177], v233 offset:28672
    ds_read_b64_tr_b16 v[178:179], v233 offset:29184
    ds_read_b64_tr_b16 v[180:181], v234
    ds_read_b64_tr_b16 v[182:183], v234 offset:64
    ds_read_b128 v[72:75], v222 offset:39936
    v_mfma_f32_16x16x32_bf16 v[208:211], v[188:191], v[60:63], v[208:211]
    ds_read_b128 a[40:43], v250 offset:43008
    v_add_u32 v234, v234, v235
    v_mfma_f32_16x16x32_bf16 v[212:215], v[224:227], v[184:187], v[212:215]
    v_mfma_f32_16x16x32_bf16 v[216:219], v[188:191], v[228:231], v[216:219]
    v_mfma_f32_16x16x32_bf16 v[240:243], a[28:31], a[28:31], v[240:243]
    v_mfma_f32_16x16x32_bf16 a[12:15], v[228:231], a[28:31], a[12:15]
    s_waitcnt lgkmcnt(12)
    v_mfma_f32_32x32x16_bf16 v[192:207], v[160:163], v[64:67], v[192:207]
    ds_read_b64_tr_b16 v[184:185], v233 offset:30720
    ds_read_b64_tr_b16 v[186:187], v233 offset:31232
    ds_read_b64_tr_b16 v[188:189], v234
    ds_read_b64_tr_b16 v[190:191], v234 offset:64
    ds_read_b128 v[76:79], v223 offset:39936
    v_mfma_f32_16x16x32_bf16 v[208:211], v[164:167], v[64:67], v[208:211]
    ds_read_b128 a[44:47], v250 offset:44032
    v_add_u32 v234, v234, v235
    v_mfma_f32_16x16x32_bf16 v[240:243], a[32:35], a[32:35], v[240:243]
    v_mfma_f32_16x16x32_bf16 a[12:15], v[228:231], a[32:35], a[12:15]
    s_waitcnt lgkmcnt(12)
    v_mfma_f32_32x32x16_bf16 v[192:207], v[168:171], v[68:71], v[192:207]
    ds_read_b64_tr_b16 v[160:161], v233 offset:32768
    ds_read_b64_tr_b16 v[162:163], v233 offset:33280
    ds_read_b64_tr_b16 v[164:165], v234
    ds_read_b64_tr_b16 v[166:167], v234 offset:64
    ds_read_b128 v[80:83], v220 offset:40960
    v_mfma_f32_16x16x32_bf16 v[208:211], v[172:175], v[68:71], v[208:211]
    ds_read_b128 a[48:51], v250 offset:45056
    v_add_u32 v234, v234, v235
    v_mfma_f32_16x16x32_bf16 v[212:215], v[224:227], v[168:171], v[212:215]
    v_mfma_f32_16x16x32_bf16 v[216:219], v[172:175], v[228:231], v[216:219]
    v_mfma_f32_16x16x32_bf16 v[240:243], a[36:39], a[36:39], v[240:243]
    v_mfma_f32_16x16x32_bf16 a[12:15], v[228:231], a[36:39], a[12:15]
    s_waitcnt lgkmcnt(12)
    v_mfma_f32_32x32x16_bf16 v[192:207], v[176:179], v[72:75], v[192:207]
    ds_read_b64_tr_b16 v[168:169], v233 offset:34816
    ds_read_b64_tr_b16 v[170:171], v233 offset:35328
    ds_read_b64_tr_b16 v[172:173], v234
    ds_read_b64_tr_b16 v[174:175], v234 offset:64
    ds_read_b128 v[84:87], v221 offset:40960
    v_mfma_f32_16x16x32_bf16 v[208:211], v[180:183], v[72:75], v[208:211]
    v_add_u32 v234, v234, v235
    v_mfma_f32_16x16x32_bf16 v[240:243], a[40:43], a[40:43], v[240:243]
    v_mfma_f32_16x16x32_bf16 a[12:15], v[228:231], a[40:43], a[12:15]
    s_waitcnt lgkmcnt(11)
    v_mfma_f32_32x32x16_bf16 v[192:207], v[184:187], v[76:79], v[192:207]
    ds_read_b64_tr_b16 v[176:177], v233 offset:36864
    ds_read_b64_tr_b16 v[178:179], v233 offset:37376
    ds_read_b64_tr_b16 v[180:181], v234
    ds_read_b64_tr_b16 v[182:183], v234 offset:64
    ds_read_b128 v[88:91], v222 offset:40960
    v_mfma_f32_16x16x32_bf16 v[208:211], v[188:191], v[76:79], v[208:211]
    v_add_u32 v234, v234, v235
    v_mfma_f32_16x16x32_bf16 v[212:215], v[224:227], v[184:187], v[212:215]
    v_mfma_f32_16x16x32_bf16 v[216:219], v[188:191], v[228:231], v[216:219]
    v_mfma_f32_16x16x32_bf16 v[240:243], a[44:47], a[44:47], v[240:243]
    v_mfma_f32_16x16x32_bf16 a[12:15], v[228:231], a[44:47], a[12:15]
    s_waitcnt lgkmcnt(10)
    v_mfma_f32_32x32x16_bf16 v[192:207], v[160:163], v[80:83], v[192:207]
    ds_read_b64_tr_b16 v[184:185], v233 offset:38912
    ds_read_b64_tr_b16 v[186:187], v233 offset:39424
    ds_read_b64_tr_b16 v[188:189], v234
    ds_read_b64_tr_b16 v[190:191], v234 offset:64
    ds_read_b128 v[92:95], v223 offset:40960
    v_mfma_f32_16x16x32_bf16 v[208:211], v[164:167], v[80:83], v[208:211]
    v_add_u32 v234, v234, v235
    v_mfma_f32_16x16x32_bf16 v[240:243], a[48:51], a[48:51], v[240:243]
    v_mfma_f32_16x16x32_bf16 a[12:15], v[228:231], a[48:51], a[12:15]
    s_waitcnt lgkmcnt(10)
    v_mfma_f32_32x32x16_bf16 v[192:207], v[168:171], v[84:87], v[192:207]
    ds_read_b64_tr_b16 v[160:161], v233 offset:40960
    ds_read_b64_tr_b16 v[162:163], v233 offset:41472
    ds_read_b64_tr_b16 v[164:165], v234
    ds_read_b64_tr_b16 v[166:167], v234 offset:64
    ds_read_b128 v[96:99], v220 offset:41984
    v_mfma_f32_16x16x32_bf16 v[208:211], v[172:175], v[84:87], v[208:211]
    v_add_u32 v234, v234, v235
    v_mfma_f32_16x16x32_bf16 v[212:215], v[224:227], v[168:171], v[212:215]
    v_mfma_f32_16x16x32_bf16 v[216:219], v[172:175], v[228:231], v[216:219]
    s_waitcnt lgkmcnt(10)
    v_mfma_f32_32x32x16_bf16 v[192:207], v[176:179], v[88:91], v[192:207]
    ds_read_b64_tr_b16 v[168:169], v233 offset:43008
    ds_read_b64_tr_b16 v[170:171], v233 offset:43520
    ds_read_b64_tr_b16 v[172:173], v234
    ds_read_b64_tr_b16 v[174:175], v234 offset:64
    ds_read_b128 v[100:103], v221 offset:41984
    v_mfma_f32_16x16x32_bf16 v[208:211], v[180:183], v[88:91], v[208:211]
    v_add_u32 v234, v234, v235
    s_mov_b32 vcc_lo, 0xaaaaaaaa
    s_mov_b32 vcc_hi, 0xaaaaaaaa
    v_cndmask_b32 v241, v240, v241, vcc
    v_cndmask_b32 v243, v242, v243, vcc
    s_mov_b32 vcc_lo, 0xcccccccc
    s_mov_b32 vcc_hi, 0xcccccccc
    v_accvgpr_read_b32 v240, a12
    v_cndmask_b32 v241, v241, v243, vcc
    s_mov_b32 exec_lo, 0x00f0000f
    s_mov_b32 exec_hi, 0xf0000f00
    ds_write_b64 v251, v[240:241] offset:32256
    s_mov_b64 exec, -1
    s_waitcnt lgkmcnt(11)
    v_mfma_f32_32x32x16_bf16 v[192:207], v[184:187], v[92:95], v[192:207]
    ds_read_b64_tr_b16 v[176:177], v233 offset:45056
    ds_read_b64_tr_b16 v[178:179], v233 offset:45568
    ds_read_b64_tr_b16 v[180:181], v234
    ds_read_b64_tr_b16 v[182:183], v234 offset:64
    ds_read_b128 v[104:107], v222 offset:41984
    v_mfma_f32_16x16x32_bf16 v[208:211], v[188:191], v[92:95], v[208:211]
    v_add_u32 v234, v234, v235
    v_mfma_f32_16x16x32_bf16 v[212:215], v[224:227], v[184:187], v[212:215]
    v_mfma_f32_16x16x32_bf16 v[216:219], v[188:191], v[228:231], v[216:219]
    s_waitcnt lgkmcnt(11)
    v_mfma_f32_32x32x16_bf16 v[192:207], v[160:163], v[96:99], v[192:207]
    ds_read_b64_tr_b16 v[184:185], v233 offset:47104
    ds_read_b64_tr_b16 v[186:187], v233 offset:47616
    ds_read_b64_tr_b16 v[188:189], v234
    ds_read_b64_tr_b16 v[190:191], v234 offset:64
    ds_read_b128 v[108:111], v223 offset:41984
    v_mfma_f32_16x16x32_bf16 v[208:211], v[164:167], v[96:99], v[208:211]
    v_add_u32 v234, v234, v235
    s_waitcnt lgkmcnt(11)
    v_mfma_f32_32x32x16_bf16 v[192:207], v[168:171], v[100:103], v[192:207]
    s_waitcnt vmcnt(0) lgkmcnt(10)
    s_barrier
    ds_read_b64_tr_b16 v[160:161], v14 offset:0
    ds_read_b64_tr_b16 v[162:163], v14 offset:512
    ds_read_b64_tr_b16 v[164:165], v234
    ds_read_b64_tr_b16 v[166:167], v234 offset:64
    ds_read_b128 v[112:115], v220 offset:43008
    v_mfma_f32_16x16x32_bf16 v[208:211], v[172:175], v[100:103], v[208:211]
    v_add_u32 v234, v234, v235
    v_mfma_f32_16x16x32_bf16 v[212:215], v[224:227], v[168:171], v[212:215]
    v_mfma_f32_16x16x32_bf16 v[216:219], v[172:175], v[228:231], v[216:219]
    s_waitcnt lgkmcnt(10)
    v_mfma_f32_32x32x16_bf16 v[192:207], v[176:179], v[104:107], v[192:207]
    ds_read_b64_tr_b16 v[168:169], v14 offset:2048
    ds_read_b64_tr_b16 v[170:171], v14 offset:2560
    ds_read_b64_tr_b16 v[172:173], v234
    ds_read_b64_tr_b16 v[174:175], v234 offset:64
    ds_read_b128 v[116:119], v221 offset:43008
    v_mfma_f32_16x16x32_bf16 v[208:211], v[180:183], v[104:107], v[208:211]
    v_add_u32 v234, v234, v235
    ds_read_b64 v[4:5], v8 offset:32256
    ds_read_b64 v[6:7], v8 offset:32512
    s_waitcnt lgkmcnt(12)
    v_mfma_f32_32x32x16_bf16 v[192:207], v[184:187], v[108:111], v[192:207]
    ds_read_b64_tr_b16 v[176:177], v14 offset:4096
    ds_read_b64_tr_b16 v[178:179], v14 offset:4608
    ds_read_b64_tr_b16 v[180:181], v234
    ds_read_b64_tr_b16 v[182:183], v234 offset:64
    ds_read_b128 v[120:123], v222 offset:43008
    v_mfma_f32_16x16x32_bf16 v[208:211], v[188:191], v[108:111], v[208:211]
    v_add_u32 v234, v234, v235
    v_mfma_f32_16x16x32_bf16 v[212:215], v[224:227], v[184:187], v[212:215]
    v_mfma_f32_16x16x32_bf16 v[216:219], v[188:191], v[228:231], v[216:219]
    s_waitcnt lgkmcnt(12)
    v_mfma_f32_32x32x16_bf16 v[192:207], v[160:163], v[112:115], v[192:207]
    ds_read_b64_tr_b16 v[184:185], v14 offset:6144
    ds_read_b64_tr_b16 v[186:187], v14 offset:6656
    ds_read_b64_tr_b16 v[188:189], v234
    ds_read_b64_tr_b16 v[190:191], v234 offset:64
    ds_read_b128 v[124:127], v223 offset:43008
    v_mfma_f32_16x16x32_bf16 v[208:211], v[164:167], v[112:115], v[208:211]
    v_add_u32 v234, v234, v235
    s_waitcnt lgkmcnt(10)
    v_add_f32 v10, v4, v6
    v_add_f32 v11, v5, v7
    v_mul_f32 v10, 0xbae38e39, v10
    v_mul_f32 v11, 0x3ae38e39, v11
    v_fma_f32 v11, -v10, v10, v11
    v_add_f32 v11, 0x3727c5ac, v11
    v_rsq_f32 v11, v11
    v_mfma_f32_32x32x16_bf16 v[192:207], v[168:171], v[116:119], v[192:207]
    ds_read_b64_tr_b16 v[160:161], v14 offset:8192
    ds_read_b64_tr_b16 v[162:163], v14 offset:8704
    ds_read_b64_tr_b16 v[164:165], v234
    ds_read_b64_tr_b16 v[166:167], v234 offset:64
    ds_read_b128 v[128:131], v220 offset:44032
    v_mfma_f32_16x16x32_bf16 v[208:211], v[172:175], v[116:119], v[208:211]
    v_add_u32 v234, v234, v235
    v_mfma_f32_16x16x32_bf16 v[212:215], v[224:227], v[168:171], v[212:215]
    v_mfma_f32_16x16x32_bf16 v[216:219], v[172:175], v[228:231], v[216:219]
    s_waitcnt lgkmcnt(10)
    v_mfma_f32_32x32x16_bf16 v[192:207], v[176:179], v[120:123], v[192:207]
    ds_read_b64_tr_b16 v[168:169], v14 offset:10240
    ds_read_b64_tr_b16 v[170:171], v14 offset:10752
    ds_read_b64_tr_b16 v[172:173], v234
    ds_read_b64_tr_b16 v[174:175], v234 offset:64
    ds_read_b128 v[132:135], v221 offset:44032
    v_mfma_f32_16x16x32_bf16 v[208:211], v[180:183], v[120:123], v[208:211]
    v_add_u32 v234, v234, v235
    s_waitcnt lgkmcnt(10)
    v_mfma_f32_32x32x16_bf16 v[192:207], v[184:187], v[124:127], v[192:207]
    ds_read_b64_tr_b16 v[176:177], v14 offset:12288
    ds_read_b64_tr_b16 v[178:179], v14 offset:12800
    ds_read_b64_tr_b16 v[180:181], v234
    ds_read_b64_tr_b16 v[182:183], v234 offset:64
    ds_read_b128 v[136:139], v222 offset:44032
    v_mfma_f32_16x16x32_bf16 v[208:211], v[188:191], v[124:127], v[208:211]
    v_add_u32 v234, v234, v235
    v_mfma_f32_16x16x32_bf16 v[212:215], v[224:227], v[184:187], v[212:215]
    v_mfma_f32_16x16x32_bf16 v[216:219], v[188:191], v[228:231], v[216:219]
    v_cvt_pk_bf16_f32 v6, v10, v10
    v_cmp_gt_u32 vcc, 32, v1
    v_lshlrev_b32 v6, 16, v6
    v_sub_f32 v6, v10, v6
    v_cvt_pk_bf16_f32 v6, v10, v6
    v_cndmask_b32 v6, 0, v6, vcc
    v_mov_b32 v7, v6
    s_waitcnt lgkmcnt(10)
    v_mfma_f32_32x32x16_bf16 v[192:207], v[160:163], v[128:131], v[192:207]
    ds_read_b64_tr_b16 v[184:185], v14 offset:14336
    ds_read_b64_tr_b16 v[186:187], v14 offset:14848
    ds_read_b64_tr_b16 v[188:189], v234
    ds_read_b64_tr_b16 v[190:191], v234 offset:64
    ds_read_b128 v[140:143], v223 offset:44032
    v_mfma_f32_16x16x32_bf16 v[208:211], v[164:167], v[128:131], v[208:211]
    v_add_u32 v234, v234, v235
    v_mul_f32 v11, 0x3eae1a93, v11
    v_lshlrev_b32 v5, 6, v1
    s_mov_b32 s23, 3375104
    s_lshl_b32 s18, s16, 11
    s_add_u32 s18, s18, 0x20000
    v_add_u32 v12, s18, v2
    s_waitcnt lgkmcnt(10)
    v_mfma_f32_32x32x16_bf16 v[192:207], v[168:171], v[132:135], v[192:207]
    ds_read_b64_tr_b16 v[160:161], v14 offset:16384
    ds_read_b64_tr_b16 v[162:163], v14 offset:16896
    ds_read_b64_tr_b16 v[164:165], v234
    ds_read_b64_tr_b16 v[166:167], v234 offset:64
    ds_read_b128 v[144:147], v220 offset:45056
    v_mfma_f32_16x16x32_bf16 v[208:211], v[172:175], v[132:135], v[208:211]
    v_add_u32 v234, v234, v235
    v_mfma_f32_16x16x32_bf16 v[212:215], v[224:227], v[168:171], v[212:215]
    v_mfma_f32_16x16x32_bf16 v[216:219], v[172:175], v[228:231], v[216:219]
    s_waitcnt lgkmcnt(10)
    v_mfma_f32_32x32x16_bf16 v[192:207], v[176:179], v[136:139], v[192:207]
    ds_read_b64_tr_b16 v[168:169], v14 offset:18432
    ds_read_b64_tr_b16 v[170:171], v14 offset:18944
    ds_read_b64_tr_b16 v[172:173], v234
    ds_read_b64_tr_b16 v[174:175], v234 offset:64
    ds_read_b128 v[148:151], v221 offset:45056
    v_mfma_f32_16x16x32_bf16 v[208:211], v[180:183], v[136:139], v[208:211]
    v_add_u32 v234, v234, v235
    s_waitcnt lgkmcnt(10)
    v_mfma_f32_32x32x16_bf16 v[192:207], v[184:187], v[140:143], v[192:207]
    ds_read_b64_tr_b16 v[176:177], v14 offset:20480
    ds_read_b64_tr_b16 v[178:179], v14 offset:20992
    ds_read_b64_tr_b16 v[180:181], v234
    ds_read_b64_tr_b16 v[182:183], v234 offset:64
    ds_read_b128 v[152:155], v222 offset:45056
    v_mfma_f32_16x16x32_bf16 v[208:211], v[188:191], v[140:143], v[208:211]
    v_add_u32 v234, v234, v235
    v_mfma_f32_16x16x32_bf16 v[212:215], v[224:227], v[184:187], v[212:215]
    v_mfma_f32_16x16x32_bf16 v[216:219], v[188:191], v[228:231], v[216:219]
    s_waitcnt lgkmcnt(10)
    v_mfma_f32_32x32x16_bf16 v[192:207], v[160:163], v[144:147], v[192:207]
    ds_read_b64_tr_b16 v[184:185], v14 offset:22528
    ds_read_b64_tr_b16 v[186:187], v14 offset:23040
    ds_read_b64_tr_b16 v[188:189], v234
    ds_read_b64_tr_b16 v[190:191], v234 offset:64
    ds_read_b128 v[156:159], v223 offset:45056
    v_mfma_f32_16x16x32_bf16 v[208:211], v[164:167], v[144:147], v[208:211]
    v_add_u32 v234, v234, v235
    v_mfma_f32_16x16x32_bf16 v[16:19], v[224:227], v[160:163], 0
    v_mfma_f32_16x16x32_bf16 v[20:23], v[164:167], v[228:231], 0
    ds_write_b128 v12, v[216:219] offset:1024
    ds_write_b32 v12, v212 offset:2048
    v_xor_b32 v12, 2048, v12
    s_waitcnt lgkmcnt(12)
    v_mfma_f32_32x32x16_bf16 v[192:207], v[168:171], v[148:151], v[192:207]
    v_mfma_f32_16x16x32_bf16 v[208:211], v[172:175], v[148:151], v[208:211]
    v_mfma_f32_16x16x32_bf16 v[16:19], v[224:227], v[168:171], v[16:19]
    v_mfma_f32_16x16x32_bf16 v[20:23], v[172:175], v[228:231], v[20:23]
    s_waitcnt vmcnt(0)
p1_mk1:
    v_readfirstlane_b32 s17, v255
    s_cmp_lg_u32 s17, 0
    s_cbranch_scc0 p1_mkslow1
p1_mkok1:
    buffer_load_dwordx2 v[254:255], v5, s[36:39], s23 offen sc1
    s_waitcnt lgkmcnt(7)
    v_mfma_f32_32x32x16_bf16 v[192:207], v[176:179], v[152:155], v[192:207]
    v_mfma_f32_16x16x32_bf16 v[208:211], v[180:183], v[152:155], v[208:211]
    v_mfma_f32_16x16x32_bf16 v[16:19], v[224:227], v[176:179], v[16:19]
    v_mfma_f32_16x16x32_bf16 v[20:23], v[180:183], v[228:231], v[20:23]
    s_waitcnt lgkmcnt(0)
    s_barrier
    ds_read_b128 v[24:27], v12 offset:1024
    ds_read_b32 v28, v12 offset:2048
    v_mfma_f32_32x32x16_bf16 v[192:207], v[184:187], v[156:159], v[192:207]
    v_mfma_f32_16x16x32_bf16 v[208:211], v[188:191], v[156:159], v[208:211]
    v_mfma_f32_16x16x32_bf16 v[16:19], v[224:227], v[184:187], v[16:19]
    v_mfma_f32_16x16x32_bf16 v[20:23], v[188:191], v[228:231], v[20:23]
    s_branch p1_qx
p1_r2:
    s_waitcnt vmcnt(27)
    s_barrier
    ds_read_b128 v[16:19], v220 offset:0
    ds_read_b128 v[20:23], v221 offset:0
    ds_read_b128 v[24:27], v222 offset:0
    ds_read_b128 v[28:31], v223 offset:0
    s_waitcnt lgkmcnt(3)
    ds_read_b128 v[32:35], v220 offset:1024
    ds_read_b128 v[40:43], v222 offset:1024
    s_add_u32 m0, s41, 86016
    s_add_u32 s17, s40, 110592
    buffer_load_dwordx4 v232, s[56:59], s17 offen lds
    v_dot2_f32_bf16 v160, v16, s42, 0
    v_dot2_f32_bf16 v161, v16, v16, 0
    v_dot2_f32_bf16 v162, v17, s42, 0
    v_dot2_f32_bf16 v163, v17, v17, 0
    v_dot2_f32_bf16 v160, v18, s42, v160
    v_dot2_f32_bf16 v161, v18, v18, v161
    v_dot2_f32_bf16 v162, v19, s42, v162
    v_dot2_f32_bf16 v163, v19, v19, v163
    s_waitcnt lgkmcnt(4)
    ds_read_b128 v[36:39], v221 offset:1024
    ds_read_b128 v[44:47], v223 offset:1024
    s_add_u32 m0, s41, 89088
    s_add_u32 s17, s40, 138240
    buffer_load_dwordx4 v232, s[56:59], s17 offen lds
    v_dot2_f32_bf16 v160, v20, s42, v160
    v_dot2_f32_bf16 v161, v20, v20, v161
    v_dot2_f32_bf16 v162, v21, s42, v162
    v_dot2_f32_bf16 v163, v21, v21, v163
    v_dot2_f32_bf16 v160, v22, s42, v160
    v_dot2_f32_bf16 v161, v22, v22, v161
    v_dot2_f32_bf16 v162, v23, s42, v162
    v_dot2_f32_bf16 v163, v23, v23, v163
    s_waitcnt lgkmcnt(5)
    s_waitcnt vmcnt(23)
    s_barrier
    ds_read_b128 v[64:67], v220 offset:3072
    ds_read_b128 v[48:51], v220 offset:2048
    s_add_u32 m0, s99, 124416
    s_add_u32 s17, s98, 110592
    buffer_load_dword v13, s[56:59], s17 offen lds
    v_dot2_f32_bf16 v160, v24, s42, v160
    v_dot2_f32_bf16 v161, v24, v24, v161
    v_dot2_f32_bf16 v162, v25, s42, v162
    v_dot2_f32_bf16 v163, v25, v25, v163
    v_dot2_f32_bf16 v160, v26, s42, v160
    v_dot2_f32_bf16 v161, v26, v26, v161
    v_dot2_f32_bf16 v162, v27, s42, v162
    v_dot2_f32_bf16 v163, v27, v27, v163
    s_waitcnt lgkmcnt(6)
    ds_read_b128 v[68:71], v221 offset:3072
    ds_read_b128 v[52:55], v221 offset:2048
    s_add_u32 m0, s41, 92160
    s_add_u32 s17, s40, 165888
    buffer_load_dwordx4 v232, s[56:59], s17 offen lds
    v_dot2_f32_bf16 v160, v28, s42, v160
    v_dot2_f32_bf16 v161, v28, v28, v161
    v_dot2_f32_bf16 v162, v29, s42, v162
    v_dot2_f32_bf16 v163, v29, v29, v163
    v_dot2_f32_bf16 v160, v30, s42, v160
    v_dot2_f32_bf16 v161, v30, v30, v161
    v_dot2_f32_bf16 v162, v31, s42, v162
    v_dot2_f32_bf16 v163, v31, v31, v163
    s_waitcnt lgkmcnt(7)
    ds_read_b128 v[72:75], v222 offset:3072
    ds_read_b128 v[56:59], v222 offset:2048
    s_add_u32 m0, s41, 95232
    s_add_u32 s17, s40, 193536
    buffer_load_dwordx4 v232, s[56:59], s17 offen lds
    v_dot2_f32_bf16 v160, v32, s42, v160
    v_dot2_f32_bf16 v161, v32, v32, v161
    v_dot2_f32_bf16 v162, v33, s42, v162
    v_dot2_f32_bf16 v163, v33, v33, v163
    v_dot2_f32_bf16 v160, v34, s42, v160
    v_dot2_f32_bf16 v161, v34, v34, v161
    v_dot2_f32_bf16 v162, v35, s42, v162
    v_dot2_f32_bf16 v163, v35, v35, v163
    s_waitcnt lgkmcnt(7)
    ds_read_b128 v[76:79], v223 offset:3072
    ds_read_b128 v[60:63], v223 offset:2048
    s_add_u32 m0, s99, 125184
    s_add_u32 s17, s98, 165888
    buffer_load_dword v13, s[56:59], s17 offen lds
    v_dot2_f32_bf16 v160, v36, s42, v160
    v_dot2_f32_bf16 v161, v36, v36, v161
    v_dot2_f32_bf16 v162, v37, s42, v162
    v_dot2_f32_bf16 v163, v37, v37, v163
    v_dot2_f32_bf16 v160, v38, s42, v160
    v_dot2_f32_bf16 v161, v38, v38, v161
    v_dot2_f32_bf16 v162, v39, s42, v162
    v_dot2_f32_bf16 v163, v39, v39, v163
    s_waitcnt lgkmcnt(7)
    ds_read_b128 v[80:83], v220 offset:4096
    ds_read_b128 v[88:91], v222 offset:4096
    s_add_u32 m0, s41, 98304
    s_add_u32 s17, s40, 221184
    buffer_load_dwordx4 v232, s[56:59], s17 offen lds
    v_dot2_f32_bf16 v160, v64, s42, v160
    v_dot2_f32_bf16 v161, v64, v64, v161
    v_dot2_f32_bf16 v162, v65, s42, v162
    v_dot2_f32_bf16 v163, v65, v65, v163
    v_dot2_f32_bf16 v160, v66, s42, v160
    v_dot2_f32_bf16 v161, v66, v66, v161
    v_dot2_f32_bf16 v162, v67, s42, v162
    v_dot2_f32_bf16 v163, v67, v67, v163
    s_waitcnt lgkmcnt(7)
    ds_read_b128 v[84:87], v221 offset:4096
    ds_read_b128 v[92:95], v223 offset:4096
    s_add_u32 m0, s41, 101376
    s_add_u32 s17, s40, 248832
    buffer_load_dwordx4 v232, s[56:59], s17 offen lds
    v_dot2_f32_bf16 v160, v68, s42, v160
    v_dot2_f32_bf16 v161, v68, v68, v161
    v_dot2_f32_bf16 v162, v69, s42, v162
    v_dot2_f32_bf16 v163, v69, v69, v163
    v_dot2_f32_bf16 v160, v70, s42, v160
    v_dot2_f32_bf16 v161, v70, v70, v161
    v_dot2_f32_bf16 v162, v71, s42, v162
    v_dot2_f32_bf16 v163, v71, v71, v163
    s_waitcnt lgkmcnt(7)
    s_waitcnt vmcnt(23)
    s_barrier
    ds_read_b128 v[112:115], v220 offset:6144
    ds_read_b128 v[96:99], v220 offset:5120
    s_add_u32 m0, s99, 125952
    s_add_u32 s17, s98, 221184
    buffer_load_dword v13, s[56:59], s17 offen lds
    v_dot2_f32_bf16 v160, v72, s42, v160
    v_dot2_f32_bf16 v161, v72, v72, v161
    v_dot2_f32_bf16 v162, v73, s42, v162
    v_dot2_f32_bf16 v163, v73, v73, v163
    v_dot2_f32_bf16 v160, v74, s42, v160
    v_dot2_f32_bf16 v161, v74, v74, v161
    v_dot2_f32_bf16 v162, v75, s42, v162
    v_dot2_f32_bf16 v163, v75, v75, v163
    s_waitcnt lgkmcnt(7)
    ds_read_b128 v[116:119], v221 offset:6144
    ds_read_b128 v[100:103], v221 offset:5120
    s_add_u32 m0, s41, 104448
    s_add_u32 s17, s40, 276480
    buffer_load_dwordx4 v232, s[56:59], s17 offen lds
    v_dot2_f32_bf16 v160, v76, s42, v160
    v_dot2_f32_bf16 v161, v76, v76, v161
    v_dot2_f32_bf16 v162, v77, s42, v162
    v_dot2_f32_bf16 v163, v77, v77, v163
    v_dot2_f32_bf16 v160, v78, s42, v160
    v_dot2_f32_bf16 v161, v78, v78, v161
    v_dot2_f32_bf16 v162, v79, s42, v162
    v_dot2_f32_bf16 v163, v79, v79, v163
    s_waitcnt lgkmcnt(7)
    ds_read_b128 v[120:123], v222 offset:6144
    ds_read_b128 v[104:107], v222 offset:5120
    s_add_u32 m0, s41, 107520
    s_add_u32 s17, s40, 304128
    buffer_load_dwordx4 v232, s[56:59], s17 offen lds
    v_dot2_f32_bf16 v160, v80, s42, v160
    v_dot2_f32_bf16 v161, v80, v80, v161
    v_dot2_f32_bf16 v162, v81, s42, v162
    v_dot2_f32_bf16 v163, v81, v81, v163
    v_dot2_f32_bf16 v160, v82, s42, v160
    v_dot2_f32_bf16 v161, v82, v82, v161
    v_dot2_f32_bf16 v162, v83, s42, v162
    v_dot2_f32_bf16 v163, v83, v83, v163
    s_waitcnt lgkmcnt(7)
    ds_read_b128 v[124:127], v223 offset:6144
    ds_read_b128 v[108:111], v223 offset:5120
    s_add_u32 m0, s99, 126720
    s_add_u32 s17, s98, 276480
    buffer_load_dword v13, s[56:59], s17 offen lds
    v_dot2_f32_bf16 v160, v84, s42, v160
    v_dot2_f32_bf16 v161, v84, v84, v161
    v_dot2_f32_bf16 v162, v85, s42, v162
    v_dot2_f32_bf16 v163, v85, v85, v163
    v_dot2_f32_bf16 v160, v86, s42, v160
    v_dot2_f32_bf16 v161, v86, v86, v161
    v_dot2_f32_bf16 v162, v87, s42, v162
    v_dot2_f32_bf16 v163, v87, v87, v163
    s_waitcnt lgkmcnt(7)
    ds_read_b128 v[128:131], v220 offset:7168
    ds_read_b128 v[136:139], v222 offset:7168
    s_add_u32 m0, s41, 110592
    s_add_u32 s17, s40, 331776
    buffer_load_dwordx4 v232, s[56:59], s17 offen lds
    v_dot2_f32_bf16 v160, v112, s42, v160
    v_dot2_f32_bf16 v161, v112, v112, v161
    v_dot2_f32_bf16 v162, v113, s42, v162
    v_dot2_f32_bf16 v163, v113, v113, v163
    v_dot2_f32_bf16 v160, v114, s42, v160
    v_dot2_f32_bf16 v161, v114, v114, v161
    v_dot2_f32_bf16 v162, v115, s42, v162
    v_dot2_f32_bf16 v163, v115, v115, v163
    s_waitcnt lgkmcnt(7)
    ds_read_b128 v[132:135], v221 offset:7168
    ds_read_b128 v[140:143], v223 offset:7168
    s_add_u32 m0, s41, 113664
    s_add_u32 s17, s40, 359424
    buffer_load_dwordx4 v232, s[56:59], s17 offen lds
    v_dot2_f32_bf16 v160, v116, s42, v160
    v_dot2_f32_bf16 v161, v116, v116, v161
    v_dot2_f32_bf16 v162, v117, s42, v162
    v_dot2_f32_bf16 v163, v117, v117, v163
    v_dot2_f32_bf16 v160, v118, s42, v160
    v_dot2_f32_bf16 v161, v118, v118, v161
    v_dot2_f32_bf16 v162, v119, s42, v162
    v_dot2_f32_bf16 v163, v119, v119, v163
    s_waitcnt lgkmcnt(7)
    ds_read_b128 v[144:147], v220 offset:8192
    s_add_u32 m0, s99, 127488
    s_add_u32 s17, s98, 331776
    buffer_load_dword v13, s[56:59], s17 offen lds
    v_dot2_f32_bf16 v160, v120, s42, v160
    v_dot2_f32_bf16 v161, v120, v120, v161
    v_dot2_f32_bf16 v162, v121, s42, v162
    v_dot2_f32_bf16 v163, v121, v121, v163
    v_dot2_f32_bf16 v160, v122, s42, v160
    v_dot2_f32_bf16 v161, v122, v122, v161
    v_dot2_f32_bf16 v162, v123, s42, v162
    v_dot2_f32_bf16 v163, v123, v123, v163
    s_waitcnt lgkmcnt(6)
    ds_read_b128 v[148:151], v221 offset:8192
    s_add_u32 m0, s41, 116736
    s_add_u32 s17, s40, 387072
    buffer_load_dwordx4 v232, s[56:59], s17 offen lds
    v_dot2_f32_bf16 v160, v124, s42, v160
    v_dot2_f32_bf16 v161, v124, v124, v161
    v_dot2_f32_bf16 v162, v125, s42, v162
    v_dot2_f32_bf16 v163, v125, v125, v163
    v_dot2_f32_bf16 v160, v126, s42, v160
    v_dot2_f32_bf16 v161, v126, v126, v161
    v_dot2_f32_bf16 v162, v127, s42, v162
    v_dot2_f32_bf16 v163, v127, v127, v163
    s_waitcnt lgkmcnt(5)
    ds_read_b128 v[152:155], v222 offset:8192
    s_add_u32 m0, s41, 119808
    s_add_u32 s17, s40, 414720
    buffer_load_dwordx4 v232, s[56:59], s17 offen lds
    v_dot2_f32_bf16 v160, v128, s42, v160
    v_dot2_f32_bf16 v161, v128, v128, v161
    v_dot2_f32_bf16 v162, v129, s42, v162
    v_dot2_f32_bf16 v163, v129, v129, v163
    v_dot2_f32_bf16 v160, v130, s42, v160
    v_dot2_f32_bf16 v161, v130, v130, v161
    v_dot2_f32_bf16 v162, v131, s42, v162
    v_dot2_f32_bf16 v163, v131, v131, v163
    s_waitcnt lgkmcnt(4)
    ds_read_b128 v[156:159], v223 offset:8192
    s_add_u32 m0, s99, 128256
    s_add_u32 s17, s98, 387072
    buffer_load_dword v13, s[56:59], s17 offen lds
    v_dot2_f32_bf16 v160, v132, s42, v160
    v_dot2_f32_bf16 v161, v132, v132, v161
    v_dot2_f32_bf16 v162, v133, s42, v162
    v_dot2_f32_bf16 v163, v133, v133, v163
    v_dot2_f32_bf16 v160, v134, s42, v160
    v_dot2_f32_bf16 v161, v134, v134, v161
    v_dot2_f32_bf16 v162, v135, s42, v162
    v_dot2_f32_bf16 v163, v135, v135, v163
    buffer_load_dword v255, off, s[64:67], 0 sc1
    s_nop 0
    v_add_f32 v160, v160, v162
    v_add_f32 v161, v161, v163
    v_mov_b32 v162, v160
    v_mov_b32 v163, v161
    s_nop 0
    v_permlane32_swap_b32 v160, v162
    v_permlane32_swap_b32 v161, v163
    v_add_f32 v160, v160, v162
    v_add_f32 v161, v161, v163
    ds_write_b64 v8, v[160:161] offset:31744
    s_waitcnt vmcnt(13)
    s_waitcnt lgkmcnt(0)
    s_barrier
    ds_read_b64 v[160:161], v8 offset:31744
    ds_read_b64 v[162:163], v8 offset:32000
    s_add_u32 m0, s41, 0
    s_add_u32 s17, s40, 442368
    buffer_load_dwordx4 v232, s[56:59], s17 offen lds
    s_add_u32 m0, s41, 3072
    s_add_u32 s17, s40, 470016
    buffer_load_dwordx4 v232, s[56:59], s17 offen lds
    s_add_u32 m0, s99, 129024
    s_add_u32 s17, s98, 442368
    buffer_load_dword v13, s[56:59], s17 offen lds
    s_add_u32 m0, s41, 6144
    s_add_u32 s17, s40, 497664
    buffer_load_dwordx4 v232, s[56:59], s17 offen lds
    s_add_u32 m0, s41, 9216
    s_add_u32 s17, s40, 525312
    buffer_load_dwordx4 v232, s[56:59], s17 offen lds
    s_add_u32 m0, s99, 129792
    s_add_u32 s17, s98, 497664
    buffer_load_dword v13, s[56:59], s17 offen lds
    s_add_u32 m0, s41, 12288
    s_add_u32 s17, s40, 552960
    buffer_load_dwordx4 v232, s[56:59], s17 offen lds
    s_add_u32 m0, s41, 15360
    s_add_u32 s17, s40, 580608
    buffer_load_dwordx4 v232, s[56:59], s17 offen lds
    s_add_u32 m0, s99, 130560
    s_add_u32 s17, s98, 552960
    buffer_load_dword v13, s[56:59], s17 offen lds
    s_add_u32 m0, s41, 18432
    s_add_u32 s17, s40, 608256
    buffer_load_dwordx4 v232, s[56:59], s17 offen lds
    s_add_u32 m0, s41, 21504
    s_add_u32 s17, s40, 635904
    buffer_load_dwordx4 v232, s[56:59], s17 offen lds
    s_add_u32 m0, s99, 131328
    s_add_u32 s17, s98, 608256
    buffer_load_dword v13, s[56:59], s17 offen lds
    s_waitcnt lgkmcnt(0)
    v_add_f32 v10, v160, v162
    v_add_f32 v11, v161, v163
    v_mul_f32 v10, 0xbae38e39, v10
    v_mul_f32 v11, 0x3ae38e39, v11
    v_fma_f32 v11, -v10, v10, v11
    v_add_f32 v11, 0x3727c5ac, v11
    v_rsq_f32 v11, v11
p1_qe:
    s_waitcnt lgkmcnt(0)
    ds_read_b64_tr_b16 v[160:161], v233 offset:0
    ds_read_b64_tr_b16 v[162:163], v233 offset:512
    ds_read_b64_tr_b16 v[164:165], v234
    ds_read_b64_tr_b16 v[166:167], v234 offset:64
    v_add_u32 v234, v234, v235
    ds_read_b64_tr_b16 v[168:169], v233 offset:2048
    ds_read_b64_tr_b16 v[170:171], v233 offset:2560
    ds_read_b64_tr_b16 v[172:173], v234
    ds_read_b64_tr_b16 v[174:175], v234 offset:64
    v_add_u32 v234, v234, v235
    ds_read_b64_tr_b16 v[176:177], v233 offset:4096
    ds_read_b64_tr_b16 v[178:179], v233 offset:4608
    ds_read_b64_tr_b16 v[180:181], v234
    ds_read_b64_tr_b16 v[182:183], v234 offset:64
    v_add_u32 v234, v234, v235
    s_waitcnt lgkmcnt(8)
    v_mfma_f32_32x32x16_bf16 v[192:207], v[160:163], v[16:19], 0
    ds_read_b64_tr_b16 v[184:185], v233 offset:6144
    ds_read_b64_tr_b16 v[186:187], v233 offset:6656
    ds_read_b64_tr_b16 v[188:189], v234
    ds_read_b64_tr_b16 v[190:191], v234 offset:64
    v_add_u32 v234, v234, v235
    v_mfma_f32_16x16x32_bf16 v[208:211], v[164:167], v[16:19], 0
    s_waitcnt lgkmcnt(8)
    v_mfma_f32_32x32x16_bf16 v[192:207], v[168:171], v[20:23], v[192:207]
    ds_read_b64_tr_b16 v[160:161], v233 offset:8192
    ds_read_b64_tr_b16 v[162:163], v233 offset:8704
    ds_read_b64_tr_b16 v[164:165], v234
    ds_read_b64_tr_b16 v[166:167], v234 offset:64
    v_add_u32 v234, v234, v235
    v_mfma_f32_16x16x32_bf16 v[208:211], v[172:175], v[20:23], v[208:211]
    s_waitcnt lgkmcnt(8)
    v_mfma_f32_32x32x16_bf16 v[192:207], v[176:179], v[24:27], v[192:207]
    ds_read_b64_tr_b16 v[168:169], v233 offset:10240
    ds_read_b64_tr_b16 v[170:171], v233 offset:10752
    ds_read_b64_tr_b16 v[172:173], v234
    ds_read_b64_tr_b16 v[174:175], v234 offset:64
    v_add_u32 v234, v234, v235
    v_mfma_f32_16x16x32_bf16 v[208:211], v[180:183], v[24:27], v[208:211]
    s_waitcnt lgkmcnt(8)
    v_mfma_f32_32x32x16_bf16 v[192:207], v[184:187], v[28:31], v[192:207]
    ds_read_b64_tr_b16 v[176:177], v233 offset:12288
    ds_read_b64_tr_b16 v[178:179], v233 offset:12800
    ds_read_b64_tr_b16 v[180:181], v234
    ds_read_b64_tr_b16 v[182:183], v234 offset:64
    v_add_u32 v234, v234, v235
    v_mfma_f32_16x16x32_bf16 v[208:211], v[188:191], v[28:31], v[208:211]
    s_waitcnt lgkmcnt(8)
    v_mfma_f32_32x32x16_bf16 v[192:207], v[160:163], v[32:35], v[192:207]
    ds_read_b64_tr_b16 v[184:185], v233 offset:14336
    ds_read_b64_tr_b16 v[186:187], v233 offset:14848
    ds_read_b64_tr_b16 v[188:189], v234
    ds_read_b64_tr_b16 v[190:191], v234 offset:64
    v_add_u32 v234, v234, v235
    v_mfma_f32_16x16x32_bf16 v[208:211], v[164:167], v[32:35], v[208:211]
    s_waitcnt lgkmcnt(8)
    v_mfma_f32_32x32x16_bf16 v[192:207], v[168:171], v[36:39], v[192:207]
    ds_read_b64_tr_b16 v[160:161], v233 offset:16384
    ds_read_b64_tr_b16 v[162:163], v233 offset:16896
    ds_read_b64_tr_b16 v[164:165], v234
    ds_read_b64_tr_b16 v[166:167], v234 offset:64
    ds_read_b128 a[16:19], v250 offset:36864
    v_mfma_f32_16x16x32_bf16 v[208:211], v[172:175], v[36:39], v[208:211]
    v_add_u32 v234, v234, v235
    s_waitcnt lgkmcnt(9)
    v_mfma_f32_32x32x16_bf16 v[192:207], v[176:179], v[40:43], v[192:207]
    ds_read_b64_tr_b16 v[168:169], v233 offset:18432
    ds_read_b64_tr_b16 v[170:171], v233 offset:18944
    ds_read_b64_tr_b16 v[172:173], v234
    ds_read_b64_tr_b16 v[174:175], v234 offset:64
    ds_read_b128 a[20:23], v250 offset:37888
    v_mfma_f32_16x16x32_bf16 v[208:211], v[180:183], v[40:43], v[208:211]
    v_add_u32 v234, v234, v235
    v_cvt_pk_bf16_f32 v6, v10, v10
    v_cmp_gt_u32 vcc, 32, v1
    v_lshlrev_b32 v6, 16, v6
    v_sub_f32 v6, v10, v6
    v_cvt_pk_bf16_f32 v6, v10, v6
    v_cndmask_b32 v6, 0, v6, vcc
    v_mov_b32 v7, v6
    s_waitcnt lgkmcnt(10)
    v_mfma_f32_32x32x16_bf16 v[192:207], v[184:187], v[44:47], v[192:207]
    ds_read_b64_tr_b16 v[176:177], v233 offset:20480
    ds_read_b64_tr_b16 v[178:179], v233 offset:20992
    ds_read_b64_tr_b16 v[180:181], v234
    ds_read_b64_tr_b16 v[182:183], v234 offset:64
    ds_read_b128 a[24:27], v250 offset:38912
    v_mfma_f32_16x16x32_bf16 v[208:211], v[188:191], v[44:47], v[208:211]
    v_add_u32 v234, v234, v235
    v_mul_f32 v11, 0x3eae1a93, v11
    v_lshlrev_b32 v5, 6, v1
    s_mov_b32 s23, 3375104
    s_lshl_b32 s18, s16, 11
    s_add_u32 s18, s18, 0x20000
    v_add_u32 v12, s18, v2
    s_waitcnt lgkmcnt(10)
    v_mfma_f32_32x32x16_bf16 v[192:207], v[160:163], v[48:51], v[192:207]
    ds_read_b64_tr_b16 v[184:185], v233 offset:22528
    ds_read_b64_tr_b16 v[186:187], v233 offset:23040
    ds_read_b64_tr_b16 v[188:189], v234
    ds_read_b64_tr_b16 v[190:191], v234 offset:64
    ds_read_b128 a[28:31], v250 offset:39936
    v_mfma_f32_16x16x32_bf16 v[208:211], v[164:167], v[48:51], v[208:211]
    v_add_u32 v234, v234, v235
    v_mfma_f32_16x16x32_bf16 v[240:243], a[16:19], a[16:19], 0
    v_mfma_f32_16x16x32_bf16 a[12:15], v[228:231], a[16:19], 0
    s_cmp_gt_i32 s54, 0
    s_cbranch_scc0 p1_nofl
    s_waitcnt vmcnt(0)
p1_mk2:
    v_readfirstlane_b32 s17, v255
    s_cmp_lg_u32 s17, 0
    s_cbranch_scc0 p1_mkslow2
p1_mkok2:
    s_mov_b64 exec, 1
    buffer_store_dword v13, off, s[36:39], s22 sc1
    s_mov_b64 exec, -1
p1_nofl:
    s_waitcnt lgkmcnt(10)
    v_mfma_f32_32x32x16_bf16 v[192:207], v[168:171], v[52:55], v[192:207]
    s_waitcnt vmcnt(13)
    s_barrier
    ds_read_b64_tr_b16 v[160:161], v233 offset:24576
    ds_read_b64_tr_b16 v[162:163], v233 offset:25088
    ds_read_b64_tr_b16 v[164:165], v234
    ds_read_b64_tr_b16 v[166:167], v234 offset:64
    ds_read_b128 a[32:35], v250 offset:40960
    v_mfma_f32_16x16x32_bf16 v[208:211], v[172:175], v[52:55], v[208:211]
    v_add_u32 v234, v234, v235
    v_mfma_f32_16x16x32_bf16 v[240:243], a[20:23], a[20:23], v[240:243]
    v_mfma_f32_16x16x32_bf16 a[12:15], v[228:231], a[20:23], a[12:15]
    s_waitcnt lgkmcnt(10)
    v_mfma_f32_32x32x16_bf16 v[192:207], v[176:179], v[56:59], v[192:207]
    ds_read_b64_tr_b16 v[168:169], v233 offset:26624
    ds_read_b64_tr_b16 v[170:171], v233 offset:27136
    ds_read_b64_tr_b16 v[172:173], v234
    ds_read_b64_tr_b16 v[174:175], v234 offset:64
    ds_read_b128 a[36:39], v250 offset:41984
    v_mfma_f32_16x16x32_bf16 v[208:211], v[180:183], v[56:59], v[208:211]
    v_add_u32 v234, v234, v235
    v_mfma_f32_16x16x32_bf16 v[212:215], v[224:227], v[176:179], 0
    v_mfma_f32_16x16x32_bf16 v[216:219], v[180:183], v[228:231], 0
    v_mfma_f32_16x16x32_bf16 v[240:243], a[24:27], a[24:27], v[240:243]
    v_mfma_f32_16x16x32_bf16 a[12:15], v[228:231], a[24:27], a[12:15]
    s_waitcnt lgkmcnt(10)
    v_mfma_f32_32x32x16_bf16 v[192:207], v[184:187], v[60:63], v[192:207]
    ds_read_b64_tr_b16 v[176:177], v233 offset:28672
    ds_read_b64_tr_b16 v[178:179], v233 offset:29184
    ds_read_b64_tr_b16 v[180:181], v234
    ds_read_b64_tr_b16 v[182:183], v234 offset:64
    ds_read_b128 a[40:43], v250 offset:43008
    v_mfma_f32_16x16x32_bf16 v[208:211], v[188:191], v[60:63], v[208:211]
    v_add_u32 v234, v234, v235
    v_mfma_f32_16x16x32_bf16 v[240:243], a[28:31], a[28:31], v[240:243]
    v_mfma_f32_16x16x32_bf16 a[12:15], v[228:231], a[28:31], a[12:15]
    s_waitcnt lgkmcnt(10)
    v_mfma_f32_32x32x16_bf16 v[192:207], v[160:163], v[64:67], v[192:207]
    ds_read_b64_tr_b16 v[184:185], v233 offset:30720
    ds_read_b64_tr_b16 v[186:187], v233 offset:31232
    ds_read_b64_tr_b16 v[188:189], v234
    ds_read_b64_tr_b16 v[190:191], v234 offset:64
    ds_read_b128 a[44:47], v250 offset:44032
    v_mfma_f32_16x16x32_bf16 v[208:211], v[164:167], v[64:67], v[208:211]
    v_add_u32 v234, v234, v235
    v_mfma_f32_16x16x32_bf16 v[212:215], v[224:227], v[160:163], v[212:215]
    v_mfma_f32_16x16x32_bf16 v[216:219], v[164:167], v[228:231], v[216:219]
    v_mfma_f32_16x16x32_bf16 v[240:243], a[32:35], a[32:35], v[240:243]
    v_mfma_f32_16x16x32_bf16 a[12:15], v[228:231], a[32:35], a[12:15]
    s_waitcnt lgkmcnt(10)
    v_mfma_f32_32x32x16_bf16 v[192:207], v[168:171], v[68:71], v[192:207]
    ds_read_b64_tr_b16 v[160:161], v233 offset:32768
    ds_read_b64_tr_b16 v[162:163], v233 offset:33280
    ds_read_b64_tr_b16 v[164:165], v234
    ds_read_b64_tr_b16 v[166:167], v234 offset:64
    ds_read_b128 a[48:51], v250 offset:45056
    v_mfma_f32_16x16x32_bf16 v[208:211], v[172:175], v[68:71], v[208:211]
    v_add_u32 v234, v234, v235
    v_mfma_f32_16x16x32_bf16 v[240:243], a[36:39], a[36:39], v[240:243]
    v_mfma_f32_16x16x32_bf16 a[12:15], v[228:231], a[36:39], a[12:15]
    s_waitcnt lgkmcnt(10)
    v_mfma_f32_32x32x16_bf16 v[192:207], v[176:179], v[72:75], v[192:207]
    ds_read_b64_tr_b16 v[168:169], v233 offset:34816
    ds_read_b64_tr_b16 v[170:171], v233 offset:35328
    ds_read_b64_tr_b16 v[172:173], v234
    ds_read_b64_tr_b16 v[174:175], v234 offset:64
    v_add_u32 v234, v234, v235
    v_mfma_f32_16x16x32_bf16 v[208:211], v[180:183], v[72:75], v[208:211]
    v_mfma_f32_16x16x32_bf16 v[212:215], v[224:227], v[176:179], v[212:215]
    v_mfma_f32_16x16x32_bf16 v[216:219], v[180:183], v[228:231], v[216:219]
    v_mfma_f32_16x16x32_bf16 v[240:243], a[40:43], a[40:43], v[240:243]
    v_mfma_f32_16x16x32_bf16 a[12:15], v[228:231], a[40:43], a[12:15]
    s_waitcnt lgkmcnt(9)
    v_mfma_f32_32x32x16_bf16 v[192:207], v[184:187], v[76:79], v[192:207]
    ds_read_b64_tr_b16 v[176:177], v233 offset:36864
    ds_read_b64_tr_b16 v[178:179], v233 offset:37376
    ds_read_b64_tr_b16 v[180:181], v234
    ds_read_b64_tr_b16 v[182:183], v234 offset:64
    v_add_u32 v234, v234, v235
    v_mfma_f32_16x16x32_bf16 v[208:211], v[188:191], v[76:79], v[208:211]
    v_mfma_f32_16x16x32_bf16 v[240:243], a[44:47], a[44:47], v[240:243]
    v_mfma_f32_16x16x32_bf16 a[12:15], v[228:231], a[44:47], a[12:15]
    s_waitcnt lgkmcnt(8)
    v_mfma_f32_32x32x16_bf16 v[192:207], v[160:163], v[80:83], v[192:207]
    ds_read_b64_tr_b16 v[184:185], v233 offset:38912
    ds_read_b64_tr_b16 v[186:187], v233 offset:39424
    ds_read_b64_tr_b16 v[188:189], v234
    ds_read_b64_tr_b16 v[190:191], v234 offset:64
    v_add_u32 v234, v234, v235
    v_mfma_f32_16x16x32_bf16 v[208:211], v[164:167], v[80:83], v[208:211]
    v_mfma_f32_16x16x32_bf16 v[212:215], v[224:227], v[160:163], v[212:215]
    v_mfma_f32_16x16x32_bf16 v[216:219], v[164:167], v[228:231], v[216:219]
    v_mfma_f32_16x16x32_bf16 v[240:243], a[48:51], a[48:51], v[240:243]
    v_mfma_f32_16x16x32_bf16 a[12:15], v[228:231], a[48:51], a[12:15]
    s_waitcnt lgkmcnt(8)
    v_mfma_f32_32x32x16_bf16 v[192:207], v[168:171], v[84:87], v[192:207]
    ds_read_b64_tr_b16 v[160:161], v233 offset:40960
    ds_read_b64_tr_b16 v[162:163], v233 offset:41472
    ds_read_b64_tr_b16 v[164:165], v234
    ds_read_b64_tr_b16 v[166:167], v234 offset:64
    v_add_u32 v234, v234, v235
    v_mfma_f32_16x16x32_bf16 v[208:211], v[172:175], v[84:87], v[208:211]
    s_waitcnt lgkmcnt(8)
    v_mfma_f32_32x32x16_bf16 v[192:207], v[176:179], v[88:91], v[192:207]
    ds_read_b64_tr_b16 v[168:169], v233 offset:43008
    ds_read_b64_tr_b16 v[170:171], v233 offset:43520
    ds_read_b64_tr_b16 v[172:173], v234
    ds_read_b64_tr_b16 v[174:175], v234 offset:64
    v_add_u32 v234, v234, v235
    v_mfma_f32_16x16x32_bf16 v[208:211], v[180:183], v[88:91], v[208:211]
    v_mfma_f32_16x16x32_bf16 v[212:215], v[224:227], v[176:179], v[212:215]
    v_mfma_f32_16x16x32_bf16 v[216:219], v[180:183], v[228:231], v[216:219]
    s_mov_b32 vcc_lo, 0xaaaaaaaa
    s_mov_b32 vcc_hi, 0xaaaaaaaa
    v_cndmask_b32 v241, v240, v241, vcc
    v_cndmask_b32 v243, v242, v243, vcc
    s_mov_b32 vcc_lo, 0xcccccccc
    s_mov_b32 vcc_hi, 0xcccccccc
    v_accvgpr_read_b32 v240, a12
    v_cndmask_b32 v241, v241, v243, vcc
    s_mov_b32 exec_lo, 0x00f0000f
    s_mov_b32 exec_hi, 0xf0000f00
    ds_write_b64 v251, v[240:241] offset:32256
    s_mov_b64 exec, -1
    s_waitcnt lgkmcnt(9)
    v_mfma_f32_32x32x16_bf16 v[192:207], v[184:187], v[92:95], v[192:207]
    ds_read_b64_tr_b16 v[176:177], v233 offset:45056
    ds_read_b64_tr_b16 v[178:179], v233 offset:45568
    ds_read_b64_tr_b16 v[180:181], v234
    ds_read_b64_tr_b16 v[182:183], v234 offset:64
    v_add_u32 v234, v234, v235
    v_mfma_f32_16x16x32_bf16 v[208:211], v[188:191], v[92:95], v[208:211]
    s_waitcnt lgkmcnt(9)
    v_mfma_f32_32x32x16_bf16 v[192:207], v[160:163], v[96:99], v[192:207]
    ds_read_b64_tr_b16 v[184:185], v233 offset:47104
    ds_read_b64_tr_b16 v[186:187], v233 offset:47616
    ds_read_b64_tr_b16 v[188:189], v234
    ds_read_b64_tr_b16 v[190:191], v234 offset:64
    v_add_u32 v234, v234, v235
    v_mfma_f32_16x16x32_bf16 v[208:211], v[164:167], v[96:99], v[208:211]
    v_mfma_f32_16x16x32_bf16 v[212:215], v[224:227], v[160:163], v[212:215]
    v_mfma_f32_16x16x32_bf16 v[216:219], v[164:167], v[228:231], v[216:219]
    s_waitcnt lgkmcnt(9)
    v_mfma_f32_32x32x16_bf16 v[192:207], v[168:171], v[100:103], v[192:207]
    s_waitcnt vmcnt(0) lgkmcnt(8)
    s_barrier
    ds_read_b64_tr_b16 v[160:161], v14 offset:0
    ds_read_b64_tr_b16 v[162:163], v14 offset:512
    ds_read_b64_tr_b16 v[164:165], v234
    ds_read_b64_tr_b16 v[166:167], v234 offset:64
    v_add_u32 v234, v234, v235
    v_mfma_f32_16x16x32_bf16 v[208:211], v[172:175], v[100:103], v[208:211]
    s_waitcnt lgkmcnt(8)
    v_mfma_f32_32x32x16_bf16 v[192:207], v[176:179], v[104:107], v[192:207]
    ds_read_b64_tr_b16 v[168:169], v14 offset:2048
    ds_read_b64_tr_b16 v[170:171], v14 offset:2560
    ds_read_b64_tr_b16 v[172:173], v234
    ds_read_b64_tr_b16 v[174:175], v234 offset:64
    v_add_u32 v234, v234, v235
    v_mfma_f32_16x16x32_bf16 v[208:211], v[180:183], v[104:107], v[208:211]
    v_mfma_f32_16x16x32_bf16 v[212:215], v[224:227], v[176:179], v[212:215]
    v_mfma_f32_16x16x32_bf16 v[216:219], v[180:183], v[228:231], v[216:219]
    s_waitcnt lgkmcnt(8)
    v_mfma_f32_32x32x16_bf16 v[192:207], v[184:187], v[108:111], v[192:207]
    ds_read_b64_tr_b16 v[176:177], v14 offset:4096
    ds_read_b64_tr_b16 v[178:179], v14 offset:4608
    ds_read_b64_tr_b16 v[180:181], v234
    ds_read_b64_tr_b16 v[182:183], v234 offset:64
    v_add_u32 v234, v234, v235
    v_mfma_f32_16x16x32_bf16 v[208:211], v[188:191], v[108:111], v[208:211]
    s_waitcnt lgkmcnt(8)
    v_mfma_f32_32x32x16_bf16 v[192:207], v[160:163], v[112:115], v[192:207]
    ds_read_b64_tr_b16 v[184:185], v14 offset:6144
    ds_read_b64_tr_b16 v[186:187], v14 offset:6656
    ds_read_b64_tr_b16 v[188:189], v234
    ds_read_b64_tr_b16 v[190:191], v234 offset:64
    v_add_u32 v234, v234, v235
    v_mfma_f32_16x16x32_bf16 v[208:211], v[164:167], v[112:115], v[208:211]
    v_mfma_f32_16x16x32_bf16 v[212:215], v[224:227], v[160:163], v[212:215]
    v_mfma_f32_16x16x32_bf16 v[216:219], v[164:167], v[228:231], v[216:219]
    s_waitcnt lgkmcnt(8)
    v_mfma_f32_32x32x16_bf16 v[192:207], v[168:171], v[116:119], v[192:207]
    ds_read_b64_tr_b16 v[160:161], v14 offset:8192
    ds_read_b64_tr_b16 v[162:163], v14 offset:8704
    ds_read_b64_tr_b16 v[164:165], v234
    ds_read_b64_tr_b16 v[166:167], v234 offset:64
    v_add_u32 v234, v234, v235
    v_mfma_f32_16x16x32_bf16 v[208:211], v[172:175], v[116:119], v[208:211]
    s_waitcnt lgkmcnt(8)
    v_mfma_f32_32x32x16_bf16 v[192:207], v[176:179], v[120:123], v[192:207]
    ds_read_b64_tr_b16 v[168:169], v14 offset:10240
    ds_read_b64_tr_b16 v[170:171], v14 offset:10752
    ds_read_b64_tr_b16 v[172:173], v234
    ds_read_b64_tr_b16 v[174:175], v234 offset:64
    v_add_u32 v234, v234, v235
    v_mfma_f32_16x16x32_bf16 v[208:211], v[180:183], v[120:123], v[208:211]
    v_mfma_f32_16x16x32_bf16 v[212:215], v[224:227], v[176:179], v[212:215]
    v_mfma_f32_16x16x32_bf16 v[216:219], v[180:183], v[228:231], v[216:219]
    s_waitcnt lgkmcnt(8)
    v_mfma_f32_32x32x16_bf16 v[192:207], v[184:187], v[124:127], v[192:207]
    ds_read_b64_tr_b16 v[176:177], v14 offset:12288
    ds_read_b64_tr_b16 v[178:179], v14 offset:12800
    ds_read_b64_tr_b16 v[180:181], v234
    ds_read_b64_tr_b16 v[182:183], v234 offset:64
    v_add_u32 v234, v234, v235
    v_mfma_f32_16x16x32_bf16 v[208:211], v[188:191], v[124:127], v[208:211]
    s_waitcnt lgkmcnt(8)
    v_mfma_f32_32x32x16_bf16 v[192:207], v[160:163], v[128:131], v[192:207]
    ds_read_b64_tr_b16 v[184:185], v14 offset:14336
    ds_read_b64_tr_b16 v[186:187], v14 offset:14848
    ds_read_b64_tr_b16 v[188:189], v234
    ds_read_b64_tr_b16 v[190:191], v234 offset:64
    v_add_u32 v234, v234, v235
    v_mfma_f32_16x16x32_bf16 v[208:211], v[164:167], v[128:131], v[208:211]
    v_mfma_f32_16x16x32_bf16 v[212:215], v[224:227], v[160:163], v[212:215]
    v_mfma_f32_16x16x32_bf16 v[216:219], v[164:167], v[228:231], v[216:219]
    s_waitcnt lgkmcnt(8)
    v_mfma_f32_32x32x16_bf16 v[192:207], v[168:171], v[132:135], v[192:207]
    ds_read_b64_tr_b16 v[160:161], v14 offset:16384
    ds_read_b64_tr_b16 v[162:163], v14 offset:16896
    ds_read_b64_tr_b16 v[164:165], v234
    ds_read_b64_tr_b16 v[166:167], v234 offset:64
    v_add_u32 v234, v234, v235
    v_mfma_f32_16x16x32_bf16 v[208:211], v[172:175], v[132:135], v[208:211]
    s_waitcnt lgkmcnt(8)
    v_mfma_f32_32x32x16_bf16 v[192:207], v[176:179], v[136:139], v[192:207]
    ds_read_b64_tr_b16 v[168:169], v14 offset:18432
    ds_read_b64_tr_b16 v[170:171], v14 offset:18944
    ds_read_b64_tr_b16 v[172:173], v234
    ds_read_b64_tr_b16 v[174:175], v234 offset:64
    v_add_u32 v234, v234, v235
    v_mfma_f32_16x16x32_bf16 v[208:211], v[180:183], v[136:139], v[208:211]
    v_mfma_f32_16x16x32_bf16 v[212:215], v[224:227], v[176:179], v[212:215]
    v_mfma_f32_16x16x32_bf16 v[216:219], v[180:183], v[228:231], v[216:219]
    s_waitcnt lgkmcnt(8)
    v_mfma_f32_32x32x16_bf16 v[192:207], v[184:187], v[140:143], v[192:207]
    ds_read_b64_tr_b16 v[176:177], v14 offset:20480
    ds_read_b64_tr_b16 v[178:179], v14 offset:20992
    ds_read_b64_tr_b16 v[180:181], v234
    ds_read_b64_tr_b16 v[182:183], v234 offset:64
    v_add_u32 v234, v234, v235
    v_mfma_f32_16x16x32_bf16 v[208:211], v[188:191], v[140:143], v[208:211]
    s_waitcnt lgkmcnt(8)
    v_mfma_f32_32x32x16_bf16 v[192:207], v[160:163], v[144:147], v[192:207]
    ds_read_b64_tr_b16 v[184:185], v14 offset:22528
    ds_read_b64_tr_b16 v[186:187], v14 offset:23040
    ds_read_b64_tr_b16 v[188:189], v234
    ds_read_b64_tr_b16 v[190:191], v234 offset:64
    v_add_u32 v234, v234, v235
    v_mfma_f32_16x16x32_bf16 v[208:211], v[164:167], v[144:147], v[208:211]
    v_mfma_f32_16x16x32_bf16 v[16:19], v[224:227], v[160:163], 0
    v_mfma_f32_16x16x32_bf16 v[20:23], v[164:167], v[228:231], 0
    ds_write_b128 v12, v[216:219] offset:1024
    ds_write_b32 v12, v212 offset:2048
    v_xor_b32 v12, 2048, v12
    s_waitcnt lgkmcnt(10)
    v_mfma_f32_32x32x16_bf16 v[192:207], v[168:171], v[148:151], v[192:207]
    v_mfma_f32_16x16x32_bf16 v[208:211], v[172:175], v[148:151], v[208:211]
    v_mfma_f32_16x16x32_bf16 v[16:19], v[224:227], v[168:171], v[16:19]
    v_mfma_f32_16x16x32_bf16 v[20:23], v[172:175], v[228:231], v[20:23]
    s_waitcnt vmcnt(0)
p1_mk0:
    v_readfirstlane_b32 s17, v255
    s_cmp_lg_u32 s17, 0
    s_cbranch_scc0 p1_mkslow0
p1_mkok0:
    buffer_load_dwordx2 v[254:255], v5, s[36:39], s23 offen sc1
    s_waitcnt lgkmcnt(6)
    v_mfma_f32_32x32x16_bf16 v[192:207], v[176:179], v[152:155], v[192:207]
    v_mfma_f32_16x16x32_bf16 v[208:211], v[180:183], v[152:155], v[208:211]
    v_mfma_f32_16x16x32_bf16 v[16:19], v[224:227], v[176:179], v[16:19]
    v_mfma_f32_16x16x32_bf16 v[20:23], v[180:183], v[228:231], v[20:23]
    s_waitcnt lgkmcnt(0)
    s_barrier
    ds_read_b128 v[24:27], v12 offset:1024
    ds_read_b32 v28, v12 offset:2048
    v_mfma_f32_32x32x16_bf16 v[192:207], v[184:187], v[156:159], v[192:207]
    v_mfma_f32_16x16x32_bf16 v[208:211], v[188:191], v[156:159], v[208:211]
    v_mfma_f32_16x16x32_bf16 v[16:19], v[224:227], v[184:187], v[16:19]
    v_mfma_f32_16x16x32_bf16 v[20:23], v[188:191], v[228:231], v[20:23]
p1_qx:
p1_poll:
    s_waitcnt vmcnt(0)
    v_min_u32 v13, v254, v255
    v_mov_b32 v15, v254
    v_cmp_eq_u32 vcc, 0, v13
    s_cbranch_vccnz p1_pslow
p1_ok:
    buffer_load_dwordx4 a[192:195], v2, s[36:39], s21 offen offset:0 sc1
    buffer_load_dwordx4 a[0:3], v2, s[36:39], s43 offen offset:0 sc1
    buffer_load_dwordx4 a[4:7], v3, s[36:39], s43 offen offset:1024 sc1
    buffer_load_dwordx4 a[8:11], v3, s[36:39], s43 offen offset:1664 sc1
    buffer_load_dwordx4 a[12:15], v2, s[36:39], s43 offen offset:2304 sc1
    buffer_load_dwordx4 a[16:19], v3, s[36:39], s43 offen offset:3328 sc1
    buffer_load_dwordx4 a[20:23], v3, s[36:39], s43 offen offset:3968 sc1
    s_add_u32 s43, s43, 4608
    buffer_load_dwordx4 a[24:27], v2, s[36:39], s43 offen offset:0 sc1
    buffer_load_dwordx4 a[28:31], v3, s[36:39], s43 offen offset:1024 sc1
    buffer_load_dwordx4 a[32:35], v3, s[36:39], s43 offen offset:1664 sc1
    s_waitcnt lgkmcnt(0)
    v_add_f32 v212, v212, v16
    v_add_f32 v212, v212, v28
    v_cvt_pk_bf16_f32 v160, v212, v212
    v_lshlrev_b32 v161, 16, v160
    v_sub_f32 v161, v212, v161
    v_cvt_pk_bf16_f32 v161, v161, v161
    s_nop 1
    v_mfma_f32_32x32x8bf16_1k v[192:207], v[160:161], v[6:7], v[192:207]
    v_add_f32 v216, v216, v20
    v_add_f32 v217, v217, v21
    v_add_f32 v218, v218, v22
    v_add_f32 v219, v219, v23
    v_add_f32 v216, v216, v24
    v_add_f32 v217, v217, v25
    v_add_f32 v218, v218, v26
    v_add_f32 v219, v219, v27
    v_fmac_f32 v208, v216, v10
    v_fmac_f32 v209, v217, v10
    v_fmac_f32 v210, v218, v10
    v_fmac_f32 v211, v219, v10
    v_mov_b32 v14, v15
    v_cmp_gt_u32 s[52:53], 32, v1
    s_nop 0
    v_permlane32_swap_b32 v14, v15
    v_mul_f32 v208, v208, v11
    v_mul_f32 v209, v209, v11
    v_mul_f32 v210, v210, v11
    v_mul_f32 v211, v211, v11
    v_max_u32 v15, v14, v15
    v_mov_b32 v14, v15
    buffer_load_dwordx4 a[36:39], v2, s[36:39], s43 offen offset:2304 sc1
    buffer_load_dwordx4 a[40:43], v3, s[36:39], s43 offen offset:3328 sc1
    buffer_load_dwordx4 a[44:47], v3, s[36:39], s43 offen offset:3968 sc1
    s_add_u32 s43, s43, 4608
    buffer_load_dwordx4 a[196:199], v2, s[36:39], s21 offen offset:1024 sc1
    v_mul_f32 v192, v192, v11
    v_permlane16_swap_b32 v14, v15
    v_mul_f32 v193, v193, v11
    v_mul_f32 v194, v194, v11
    v_max_u32 v15, v14, v15
    v_mul_f32 v195, v195, v11
    v_mul_f32 v196, v196, v11
    v_mul_f32 v197, v197, v11
    v_max_u32_dpp v15, v15, v15 row_ror:8 row_mask:0xf bank_mask:0xf
    v_mul_f32 v198, v198, v11
    v_mul_f32 v199, v199, v11
    v_mul_f32 v200, v200, v11
    v_max_u32_dpp v15, v15, v15 row_ror:4 row_mask:0xf bank_mask:0xf
    v_mul_f32 v201, v201, v11
    v_mul_f32 v202, v202, v11
    v_mul_f32 v203, v203, v11
    v_max_u32_dpp v15, v15, v15 row_ror:2 row_mask:0xf bank_mask:0xf
    v_mul_f32 v204, v204, v11
    v_mul_f32 v205, v205, v11
    v_mul_f32 v206, v206, v11
    v_max_u32_dpp v15, v15, v15 row_ror:1 row_mask:0xf bank_mask:0xf
    v_mul_f32 v207, v207, v11
    v_mul_f32 v168, v192, v192
    v_mul_f32 v169, v200, v200
    v_fmac_f32 v168, v193, v193
    v_fmac_f32 v169, v201, v201
    v_fmac_f32 v168, v194, v194
    v_fmac_f32 v169, v202, v202
    v_fmac_f32 v168, v195, v195
    v_fmac_f32 v169, v203, v203
    v_fmac_f32 v168, v196, v196
    v_fmac_f32 v169, v204, v204
    v_fmac_f32 v168, v197, v197
    v_fmac_f32 v169, v205, v205
    v_fmac_f32 v168, v198, v198
    v_fmac_f32 v169, v206, v206
    v_fmac_f32 v168, v199, v199
    v_fmac_f32 v169, v207, v207
    v_mov_b32 v170, v168
    v_mov_b32 v171, v169
    v_cvt_pk_bf16_f32 v16, v192, v193
    v_cvt_pk_bf16_f32 v17, v194, v195
    v_permlane32_swap_b32 v170, v168
    v_permlane32_swap_b32 v171, v169
    v_add_f32 v168, v168, v170
    v_add_f32 v169, v169, v171
    v_fmac_f32 v168, v208, v208
    v_fmac_f32 v169, v210, v210
    v_fmac_f32 v168, v209, v209
    v_fmac_f32 v169, v211, v211
    v_mul_f32 v168, v168, v15
    v_mul_f32 v169, v169, v15
    v_sqrt_f32 v170, v168
    v_sqrt_f32 v171, v169
    v_max_f32 v14, v168, v169
    v_cmp_nge_f32 vcc, 0x44c80000, v14
    v_cvt_pk_bf16_f32 v18, v196, v197
    v_cvt_pk_bf16_f32 v19, v198, v199
    v_cvt_pk_bf16_f32 v24, v200, v201
    v_cvt_pk_bf16_f32 v25, v202, v203
    v_cvt_pk_bf16_f32 v26, v204, v205
    v_cvt_pk_bf16_f32 v27, v206, v207
    v_cvt_pk_bf16_f32 v168, v208, v209
    v_cvt_pk_bf16_f32 v169, v210, v211
    v_cvt_pk_bf16_f32 v170, -v170, 0
    v_cvt_pk_bf16_f32 v171, -v171, 0
    v_mov_b32 v21, 0
    v_mov_b32 v22, 0
    v_cndmask_b32 v20, v170, v168, s[52:53]
    v_mov_b32 v29, 0
    v_mov_b32 v30, 0
    v_cndmask_b32 v28, v171, v169, s[52:53]
    s_cbranch_vccnz k2_fallback
k2_main:
    s_mul_i32 s47, s15, 144
    s_mul_i32 s40, s16, 165888
    s_add_u32 s40, s40, s47
    s_lshl_b32 s41, s16, 14
    s_lshl_b32 s46, s16, 11
    s_lshr_b32 s17, s16, 1
    s_lshl_b32 s18, s14, 1
    s_add_u32 s19, s17, s18
    s_mul_i32 s19, s19, 36864
    s_add_u32 s48, s19, s47
    s_and_b32 s18, s16, 1
    s_lshl_b32 s18, s18, 6
    s_add_u32 s49, s48, s18
    s_lshl_b32 s18, s15, 2
    s_add_u32 s18, s18, s16
    s_mul_i32 s18, s18, 331776
    s_add_u32 s18, s18, 4198400
    s_add_u32 s98, s36, s18
    s_addc_u32 s99, s37, 0
    s_add_u32 s100, s98, 16384
    s_addc_u32 s101, s99, 0
    v_add_u32 v13, 8192, v2
    s_add_u32 s56, s36, s62
    s_addc_u32 s57, s37, 0
    s_add_u32 s58, s36, s20
    s_addc_u32 s59, s37, 0
    s_and_b32 s17, s2, 63
    s_lshl_b32 s17, s17, 6
    s_lshr_b32 s18, s2, 6
    s_lshl_b32 s18, s18, 2
    s_add_u32 s17, s17, s18
    s_lshl_b32 s18, s16, 12
    s_add_u32 s17, s17, s18
    s_cmp_eq_u32 s16, 0
    s_cselect_b32 s18, 0, 32768
    s_add_u32 s17, s17, 3375104
    s_add_u32 s20, s17, s18
    v_mov_b32 v23, v20
    ds_write_b128 v246, v[16:19] offset:24576
    ds_write_b32 v246, v20 offset:26624
    v_mov_b32 v31, v28
    ds_write_b128 v246, v[24:27] offset:25600
    ds_write_b32 v246, v28 offset:26628
    v_mov_b32 v128, 0
    v_mov_b32 v129, 0
    v_mov_b32 v94, 0xdddddddd
    buffer_load_dwordx4 a[48:51], v2, s[36:39], s43 offen offset:0 sc1
    buffer_load_dwordx4 a[52:55], v3, s[36:39], s43 offen offset:1024 sc1
    buffer_load_dwordx4 a[56:59], v3, s[36:39], s43 offen offset:1664 sc1
    v_mfma_f32_32x32x8bf16_1k v[32:47], v[128:129], v[128:129], 0
    v_mfma_f32_32x32x8bf16_1k v[48:63], v[128:129], v[128:129], 0
    s_waitcnt vmcnt(13)
    v_mfma_f32_32x32x16_bf16 v[96:111], a[0:3], v[16:19], 0
    v_mfma_f32_32x32x8bf16_1k v[96:111], a[192:193], v[20:21], v[96:111]
    s_nop 11
    v_exp_f32 v96, v96
    v_mfma_f32_32x32x16_bf16 v[112:127], a[0:3], v[24:27], 0
    buffer_load_dwordx4 a[60:63], v2, s[36:39], s43 offen offset:2304 sc1
    v_exp_f32 v97, v97
    v_exp_f32 v98, v98
    v_exp_f32 v99, v99
    v_exp_f32 v100, v100
    v_mfma_f32_32x32x8bf16_1k v[112:127], a[192:193], v[28:29], v[112:127]
    v_exp_f32 v101, v101
    v_exp_f32 v102, v102
    v_exp_f32 v103, v103
    v_exp_f32 v104, v104
    buffer_load_dwordx4 a[64:67], v3, s[36:39], s43 offen offset:3328 sc1
    v_exp_f32 v105, v105
    v_exp_f32 v106, v106
    v_exp_f32 v107, v107
    v_exp_f32 v108, v108
    buffer_load_dwordx4 a[68:71], v3, s[36:39], s43 offen offset:3968 sc1
    s_add_u32 s43, s43, 4608
    v_exp_f32 v109, v109
    v_exp_f32 v110, v110
    v_exp_f32 v111, v111
    v_exp_f32 v112, v112
    s_waitcnt vmcnt(13)
    v_mfma_f32_32x32x16_bf16 v[128:143], a[12:15], v[16:19], 0
    buffer_load_dwordx4 a[72:75], v2, s[36:39], s43 offen offset:0 sc1
    v_exp_f32 v113, v113
    v_exp_f32 v114, v114
    v_exp_f32 v115, v115
    v_exp_f32 v116, v116
    v_mfma_f32_32x32x8bf16_1k v[128:143], a[192:193], v[22:23], v[128:143]
    v_exp_f32 v117, v117
    v_exp_f32 v118, v118
    v_exp_f32 v119, v119
    v_exp_f32 v120, v120
    v_smfmac_f32_32x32x32_bf16 v[32:47], a[4:7], v[96:103], v94
    buffer_load_dwordx4 a[76:79], v3, s[36:39], s43 offen offset:1024 sc1
    v_exp_f32 v121, v121
    v_exp_f32 v122, v122
    v_exp_f32 v123, v123
    v_exp_f32 v124, v124
    v_smfmac_f32_32x32x32_bf16 v[32:47], a[8:11], v[104:111], v94
    buffer_load_dwordx4 a[80:83], v3, s[36:39], s43 offen offset:1664 sc1
    v_exp_f32 v125, v125
    v_exp_f32 v126, v126
    v_exp_f32 v127, v127
    v_exp_f32 v128, v128
    v_mfma_f32_32x32x16_bf16 v[96:111], a[12:15], v[24:27], 0
    buffer_load_dwordx4 a[84:87], v2, s[36:39], s43 offen offset:2304 sc1
    v_exp_f32 v129, v129
    v_exp_f32 v130, v130
    v_exp_f32 v131, v131
    v_exp_f32 v132, v132
    v_mfma_f32_32x32x8bf16_1k v[96:111], a[192:193], v[30:31], v[96:111]
    v_exp_f32 v133, v133
    v_exp_f32 v134, v134
    v_exp_f32 v135, v135
    v_exp_f32 v136, v136
    v_smfmac_f32_32x32x32_bf16 v[48:63], a[4:7], v[112:119], v94
    buffer_load_dwordx4 a[88:91], v3, s[36:39], s43 offen offset:3328 sc1
    v_exp_f32 v137, v137
    v_exp_f32 v138, v138
    v_exp_f32 v139, v139
    v_exp_f32 v140, v140
    v_smfmac_f32_32x32x32_bf16 v[48:63], a[8:11], v[120:127], v94
    buffer_load_dwordx4 a[92:95], v3, s[36:39], s43 offen offset:3968 sc1
    s_add_u32 s43, s43, 4608
    v_exp_f32 v141, v141
    v_exp_f32 v142, v142
    v_exp_f32 v143, v143
    v_exp_f32 v96, v96
    s_waitcnt vmcnt(16)
    v_mfma_f32_32x32x16_bf16 v[112:127], a[24:27], v[16:19], 0
    buffer_load_dwordx4 a[200:203], v2, s[36:39], s21 offen offset:2048 sc1
    v_exp_f32 v97, v97
    v_exp_f32 v98, v98
    v_exp_f32 v99, v99
    v_exp_f32 v100, v100
    v_mfma_f32_32x32x8bf16_1k v[112:127], a[194:195], v[20:21], v[112:127]
    v_exp_f32 v101, v101
    v_exp_f32 v102, v102
    v_exp_f32 v103, v103
    v_exp_f32 v104, v104
    v_smfmac_f32_32x32x32_bf16 v[32:47], a[16:19], v[128:135], v94
    buffer_load_dwordx4 a[96:99], v2, s[36:39], s43 offen offset:0 sc1
    v_exp_f32 v105, v105
    v_exp_f32 v106, v106
    v_exp_f32 v107, v107
    v_exp_f32 v108, v108
    v_smfmac_f32_32x32x32_bf16 v[32:47], a[20:23], v[136:143], v94
    buffer_load_dwordx4 a[100:103], v3, s[36:39], s43 offen offset:1024 sc1
    v_exp_f32 v109, v109
    v_exp_f32 v110, v110
    v_exp_f32 v111, v111
    s_waitcnt lgkmcnt(0)
    s_barrier
    v_exp_f32 v112, v112
    v_mfma_f32_32x32x16_bf16 v[128:143], a[24:27], v[24:27], 0
    buffer_load_dwordx4 a[104:107], v3, s[36:39], s43 offen offset:1664 sc1
    v_exp_f32 v113, v113
    v_exp_f32 v114, v114
    v_exp_f32 v115, v115
    v_exp_f32 v116, v116
    v_mfma_f32_32x32x8bf16_1k v[128:143], a[194:195], v[28:29], v[128:143]
    v_exp_f32 v117, v117
    v_exp_f32 v118, v118
    v_exp_f32 v119, v119
    v_exp_f32 v120, v120
    v_smfmac_f32_32x32x32_bf16 v[48:63], a[16:19], v[96:103], v94
    buffer_load_dwordx4 a[108:111], v2, s[36:39], s43 offen offset:2304 sc1
    v_exp_f32 v121, v121
    v_exp_f32 v122, v122
    v_exp_f32 v123, v123
    v_exp_f32 v124, v124
    v_smfmac_f32_32x32x32_bf16 v[48:63], a[20:23], v[104:111], v94
    buffer_load_dwordx4 a[112:115], v3, s[36:39], s43 offen offset:3328 sc1
    v_exp_f32 v125, v125
    v_exp_f32 v126, v126
    v_exp_f32 v127, v127
    v_exp_f32 v128, v128
    s_waitcnt vmcnt(19)
    v_mfma_f32_32x32x16_bf16 v[96:111], a[36:39], v[16:19], 0
    buffer_load_dwordx4 a[116:119], v3, s[36:39], s43 offen offset:3968 sc1
    v_exp_f32 v129, v129
    v_exp_f32 v130, v130
    v_exp_f32 v131, v131
    v_exp_f32 v132, v132
    v_mfma_f32_32x32x8bf16_1k v[96:111], a[194:195], v[22:23], v[96:111]
    v_exp_f32 v133, v133
    v_exp_f32 v134, v134
    v_exp_f32 v135, v135
    v_exp_f32 v136, v136
    v_smfmac_f32_32x32x32_bf16 v[32:47], a[28:31], v[112:119], v94
    s_add_u32 s43, s43, 4608
    v_exp_f32 v137, v137
    v_exp_f32 v138, v138
    v_exp_f32 v139, v139
    v_exp_f32 v140, v140
    v_smfmac_f32_32x32x32_bf16 v[32:47], a[32:35], v[120:127], v94
    buffer_load_dwordx4 a[120:123], v2, s[36:39], s43 offen offset:0 sc1
    buffer_load_dwordx4 a[124:127], v3, s[36:39], s43 offen offset:1024 sc1
    v_exp_f32 v141, v141
    v_exp_f32 v142, v142
    v_exp_f32 v143, v143
    v_exp_f32 v96, v96
    v_mfma_f32_32x32x16_bf16 v[112:127], a[36:39], v[24:27], 0
    buffer_load_dwordx4 a[128:131], v3, s[36:39], s43 offen offset:1664 sc1
    v_exp_f32 v97, v97
    v_exp_f32 v98, v98
    v_exp_f32 v99, v99
    v_exp_f32 v100, v100
    v_mfma_f32_32x32x8bf16_1k v[112:127], a[194:195], v[30:31], v[112:127]
    v_exp_f32 v101, v101
    v_exp_f32 v102, v102
    v_exp_f32 v103, v103
    v_exp_f32 v104, v104
    v_smfmac_f32_32x32x32_bf16 v[48:63], a[28:31], v[128:135], v94
    buffer_load_dwordx4 a[132:135], v2, s[36:39], s43 offen offset:2304 sc1
    v_exp_f32 v105, v105
    v_exp_f32 v106, v106
    v_exp_f32 v107, v107
    v_exp_f32 v108, v108
    v_smfmac_f32_32x32x32_bf16 v[48:63], a[32:35], v[136:143], v94
    buffer_load_dwordx4 a[136:139], v3, s[36:39], s43 offen offset:3328 sc1
    v_exp_f32 v109, v109
    v_exp_f32 v110, v110
    v_exp_f32 v111, v111
    v_exp_f32 v112, v112
    s_waitcnt vmcnt(21)
    v_mfma_f32_32x32x16_bf16 v[128:143], a[48:51], v[16:19], 0
    buffer_load_dwordx4 a[140:143], v3, s[36:39], s43 offen offset:3968 sc1
    v_exp_f32 v113, v113
    v_exp_f32 v114, v114
    v_exp_f32 v115, v115
    v_exp_f32 v116, v116
    v_mfma_f32_32x32x8bf16_1k v[128:143], a[196:197], v[20:21], v[128:143]
    v_exp_f32 v117, v117
    v_exp_f32 v118, v118
    v_exp_f32 v119, v119
    v_exp_f32 v120, v120
    v_smfmac_f32_32x32x32_bf16 v[32:47], a[40:43], v[96:103], v94
    s_add_u32 s43, s43, 4608
    v_exp_f32 v121, v121
    v_exp_f32 v122, v122
    v_exp_f32 v123, v123
    v_exp_f32 v124, v124
    v_smfmac_f32_32x32x32_bf16 v[32:47], a[44:47], v[104:111], v94
    buffer_load_dwordx4 a[204:207], v2, s[36:39], s21 offen offset:3072 sc1
    buffer_load_dwordx4 a[144:147], v2, s[36:39], s43 offen offset:0 sc1
    v_exp_f32 v125, v125
    v_exp_f32 v126, v126
    v_exp_f32 v127, v127
    v_exp_f32 v128, v128
    v_mfma_f32_32x32x16_bf16 v[96:111], a[48:51], v[24:27], 0
    buffer_load_dwordx4 a[148:151], v3, s[36:39], s43 offen offset:1024 sc1
    v_exp_f32 v129, v129
    v_exp_f32 v130, v130
    v_exp_f32 v131, v131
    v_exp_f32 v132, v132
    v_mfma_f32_32x32x8bf16_1k v[96:111], a[196:197], v[28:29], v[96:111]
    v_exp_f32 v133, v133
    v_exp_f32 v134, v134
    v_exp_f32 v135, v135
    v_exp_f32 v136, v136
    v_smfmac_f32_32x32x32_bf16 v[48:63], a[40:43], v[112:119], v94
    buffer_load_dwordx4 a[152:155], v3, s[36:39], s43 offen offset:1664 sc1
    v_exp_f32 v137, v137
    v_exp_f32 v138, v138
    v_exp_f32 v139, v139
    v_exp_f32 v140, v140
    v_smfmac_f32_32x32x32_bf16 v[48:63], a[44:47], v[120:127], v94
    buffer_load_dwordx4 a[156:159], v2, s[36:39], s43 offen offset:2304 sc1
    v_exp_f32 v141, v141
    v_exp_f32 v142, v142
    v_exp_f32 v143, v143
    v_exp_f32 v96, v96
    s_waitcnt vmcnt(24)
    v_mfma_f32_32x32x16_bf16 v[112:127], a[60:63], v[16:19], 0
    buffer_load_dwordx4 a[160:163], v3, s[36:39], s43 offen offset:3328 sc1
    v_exp_f32 v97, v97
    v_exp_f32 v98, v98
    v_exp_f32 v99, v99
    v_exp_f32 v100, v100
    v_mfma_f32_32x32x8bf16_1k v[112:127], a[196:197], v[22:23], v[112:127]
    v_exp_f32 v101, v101
    v_exp_f32 v102, v102
    v_exp_f32 v103, v103
    v_exp_f32 v104, v104
    v_smfmac_f32_32x32x32_bf16 v[32:47], a[52:55], v[128:135], v94
    buffer_load_dwordx4 a[164:167], v3, s[36:39], s43 offen offset:3968 sc1
    v_exp_f32 v105, v105
    v_exp_f32 v106, v106
    v_exp_f32 v107, v107
    v_exp_f32 v108, v108
    v_smfmac_f32_32x32x32_bf16 v[32:47], a[56:59], v[136:143], v94
    s_add_u32 s43, s43, 4608
    buffer_load_dwordx4 a[168:171], v2, s[36:39], s43 offen offset:0 sc1
    v_exp_f32 v109, v109
    v_exp_f32 v110, v110
    v_exp_f32 v111, v111
    v_exp_f32 v112, v112
    v_mfma_f32_32x32x16_bf16 v[128:143], a[60:63], v[24:27], 0
    buffer_load_dwordx4 a[172:175], v3, s[36:39], s43 offen offset:1024 sc1
    v_exp_f32 v113, v113
    v_exp_f32 v114, v114
    v_exp_f32 v115, v115
    v_exp_f32 v116, v116
    v_mfma_f32_32x32x8bf16_1k v[128:143], a[196:197], v[30:31], v[128:143]
    v_exp_f32 v117, v117
    v_exp_f32 v118, v118
    v_exp_f32 v119, v119
    v_exp_f32 v120, v120
    v_smfmac_f32_32x32x32_bf16 v[48:63], a[52:55], v[96:103], v94
    buffer_load_dwordx4 a[176:179], v3, s[36:39], s43 offen offset:1664 sc1
    v_exp_f32 v121, v121
    v_exp_f32 v122, v122
    v_exp_f32 v123, v123
    v_exp_f32 v124, v124
    v_smfmac_f32_32x32x32_bf16 v[48:63], a[56:59], v[104:111], v94
    buffer_load_dwordx4 a[180:183], v2, s[36:39], s43 offen offset:2304 sc1
    v_exp_f32 v125, v125
    v_exp_f32 v126, v126
    v_exp_f32 v127, v127
    v_exp_f32 v128, v128
    s_waitcnt vmcnt(27)
    v_mfma_f32_32x32x16_bf16 v[96:111], a[72:75], v[16:19], 0
    buffer_load_dwordx4 a[184:187], v3, s[36:39], s43 offen offset:3328 sc1
    v_exp_f32 v129, v129
    v_exp_f32 v130, v130
    v_exp_f32 v131, v131
    v_exp_f32 v132, v132
    v_mfma_f32_32x32x8bf16_1k v[96:111], a[198:199], v[20:21], v[96:111]
    v_exp_f32 v133, v133
    v_exp_f32 v134, v134
    v_exp_f32 v135, v135
    v_exp_f32 v136, v136
    v_smfmac_f32_32x32x32_bf16 v[32:47], a[64:67], v[112:119], v94
    buffer_load_dwordx4 a[188:191], v3, s[36:39], s43 offen offset:3968 sc1
    v_exp_f32 v137, v137
    v_exp_f32 v138, v138
    v_exp_f32 v139, v139
    v_exp_f32 v140, v140
    v_smfmac_f32_32x32x32_bf16 v[32:47], a[68:71], v[120:127], v94
    s_add_u32 s43, s43, 4608
    v_exp_f32 v141, v141
    v_exp_f32 v142, v142
    v_exp_f32 v143, v143
    v_exp_f32 v96, v96
    v_mfma_f32_32x32x16_bf16 v[112:127], a[72:75], v[24:27], 0
    s_add_u32 m0, s61, 0
    v_exp_f32 v97, v97
    v_exp_f32 v98, v98
    v_exp_f32 v99, v99
    v_exp_f32 v100, v100
    v_mfma_f32_32x32x8bf16_1k v[112:127], a[198:199], v[28:29], v[112:127]
    v_exp_f32 v101, v101
    v_exp_f32 v102, v102
    v_exp_f32 v103, v103
    v_exp_f32 v104, v104
    v_smfmac_f32_32x32x32_bf16 v[48:63], a[64:67], v[128:135], v94
wb_pad0:
    s_cbranch_execz wb_pad4
    buffer_load_dwordx4 v252, s[24:27], s44 offen offset:0 nt lds
    v_exp_f32 v105, v105
    v_exp_f32 v106, v106
    v_exp_f32 v107, v107
    v_exp_f32 v108, v108
    v_smfmac_f32_32x32x32_bf16 v[48:63], a[68:71], v[136:143], v94
    v_accvgpr_read_b32 v232, a248
    v_exp_f32 v109, v109
    v_exp_f32 v110, v110
    v_exp_f32 v111, v111
    v_exp_f32 v112, v112
    s_waitcnt vmcnt(27)
    v_mfma_f32_32x32x16_bf16 v[128:143], a[84:87], v[16:19], 0
    s_add_u32 m0, s61, 960
    v_exp_f32 v113, v113
    v_exp_f32 v114, v114
    v_exp_f32 v115, v115
    v_exp_f32 v116, v116
    v_mfma_f32_32x32x8bf16_1k v[128:143], a[198:199], v[22:23], v[128:143]
    v_exp_f32 v117, v117
    v_exp_f32 v118, v118
    v_exp_f32 v119, v119
    v_exp_f32 v120, v120
    v_smfmac_f32_32x32x32_bf16 v[32:47], a[76:79], v[96:103], v94
    buffer_load_dwordx4 v252, s[24:27], s44 offen offset:64 nt lds
    v_exp_f32 v121, v121
    v_exp_f32 v122, v122
    v_exp_f32 v123, v123
    v_exp_f32 v124, v124
    v_smfmac_f32_32x32x32_bf16 v[32:47], a[80:83], v[104:111], v94
    v_accvgpr_read_b32 v233, a249
    v_exp_f32 v125, v125
    v_exp_f32 v126, v126
    v_exp_f32 v127, v127
    v_exp_f32 v128, v128
    v_mfma_f32_32x32x16_bf16 v[96:111], a[84:87], v[24:27], 0
    s_add_u32 m0, s61, 1920
    v_exp_f32 v129, v129
    v_exp_f32 v130, v130
    v_exp_f32 v131, v131
    v_exp_f32 v132, v132
    v_mfma_f32_32x32x8bf16_1k v[96:111], a[198:199], v[30:31], v[96:111]
    v_exp_f32 v133, v133
    v_exp_f32 v134, v134
    v_exp_f32 v135, v135
    v_exp_f32 v136, v136
    v_smfmac_f32_32x32x32_bf16 v[48:63], a[76:79], v[112:119], v94
    buffer_load_dwordx4 v252, s[24:27], s44 offen offset:128 nt lds
    v_exp_f32 v137, v137
    v_exp_f32 v138, v138
    v_exp_f32 v139, v139
    v_exp_f32 v140, v140
    v_smfmac_f32_32x32x32_bf16 v[48:63], a[80:83], v[120:127], v94
    v_accvgpr_read_b32 v234, a250
    v_exp_f32 v141, v141
    v_exp_f32 v142, v142
    v_exp_f32 v143, v143
    v_exp_f32 v96, v96
    s_waitcnt vmcnt(25)
    v_mfma_f32_32x32x16_bf16 v[112:127], a[96:99], v[16:19], 0
    s_add_u32 m0, s61, 2880
    v_exp_f32 v97, v97
    v_exp_f32 v98, v98
    v_exp_f32 v99, v99
    v_exp_f32 v100, v100
    v_mfma_f32_32x32x8bf16_1k v[112:127], a[200:201], v[20:21], v[112:127]
    v_exp_f32 v101, v101
    v_exp_f32 v102, v102
    v_exp_f32 v103, v103
    v_exp_f32 v104, v104
    v_smfmac_f32_32x32x32_bf16 v[32:47], a[88:91], v[128:135], v94
    buffer_load_dwordx4 v252, s[24:27], s44 offen offset:192 nt lds
    v_exp_f32 v105, v105
    v_exp_f32 v106, v106
    v_exp_f32 v107, v107
    v_exp_f32 v108, v108
    v_smfmac_f32_32x32x32_bf16 v[32:47], a[92:95], v[136:143], v94
    v_accvgpr_read_b32 v235, a251
    v_exp_f32 v109, v109
    v_exp_f32 v110, v110
    v_exp_f32 v111, v111
    v_exp_f32 v112, v112
    s_waitcnt vmcnt(23)
    v_mfma_f32_32x32x16_bf16 v[128:143], a[108:111], v[16:19], 0
    s_add_u32 m0, s61, 3840
    v_exp_f32 v113, v113
    v_exp_f32 v114, v114
    v_exp_f32 v115, v115
    v_exp_f32 v116, v116
    v_mfma_f32_32x32x8bf16_1k v[128:143], a[200:201], v[22:23], v[128:143]
    v_exp_f32 v117, v117
    v_exp_f32 v118, v118
    v_exp_f32 v119, v119
    v_exp_f32 v120, v120
    v_smfmac_f32_32x32x32_bf16 v[48:63], a[88:91], v[96:103], v94
    buffer_load_dwordx4 v252, s[24:27], s44 offen offset:256 nt lds
    v_exp_f32 v121, v121
    v_exp_f32 v122, v122
    v_exp_f32 v123, v123
    v_exp_f32 v124, v124
    v_smfmac_f32_32x32x32_bf16 v[48:63], a[92:95], v[104:111], v94
    v_add_u32 v64, 8192, v232
    v_exp_f32 v125, v125
    v_exp_f32 v126, v126
    v_exp_f32 v127, v127
    v_exp_f32 v128, v128
    s_waitcnt vmcnt(21)
    v_mfma_f32_32x32x16_bf16 v[96:111], a[120:123], v[16:19], 0
    s_add_u32 m0, s61, 4800
    v_exp_f32 v129, v129
    v_exp_f32 v130, v130
    v_exp_f32 v131, v131
    v_exp_f32 v132, v132
    v_mfma_f32_32x32x8bf16_1k v[96:111], a[202:203], v[20:21], v[96:111]
    v_exp_f32 v133, v133
    v_exp_f32 v134, v134
    v_exp_f32 v135, v135
    v_exp_f32 v136, v136
    v_smfmac_f32_32x32x32_bf16 v[32:47], a[100:103], v[112:119], v94
    buffer_load_dwordx4 v252, s[24:27], s44 offen offset:320 nt lds
    v_exp_f32 v137, v137
    v_exp_f32 v138, v138
    v_exp_f32 v139, v139
    v_exp_f32 v140, v140
    v_smfmac_f32_32x32x32_bf16 v[32:47], a[104:107], v[120:127], v94
    v_add_u32 v65, 18688, v232
    v_exp_f32 v141, v141
    v_exp_f32 v142, v142
    v_exp_f32 v143, v143
    v_exp_f32 v96, v96
    s_waitcnt vmcnt(19)
    v_mfma_f32_32x32x16_bf16 v[112:127], a[132:135], v[16:19], 0
    s_add_u32 m0, s61, 5760
    v_exp_f32 v97, v97
    v_exp_f32 v98, v98
    v_exp_f32 v99, v99
    v_exp_f32 v100, v100
    v_mfma_f32_32x32x8bf16_1k v[112:127], a[202:203], v[22:23], v[112:127]
    v_exp_f32 v101, v101
    v_exp_f32 v102, v102
    v_exp_f32 v103, v103
    v_exp_f32 v104, v104
    v_smfmac_f32_32x32x32_bf16 v[32:47], a[112:115], v[128:135], v94
    buffer_load_dwordx4 v252, s[24:27], s44 offen offset:384 nt lds
    v_exp_f32 v105, v105
    v_exp_f32 v106, v106
    v_exp_f32 v107, v107
    v_exp_f32 v108, v108
    v_smfmac_f32_32x32x32_bf16 v[32:47], a[116:119], v[136:143], v94
    v_add_u32 v66, 26880, v232
    v_exp_f32 v109, v109
    v_exp_f32 v110, v110
    v_exp_f32 v111, v111
    v_exp_f32 v112, v112
    s_waitcnt vmcnt(16)
    v_mfma_f32_32x32x16_bf16 v[128:143], a[144:147], v[16:19], 0
    s_add_u32 m0, s61, 6720
    v_exp_f32 v113, v113
    v_exp_f32 v114, v114
    v_exp_f32 v115, v115
    v_exp_f32 v116, v116
    v_mfma_f32_32x32x8bf16_1k v[128:143], a[204:205], v[20:21], v[128:143]
    v_exp_f32 v117, v117
    v_exp_f32 v118, v118
    v_exp_f32 v119, v119
    v_exp_f32 v120, v120
    v_smfmac_f32_32x32x32_bf16 v[32:47], a[124:127], v[96:103], v94
    buffer_load_dwordx4 v252, s[24:27], s44 offen offset:448 nt lds
    v_exp_f32 v121, v121
    v_exp_f32 v122, v122
    v_exp_f32 v123, v123
    v_exp_f32 v124, v124
    v_smfmac_f32_32x32x32_bf16 v[32:47], a[128:131], v[104:111], v94
    v_exp_f32 v125, v125
    v_exp_f32 v126, v126
    v_exp_f32 v127, v127
    v_exp_f32 v128, v128
    s_waitcnt vmcnt(14)
    v_mfma_f32_32x32x16_bf16 v[96:111], a[156:159], v[16:19], 0
    s_add_u32 m0, s61, 7680
    v_exp_f32 v129, v129
    v_exp_f32 v130, v130
    v_exp_f32 v131, v131
    v_exp_f32 v132, v132
    v_mfma_f32_32x32x8bf16_1k v[96:111], a[204:205], v[22:23], v[96:111]
    v_exp_f32 v133, v133
    v_exp_f32 v134, v134
    v_exp_f32 v135, v135
    v_exp_f32 v136, v136
    v_smfmac_f32_32x32x32_bf16 v[32:47], a[136:139], v[112:119], v94
    buffer_load_dwordx4 v252, s[24:27], s44 offen offset:512 nt lds
    v_exp_f32 v137, v137
    v_exp_f32 v138, v138
    v_exp_f32 v139, v139
    v_exp_f32 v140, v140
    v_smfmac_f32_32x32x32_bf16 v[32:47], a[140:143], v[120:127], v94
    v_exp_f32 v141, v141
    v_exp_f32 v142, v142
    v_exp_f32 v143, v143
    v_exp_f32 v96, v96
    s_waitcnt vmcnt(12)
    v_mfma_f32_32x32x16_bf16 v[112:127], a[168:171], v[16:19], 0
    s_mov_b32 m0, s60
    v_exp_f32 v97, v97
    v_exp_f32 v98, v98
    v_exp_f32 v99, v99
    v_exp_f32 v100, v100
    v_mfma_f32_32x32x8bf16_1k v[112:127], a[206:207], v[20:21], v[112:127]
    v_exp_f32 v101, v101
    v_exp_f32 v102, v102
    v_exp_f32 v103, v103
    v_exp_f32 v104, v104
    v_smfmac_f32_32x32x32_bf16 v[32:47], a[148:151], v[128:135], v94
    buffer_load_dwordx4 v253, s[28:31], s91 offen nt lds
    v_exp_f32 v105, v105
    v_exp_f32 v106, v106
    v_exp_f32 v107, v107
    v_exp_f32 v108, v108
    v_smfmac_f32_32x32x32_bf16 v[32:47], a[152:155], v[136:143], v94
    v_exp_f32 v109, v109
    v_exp_f32 v110, v110
    v_exp_f32 v111, v111
    v_exp_f32 v112, v112
    s_waitcnt vmcnt(10)
    v_mfma_f32_32x32x16_bf16 v[128:143], a[180:183], v[16:19], 0
    s_add_u32 m0, s60, 512
    v_exp_f32 v113, v113
    v_exp_f32 v114, v114
    v_exp_f32 v115, v115
    v_exp_f32 v116, v116
    v_mfma_f32_32x32x8bf16_1k v[128:143], a[206:207], v[22:23], v[128:143]
    v_exp_f32 v117, v117
    v_exp_f32 v118, v118
    v_exp_f32 v119, v119
    v_exp_f32 v120, v120
    v_smfmac_f32_32x32x32_bf16 v[32:47], a[160:163], v[96:103], v94
    buffer_load_dwordx4 v253, s[28:31], s45 offen offset:512 nt lds
    v_exp_f32 v121, v121
    v_exp_f32 v122, v122
    v_exp_f32 v123, v123
    v_exp_f32 v124, v124
    v_smfmac_f32_32x32x32_bf16 v[32:47], a[164:167], v[104:111], v94
    v_exp_f32 v125, v125
    v_exp_f32 v126, v126
    v_exp_f32 v127, v127
    v_exp_f32 v128, v128
    v_mfma_f32_32x32x16_bf16 v[96:111], a[96:99], v[24:27], 0
    s_add_u32 m0, s41, 73728
    v_exp_f32 v129, v129
    v_exp_f32 v130, v130
    v_exp_f32 v131, v131
    v_exp_f32 v132, v132
    v_mfma_f32_32x32x8bf16_1k v[96:111], a[200:201], v[28:29], v[96:111]
    v_exp_f32 v133, v133
    v_exp_f32 v134, v134
    v_exp_f32 v135, v135
    v_exp_f32 v136, v136
    v_smfmac_f32_32x32x32_bf16 v[32:47], a[172:175], v[112:119], v94
    buffer_load_dwordx4 v232, s[4:7], s40 offen offset:0 lds
    v_exp_f32 v137, v137
    v_exp_f32 v138, v138
    v_exp_f32 v139, v139
    v_exp_f32 v140, v140
    v_smfmac_f32_32x32x32_bf16 v[32:47], a[176:179], v[120:127], v94
    v_exp_f32 v141, v141
    v_exp_f32 v142, v142
    v_exp_f32 v143, v143
    v_exp_f32 v96, v96
    v_mfma_f32_32x32x16_bf16 v[112:127], a[108:111], v[24:27], 0
    ds_read_b128 v[16:19], v247 offset:24576
    v_exp_f32 v97, v97
    v_exp_f32 v98, v98
    v_exp_f32 v99, v99
    v_exp_f32 v100, v100
    v_mfma_f32_32x32x8bf16_1k v[112:127], a[200:201], v[30:31], v[112:127]
    v_exp_f32 v101, v101
    v_exp_f32 v102, v102
    v_exp_f32 v103, v103
    v_exp_f32 v104, v104
    v_smfmac_f32_32x32x32_bf16 v[32:47], a[184:187], v[128:135], v94
    ds_read_b32 v20, v247 offset:26624
    v_exp_f32 v105, v105
    v_exp_f32 v106, v106
    v_exp_f32 v107, v107
    v_exp_f32 v108, v108
    v_smfmac_f32_32x32x32_bf16 v[32:47], a[188:191], v[136:143], v94
    ds_read_b32 v23, v247 offset:26624
    v_exp_f32 v109, v109
    v_exp_f32 v110, v110
    v_exp_f32 v111, v111
    v_exp_f32 v112, v112
    v_mfma_f32_32x32x16_bf16 v[128:143], a[120:123], v[24:27], 0
    buffer_load_dwordx4 v64, s[4:7], s40 offen offset:1024 lds
    v_exp_f32 v113, v113
    v_exp_f32 v114, v114
    v_exp_f32 v115, v115
    v_exp_f32 v116, v116
    v_mfma_f32_32x32x8bf16_1k v[128:143], a[202:203], v[28:29], v[128:143]
    v_exp_f32 v117, v117
    v_exp_f32 v118, v118
    v_exp_f32 v119, v119
    v_exp_f32 v120, v120
    v_smfmac_f32_32x32x32_bf16 v[48:63], a[100:103], v[96:103], v94
    v_exp_f32 v121, v121
    v_exp_f32 v122, v122
    v_exp_f32 v123, v123
    v_exp_f32 v124, v124
    v_smfmac_f32_32x32x32_bf16 v[48:63], a[104:107], v[104:111], v94
    v_exp_f32 v125, v125
    v_exp_f32 v126, v126
    v_exp_f32 v127, v127
    v_exp_f32 v128, v128
    v_mfma_f32_32x32x16_bf16 v[96:111], a[132:135], v[24:27], 0
    ds_write_b128 v246, v[32:35] offset:0
    v_exp_f32 v129, v129
    v_exp_f32 v130, v130
    v_exp_f32 v131, v131
    v_exp_f32 v132, v132
    v_mfma_f32_32x32x8bf16_1k v[96:111], a[202:203], v[30:31], v[96:111]
    v_exp_f32 v133, v133
    v_exp_f32 v134, v134
    v_exp_f32 v135, v135
    v_exp_f32 v136, v136
    v_smfmac_f32_32x32x32_bf16 v[48:63], a[112:115], v[112:119], v94
    v_and_b32 v12, 0x70, v2
    v_exp_f32 v137, v137
    v_exp_f32 v138, v138
    v_exp_f32 v139, v139
    v_exp_f32 v140, v140
    v_smfmac_f32_32x32x32_bf16 v[48:63], a[116:119], v[120:127], v94
    v_bfe_u32 v11, v2, 7, 1
    v_exp_f32 v141, v141
    v_exp_f32 v142, v142
    v_exp_f32 v143, v143
    v_exp_f32 v96, v96
    v_mfma_f32_32x32x16_bf16 v[112:127], a[144:147], v[24:27], 0
    ds_write_b128 v246, v[36:39] offset:1024
    v_exp_f32 v97, v97
    v_exp_f32 v98, v98
    v_exp_f32 v99, v99
    v_exp_f32 v100, v100
    v_mfma_f32_32x32x8bf16_1k v[112:127], a[204:205], v[28:29], v[112:127]
    v_exp_f32 v101, v101
    v_exp_f32 v102, v102
    v_exp_f32 v103, v103
    v_exp_f32 v104, v104
    v_smfmac_f32_32x32x32_bf16 v[48:63], a[124:127], v[128:135], v94
    v_lshl_add_u32 v12, v11, 10, v12
    v_exp_f32 v105, v105
    v_exp_f32 v106, v106
    v_exp_f32 v107, v107
    v_exp_f32 v108, v108
    v_smfmac_f32_32x32x32_bf16 v[48:63], a[128:131], v[136:143], v94
    v_lshrrev_b32 v11, 8, v2
    v_exp_f32 v109, v109
    v_exp_f32 v110, v110
    v_exp_f32 v111, v111
    v_exp_f32 v112, v112
    v_mfma_f32_32x32x16_bf16 v[128:143], a[156:159], v[24:27], 0
    ds_write_b128 v246, v[40:43] offset:2048
    v_exp_f32 v113, v113
    v_exp_f32 v114, v114
    v_exp_f32 v115, v115
    v_exp_f32 v116, v116
    v_mfma_f32_32x32x8bf16_1k v[128:143], a[204:205], v[30:31], v[128:143]
    v_exp_f32 v117, v117
    v_exp_f32 v118, v118
    v_exp_f32 v119, v119
    v_exp_f32 v120, v120
    v_smfmac_f32_32x32x32_bf16 v[48:63], a[136:139], v[96:103], v94
    v_lshl_add_u32 v12, v11, 7, v12
    v_exp_f32 v121, v121
    v_exp_f32 v122, v122
    v_exp_f32 v123, v123
    v_exp_f32 v124, v124
    v_smfmac_f32_32x32x32_bf16 v[48:63], a[140:143], v[104:111], v94
    buffer_load_dwordx4 v65, s[4:7], s40 offen offset:2048 lds
    v_exp_f32 v125, v125
    v_exp_f32 v126, v126
    v_exp_f32 v127, v127
    v_exp_f32 v128, v128
    v_mfma_f32_32x32x16_bf16 v[96:111], a[168:171], v[24:27], 0
    buffer_load_dwordx4 v66, s[4:7], s40 offen offset:3072 lds
    v_exp_f32 v129, v129
    v_exp_f32 v130, v130
    v_exp_f32 v131, v131
    v_exp_f32 v132, v132
    v_mfma_f32_32x32x8bf16_1k v[96:111], a[206:207], v[28:29], v[96:111]
    v_exp_f32 v133, v133
    v_exp_f32 v134, v134
    v_exp_f32 v135, v135
    v_exp_f32 v136, v136
    v_smfmac_f32_32x32x32_bf16 v[48:63], a[148:151], v[112:119], v94
    s_add_u32 s40, s40, 41472
    v_exp_f32 v137, v137
    v_exp_f32 v138, v138
    v_exp_f32 v139, v139
    v_exp_f32 v140, v140
    v_smfmac_f32_32x32x32_bf16 v[48:63], a[152:155], v[120:127], v94
    v_exp_f32 v141, v141
    v_exp_f32 v142, v142
    v_exp_f32 v143, v143
    s_waitcnt lgkmcnt(0)
    s_barrier
    v_exp_f32 v96, v96
    v_mfma_f32_32x32x16_bf16 v[112:127], a[180:183], v[24:27], 0
    ds_read_b128 v[32:35], v247 offset:0
    v_exp_f32 v97, v97
    v_exp_f32 v98, v98
    v_exp_f32 v99, v99
    v_exp_f32 v100, v100
    v_mfma_f32_32x32x8bf16_1k v[112:127], a[206:207], v[30:31], v[112:127]
    v_exp_f32 v101, v101
    v_exp_f32 v102, v102
    v_exp_f32 v103, v103
    v_exp_f32 v104, v104
    v_smfmac_f32_32x32x32_bf16 v[48:63], a[160:163], v[128:135], v94
    ds_read_b128 v[36:39], v247 offset:1024
    v_exp_f32 v105, v105
    v_exp_f32 v106, v106
    v_exp_f32 v107, v107
    v_exp_f32 v108, v108
    v_smfmac_f32_32x32x32_bf16 v[48:63], a[164:167], v[136:143], v94
    ds_read_b128 v[40:43], v247 offset:2048
    v_exp_f32 v109, v109
    v_exp_f32 v110, v110
    v_exp_f32 v111, v111
    v_exp_f32 v112, v112
    v_mfma_f32_32x32x16_bf16 v[128:143], a[0:3], v[16:19], 0
    s_add_u32 m0, s41, 77824
    v_exp_f32 v113, v113
    v_exp_f32 v114, v114
    v_exp_f32 v115, v115
    v_exp_f32 v116, v116
    v_mfma_f32_32x32x8bf16_1k v[128:143], a[192:193], v[20:21], v[128:143]
    v_exp_f32 v117, v117
    v_exp_f32 v118, v118
    v_exp_f32 v119, v119
    v_exp_f32 v120, v120
    v_smfmac_f32_32x32x32_bf16 v[48:63], a[172:175], v[96:103], v94
    buffer_load_dwordx4 v232, s[4:7], s40 offen offset:0 lds
    v_exp_f32 v121, v121
    v_exp_f32 v122, v122
    v_exp_f32 v123, v123
    v_exp_f32 v124, v124
    v_smfmac_f32_32x32x32_bf16 v[48:63], a[176:179], v[104:111], v94
    s_mul_i32 s21, s14, 33
    v_exp_f32 v125, v125
    v_exp_f32 v126, v126
    v_exp_f32 v127, v127
    v_exp_f32 v128, v128
    v_mfma_f32_32x32x16_bf16 v[96:111], a[12:15], v[16:19], 0
    ds_read_b128 v[24:27], v247 offset:25600
    v_exp_f32 v129, v129
    v_exp_f32 v130, v130
    v_exp_f32 v131, v131
    v_exp_f32 v132, v132
    v_mfma_f32_32x32x8bf16_1k v[96:111], a[192:193], v[22:23], v[96:111]
    v_exp_f32 v133, v133
    v_exp_f32 v134, v134
    v_exp_f32 v135, v135
    v_exp_f32 v136, v136
    v_smfmac_f32_32x32x32_bf16 v[48:63], a[184:187], v[112:119], v94
    ds_read_b32 v28, v247 offset:26628
    v_exp_f32 v137, v137
    v_exp_f32 v138, v138
    v_exp_f32 v139, v139
    v_exp_f32 v140, v140
    v_smfmac_f32_32x32x32_bf16 v[48:63], a[188:191], v[120:127], v94
    ds_read_b32 v31, v247 offset:26628
    v_exp_f32 v141, v141
    v_exp_f32 v142, v142
    v_exp_f32 v143, v143
    v_exp_f32 v96, v96
    v_mfma_f32_32x32x16_bf16 v[112:127], a[24:27], v[16:19], 0
    buffer_load_dwordx4 v64, s[4:7], s40 offen offset:1024 lds
    v_exp_f32 v97, v97
    v_exp_f32 v98, v98
    v_exp_f32 v99, v99
    v_exp_f32 v100, v100
    v_mfma_f32_32x32x8bf16_1k v[112:127], a[194:195], v[20:21], v[112:127]
    v_exp_f32 v101, v101
    v_exp_f32 v102, v102
    v_exp_f32 v103, v103
    v_exp_f32 v104, v104
    s_waitcnt lgkmcnt(3)
    v_smfmac_f32_32x32x32_bf16 v[32:47], a[4:7], v[128:135], v94
    s_add_u32 s21, s21, s16
    v_exp_f32 v105, v105
    v_exp_f32 v106, v106
    v_exp_f32 v107, v107
    v_exp_f32 v108, v108
    v_smfmac_f32_32x32x32_bf16 v[32:47], a[8:11], v[136:143], v94
    s_lshl_b32 s43, s15, 10
    v_exp_f32 v109, v109
    v_exp_f32 v110, v110
    v_exp_f32 v111, v111
    v_exp_f32 v112, v112
    v_mfma_f32_32x32x16_bf16 v[128:143], a[36:39], v[16:19], 0
    ds_write_b128 v246, v[48:51] offset:12288
    v_exp_f32 v113, v113
    v_exp_f32 v114, v114
    v_exp_f32 v115, v115
    v_exp_f32 v116, v116
    v_mfma_f32_32x32x8bf16_1k v[128:143], a[194:195], v[22:23], v[128:143]
    v_exp_f32 v117, v117
    v_exp_f32 v118, v118
    v_exp_f32 v119, v119
    v_exp_f32 v120, v120
    v_smfmac_f32_32x32x32_bf16 v[32:47], a[16:19], v[96:103], v94
    buffer_load_dwordx4 v65, s[4:7], s40 offen offset:2048 lds
    v_exp_f32 v121, v121
    v_exp_f32 v122, v122
    v_exp_f32 v123, v123
    v_exp_f32 v124, v124
    v_smfmac_f32_32x32x32_bf16 v[32:47], a[20:23], v[104:111], v94
    s_lshl_b32 s21, s21, 8
    v_exp_f32 v125, v125
    v_exp_f32 v126, v126
    v_exp_f32 v127, v127
    v_exp_f32 v128, v128
    v_mfma_f32_32x32x16_bf16 v[96:111], a[48:51], v[16:19], 0
    ds_write_b128 v246, v[52:55] offset:13312
    v_exp_f32 v129, v129
    v_exp_f32 v130, v130
    v_exp_f32 v131, v131
    v_exp_f32 v132, v132
    v_mfma_f32_32x32x8bf16_1k v[96:111], a[196:197], v[20:21], v[96:111]
    v_exp_f32 v133, v133
    v_exp_f32 v134, v134
    v_exp_f32 v135, v135
    v_exp_f32 v136, v136
    v_smfmac_f32_32x32x32_bf16 v[32:47], a[28:31], v[112:119], v94
    buffer_load_dwordx4 v66, s[4:7], s40 offen offset:3072 lds
    v_exp_f32 v137, v137
    v_exp_f32 v138, v138
    v_exp_f32 v139, v139
    v_exp_f32 v140, v140
    v_smfmac_f32_32x32x32_bf16 v[32:47], a[32:35], v[120:127], v94
    s_add_u32 s40, s40, 41472
    v_exp_f32 v141, v141
    v_exp_f32 v142, v142
    v_exp_f32 v143, v143
    v_exp_f32 v96, v96
    v_mfma_f32_32x32x16_bf16 v[112:127], a[60:63], v[16:19], 0
    ds_write_b128 v246, v[56:59] offset:14336
    v_exp_f32 v97, v97
    v_exp_f32 v98, v98
    v_exp_f32 v99, v99
    v_exp_f32 v100, v100
    v_mfma_f32_32x32x8bf16_1k v[112:127], a[196:197], v[22:23], v[112:127]
    v_exp_f32 v101, v101
    v_exp_f32 v102, v102
    v_exp_f32 v103, v103
    v_exp_f32 v104, v104
    v_smfmac_f32_32x32x32_bf16 v[32:47], a[40:43], v[128:135], v94
    s_add_u32 m0, s41, 81920
    v_exp_f32 v105, v105
    v_exp_f32 v106, v106
    v_exp_f32 v107, v107
    v_exp_f32 v108, v108
    v_smfmac_f32_32x32x32_bf16 v[32:47], a[44:47], v[136:143], v94
    buffer_load_dwordx4 v232, s[4:7], s40 offen offset:0 lds
    v_exp_f32 v109, v109
    v_exp_f32 v110, v110
    v_exp_f32 v111, v111
    v_exp_f32 v112, v112
    v_mfma_f32_32x32x16_bf16 v[128:143], a[72:75], v[16:19], 0
    buffer_load_dwordx4 v64, s[4:7], s40 offen offset:1024 lds
    v_exp_f32 v113, v113
    v_exp_f32 v114, v114
    v_exp_f32 v115, v115
    v_exp_f32 v116, v116
    v_mfma_f32_32x32x8bf16_1k v[128:143], a[198:199], v[20:21], v[128:143]
    v_exp_f32 v117, v117
    v_exp_f32 v118, v118
    v_exp_f32 v119, v119
    v_exp_f32 v120, v120
    v_smfmac_f32_32x32x32_bf16 v[32:47], a[52:55], v[96:103], v94
    s_add_u32 s21, s21, 22675456
    v_exp_f32 v121, v121
    v_exp_f32 v122, v122
    v_exp_f32 v123, v123
    v_exp_f32 v124, v124
    v_smfmac_f32_32x32x32_bf16 v[32:47], a[56:59], v[104:111], v94
    s_add_u32 s43, s43, s21
    v_exp_f32 v125, v125
    v_exp_f32 v126, v126
    v_exp_f32 v127, v127
    s_waitcnt lgkmcnt(0)
    s_barrier
    v_exp_f32 v128, v128
    v_mfma_f32_32x32x16_bf16 v[96:111], a[84:87], v[16:19], 0
    ds_read_b128 v[48:51], v247 offset:12288
    v_exp_f32 v129, v129
    v_exp_f32 v130, v130
    v_exp_f32 v131, v131
    v_exp_f32 v132, v132
    v_mfma_f32_32x32x8bf16_1k v[96:111], a[198:199], v[22:23], v[96:111]
    v_exp_f32 v133, v133
    v_exp_f32 v134, v134
    v_exp_f32 v135, v135
    v_exp_f32 v136, v136
    v_smfmac_f32_32x32x32_bf16 v[32:47], a[64:67], v[112:119], v94
    ds_read_b128 v[52:55], v247 offset:13312
    v_exp_f32 v137, v137
    v_exp_f32 v138, v138
    v_exp_f32 v139, v139
    v_exp_f32 v140, v140
    v_smfmac_f32_32x32x32_bf16 v[32:47], a[68:71], v[120:127], v94
    ds_read_b128 v[56:59], v247 offset:14336
    v_exp_f32 v141, v141
    v_exp_f32 v142, v142
    v_exp_f32 v143, v143
    v_exp_f32 v96, v96
    v_mfma_f32_32x32x16_bf16 v[112:127], a[96:99], v[16:19], 0
    buffer_load_dwordx4 v65, s[4:7], s40 offen offset:2048 lds
    v_exp_f32 v97, v97
    v_exp_f32 v98, v98
    v_exp_f32 v99, v99
    v_exp_f32 v100, v100
    v_mfma_f32_32x32x8bf16_1k v[112:127], a[200:201], v[20:21], v[112:127]
    v_exp_f32 v101, v101
    v_exp_f32 v102, v102
    v_exp_f32 v103, v103
    v_exp_f32 v104, v104
    v_smfmac_f32_32x32x32_bf16 v[32:47], a[76:79], v[128:135], v94
    v_lshlrev_b32 v90, 2, v1
    v_exp_f32 v105, v105
    v_exp_f32 v106, v106
    v_exp_f32 v107, v107
    v_exp_f32 v108, v108
    v_smfmac_f32_32x32x32_bf16 v[32:47], a[80:83], v[136:143], v94
    v_and_b32 v92, 7, v1
    v_exp_f32 v109, v109
    v_exp_f32 v110, v110
    v_exp_f32 v111, v111
    v_exp_f32 v112, v112
    v_mfma_f32_32x32x16_bf16 v[128:143], a[108:111], v[16:19], 0
    buffer_load_dwordx4 v66, s[4:7], s40 offen offset:3072 lds
    v_exp_f32 v113, v113
    v_exp_f32 v114, v114
    v_exp_f32 v115, v115
    v_exp_f32 v116, v116
    v_mfma_f32_32x32x8bf16_1k v[128:143], a[200:201], v[22:23], v[128:143]
    v_exp_f32 v117, v117
    v_exp_f32 v118, v118
    v_exp_f32 v119, v119
    v_exp_f32 v120, v120
    v_smfmac_f32_32x32x32_bf16 v[32:47], a[88:91], v[96:103], v94
    s_add_u32 s40, s40, 41472
    v_exp_f32 v121, v121
    v_exp_f32 v122, v122
    v_exp_f32 v123, v123
    v_exp_f32 v124, v124
    v_smfmac_f32_32x32x32_bf16 v[32:47], a[92:95], v[104:111], v94
    v_lshlrev_b32 v92, 10, v92
    v_exp_f32 v125, v125
    v_exp_f32 v126, v126
    v_exp_f32 v127, v127
    v_exp_f32 v128, v128
    v_mfma_f32_32x32x16_bf16 v[96:111], a[120:123], v[16:19], 0
    s_add_u32 m0, s41, 86016
    v_exp_f32 v129, v129
    v_exp_f32 v130, v130
    v_exp_f32 v131, v131
    v_exp_f32 v132, v132
    v_mfma_f32_32x32x8bf16_1k v[96:111], a[202:203], v[20:21], v[96:111]
    v_exp_f32 v133, v133
    v_exp_f32 v134, v134
    v_exp_f32 v135, v135
    v_exp_f32 v136, v136
    v_smfmac_f32_32x32x32_bf16 v[32:47], a[100:103], v[112:119], v94
    buffer_load_dwordx4 v232, s[4:7], s40 offen offset:0 lds
    v_exp_f32 v137, v137
    v_exp_f32 v138, v138
    v_exp_f32 v139, v139
    v_exp_f32 v140, v140
    v_smfmac_f32_32x32x32_bf16 v[32:47], a[104:107], v[120:127], v94
    v_exp_f32 v141, v141
    v_exp_f32 v142, v142
    v_exp_f32 v143, v143
    s_waitcnt vmcnt(13)
    v_exp_f32 v96, v96
    v_mfma_f32_32x32x16_bf16 v[112:127], a[132:135], v[16:19], 0
    buffer_load_dwordx4 v64, s[4:7], s40 offen offset:1024 lds
    v_exp_f32 v97, v97
    v_exp_f32 v98, v98
    v_exp_f32 v99, v99
    v_exp_f32 v100, v100
    v_mfma_f32_32x32x8bf16_1k v[112:127], a[202:203], v[22:23], v[112:127]
    v_exp_f32 v101, v101
    v_exp_f32 v102, v102
    v_exp_f32 v103, v103
    v_exp_f32 v104, v104
    v_smfmac_f32_32x32x32_bf16 v[32:47], a[112:115], v[128:135], v94
    v_exp_f32 v105, v105
    v_exp_f32 v106, v106
    v_exp_f32 v107, v107
    v_exp_f32 v108, v108
    v_smfmac_f32_32x32x32_bf16 v[32:47], a[116:119], v[136:143], v94
    v_exp_f32 v109, v109
    v_exp_f32 v110, v110
    v_exp_f32 v111, v111
    v_exp_f32 v112, v112
    v_mfma_f32_32x32x16_bf16 v[128:143], a[144:147], v[16:19], 0
    buffer_load_dwordx4 v65, s[4:7], s40 offen offset:2048 lds
    v_exp_f32 v113, v113
    v_exp_f32 v114, v114
    v_exp_f32 v115, v115
    v_exp_f32 v116, v116
    v_mfma_f32_32x32x8bf16_1k v[128:143], a[204:205], v[20:21], v[128:143]
    v_exp_f32 v117, v117
    v_exp_f32 v118, v118
    v_exp_f32 v119, v119
    v_exp_f32 v120, v120
    v_smfmac_f32_32x32x32_bf16 v[32:47], a[124:127], v[96:103], v94
    v_exp_f32 v121, v121
    v_exp_f32 v122, v122
    v_exp_f32 v123, v123
    v_exp_f32 v124, v124
    v_smfmac_f32_32x32x32_bf16 v[32:47], a[128:131], v[104:111], v94
    v_exp_f32 v125, v125
    v_exp_f32 v126, v126
    v_exp_f32 v127, v127
    v_exp_f32 v128, v128
    v_mfma_f32_32x32x16_bf16 v[96:111], a[156:159], v[16:19], 0
    ds_read_b64_tr_b16 v[144:145], v244 offset:0
    v_exp_f32 v129, v129
    v_exp_f32 v130, v130
    v_exp_f32 v131, v131
    v_exp_f32 v132, v132
    v_mfma_f32_32x32x8bf16_1k v[96:111], a[204:205], v[22:23], v[96:111]
    v_exp_f32 v133, v133
    v_exp_f32 v134, v134
    v_exp_f32 v135, v135
    v_exp_f32 v136, v136
    v_smfmac_f32_32x32x32_bf16 v[32:47], a[136:139], v[112:119], v94
    ds_read_b64_tr_b16 v[146:147], v244 offset:256
    v_exp_f32 v137, v137
    v_exp_f32 v138, v138
    v_exp_f32 v139, v139
    v_exp_f32 v140, v140
    v_smfmac_f32_32x32x32_bf16 v[32:47], a[140:143], v[120:127], v94
    v_xor_b32 v253, s80, v12
    v_exp_f32 v141, v141
    v_exp_f32 v142, v142
    v_exp_f32 v143, v143
    v_exp_f32 v96, v96
    v_mfma_f32_32x32x16_bf16 v[112:127], a[168:171], v[16:19], 0
    buffer_load_dwordx4 v66, s[4:7], s40 offen offset:3072 lds
    v_exp_f32 v97, v97
    v_exp_f32 v98, v98
    v_exp_f32 v99, v99
    v_exp_f32 v100, v100
    v_mfma_f32_32x32x8bf16_1k v[112:127], a[206:207], v[20:21], v[112:127]
    v_exp_f32 v101, v101
    v_exp_f32 v102, v102
    v_exp_f32 v103, v103
    v_exp_f32 v104, v104
    v_smfmac_f32_32x32x32_bf16 v[32:47], a[148:151], v[128:135], v94
    v_exp_f32 v105, v105
    v_exp_f32 v106, v106
    v_exp_f32 v107, v107
    v_exp_f32 v108, v108
    v_smfmac_f32_32x32x32_bf16 v[32:47], a[152:155], v[136:143], v94
    v_exp_f32 v109, v109
    v_exp_f32 v110, v110
    v_exp_f32 v111, v111
    v_exp_f32 v112, v112
    v_mfma_f32_32x32x16_bf16 v[128:143], a[180:183], v[16:19], 0
    s_waitcnt lgkmcnt(0)
    global_store_dwordx4 v253, v[144:147], s[36:37] sc1
    v_exp_f32 v113, v113
    v_exp_f32 v114, v114
    v_exp_f32 v115, v115
    v_exp_f32 v116, v116
    v_mfma_f32_32x32x8bf16_1k v[128:143], a[206:207], v[22:23], v[128:143]
    v_exp_f32 v117, v117
    v_exp_f32 v118, v118
    v_exp_f32 v119, v119
    v_exp_f32 v120, v120
    v_smfmac_f32_32x32x32_bf16 v[32:47], a[160:163], v[96:103], v94
    ds_read_b64_tr_b16 v[148:149], v244 offset:1024
    v_exp_f32 v121, v121
    v_exp_f32 v122, v122
    v_exp_f32 v123, v123
    v_exp_f32 v124, v124
    v_smfmac_f32_32x32x32_bf16 v[32:47], a[164:167], v[104:111], v94
    ds_read_b64_tr_b16 v[150:151], v244 offset:1280
    v_xor_b32 v252, s81, v12
    v_exp_f32 v125, v125
    v_exp_f32 v126, v126
    v_exp_f32 v127, v127
    v_exp_f32 v128, v128
    v_mfma_f32_32x32x16_bf16 v[96:111], a[0:3], v[24:27], 0
    s_add_u32 s17, s40, 4294861312
    v_exp_f32 v129, v129
    v_exp_f32 v130, v130
    v_exp_f32 v131, v131
    v_exp_f32 v132, v132
    v_mfma_f32_32x32x8bf16_1k v[96:111], a[192:193], v[28:29], v[96:111]
wb_pad1:
    s_cbranch_execz wb_pad5
    v_exp_f32 v133, v133
    v_exp_f32 v134, v134
    v_exp_f32 v135, v135
    v_exp_f32 v136, v136
    v_smfmac_f32_32x32x32_bf16 v[32:47], a[172:175], v[112:119], v94
    s_add_u32 m0, s46, 139264
    v_exp_f32 v137, v137
    v_exp_f32 v138, v138
    v_exp_f32 v139, v139
    v_exp_f32 v140, v140
    v_smfmac_f32_32x32x32_bf16 v[32:47], a[176:179], v[120:127], v94
    buffer_load_dwordx4 v233, s[4:7], s17 offen lds
    v_exp_f32 v141, v141
    v_exp_f32 v142, v142
    v_exp_f32 v143, v143
    v_exp_f32 v96, v96
    v_mfma_f32_32x32x16_bf16 v[112:127], a[12:15], v[24:27], 0
    ds_read_b128 v[16:19], v248 offset:24576
    v_exp_f32 v97, v97
    v_exp_f32 v98, v98
    v_exp_f32 v99, v99
    v_exp_f32 v100, v100
    v_mfma_f32_32x32x8bf16_1k v[112:127], a[192:193], v[30:31], v[112:127]
    v_exp_f32 v101, v101
    v_exp_f32 v102, v102
    v_exp_f32 v103, v103
    v_exp_f32 v104, v104
    v_smfmac_f32_32x32x32_bf16 v[32:47], a[184:187], v[128:135], v94
    ds_read_b32 v20, v248 offset:26624
    v_exp_f32 v105, v105
    v_exp_f32 v106, v106
    v_exp_f32 v107, v107
    v_exp_f32 v108, v108
    v_smfmac_f32_32x32x32_bf16 v[32:47], a[188:191], v[136:143], v94
    ds_read_b32 v23, v248 offset:26624
    v_exp_f32 v109, v109
    v_exp_f32 v110, v110
    v_exp_f32 v111, v111
    v_exp_f32 v112, v112
    v_mfma_f32_32x32x16_bf16 v[128:143], a[24:27], v[24:27], 0
    s_waitcnt lgkmcnt(3)
    global_store_dwordx4 v252, v[148:151], s[36:37] sc1
    v_exp_f32 v113, v113
    v_exp_f32 v114, v114
    v_exp_f32 v115, v115
    v_exp_f32 v116, v116
    v_mfma_f32_32x32x8bf16_1k v[128:143], a[194:195], v[28:29], v[128:143]
    v_exp_f32 v117, v117
    v_exp_f32 v118, v118
    v_exp_f32 v119, v119
    v_exp_f32 v120, v120
    v_smfmac_f32_32x32x32_bf16 v[48:63], a[4:7], v[96:103], v94
    ds_read_b64_tr_b16 v[152:153], v244 offset:2048
    v_exp_f32 v121, v121
    v_exp_f32 v122, v122
    v_exp_f32 v123, v123
    v_exp_f32 v124, v124
    v_smfmac_f32_32x32x32_bf16 v[48:63], a[8:11], v[104:111], v94
    ds_read_b64_tr_b16 v[154:155], v244 offset:2304
    v_xor_b32 v253, s82, v12
    v_exp_f32 v125, v125
    v_exp_f32 v126, v126
    v_exp_f32 v127, v127
    v_exp_f32 v128, v128
    v_mfma_f32_32x32x16_bf16 v[96:111], a[36:39], v[24:27], 0
    ds_write_b128 v246, v[32:35] offset:0
    v_exp_f32 v129, v129
    v_exp_f32 v130, v130
    v_exp_f32 v131, v131
    v_exp_f32 v132, v132
    v_mfma_f32_32x32x8bf16_1k v[96:111], a[194:195], v[30:31], v[96:111]
    v_exp_f32 v133, v133
    v_exp_f32 v134, v134
    v_exp_f32 v135, v135
    v_exp_f32 v136, v136
    v_smfmac_f32_32x32x32_bf16 v[48:63], a[16:19], v[112:119], v94
    global_store_dwordx4 v2, v[236:239], s[58:59] offset:-4096 sc1
    v_exp_f32 v137, v137
    v_exp_f32 v138, v138
    v_exp_f32 v139, v139
    v_exp_f32 v140, v140
    v_smfmac_f32_32x32x32_bf16 v[48:63], a[20:23], v[120:127], v94
    v_exp_f32 v141, v141
    v_exp_f32 v142, v142
    v_exp_f32 v143, v143
    v_exp_f32 v96, v96
    v_mfma_f32_32x32x16_bf16 v[112:127], a[48:51], v[24:27], 0
    ds_write_b128 v246, v[36:39] offset:1024
    v_exp_f32 v97, v97
    v_exp_f32 v98, v98
    v_exp_f32 v99, v99
    v_exp_f32 v100, v100
    v_mfma_f32_32x32x8bf16_1k v[112:127], a[196:197], v[28:29], v[112:127]
    v_exp_f32 v101, v101
    v_exp_f32 v102, v102
    v_exp_f32 v103, v103
    v_exp_f32 v104, v104
    v_smfmac_f32_32x32x32_bf16 v[48:63], a[28:31], v[128:135], v94
    global_store_dwordx4 v2, v[236:239], s[58:59] offset:-3072 sc1
    v_exp_f32 v105, v105
    v_exp_f32 v106, v106
    v_exp_f32 v107, v107
    v_exp_f32 v108, v108
    v_smfmac_f32_32x32x32_bf16 v[48:63], a[32:35], v[136:143], v94
    v_exp_f32 v109, v109
    v_exp_f32 v110, v110
    v_exp_f32 v111, v111
    v_exp_f32 v112, v112
    v_mfma_f32_32x32x16_bf16 v[128:143], a[60:63], v[24:27], 0
    ds_write_b128 v246, v[40:43] offset:2048
    v_exp_f32 v113, v113
    v_exp_f32 v114, v114
    v_exp_f32 v115, v115
    v_exp_f32 v116, v116
    v_mfma_f32_32x32x8bf16_1k v[128:143], a[196:197], v[30:31], v[128:143]
    v_exp_f32 v117, v117
    v_exp_f32 v118, v118
    v_exp_f32 v119, v119
    v_exp_f32 v120, v120
    v_smfmac_f32_32x32x32_bf16 v[48:63], a[40:43], v[96:103], v94
    global_store_dwordx4 v2, v[236:239], s[58:59] offset:-2048 sc1
    v_exp_f32 v121, v121
    v_exp_f32 v122, v122
    v_exp_f32 v123, v123
    v_exp_f32 v124, v124
    v_smfmac_f32_32x32x32_bf16 v[48:63], a[44:47], v[104:111], v94
    v_exp_f32 v125, v125
    v_exp_f32 v126, v126
    v_exp_f32 v127, v127
    v_exp_f32 v128, v128
    v_mfma_f32_32x32x16_bf16 v[96:111], a[72:75], v[24:27], 0
    s_waitcnt lgkmcnt(3)
    global_store_dwordx4 v253, v[152:155], s[36:37] sc1
    v_exp_f32 v129, v129
    v_exp_f32 v130, v130
    v_exp_f32 v131, v131
    v_exp_f32 v132, v132
    v_mfma_f32_32x32x8bf16_1k v[96:111], a[198:199], v[28:29], v[96:111]
    v_exp_f32 v133, v133
    v_exp_f32 v134, v134
    v_exp_f32 v135, v135
    v_exp_f32 v136, v136
    v_smfmac_f32_32x32x32_bf16 v[48:63], a[52:55], v[112:119], v94
    ds_read_b64_tr_b16 v[156:157], v244 offset:3072
    v_exp_f32 v137, v137
    v_exp_f32 v138, v138
    v_exp_f32 v139, v139
    v_exp_f32 v140, v140
    v_smfmac_f32_32x32x32_bf16 v[48:63], a[56:59], v[120:127], v94
    ds_read_b64_tr_b16 v[158:159], v244 offset:3328
    v_xor_b32 v252, s83, v12
    v_exp_f32 v141, v141
    v_exp_f32 v142, v142
    v_exp_f32 v143, v143
    s_waitcnt lgkmcnt(2)
    s_barrier
    v_exp_f32 v96, v96
    v_mfma_f32_32x32x16_bf16 v[112:127], a[84:87], v[24:27], 0
    ds_read_b128 v[32:35], v247 offset:0
    v_exp_f32 v97, v97
    v_exp_f32 v98, v98
    v_exp_f32 v99, v99
    v_exp_f32 v100, v100
    v_mfma_f32_32x32x8bf16_1k v[112:127], a[198:199], v[30:31], v[112:127]
    v_exp_f32 v101, v101
    v_exp_f32 v102, v102
    v_exp_f32 v103, v103
    v_exp_f32 v104, v104
    v_smfmac_f32_32x32x32_bf16 v[48:63], a[64:67], v[128:135], v94
    ds_read_b128 v[36:39], v247 offset:1024
    v_exp_f32 v105, v105
    v_exp_f32 v106, v106
    v_exp_f32 v107, v107
    v_exp_f32 v108, v108
    v_smfmac_f32_32x32x32_bf16 v[48:63], a[68:71], v[136:143], v94
    ds_read_b128 v[40:43], v247 offset:2048
    v_exp_f32 v109, v109
    v_exp_f32 v110, v110
    v_exp_f32 v111, v111
    v_exp_f32 v112, v112
    v_mfma_f32_32x32x16_bf16 v[128:143], a[96:99], v[24:27], 0
    s_waitcnt lgkmcnt(3)
    global_store_dwordx4 v252, v[156:159], s[36:37] sc1
    v_exp_f32 v113, v113
    v_exp_f32 v114, v114
    v_exp_f32 v115, v115
    v_exp_f32 v116, v116
    v_mfma_f32_32x32x8bf16_1k v[128:143], a[200:201], v[28:29], v[128:143]
    v_exp_f32 v117, v117
    v_exp_f32 v118, v118
    v_exp_f32 v119, v119
    v_exp_f32 v120, v120
    v_smfmac_f32_32x32x32_bf16 v[48:63], a[76:79], v[96:103], v94
    ds_read_b64_tr_b16 v[160:161], v244 offset:4096
    v_exp_f32 v121, v121
    v_exp_f32 v122, v122
    v_exp_f32 v123, v123
    v_exp_f32 v124, v124
    v_smfmac_f32_32x32x32_bf16 v[48:63], a[80:83], v[104:111], v94
    ds_read_b64_tr_b16 v[162:163], v244 offset:4352
    v_xor_b32 v253, s84, v12
    v_exp_f32 v125, v125
    v_exp_f32 v126, v126
    v_exp_f32 v127, v127
    v_exp_f32 v128, v128
    v_mfma_f32_32x32x16_bf16 v[96:111], a[108:111], v[24:27], 0
    s_waitcnt lgkmcnt(0)
    global_store_dwordx4 v253, v[160:163], s[36:37] sc1
    v_exp_f32 v129, v129
    v_exp_f32 v130, v130
    v_exp_f32 v131, v131
    v_exp_f32 v132, v132
    v_mfma_f32_32x32x8bf16_1k v[96:111], a[200:201], v[30:31], v[96:111]
    v_exp_f32 v133, v133
    v_exp_f32 v134, v134
    v_exp_f32 v135, v135
    v_exp_f32 v136, v136
    v_smfmac_f32_32x32x32_bf16 v[48:63], a[88:91], v[112:119], v94
    ds_read_b64_tr_b16 v[164:165], v244 offset:5120
    v_exp_f32 v137, v137
    v_exp_f32 v138, v138
    v_exp_f32 v139, v139
    v_exp_f32 v140, v140
    v_smfmac_f32_32x32x32_bf16 v[48:63], a[92:95], v[120:127], v94
    ds_read_b64_tr_b16 v[166:167], v244 offset:5376
    v_xor_b32 v252, s85, v12
    v_exp_f32 v141, v141
    v_exp_f32 v142, v142
    v_exp_f32 v143, v143
    v_exp_f32 v96, v96
    v_mfma_f32_32x32x16_bf16 v[112:127], a[120:123], v[24:27], 0
    s_waitcnt lgkmcnt(0)
    global_store_dwordx4 v252, v[164:167], s[36:37] sc1
    v_exp_f32 v97, v97
    v_exp_f32 v98, v98
    v_exp_f32 v99, v99
    v_exp_f32 v100, v100
    v_mfma_f32_32x32x8bf16_1k v[112:127], a[202:203], v[28:29], v[112:127]
    v_exp_f32 v101, v101
    v_exp_f32 v102, v102
    v_exp_f32 v103, v103
    v_exp_f32 v104, v104
    v_smfmac_f32_32x32x32_bf16 v[48:63], a[100:103], v[128:135], v94
    ds_read_b64_tr_b16 v[168:169], v244 offset:6144
    v_exp_f32 v105, v105
    v_exp_f32 v106, v106
    v_exp_f32 v107, v107
    v_exp_f32 v108, v108
    v_smfmac_f32_32x32x32_bf16 v[48:63], a[104:107], v[136:143], v94
    ds_read_b64_tr_b16 v[170:171], v244 offset:6400
    v_xor_b32 v253, s86, v12
    v_exp_f32 v109, v109
    v_exp_f32 v110, v110
    v_exp_f32 v111, v111
    v_exp_f32 v112, v112
    v_mfma_f32_32x32x16_bf16 v[128:143], a[132:135], v[24:27], 0
    s_waitcnt lgkmcnt(0)
    global_store_dwordx4 v253, v[168:171], s[36:37] sc1
    v_exp_f32 v113, v113
    v_exp_f32 v114, v114
    v_exp_f32 v115, v115
    v_exp_f32 v116, v116
    v_mfma_f32_32x32x8bf16_1k v[128:143], a[202:203], v[30:31], v[128:143]
    v_exp_f32 v117, v117
    v_exp_f32 v118, v118
    v_exp_f32 v119, v119
    v_exp_f32 v120, v120
    v_smfmac_f32_32x32x32_bf16 v[48:63], a[112:115], v[96:103], v94
    ds_read_b64_tr_b16 v[172:173], v244 offset:7168
    v_exp_f32 v121, v121
    v_exp_f32 v122, v122
    v_exp_f32 v123, v123
    v_exp_f32 v124, v124
    v_smfmac_f32_32x32x32_bf16 v[48:63], a[116:119], v[104:111], v94
    ds_read_b64_tr_b16 v[174:175], v244 offset:7424
    v_xor_b32 v252, s87, v12
    v_exp_f32 v125, v125
    v_exp_f32 v126, v126
    v_exp_f32 v127, v127
    v_exp_f32 v128, v128
    v_mfma_f32_32x32x16_bf16 v[96:111], a[144:147], v[24:27], 0
    s_add_u32 s17, s40, 4294944256
    v_exp_f32 v129, v129
    v_exp_f32 v130, v130
    v_exp_f32 v131, v131
    v_exp_f32 v132, v132
    v_mfma_f32_32x32x8bf16_1k v[96:111], a[204:205], v[28:29], v[96:111]
    v_exp_f32 v133, v133
    v_exp_f32 v134, v134
    v_exp_f32 v135, v135
    v_exp_f32 v136, v136
    v_smfmac_f32_32x32x32_bf16 v[48:63], a[124:127], v[112:119], v94
    s_add_u32 m0, s46, 140288
    v_exp_f32 v137, v137
    v_exp_f32 v138, v138
    v_exp_f32 v139, v139
    v_exp_f32 v140, v140
    v_smfmac_f32_32x32x32_bf16 v[48:63], a[128:131], v[120:127], v94
    buffer_load_dwordx4 v233, s[4:7], s17 offen lds
    v_exp_f32 v141, v141
    v_exp_f32 v142, v142
    v_exp_f32 v143, v143
    v_exp_f32 v96, v96
    v_mfma_f32_32x32x16_bf16 v[112:127], a[156:159], v[24:27], 0
    s_waitcnt lgkmcnt(0)
    global_store_dwordx4 v252, v[172:175], s[36:37] sc1
    v_exp_f32 v97, v97
    v_exp_f32 v98, v98
    v_exp_f32 v99, v99
    v_exp_f32 v100, v100
    v_mfma_f32_32x32x8bf16_1k v[112:127], a[204:205], v[30:31], v[112:127]
    v_exp_f32 v101, v101
    v_exp_f32 v102, v102
    v_exp_f32 v103, v103
    v_exp_f32 v104, v104
    v_smfmac_f32_32x32x32_bf16 v[48:63], a[136:139], v[128:135], v94
    ds_read_b64_tr_b16 v[176:177], v244 offset:8192
    v_exp_f32 v105, v105
    v_exp_f32 v106, v106
    v_exp_f32 v107, v107
    v_exp_f32 v108, v108
    v_smfmac_f32_32x32x32_bf16 v[48:63], a[140:143], v[136:143], v94
    ds_read_b64_tr_b16 v[178:179], v244 offset:8448
    v_xor_b32 v253, s88, v12
    v_exp_f32 v109, v109
    v_exp_f32 v110, v110
    v_exp_f32 v111, v111
    v_exp_f32 v112, v112
    v_mfma_f32_32x32x16_bf16 v[128:143], a[168:171], v[24:27], 0
    global_store_dwordx4 v2, v[236:239], s[58:59] offset:-1024 sc1
    v_exp_f32 v113, v113
    v_exp_f32 v114, v114
    v_exp_f32 v115, v115
    v_exp_f32 v116, v116
    v_mfma_f32_32x32x8bf16_1k v[128:143], a[206:207], v[28:29], v[128:143]
    v_exp_f32 v117, v117
    v_exp_f32 v118, v118
    v_exp_f32 v119, v119
    v_exp_f32 v120, v120
    v_smfmac_f32_32x32x32_bf16 v[48:63], a[148:151], v[96:103], v94
    v_exp_f32 v121, v121
    v_exp_f32 v122, v122
    v_exp_f32 v123, v123
    v_exp_f32 v124, v124
    v_smfmac_f32_32x32x32_bf16 v[48:63], a[152:155], v[104:111], v94
    v_exp_f32 v125, v125
    v_exp_f32 v126, v126
    v_exp_f32 v127, v127
    v_exp_f32 v128, v128
    v_mfma_f32_32x32x16_bf16 v[96:111], a[180:183], v[24:27], 0
    s_waitcnt lgkmcnt(0)
    global_store_dwordx4 v253, v[176:179], s[36:37] sc1
    v_exp_f32 v129, v129
    v_exp_f32 v130, v130
    v_exp_f32 v131, v131
    v_exp_f32 v132, v132
    v_mfma_f32_32x32x8bf16_1k v[96:111], a[206:207], v[30:31], v[96:111]
    v_exp_f32 v133, v133
    v_exp_f32 v134, v134
    v_exp_f32 v135, v135
    v_exp_f32 v136, v136
    v_smfmac_f32_32x32x32_bf16 v[48:63], a[160:163], v[112:119], v94
    ds_read_b64_tr_b16 v[180:181], v245 offset:0
    v_exp_f32 v137, v137
    v_exp_f32 v138, v138
    v_exp_f32 v139, v139
    v_exp_f32 v140, v140
    v_smfmac_f32_32x32x32_bf16 v[48:63], a[164:167], v[120:127], v94
    ds_read_b64_tr_b16 v[182:183], v245 offset:256
    v_xor_b32 v252, s89, v12
    v_exp_f32 v141, v141
    v_exp_f32 v142, v142
    v_exp_f32 v143, v143
    v_exp_f32 v96, v96
    v_mfma_f32_32x32x16_bf16 v[112:127], a[0:3], v[16:19], 0
    global_store_dwordx4 v2, v[236:239], s[58:59] offset:0 sc1
    v_exp_f32 v97, v97
    v_exp_f32 v98, v98
    v_exp_f32 v99, v99
    v_exp_f32 v100, v100
    v_mfma_f32_32x32x8bf16_1k v[112:127], a[192:193], v[20:21], v[112:127]
    v_exp_f32 v101, v101
    v_exp_f32 v102, v102
    v_exp_f32 v103, v103
    v_exp_f32 v104, v104
    v_smfmac_f32_32x32x32_bf16 v[48:63], a[172:175], v[128:135], v94
    v_exp_f32 v105, v105
    v_exp_f32 v106, v106
    v_exp_f32 v107, v107
    v_exp_f32 v108, v108
    v_smfmac_f32_32x32x32_bf16 v[48:63], a[176:179], v[136:143], v94
    v_exp_f32 v109, v109
    v_exp_f32 v110, v110
    v_exp_f32 v111, v111
    v_exp_f32 v112, v112
    v_mfma_f32_32x32x16_bf16 v[128:143], a[12:15], v[16:19], 0
    ds_read_b128 v[24:27], v248 offset:25600
    v_exp_f32 v113, v113
    v_exp_f32 v114, v114
    v_exp_f32 v115, v115
    v_exp_f32 v116, v116
    v_mfma_f32_32x32x8bf16_1k v[128:143], a[192:193], v[22:23], v[128:143]
    v_exp_f32 v117, v117
    v_exp_f32 v118, v118
    v_exp_f32 v119, v119
    v_exp_f32 v120, v120
    v_smfmac_f32_32x32x32_bf16 v[48:63], a[184:187], v[96:103], v94
    ds_read_b32 v28, v248 offset:26628
    v_exp_f32 v121, v121
    v_exp_f32 v122, v122
    v_exp_f32 v123, v123
    v_exp_f32 v124, v124
    v_smfmac_f32_32x32x32_bf16 v[48:63], a[188:191], v[104:111], v94
    ds_read_b32 v31, v248 offset:26628
    v_exp_f32 v125, v125
    v_exp_f32 v126, v126
    v_exp_f32 v127, v127
    v_exp_f32 v128, v128
    v_mfma_f32_32x32x16_bf16 v[96:111], a[24:27], v[16:19], 0
    s_waitcnt lgkmcnt(3)
    global_store_dwordx4 v252, v[180:183], s[36:37] sc1
    v_exp_f32 v129, v129
    v_exp_f32 v130, v130
    v_exp_f32 v131, v131
    v_exp_f32 v132, v132
    v_mfma_f32_32x32x8bf16_1k v[96:111], a[194:195], v[20:21], v[96:111]
    v_exp_f32 v133, v133
    v_exp_f32 v134, v134
    v_exp_f32 v135, v135
    v_exp_f32 v136, v136
    v_smfmac_f32_32x32x32_bf16 v[32:47], a[4:7], v[112:119], v94
    ds_read_b64_tr_b16 v[184:185], v245 offset:1024
    v_exp_f32 v137, v137
    v_exp_f32 v138, v138
    v_exp_f32 v139, v139
    v_exp_f32 v140, v140
    v_smfmac_f32_32x32x32_bf16 v[32:47], a[8:11], v[120:127], v94
    ds_read_b64_tr_b16 v[186:187], v245 offset:1280
    v_xor_b32 v253, s90, v12
    v_exp_f32 v141, v141
    v_exp_f32 v142, v142
    v_exp_f32 v143, v143
    v_exp_f32 v96, v96
    v_mfma_f32_32x32x16_bf16 v[112:127], a[36:39], v[16:19], 0
    ds_write_b128 v246, v[48:51] offset:12288
    v_exp_f32 v97, v97
    v_exp_f32 v98, v98
    v_exp_f32 v99, v99
    v_exp_f32 v100, v100
    v_mfma_f32_32x32x8bf16_1k v[112:127], a[194:195], v[22:23], v[112:127]
    v_exp_f32 v101, v101
    v_exp_f32 v102, v102
    v_exp_f32 v103, v103
    v_exp_f32 v104, v104
    v_smfmac_f32_32x32x32_bf16 v[32:47], a[16:19], v[128:135], v94
    s_waitcnt lgkmcnt(1)
    global_store_dwordx4 v253, v[184:187], s[36:37] sc1
    v_exp_f32 v105, v105
    v_exp_f32 v106, v106
    v_exp_f32 v107, v107
    v_exp_f32 v108, v108
    v_smfmac_f32_32x32x32_bf16 v[32:47], a[20:23], v[136:143], v94
    v_exp_f32 v109, v109
    v_exp_f32 v110, v110
    v_exp_f32 v111, v111
    v_exp_f32 v112, v112
    v_mfma_f32_32x32x16_bf16 v[128:143], a[48:51], v[16:19], 0
    ds_write_b128 v246, v[52:55] offset:13312
    v_exp_f32 v113, v113
    v_exp_f32 v114, v114
    v_exp_f32 v115, v115
    v_exp_f32 v116, v116
    v_mfma_f32_32x32x8bf16_1k v[128:143], a[196:197], v[20:21], v[128:143]
    v_exp_f32 v117, v117
    v_exp_f32 v118, v118
    v_exp_f32 v119, v119
    v_exp_f32 v120, v120
    v_smfmac_f32_32x32x32_bf16 v[32:47], a[28:31], v[96:103], v94
    global_store_dwordx4 v2, v[236:239], s[56:57] offset:-4096 sc1
    v_exp_f32 v121, v121
    v_exp_f32 v122, v122
    v_exp_f32 v123, v123
    v_exp_f32 v124, v124
    v_smfmac_f32_32x32x32_bf16 v[32:47], a[32:35], v[104:111], v94
    v_exp_f32 v125, v125
    v_exp_f32 v126, v126
    v_exp_f32 v127, v127
    v_exp_f32 v128, v128
    v_mfma_f32_32x32x16_bf16 v[96:111], a[60:63], v[16:19], 0
    ds_write_b128 v246, v[56:59] offset:14336
    v_exp_f32 v129, v129
    v_exp_f32 v130, v130
    v_exp_f32 v131, v131
    v_exp_f32 v132, v132
    v_mfma_f32_32x32x8bf16_1k v[96:111], a[196:197], v[22:23], v[96:111]
    v_exp_f32 v133, v133
    v_exp_f32 v134, v134
    v_exp_f32 v135, v135
    v_exp_f32 v136, v136
    v_smfmac_f32_32x32x32_bf16 v[32:47], a[40:43], v[112:119], v94
    s_and_b32 s86, s16, 1
    v_exp_f32 v137, v137
    v_exp_f32 v138, v138
    v_exp_f32 v139, v139
    v_exp_f32 v140, v140
    v_smfmac_f32_32x32x32_bf16 v[32:47], a[44:47], v[120:127], v94
    s_mul_i32 s90, s86, 28672
    v_exp_f32 v141, v141
    v_exp_f32 v142, v142
    v_exp_f32 v143, v143
    v_exp_f32 v96, v96
    v_mfma_f32_32x32x16_bf16 v[112:127], a[72:75], v[16:19], 0
    global_store_dwordx4 v2, v[236:239], s[56:57] offset:-3072 sc1
    v_exp_f32 v97, v97
    v_exp_f32 v98, v98
    v_exp_f32 v99, v99
    v_exp_f32 v100, v100
    v_mfma_f32_32x32x8bf16_1k v[112:127], a[198:199], v[20:21], v[112:127]
    v_exp_f32 v101, v101
    v_exp_f32 v102, v102
    v_exp_f32 v103, v103
    v_exp_f32 v104, v104
    v_smfmac_f32_32x32x32_bf16 v[32:47], a[52:55], v[128:135], v94
    s_sub_u32 s90, 65536, s90
    v_exp_f32 v105, v105
    v_exp_f32 v106, v106
    v_exp_f32 v107, v107
    v_exp_f32 v108, v108
    v_smfmac_f32_32x32x32_bf16 v[32:47], a[56:59], v[136:143], v94
    s_mul_i32 s97, s86, 14
    v_exp_f32 v109, v109
    v_exp_f32 v110, v110
    v_exp_f32 v111, v111
    v_exp_f32 v112, v112
    v_mfma_f32_32x32x16_bf16 v[128:143], a[84:87], v[16:19], 0
    s_sub_u32 s97, 17, s97
    v_exp_f32 v113, v113
    v_exp_f32 v114, v114
    v_exp_f32 v115, v115
    v_exp_f32 v116, v116
    v_mfma_f32_32x32x8bf16_1k v[128:143], a[198:199], v[22:23], v[128:143]
    v_exp_f32 v117, v117
    v_exp_f32 v118, v118
    v_exp_f32 v119, v119
    v_exp_f32 v120, v120
    v_smfmac_f32_32x32x32_bf16 v[32:47], a[64:67], v[96:103], v94
    s_add_u32 s91, s19, 17825792
    v_exp_f32 v121, v121
    v_exp_f32 v122, v122
    v_exp_f32 v123, v123
    v_exp_f32 v124, v124
    v_smfmac_f32_32x32x32_bf16 v[32:47], a[68:71], v[104:111], v94
    s_lshl_b32 s92, s86, 11
    v_exp_f32 v125, v125
    v_exp_f32 v126, v126
    v_exp_f32 v127, v127
    v_exp_f32 v128, v128
    v_mfma_f32_32x32x16_bf16 v[96:111], a[96:99], v[16:19], 0
    global_store_dwordx4 v2, v[236:239], s[56:57] offset:-2048 sc1
    v_exp_f32 v129, v129
    v_exp_f32 v130, v130
    v_exp_f32 v131, v131
    v_exp_f32 v132, v132
    v_mfma_f32_32x32x8bf16_1k v[96:111], a[200:201], v[20:21], v[96:111]
    v_exp_f32 v133, v133
    v_exp_f32 v134, v134
    v_exp_f32 v135, v135
    v_exp_f32 v136, v136
    v_smfmac_f32_32x32x32_bf16 v[32:47], a[76:79], v[112:119], v94
    s_add_u32 s89, s91, s92
    v_exp_f32 v137, v137
    v_exp_f32 v138, v138
    v_exp_f32 v139, v139
    v_exp_f32 v140, v140
    v_smfmac_f32_32x32x32_bf16 v[32:47], a[80:83], v[120:127], v94
    s_add_u32 s89, s89, 32768
    v_exp_f32 v141, v141
    v_exp_f32 v142, v142
    v_exp_f32 v143, v143
    v_exp_f32 v96, v96
    v_mfma_f32_32x32x16_bf16 v[112:127], a[108:111], v[16:19], 0
    s_lshl_b32 s87, s86, 14
    v_exp_f32 v97, v97
    v_exp_f32 v98, v98
    v_exp_f32 v99, v99
    v_exp_f32 v100, v100
    v_mfma_f32_32x32x8bf16_1k v[112:127], a[200:201], v[22:23], v[112:127]
    v_exp_f32 v101, v101
    v_exp_f32 v102, v102
    v_exp_f32 v103, v103
    v_exp_f32 v104, v104
    v_smfmac_f32_32x32x32_bf16 v[32:47], a[88:91], v[128:135], v94
    s_add_u32 s87, s87, s91
    v_exp_f32 v105, v105
    v_exp_f32 v106, v106
    v_exp_f32 v107, v107
    v_exp_f32 v108, v108
    v_smfmac_f32_32x32x32_bf16 v[32:47], a[92:95], v[136:143], v94
    s_add_u32 s88, s87, 4096
    v_exp_f32 v109, v109
    v_exp_f32 v110, v110
    v_exp_f32 v111, v111
    v_exp_f32 v112, v112
    v_mfma_f32_32x32x16_bf16 v[128:143], a[120:123], v[16:19], 0
    global_store_dwordx4 v2, v[236:239], s[56:57] offset:-1024 sc1
    v_exp_f32 v113, v113
    v_exp_f32 v114, v114
    v_exp_f32 v115, v115
    v_exp_f32 v116, v116
    v_mfma_f32_32x32x8bf16_1k v[128:143], a[202:203], v[20:21], v[128:143]
    v_exp_f32 v117, v117
    v_exp_f32 v118, v118
    v_exp_f32 v119, v119
    v_exp_f32 v120, v120
    v_smfmac_f32_32x32x32_bf16 v[32:47], a[100:103], v[96:103], v94
    s_add_u32 s91, s16, 1
    v_exp_f32 v121, v121
    v_exp_f32 v122, v122
    v_exp_f32 v123, v123
    v_exp_f32 v124, v124
    v_smfmac_f32_32x32x32_bf16 v[32:47], a[104:107], v[104:111], v94
    s_xor_b32 s92, s91, s15
    v_exp_f32 v125, v125
    v_exp_f32 v126, v126
    v_exp_f32 v127, v127
    v_exp_f32 v128, v128
    v_mfma_f32_32x32x16_bf16 v[96:111], a[132:135], v[16:19], 0
    s_and_b32 s92, s92, 1
    v_exp_f32 v129, v129
    v_exp_f32 v130, v130
    v_exp_f32 v131, v131
    v_exp_f32 v132, v132
    v_mfma_f32_32x32x8bf16_1k v[96:111], a[202:203], v[22:23], v[96:111]
    v_exp_f32 v133, v133
    v_exp_f32 v134, v134
    v_exp_f32 v135, v135
    v_exp_f32 v136, v136
    v_smfmac_f32_32x32x32_bf16 v[32:47], a[112:115], v[112:119], v94
    s_lshl1_add_u32 s92, s14, s92
    v_exp_f32 v137, v137
    v_exp_f32 v138, v138
    v_exp_f32 v139, v139
    v_exp_f32 v140, v140
    v_smfmac_f32_32x32x32_bf16 v[32:47], a[116:119], v[120:127], v94
    s_mul_i32 s92, s92, 36864
    v_exp_f32 v141, v141
    v_exp_f32 v142, v142
    v_exp_f32 v143, v143
    v_exp_f32 v96, v96
    v_mfma_f32_32x32x16_bf16 v[112:127], a[144:147], v[16:19], 0
    global_store_dwordx4 v2, v[236:239], s[56:57] offset:0 sc1
    v_exp_f32 v97, v97
    v_exp_f32 v98, v98
    v_exp_f32 v99, v99
    v_exp_f32 v100, v100
    v_mfma_f32_32x32x8bf16_1k v[112:127], a[204:205], v[20:21], v[112:127]
    v_exp_f32 v101, v101
    v_exp_f32 v102, v102
    v_exp_f32 v103, v103
    v_exp_f32 v104, v104
    v_smfmac_f32_32x32x32_bf16 v[32:47], a[124:127], v[128:135], v94
    s_add_u32 s92, s92, 17825792
    v_exp_f32 v105, v105
    v_exp_f32 v106, v106
    v_exp_f32 v107, v107
    v_exp_f32 v108, v108
    v_smfmac_f32_32x32x32_bf16 v[32:47], a[128:131], v[136:143], v94
    s_and_b32 s91, s91, 2
    v_exp_f32 v109, v109
    v_exp_f32 v110, v110
    v_exp_f32 v111, v111
    s_waitcnt vmcnt(5)
    s_waitcnt lgkmcnt(0)
    s_barrier
    s_mov_b64 exec, 1
    buffer_store_dword v236, off, s[36:39], s20 offset:16 sc1
    s_mov_b64 exec, -1
    v_exp_f32 v112, v112
    v_mfma_f32_32x32x16_bf16 v[128:143], a[156:159], v[16:19], 0
    ds_read_b128 v[48:51], v247 offset:12288
    v_exp_f32 v113, v113
    v_exp_f32 v114, v114
    v_exp_f32 v115, v115
    v_exp_f32 v116, v116
    v_mfma_f32_32x32x8bf16_1k v[128:143], a[204:205], v[22:23], v[128:143]
    v_exp_f32 v117, v117
    v_exp_f32 v118, v118
    v_exp_f32 v119, v119
    v_exp_f32 v120, v120
    v_smfmac_f32_32x32x32_bf16 v[32:47], a[136:139], v[96:103], v94
    ds_read_b128 v[52:55], v247 offset:13312
    v_exp_f32 v121, v121
    v_exp_f32 v122, v122
    v_exp_f32 v123, v123
    v_exp_f32 v124, v124
    v_smfmac_f32_32x32x32_bf16 v[32:47], a[140:143], v[104:111], v94
    ds_read_b128 v[56:59], v247 offset:14336
    v_exp_f32 v125, v125
    v_exp_f32 v126, v126
    v_exp_f32 v127, v127
    v_exp_f32 v128, v128
    v_mfma_f32_32x32x16_bf16 v[96:111], a[168:171], v[16:19], 0
    global_store_dwordx4 v2, v[236:239], s[56:57] offset:1024 sc1
    v_exp_f32 v129, v129
    v_exp_f32 v130, v130
    v_exp_f32 v131, v131
    v_exp_f32 v132, v132
    v_mfma_f32_32x32x8bf16_1k v[96:111], a[206:207], v[20:21], v[96:111]
    v_exp_f32 v133, v133
    v_exp_f32 v134, v134
    v_exp_f32 v135, v135
    v_exp_f32 v136, v136
    v_smfmac_f32_32x32x32_bf16 v[32:47], a[148:151], v[112:119], v94
    s_lshl2_add_u32 s93, s15, s91
    v_exp_f32 v137, v137
    v_exp_f32 v138, v138
    v_exp_f32 v139, v139
    v_exp_f32 v140, v140
    v_smfmac_f32_32x32x32_bf16 v[32:47], a[152:155], v[120:127], v94
    s_lshl_b32 s93, s93, 10
    v_exp_f32 v141, v141
    v_exp_f32 v142, v142
    v_exp_f32 v143, v143
    v_exp_f32 v96, v96
    v_mfma_f32_32x32x16_bf16 v[112:127], a[180:183], v[16:19], 0
    global_store_dwordx4 v2, v[236:239], s[56:57] offset:2048 sc1
    v_exp_f32 v97, v97
    v_exp_f32 v98, v98
    v_exp_f32 v99, v99
    v_exp_f32 v100, v100
    v_mfma_f32_32x32x8bf16_1k v[112:127], a[206:207], v[22:23], v[112:127]
    v_exp_f32 v101, v101
    v_exp_f32 v102, v102
    v_exp_f32 v103, v103
    v_exp_f32 v104, v104
    v_smfmac_f32_32x32x32_bf16 v[32:47], a[160:163], v[128:135], v94
    s_add_u32 s93, s93, s92
    v_exp_f32 v105, v105
    v_exp_f32 v106, v106
    v_exp_f32 v107, v107
    v_exp_f32 v108, v108
    v_smfmac_f32_32x32x32_bf16 v[32:47], a[164:167], v[136:143], v94
    s_lshl_b32 s94, s15, 9
    v_exp_f32 v109, v109
    v_exp_f32 v110, v110
    v_exp_f32 v111, v111
    v_exp_f32 v112, v112
    v_mfma_f32_32x32x16_bf16 v[128:143], a[0:3], v[24:27], 0
    global_store_dwordx4 v2, v[236:239], s[56:57] offset:3072 sc1
    v_exp_f32 v113, v113
    v_exp_f32 v114, v114
    v_exp_f32 v115, v115
    v_exp_f32 v116, v116
    v_mfma_f32_32x32x8bf16_1k v[128:143], a[192:193], v[28:29], v[128:143]
    v_exp_f32 v117, v117
    v_exp_f32 v118, v118
    v_exp_f32 v119, v119
    v_exp_f32 v120, v120
    v_smfmac_f32_32x32x32_bf16 v[32:47], a[172:175], v[96:103], v94
    s_add_u32 s56, s56, 8192
    v_exp_f32 v121, v121
    v_exp_f32 v122, v122
    v_exp_f32 v123, v123
    v_exp_f32 v124, v124
    v_smfmac_f32_32x32x32_bf16 v[32:47], a[176:179], v[104:111], v94
    s_addc_u32 s57, s57, 0
    v_exp_f32 v125, v125
    v_exp_f32 v126, v126
    v_exp_f32 v127, v127
    v_exp_f32 v128, v128
    v_mfma_f32_32x32x16_bf16 v[96:111], a[12:15], v[24:27], 0
    ds_read_b128 v[16:19], v249 offset:24576
    v_exp_f32 v129, v129
    v_exp_f32 v130, v130
    v_exp_f32 v131, v131
    v_exp_f32 v132, v132
    v_mfma_f32_32x32x8bf16_1k v[96:111], a[192:193], v[30:31], v[96:111]
    v_exp_f32 v133, v133
    v_exp_f32 v134, v134
    v_exp_f32 v135, v135
    v_exp_f32 v136, v136
    v_smfmac_f32_32x32x32_bf16 v[32:47], a[184:187], v[112:119], v94
    ds_read_b32 v20, v249 offset:26624
    v_exp_f32 v137, v137
    v_exp_f32 v138, v138
    v_exp_f32 v139, v139
    v_exp_f32 v140, v140
    v_smfmac_f32_32x32x32_bf16 v[32:47], a[188:191], v[120:127], v94
    ds_read_b32 v23, v249 offset:26624
    v_exp_f32 v141, v141
    v_exp_f32 v142, v142
    v_exp_f32 v143, v143
    v_exp_f32 v96, v96
    v_mfma_f32_32x32x16_bf16 v[112:127], a[24:27], v[24:27], 0
    global_store_dwordx4 v2, v[236:239], s[56:57] offset:-4096 sc1
    v_exp_f32 v97, v97
    v_exp_f32 v98, v98
    v_exp_f32 v99, v99
    v_exp_f32 v100, v100
    v_mfma_f32_32x32x8bf16_1k v[112:127], a[194:195], v[28:29], v[112:127]
    v_exp_f32 v101, v101
    v_exp_f32 v102, v102
    v_exp_f32 v103, v103
    v_exp_f32 v104, v104
    s_waitcnt lgkmcnt(3)
    v_smfmac_f32_32x32x32_bf16 v[48:63], a[4:7], v[128:135], v94
    s_lshl2_add_u32 s94, s91, s94
    v_exp_f32 v105, v105
    v_exp_f32 v106, v106
    v_exp_f32 v107, v107
    v_exp_f32 v108, v108
    v_smfmac_f32_32x32x32_bf16 v[48:63], a[8:11], v[136:143], v94
wb_pad2:
    s_cbranch_execz wb_pad6
    s_add_u32 s94, s94, s92
    v_exp_f32 v109, v109
    v_exp_f32 v110, v110
    v_exp_f32 v111, v111
    v_exp_f32 v112, v112
    v_mfma_f32_32x32x16_bf16 v[128:143], a[36:39], v[24:27], 0
    ds_write_b128 v246, v[32:35] offset:0
    v_exp_f32 v113, v113
    v_exp_f32 v114, v114
    v_exp_f32 v115, v115
    v_exp_f32 v116, v116
    v_mfma_f32_32x32x8bf16_1k v[128:143], a[194:195], v[30:31], v[128:143]
    v_exp_f32 v117, v117
    v_exp_f32 v118, v118
    v_exp_f32 v119, v119
    v_exp_f32 v120, v120
    v_smfmac_f32_32x32x32_bf16 v[48:63], a[16:19], v[96:103], v94
    s_add_u32 s94, s94, 32768
    v_exp_f32 v121, v121
    v_exp_f32 v122, v122
    v_exp_f32 v123, v123
    v_exp_f32 v124, v124
    v_smfmac_f32_32x32x32_bf16 v[48:63], a[20:23], v[104:111], v94
    s_mov_b32 s83, 0x40000
    v_exp_f32 v125, v125
    v_exp_f32 v126, v126
    v_exp_f32 v127, v127
    v_exp_f32 v128, v128
    v_mfma_f32_32x32x16_bf16 v[96:111], a[48:51], v[24:27], 0
    ds_write_b128 v246, v[36:39] offset:1024
    v_exp_f32 v129, v129
    v_exp_f32 v130, v130
    v_exp_f32 v131, v131
    v_exp_f32 v132, v132
    v_mfma_f32_32x32x8bf16_1k v[96:111], a[196:197], v[28:29], v[96:111]
    v_exp_f32 v133, v133
    v_exp_f32 v134, v134
    v_exp_f32 v135, v135
    v_exp_f32 v136, v136
    v_smfmac_f32_32x32x32_bf16 v[48:63], a[28:31], v[112:119], v94
    global_store_dwordx4 v2, v[236:239], s[56:57] offset:-3072 sc1
    v_exp_f32 v137, v137
    v_exp_f32 v138, v138
    v_exp_f32 v139, v139
    v_exp_f32 v140, v140
    v_smfmac_f32_32x32x32_bf16 v[48:63], a[32:35], v[120:127], v94
    v_exp_f32 v141, v141
    v_exp_f32 v142, v142
    v_exp_f32 v143, v143
    v_exp_f32 v96, v96
    v_mfma_f32_32x32x16_bf16 v[112:127], a[60:63], v[24:27], 0
    ds_write_b128 v246, v[40:43] offset:2048
    v_exp_f32 v97, v97
    v_exp_f32 v98, v98
    v_exp_f32 v99, v99
    v_exp_f32 v100, v100
    v_mfma_f32_32x32x8bf16_1k v[112:127], a[196:197], v[30:31], v[112:127]
    v_exp_f32 v101, v101
    v_exp_f32 v102, v102
    v_exp_f32 v103, v103
    v_exp_f32 v104, v104
    v_smfmac_f32_32x32x32_bf16 v[48:63], a[40:43], v[128:135], v94
    global_store_dwordx4 v2, v[236:239], s[56:57] offset:-2048 sc1
    v_exp_f32 v105, v105
    v_exp_f32 v106, v106
    v_exp_f32 v107, v107
    v_exp_f32 v108, v108
    v_smfmac_f32_32x32x32_bf16 v[48:63], a[44:47], v[136:143], v94
    v_exp_f32 v109, v109
    v_exp_f32 v110, v110
    v_exp_f32 v111, v111
    v_exp_f32 v112, v112
    v_mfma_f32_32x32x16_bf16 v[128:143], a[72:75], v[24:27], 0
    global_store_dwordx4 v2, v[236:239], s[56:57] offset:-1024 sc1
    v_exp_f32 v113, v113
    v_exp_f32 v114, v114
    v_exp_f32 v115, v115
    v_exp_f32 v116, v116
    v_mfma_f32_32x32x8bf16_1k v[128:143], a[198:199], v[28:29], v[128:143]
    v_exp_f32 v117, v117
    v_exp_f32 v118, v118
    v_exp_f32 v119, v119
    v_exp_f32 v120, v120
    v_smfmac_f32_32x32x32_bf16 v[48:63], a[52:55], v[96:103], v94
    s_add_u32 s64, s36, s93
    v_exp_f32 v121, v121
    v_exp_f32 v122, v122
    v_exp_f32 v123, v123
    v_exp_f32 v124, v124
    v_smfmac_f32_32x32x32_bf16 v[48:63], a[56:59], v[104:111], v94
    s_addc_u32 s65, s37, 0
    v_exp_f32 v125, v125
    v_exp_f32 v126, v126
    v_exp_f32 v127, v127
    s_waitcnt lgkmcnt(0)
    s_barrier
    v_exp_f32 v128, v128
    v_mfma_f32_32x32x16_bf16 v[96:111], a[84:87], v[24:27], 0
    ds_read_b128 v[32:35], v247 offset:0
    v_exp_f32 v129, v129
    v_exp_f32 v130, v130
    v_exp_f32 v131, v131
    v_exp_f32 v132, v132
    v_mfma_f32_32x32x8bf16_1k v[96:111], a[198:199], v[30:31], v[96:111]
    v_exp_f32 v133, v133
    v_exp_f32 v134, v134
    v_exp_f32 v135, v135
    v_exp_f32 v136, v136
    v_smfmac_f32_32x32x32_bf16 v[48:63], a[64:67], v[112:119], v94
    ds_read_b128 v[36:39], v247 offset:1024
    v_exp_f32 v137, v137
    v_exp_f32 v138, v138
    v_exp_f32 v139, v139
    v_exp_f32 v140, v140
    v_smfmac_f32_32x32x32_bf16 v[48:63], a[68:71], v[120:127], v94
    ds_read_b128 v[40:43], v247 offset:2048
    v_exp_f32 v141, v141
    v_exp_f32 v142, v142
    v_exp_f32 v143, v143
    v_exp_f32 v96, v96
    v_mfma_f32_32x32x16_bf16 v[112:127], a[96:99], v[24:27], 0
    global_store_dwordx4 v2, v[236:239], s[56:57] offset:0 sc1
    v_exp_f32 v97, v97
    v_exp_f32 v98, v98
    v_exp_f32 v99, v99
    v_exp_f32 v100, v100
    v_mfma_f32_32x32x8bf16_1k v[112:127], a[200:201], v[28:29], v[112:127]
    v_exp_f32 v101, v101
    v_exp_f32 v102, v102
    v_exp_f32 v103, v103
    v_exp_f32 v104, v104
    v_smfmac_f32_32x32x32_bf16 v[48:63], a[76:79], v[128:135], v94
    s_add_u32 s66, s36, s94
    v_exp_f32 v105, v105
    v_exp_f32 v106, v106
    v_exp_f32 v107, v107
    v_exp_f32 v108, v108
    v_smfmac_f32_32x32x32_bf16 v[48:63], a[80:83], v[136:143], v94
    s_addc_u32 s67, s37, 0
    v_exp_f32 v109, v109
    v_exp_f32 v110, v110
    v_exp_f32 v111, v111
    v_exp_f32 v112, v112
    v_mfma_f32_32x32x16_bf16 v[128:143], a[108:111], v[24:27], 0
    global_store_dwordx4 v2, v[236:239], s[56:57] offset:1024 sc1
    v_exp_f32 v113, v113
    v_exp_f32 v114, v114
    v_exp_f32 v115, v115
    v_exp_f32 v116, v116
    v_mfma_f32_32x32x8bf16_1k v[128:143], a[200:201], v[30:31], v[128:143]
    v_exp_f32 v117, v117
    v_exp_f32 v118, v118
    v_exp_f32 v119, v119
    v_exp_f32 v120, v120
    v_smfmac_f32_32x32x32_bf16 v[48:63], a[88:91], v[96:103], v94
    s_add_u32 s24, s98, 32768
    v_exp_f32 v121, v121
    v_exp_f32 v122, v122
    v_exp_f32 v123, v123
    v_exp_f32 v124, v124
    v_smfmac_f32_32x32x32_bf16 v[48:63], a[92:95], v[104:111], v94
    s_addc_u32 s25, s99, 0
    v_exp_f32 v125, v125
    v_exp_f32 v126, v126
    v_exp_f32 v127, v127
    v_exp_f32 v128, v128
    v_mfma_f32_32x32x16_bf16 v[96:111], a[120:123], v[24:27], 0
    global_store_dwordx4 v2, v[236:239], s[56:57] offset:2048 sc1
    v_exp_f32 v129, v129
    v_exp_f32 v130, v130
    v_exp_f32 v131, v131
    v_exp_f32 v132, v132
    v_mfma_f32_32x32x8bf16_1k v[96:111], a[202:203], v[28:29], v[96:111]
    v_exp_f32 v133, v133
    v_exp_f32 v134, v134
    v_exp_f32 v135, v135
    v_exp_f32 v136, v136
    v_smfmac_f32_32x32x32_bf16 v[48:63], a[100:103], v[112:119], v94
    s_add_u32 s28, s98, 65536
    v_exp_f32 v137, v137
    v_exp_f32 v138, v138
    v_exp_f32 v139, v139
    v_exp_f32 v140, v140
    v_smfmac_f32_32x32x32_bf16 v[48:63], a[104:107], v[120:127], v94
    s_addc_u32 s29, s99, 0
    v_exp_f32 v141, v141
    v_exp_f32 v142, v142
    v_exp_f32 v143, v143
    v_exp_f32 v96, v96
    v_mfma_f32_32x32x16_bf16 v[112:127], a[132:135], v[24:27], 0
    s_add_u32 s17, s40, 4294843008
    v_exp_f32 v97, v97
    v_exp_f32 v98, v98
    v_exp_f32 v99, v99
    v_exp_f32 v100, v100
    v_mfma_f32_32x32x8bf16_1k v[112:127], a[202:203], v[30:31], v[112:127]
    v_exp_f32 v101, v101
    v_exp_f32 v102, v102
    v_exp_f32 v103, v103
    v_exp_f32 v104, v104
    v_smfmac_f32_32x32x32_bf16 v[48:63], a[112:115], v[128:135], v94
    s_add_u32 m0, s46, 147456
    v_exp_f32 v105, v105
    v_exp_f32 v106, v106
    v_exp_f32 v107, v107
    v_exp_f32 v108, v108
    v_smfmac_f32_32x32x32_bf16 v[48:63], a[116:119], v[136:143], v94
    buffer_load_dwordx4 v234, s[4:7], s17 offen lds
    v_exp_f32 v109, v109
    v_exp_f32 v110, v110
    v_exp_f32 v111, v111
    v_exp_f32 v112, v112
    v_mfma_f32_32x32x16_bf16 v[128:143], a[144:147], v[24:27], 0
    s_add_u32 s26, s98, 49152
    v_exp_f32 v113, v113
    v_exp_f32 v114, v114
    v_exp_f32 v115, v115
    v_exp_f32 v116, v116
    v_mfma_f32_32x32x8bf16_1k v[128:143], a[204:205], v[28:29], v[128:143]
    v_exp_f32 v117, v117
    v_exp_f32 v118, v118
    v_exp_f32 v119, v119
    v_exp_f32 v120, v120
    v_smfmac_f32_32x32x32_bf16 v[48:63], a[124:127], v[96:103], v94
    s_addc_u32 s27, s99, 0
    v_exp_f32 v121, v121
    v_exp_f32 v122, v122
    v_exp_f32 v123, v123
    v_exp_f32 v124, v124
    v_smfmac_f32_32x32x32_bf16 v[48:63], a[128:131], v[104:111], v94
    v_exp_f32 v125, v125
    v_exp_f32 v126, v126
    v_exp_f32 v127, v127
    v_exp_f32 v128, v128
    v_mfma_f32_32x32x16_bf16 v[96:111], a[156:159], v[24:27], 0
    s_add_u32 s30, s98, 81920
    v_exp_f32 v129, v129
    v_exp_f32 v130, v130
    v_exp_f32 v131, v131
    v_exp_f32 v132, v132
    v_mfma_f32_32x32x8bf16_1k v[96:111], a[204:205], v[30:31], v[96:111]
    v_exp_f32 v133, v133
    v_exp_f32 v134, v134
    v_exp_f32 v135, v135
    v_exp_f32 v136, v136
    v_smfmac_f32_32x32x32_bf16 v[48:63], a[136:139], v[112:119], v94
    s_addc_u32 s31, s99, 0
    v_exp_f32 v137, v137
    v_exp_f32 v138, v138
    v_exp_f32 v139, v139
    v_exp_f32 v140, v140
    v_smfmac_f32_32x32x32_bf16 v[48:63], a[140:143], v[120:127], v94
    v_exp_f32 v141, v141
    v_exp_f32 v142, v142
    v_exp_f32 v143, v143
    v_exp_f32 v96, v96
    v_mfma_f32_32x32x16_bf16 v[112:127], a[168:171], v[24:27], 0
    s_add_u32 s17, s40, 4294925952
    v_exp_f32 v97, v97
    v_exp_f32 v98, v98
    v_exp_f32 v99, v99
    v_exp_f32 v100, v100
    v_mfma_f32_32x32x8bf16_1k v[112:127], a[206:207], v[28:29], v[112:127]
    v_exp_f32 v101, v101
    v_exp_f32 v102, v102
    v_exp_f32 v103, v103
    v_exp_f32 v104, v104
    v_smfmac_f32_32x32x32_bf16 v[48:63], a[148:151], v[128:135], v94
    s_add_u32 m0, s46, 148480
    v_exp_f32 v105, v105
    v_exp_f32 v106, v106
    v_exp_f32 v107, v107
    v_exp_f32 v108, v108
    v_smfmac_f32_32x32x32_bf16 v[48:63], a[152:155], v[136:143], v94
    buffer_load_dwordx4 v234, s[4:7], s17 offen lds
    v_exp_f32 v109, v109
    v_exp_f32 v110, v110
    v_exp_f32 v111, v111
    v_exp_f32 v112, v112
    v_mfma_f32_32x32x16_bf16 v[128:143], a[180:183], v[24:27], 0
    s_add_u32 s50, s98, 98304
    v_exp_f32 v113, v113
    v_exp_f32 v114, v114
    v_exp_f32 v115, v115
    v_exp_f32 v116, v116
    v_mfma_f32_32x32x8bf16_1k v[128:143], a[206:207], v[30:31], v[128:143]
    v_exp_f32 v117, v117
    v_exp_f32 v118, v118
    v_exp_f32 v119, v119
    v_exp_f32 v120, v120
    v_smfmac_f32_32x32x32_bf16 v[48:63], a[160:163], v[96:103], v94
    s_addc_u32 s51, s99, 0
    v_exp_f32 v121, v121
    v_exp_f32 v122, v122
    v_exp_f32 v123, v123
    v_exp_f32 v124, v124
    v_smfmac_f32_32x32x32_bf16 v[48:63], a[164:167], v[104:111], v94
    v_exp_f32 v125, v125
    v_exp_f32 v126, v126
    v_exp_f32 v127, v127
    v_exp_f32 v128, v128
    v_mfma_f32_32x32x16_bf16 v[96:111], a[0:3], v[16:19], 0
    v_exp_f32 v129, v129
    v_exp_f32 v130, v130
    v_exp_f32 v131, v131
    v_exp_f32 v132, v132
    v_mfma_f32_32x32x8bf16_1k v[96:111], a[192:193], v[20:21], v[96:111]
    v_exp_f32 v133, v133
    v_exp_f32 v134, v134
    v_exp_f32 v135, v135
    v_exp_f32 v136, v136
    v_smfmac_f32_32x32x32_bf16 v[48:63], a[172:175], v[112:119], v94
    v_exp_f32 v137, v137
    v_exp_f32 v138, v138
    v_exp_f32 v139, v139
    v_exp_f32 v140, v140
    v_smfmac_f32_32x32x32_bf16 v[48:63], a[176:179], v[120:127], v94
    v_exp_f32 v141, v141
    v_exp_f32 v142, v142
    v_exp_f32 v143, v143
    v_exp_f32 v96, v96
    v_mfma_f32_32x32x16_bf16 v[112:127], a[12:15], v[16:19], 0
    ds_read_b128 v[24:27], v249 offset:25600
    v_exp_f32 v97, v97
    v_exp_f32 v98, v98
    v_exp_f32 v99, v99
    v_exp_f32 v100, v100
    v_mfma_f32_32x32x8bf16_1k v[112:127], a[192:193], v[22:23], v[112:127]
    v_exp_f32 v101, v101
    v_exp_f32 v102, v102
    v_exp_f32 v103, v103
    v_exp_f32 v104, v104
    v_smfmac_f32_32x32x32_bf16 v[48:63], a[184:187], v[128:135], v94
    ds_read_b32 v28, v249 offset:26628
    v_exp_f32 v105, v105
    v_exp_f32 v106, v106
    v_exp_f32 v107, v107
    v_exp_f32 v108, v108
    v_smfmac_f32_32x32x32_bf16 v[48:63], a[188:191], v[136:143], v94
    ds_read_b32 v31, v249 offset:26628
    v_exp_f32 v109, v109
    v_exp_f32 v110, v110
    v_exp_f32 v111, v111
    v_exp_f32 v112, v112
    v_mfma_f32_32x32x16_bf16 v[128:143], a[24:27], v[16:19], 0
    s_add_u32 s17, s47, 18560
    v_exp_f32 v113, v113
    v_exp_f32 v114, v114
    v_exp_f32 v115, v115
    v_exp_f32 v116, v116
    v_mfma_f32_32x32x8bf16_1k v[128:143], a[194:195], v[20:21], v[128:143]
    v_exp_f32 v117, v117
    v_exp_f32 v118, v118
    v_exp_f32 v119, v119
    v_exp_f32 v120, v120
    s_waitcnt lgkmcnt(3)
    v_smfmac_f32_32x32x32_bf16 v[32:47], a[4:7], v[96:103], v94
    s_mov_b32 m0, 155648
    v_exp_f32 v121, v121
    v_exp_f32 v122, v122
    v_exp_f32 v123, v123
    v_exp_f32 v124, v124
    v_smfmac_f32_32x32x32_bf16 v[32:47], a[8:11], v[104:111], v94
    buffer_load_dwordx4 v235, s[4:7], s17 offen lds
    v_exp_f32 v125, v125
    v_exp_f32 v126, v126
    v_exp_f32 v127, v127
    v_exp_f32 v128, v128
    v_mfma_f32_32x32x16_bf16 v[96:111], a[36:39], v[16:19], 0
    ds_write_b128 v246, v[48:51] offset:12288
    v_exp_f32 v129, v129
    v_exp_f32 v130, v130
    v_exp_f32 v131, v131
    v_exp_f32 v132, v132
    v_mfma_f32_32x32x8bf16_1k v[96:111], a[194:195], v[22:23], v[96:111]
    v_exp_f32 v133, v133
    v_exp_f32 v134, v134
    v_exp_f32 v135, v135
    v_exp_f32 v136, v136
    v_smfmac_f32_32x32x32_bf16 v[32:47], a[16:19], v[112:119], v94
    v_exp_f32 v137, v137
    v_exp_f32 v138, v138
    v_exp_f32 v139, v139
    v_exp_f32 v140, v140
    v_smfmac_f32_32x32x32_bf16 v[32:47], a[20:23], v[120:127], v94
    v_exp_f32 v141, v141
    v_exp_f32 v142, v142
    v_exp_f32 v143, v143
    v_exp_f32 v96, v96
    v_mfma_f32_32x32x16_bf16 v[112:127], a[48:51], v[16:19], 0
    ds_write_b128 v246, v[52:55] offset:13312
    v_exp_f32 v97, v97
    v_exp_f32 v98, v98
    v_exp_f32 v99, v99
    v_exp_f32 v100, v100
    v_mfma_f32_32x32x8bf16_1k v[112:127], a[196:197], v[20:21], v[112:127]
    v_exp_f32 v101, v101
    v_exp_f32 v102, v102
    v_exp_f32 v103, v103
    v_exp_f32 v104, v104
    v_smfmac_f32_32x32x32_bf16 v[32:47], a[28:31], v[128:135], v94
    v_exp_f32 v105, v105
    v_exp_f32 v106, v106
    v_exp_f32 v107, v107
    v_exp_f32 v108, v108
    v_smfmac_f32_32x32x32_bf16 v[32:47], a[32:35], v[136:143], v94
    v_exp_f32 v109, v109
    v_exp_f32 v110, v110
    v_exp_f32 v111, v111
    v_exp_f32 v112, v112
    v_mfma_f32_32x32x16_bf16 v[128:143], a[60:63], v[16:19], 0
    ds_write_b128 v246, v[56:59] offset:14336
    v_exp_f32 v113, v113
    v_exp_f32 v114, v114
    v_exp_f32 v115, v115
    v_exp_f32 v116, v116
    v_mfma_f32_32x32x8bf16_1k v[128:143], a[196:197], v[22:23], v[128:143]
    v_exp_f32 v117, v117
    v_exp_f32 v118, v118
    v_exp_f32 v119, v119
    v_exp_f32 v120, v120
    v_smfmac_f32_32x32x32_bf16 v[32:47], a[40:43], v[96:103], v94
    global_store_dwordx4 v2, v[236:239], s[56:57] offset:3072 sc1
    v_exp_f32 v121, v121
    v_exp_f32 v122, v122
    v_exp_f32 v123, v123
    v_exp_f32 v124, v124
    v_smfmac_f32_32x32x32_bf16 v[32:47], a[44:47], v[104:111], v94
    v_exp_f32 v125, v125
    v_exp_f32 v126, v126
    v_exp_f32 v127, v127
    v_exp_f32 v128, v128
    v_mfma_f32_32x32x16_bf16 v[96:111], a[72:75], v[16:19], 0
    v_lshlrev_b32 v240, 6, v1
    v_exp_f32 v129, v129
    v_exp_f32 v130, v130
    v_exp_f32 v131, v131
    v_exp_f32 v132, v132
    v_mfma_f32_32x32x8bf16_1k v[96:111], a[198:199], v[20:21], v[96:111]
    v_exp_f32 v133, v133
    v_exp_f32 v134, v134
    v_exp_f32 v135, v135
    v_exp_f32 v136, v136
    v_smfmac_f32_32x32x32_bf16 v[32:47], a[52:55], v[112:119], v94
    s_mov_b32 s17, 3375120
    v_exp_f32 v137, v137
    v_exp_f32 v138, v138
    v_exp_f32 v139, v139
    v_exp_f32 v140, v140
    v_smfmac_f32_32x32x32_bf16 v[32:47], a[56:59], v[120:127], v94
    buffer_load_dwordx4 v[240:243], v240, s[36:39], s17 offen sc1
    v_exp_f32 v141, v141
    v_exp_f32 v142, v142
    v_exp_f32 v143, v143
    s_waitcnt lgkmcnt(0)
    s_barrier
    v_exp_f32 v96, v96
    v_mfma_f32_32x32x16_bf16 v[112:127], a[84:87], v[16:19], 0
    ds_read_b128 v[48:51], v247 offset:12288
    v_exp_f32 v97, v97
    v_exp_f32 v98, v98
    v_exp_f32 v99, v99
    v_exp_f32 v100, v100
    v_mfma_f32_32x32x8bf16_1k v[112:127], a[198:199], v[22:23], v[112:127]
    v_exp_f32 v101, v101
    v_exp_f32 v102, v102
    v_exp_f32 v103, v103
    v_exp_f32 v104, v104
    v_smfmac_f32_32x32x32_bf16 v[32:47], a[64:67], v[128:135], v94
    ds_read_b128 v[52:55], v247 offset:13312
    v_exp_f32 v105, v105
    v_exp_f32 v106, v106
    v_exp_f32 v107, v107
    v_exp_f32 v108, v108
    v_smfmac_f32_32x32x32_bf16 v[32:47], a[68:71], v[136:143], v94
    ds_read_b128 v[56:59], v247 offset:14336
    v_exp_f32 v109, v109
    v_exp_f32 v110, v110
    v_exp_f32 v111, v111
    v_exp_f32 v112, v112
    v_mfma_f32_32x32x16_bf16 v[128:143], a[96:99], v[16:19], 0
    s_memrealtime s[68:69]
    v_exp_f32 v113, v113
    v_exp_f32 v114, v114
    v_exp_f32 v115, v115
    v_exp_f32 v116, v116
    v_mfma_f32_32x32x8bf16_1k v[128:143], a[200:201], v[20:21], v[128:143]
    v_exp_f32 v117, v117
    v_exp_f32 v118, v118
    v_exp_f32 v119, v119
    v_exp_f32 v120, v120
    v_smfmac_f32_32x32x32_bf16 v[32:47], a[76:79], v[96:103], v94
    s_add_u32 s56, s56, 8192
    v_exp_f32 v121, v121
    v_exp_f32 v122, v122
    v_exp_f32 v123, v123
    v_exp_f32 v124, v124
    v_smfmac_f32_32x32x32_bf16 v[32:47], a[80:83], v[104:111], v94
    s_addc_u32 s57, s57, 0
    v_exp_f32 v125, v125
    v_exp_f32 v126, v126
    v_exp_f32 v127, v127
    v_exp_f32 v128, v128
    v_mfma_f32_32x32x16_bf16 v[96:111], a[108:111], v[16:19], 0
    global_store_dwordx4 v2, v[236:239], s[56:57] offset:-4096 sc1
    v_exp_f32 v129, v129
    v_exp_f32 v130, v130
    v_exp_f32 v131, v131
    v_exp_f32 v132, v132
    v_mfma_f32_32x32x8bf16_1k v[96:111], a[200:201], v[22:23], v[96:111]
    v_exp_f32 v133, v133
    v_exp_f32 v134, v134
    v_exp_f32 v135, v135
    v_exp_f32 v136, v136
    v_smfmac_f32_32x32x32_bf16 v[32:47], a[88:91], v[112:119], v94
    v_exp_f32 v137, v137
    v_exp_f32 v138, v138
    v_exp_f32 v139, v139
    v_exp_f32 v140, v140
    v_smfmac_f32_32x32x32_bf16 v[32:47], a[92:95], v[120:127], v94
    v_exp_f32 v141, v141
    v_exp_f32 v142, v142
    v_exp_f32 v143, v143
    v_exp_f32 v96, v96
    v_mfma_f32_32x32x16_bf16 v[112:127], a[120:123], v[16:19], 0
    s_waitcnt lgkmcnt(0)
    v_exp_f32 v97, v97
    v_exp_f32 v98, v98
    v_exp_f32 v99, v99
    v_exp_f32 v100, v100
    v_mfma_f32_32x32x8bf16_1k v[112:127], a[202:203], v[20:21], v[112:127]
    v_exp_f32 v101, v101
    v_exp_f32 v102, v102
    v_exp_f32 v103, v103
    v_exp_f32 v104, v104
    v_smfmac_f32_32x32x32_bf16 v[32:47], a[100:103], v[128:135], v94
    v_mov_b32 v91, s68
    v_exp_f32 v105, v105
    v_exp_f32 v106, v106
    v_exp_f32 v107, v107
    v_exp_f32 v108, v108
    v_smfmac_f32_32x32x32_bf16 v[32:47], a[104:107], v[136:143], v94
    buffer_store_dword v91, v90, s[36:39], s43 offen sc1
    v_exp_f32 v109, v109
    v_exp_f32 v110, v110
    v_exp_f32 v111, v111
    s_waitcnt vmcnt(2)
k2_flchk:
    v_min3_u32 v240, v240, v241, v242
    v_min_u32 v240, v240, v243
    v_cmp_eq_u32 vcc, 0, v240
    s_cbranch_vccnz k2_flslow
k2_flok:
    v_exp_f32 v112, v112
    v_mfma_f32_32x32x16_bf16 v[128:143], a[132:135], v[16:19], 0
    global_store_dwordx4 v2, v[236:239], s[56:57] offset:-3072 sc1
    v_exp_f32 v113, v113
    v_exp_f32 v114, v114
    v_exp_f32 v115, v115
    v_exp_f32 v116, v116
    v_mfma_f32_32x32x8bf16_1k v[128:143], a[202:203], v[22:23], v[128:143]
    v_exp_f32 v117, v117
    v_exp_f32 v118, v118
    v_exp_f32 v119, v119
    v_exp_f32 v120, v120
    v_smfmac_f32_32x32x32_bf16 v[32:47], a[112:115], v[96:103], v94
    v_exp_f32 v121, v121
    v_exp_f32 v122, v122
    v_exp_f32 v123, v123
    v_exp_f32 v124, v124
    v_smfmac_f32_32x32x32_bf16 v[32:47], a[116:119], v[104:111], v94
    v_exp_f32 v125, v125
    v_exp_f32 v126, v126
    v_exp_f32 v127, v127
    v_exp_f32 v128, v128
    v_mfma_f32_32x32x16_bf16 v[96:111], a[144:147], v[16:19], 0
    v_and_b32 v250, 0x1f0, v2
    v_exp_f32 v129, v129
    v_exp_f32 v130, v130
    v_exp_f32 v131, v131
    v_exp_f32 v132, v132
    v_mfma_f32_32x32x8bf16_1k v[96:111], a[204:205], v[20:21], v[96:111]
    v_exp_f32 v133, v133
    v_exp_f32 v134, v134
    v_exp_f32 v135, v135
    v_exp_f32 v136, v136
    v_smfmac_f32_32x32x32_bf16 v[32:47], a[124:127], v[112:119], v94
    s_lshl_b32 s18, s16, 10
    v_exp_f32 v137, v137
    v_exp_f32 v138, v138
    v_exp_f32 v139, v139
    v_exp_f32 v140, v140
    v_smfmac_f32_32x32x32_bf16 v[32:47], a[128:131], v[120:127], v94
    s_add_u32 s17, s18, 3379200
    buffer_load_dwordx4 v[228:231], v2, s[36:39], s17 offen sc1
    v_exp_f32 v141, v141
    v_exp_f32 v142, v142
    v_exp_f32 v143, v143
    v_exp_f32 v96, v96
    v_mfma_f32_32x32x16_bf16 v[112:127], a[156:159], v[16:19], 0
    s_mov_b32 s17, 3383296
    v_exp_f32 v97, v97
    v_exp_f32 v98, v98
    v_exp_f32 v99, v99
    v_exp_f32 v100, v100
    v_mfma_f32_32x32x8bf16_1k v[112:127], a[204:205], v[22:23], v[112:127]
    v_exp_f32 v101, v101
    v_exp_f32 v102, v102
    v_exp_f32 v103, v103
    v_exp_f32 v104, v104
    v_smfmac_f32_32x32x32_bf16 v[32:47], a[136:139], v[128:135], v94
    buffer_load_dwordx4 v[232:235], v250, s[36:39], s17 offen sc1
    v_exp_f32 v105, v105
    v_exp_f32 v106, v106
    v_exp_f32 v107, v107
    v_exp_f32 v108, v108
    v_smfmac_f32_32x32x32_bf16 v[32:47], a[140:143], v[136:143], v94
    v_accvgpr_read_b32 v240, a255
    s_add_u32 s18, s18, 156672
    v_exp_f32 v109, v109
    v_exp_f32 v110, v110
    v_exp_f32 v111, v111
    v_exp_f32 v112, v112
    v_mfma_f32_32x32x16_bf16 v[128:143], a[168:171], v[16:19], 0
    buffer_load_dwordx4 v[216:219], v240, s[32:35], s49 offen
    v_exp_f32 v113, v113
    v_exp_f32 v114, v114
    v_exp_f32 v115, v115
    v_exp_f32 v116, v116
    v_mfma_f32_32x32x8bf16_1k v[128:143], a[206:207], v[20:21], v[128:143]
    v_exp_f32 v117, v117
    v_exp_f32 v118, v118
    v_exp_f32 v119, v119
    v_exp_f32 v120, v120
    v_smfmac_f32_32x32x32_bf16 v[32:47], a[148:151], v[96:103], v94
    buffer_load_dwordx4 v[220:223], v240, s[32:35], s49 offen offset:32
    v_exp_f32 v121, v121
    v_exp_f32 v122, v122
    v_exp_f32 v123, v123
    v_exp_f32 v124, v124
    v_smfmac_f32_32x32x32_bf16 v[32:47], a[152:155], v[104:111], v94
    buffer_load_dwordx4 v[224:227], v240, s[32:35], s48 offen offset:128
    v_add_u32 v251, s18, v2
    v_exp_f32 v125, v125
    v_exp_f32 v126, v126
    v_exp_f32 v127, v127
    v_exp_f32 v128, v128
    v_mfma_f32_32x32x16_bf16 v[96:111], a[180:183], v[16:19], 0
    global_load_dwordx4 v[208:211], v2, s[98:99] offset:-4096 sc1
    v_exp_f32 v129, v129
    v_exp_f32 v130, v130
    v_exp_f32 v131, v131
    v_exp_f32 v132, v132
    v_mfma_f32_32x32x8bf16_1k v[96:111], a[206:207], v[22:23], v[96:111]
    v_exp_f32 v133, v133
    v_exp_f32 v134, v134
    v_exp_f32 v135, v135
    v_exp_f32 v136, v136
    v_smfmac_f32_32x32x32_bf16 v[32:47], a[160:163], v[112:119], v94
    global_load_dwordx4 v[212:215], v2, s[98:99] offset:-3072 sc1
    v_exp_f32 v137, v137
    v_exp_f32 v138, v138
    v_exp_f32 v139, v139
    v_exp_f32 v140, v140
    v_smfmac_f32_32x32x32_bf16 v[32:47], a[164:167], v[120:127], v94
    v_exp_f32 v141, v141
    v_exp_f32 v142, v142
    v_exp_f32 v143, v143
    v_exp_f32 v96, v96
    v_mfma_f32_32x32x16_bf16 v[112:127], a[0:3], v[24:27], 0
    global_load_dwordx4 v[144:147], v2, s[24:25] offset:0 sc1
    v_exp_f32 v97, v97
    v_exp_f32 v98, v98
    v_exp_f32 v99, v99
    v_exp_f32 v100, v100
    v_mfma_f32_32x32x8bf16_1k v[112:127], a[192:193], v[28:29], v[112:127]
    v_exp_f32 v101, v101
    v_exp_f32 v102, v102
    v_exp_f32 v103, v103
    v_exp_f32 v104, v104
    v_smfmac_f32_32x32x32_bf16 v[32:47], a[172:175], v[128:135], v94
    global_load_dwordx4 v[148:151], v2, s[24:25] offset:1024 sc1
    v_exp_f32 v105, v105
    v_exp_f32 v106, v106
    v_exp_f32 v107, v107
    v_exp_f32 v108, v108
    v_smfmac_f32_32x32x32_bf16 v[32:47], a[176:179], v[136:143], v94
    v_exp_f32 v109, v109
    v_exp_f32 v110, v110
    v_exp_f32 v111, v111
    v_exp_f32 v112, v112
    v_mfma_f32_32x32x16_bf16 v[128:143], a[12:15], v[24:27], 0
    global_load_dwordx4 v[152:155], v2, s[98:99] offset:-2048 sc1
    v_exp_f32 v113, v113
    v_exp_f32 v114, v114
    v_exp_f32 v115, v115
    v_exp_f32 v116, v116
    v_mfma_f32_32x32x8bf16_1k v[128:143], a[192:193], v[30:31], v[128:143]
    v_exp_f32 v117, v117
    v_exp_f32 v118, v118
    v_exp_f32 v119, v119
    v_exp_f32 v120, v120
    v_smfmac_f32_32x32x32_bf16 v[32:47], a[184:187], v[96:103], v94
    global_load_dwordx4 v[156:159], v2, s[98:99] offset:-1024 sc1
    v_exp_f32 v121, v121
    v_exp_f32 v122, v122
    v_exp_f32 v123, v123
    v_exp_f32 v124, v124
    v_smfmac_f32_32x32x32_bf16 v[32:47], a[188:191], v[104:111], v94
    v_exp_f32 v125, v125
    v_exp_f32 v126, v126
    v_exp_f32 v127, v127
    v_exp_f32 v128, v128
    v_mfma_f32_32x32x16_bf16 v[96:111], a[24:27], v[24:27], 0
    global_load_dwordx4 v[160:163], v2, s[24:25] offset:2048 sc1
    v_exp_f32 v129, v129
    v_exp_f32 v130, v130
    v_exp_f32 v131, v131
    v_exp_f32 v132, v132
    v_mfma_f32_32x32x8bf16_1k v[96:111], a[194:195], v[28:29], v[96:111]
    v_exp_f32 v133, v133
    v_exp_f32 v134, v134
    v_exp_f32 v135, v135
    v_exp_f32 v136, v136
    s_waitcnt lgkmcnt(0)
    v_smfmac_f32_32x32x32_bf16 v[48:63], a[4:7], v[112:119], v94
    global_load_dwordx4 v[164:167], v2, s[24:25] offset:3072 sc1
    v_exp_f32 v137, v137
    v_exp_f32 v138, v138
    v_exp_f32 v139, v139
    v_exp_f32 v140, v140
    v_smfmac_f32_32x32x32_bf16 v[48:63], a[8:11], v[120:127], v94
    v_exp_f32 v141, v141
    v_exp_f32 v142, v142
    v_exp_f32 v143, v143
    v_rcp_f32 v42, v42
    v_accvgpr_read_b32 v237, a254
    v_mul_f32 v32, v32, v42
    v_mul_f32 v33, v33, v42
    v_mul_f32 v34, v34, v42
    v_mul_f32 v35, v35, v42
    v_mul_f32 v36, v36, v42
    v_mul_f32 v37, v37, v42
    v_mul_f32 v38, v38, v42
    v_mul_f32 v39, v39, v42
    v_mul_f32 v40, v40, v42
    v_mul_f32 v41, v41, v42
    v_cvt_pk_bf16_f32 v4, v32, v33
    v_cvt_pk_bf16_f32 v5, v34, v35
    v_cvt_pk_bf16_f32 v6, v36, v37
    v_cvt_pk_bf16_f32 v7, v38, v39
    v_cvt_pk_bf16_f32 v10, v40, v41
    v_min_u32 v4, -2, v4
    v_min_u32 v5, -2, v5
    v_min_u32 v6, -2, v6
    v_min_u32 v7, -2, v7
    v_min_u32 v10, -2, v10
    v_exp_f32 v96, v96
    v_mfma_f32_32x32x16_bf16 v[112:127], a[36:39], v[24:27], 0
    global_store_dwordx4 v2, v[4:7], s[64:65] offset:0 sc1
    v_exp_f32 v97, v97
    v_exp_f32 v98, v98
    v_exp_f32 v99, v99
    v_exp_f32 v100, v100
    v_mfma_f32_32x32x8bf16_1k v[112:127], a[194:195], v[30:31], v[112:127]
    v_exp_f32 v101, v101
    v_exp_f32 v102, v102
    v_exp_f32 v103, v103
    v_exp_f32 v104, v104
    v_smfmac_f32_32x32x32_bf16 v[48:63], a[16:19], v[128:135], v94
    global_load_dwordx4 v[168:171], v2, s[98:99] offset:0 sc1
    v_exp_f32 v105, v105
    v_exp_f32 v106, v106
    v_exp_f32 v107, v107
    v_exp_f32 v108, v108
    v_smfmac_f32_32x32x32_bf16 v[48:63], a[20:23], v[136:143], v94
    global_load_dwordx4 v[172:175], v2, s[98:99] offset:1024 sc1
    v_exp_f32 v109, v109
    v_exp_f32 v110, v110
    v_exp_f32 v111, v111
    v_exp_f32 v112, v112
    v_mfma_f32_32x32x16_bf16 v[128:143], a[48:51], v[24:27], 0
    global_load_dwordx4 v[176:179], v13, s[24:25] offset:-4096 sc1
    v_exp_f32 v113, v113
    v_exp_f32 v114, v114
    v_exp_f32 v115, v115
    v_exp_f32 v116, v116
    v_mfma_f32_32x32x8bf16_1k v[128:143], a[196:197], v[28:29], v[128:143]
    v_exp_f32 v117, v117
    v_exp_f32 v118, v118
    v_exp_f32 v119, v119
    v_exp_f32 v120, v120
    v_smfmac_f32_32x32x32_bf16 v[48:63], a[28:31], v[96:103], v94
    global_load_dwordx4 v[180:183], v13, s[24:25] offset:-3072 sc1
    v_exp_f32 v121, v121
    v_exp_f32 v122, v122
    v_exp_f32 v123, v123
    v_exp_f32 v124, v124
    v_smfmac_f32_32x32x32_bf16 v[48:63], a[32:35], v[104:111], v94
    v_exp_f32 v125, v125
    v_exp_f32 v126, v126
    v_exp_f32 v127, v127
    v_exp_f32 v128, v128
    v_mfma_f32_32x32x16_bf16 v[96:111], a[60:63], v[24:27], 0
    global_load_dwordx4 v[184:187], v2, s[98:99] offset:2048 sc1
    v_exp_f32 v129, v129
    v_exp_f32 v130, v130
    v_exp_f32 v131, v131
    v_exp_f32 v132, v132
    v_mfma_f32_32x32x8bf16_1k v[96:111], a[196:197], v[30:31], v[96:111]
wb_pad3:
    s_cbranch_execz wb_pad7
    v_exp_f32 v133, v133
    v_exp_f32 v134, v134
    v_exp_f32 v135, v135
    v_exp_f32 v136, v136
    v_smfmac_f32_32x32x32_bf16 v[48:63], a[40:43], v[112:119], v94
    global_load_dwordx4 v[188:191], v2, s[98:99] offset:3072 sc1
    v_exp_f32 v137, v137
    v_exp_f32 v138, v138
    v_exp_f32 v139, v139
    v_exp_f32 v140, v140
    v_smfmac_f32_32x32x32_bf16 v[48:63], a[44:47], v[120:127], v94
    v_exp_f32 v141, v141
    v_exp_f32 v142, v142
    v_exp_f32 v143, v143
    v_exp_f32 v96, v96
    v_mfma_f32_32x32x16_bf16 v[112:127], a[72:75], v[24:27], 0
    global_load_dwordx4 v[192:195], v13, s[24:25] offset:-2048 sc1
    v_exp_f32 v97, v97
    v_exp_f32 v98, v98
    v_exp_f32 v99, v99
    v_exp_f32 v100, v100
    v_mfma_f32_32x32x8bf16_1k v[112:127], a[198:199], v[28:29], v[112:127]
    v_exp_f32 v101, v101
    v_exp_f32 v102, v102
    v_exp_f32 v103, v103
    v_exp_f32 v104, v104
    v_smfmac_f32_32x32x32_bf16 v[48:63], a[52:55], v[128:135], v94
    global_load_dwordx4 v[196:199], v13, s[24:25] offset:-1024 sc1
    v_exp_f32 v105, v105
    v_exp_f32 v106, v106
    v_exp_f32 v107, v107
    v_exp_f32 v108, v108
    v_smfmac_f32_32x32x32_bf16 v[48:63], a[56:59], v[136:143], v94
    v_exp_f32 v109, v109
    v_exp_f32 v110, v110
    v_exp_f32 v111, v111
    v_exp_f32 v112, v112
    v_mfma_f32_32x32x16_bf16 v[128:143], a[84:87], v[24:27], 0
    global_load_dwordx4 v[200:203], v2, s[100:101] offset:-4096 sc1
    v_exp_f32 v113, v113
    v_exp_f32 v114, v114
    v_exp_f32 v115, v115
    v_exp_f32 v116, v116
    v_mfma_f32_32x32x8bf16_1k v[128:143], a[198:199], v[30:31], v[128:143]
    v_exp_f32 v117, v117
    v_exp_f32 v118, v118
    v_exp_f32 v119, v119
    v_exp_f32 v120, v120
    v_smfmac_f32_32x32x32_bf16 v[48:63], a[64:67], v[96:103], v94
    global_load_dwordx4 v[204:207], v2, s[100:101] offset:-3072 sc1
    v_exp_f32 v121, v121
    v_exp_f32 v122, v122
    v_exp_f32 v123, v123
    v_exp_f32 v124, v124
    v_smfmac_f32_32x32x32_bf16 v[48:63], a[68:71], v[104:111], v94
    v_exp_f32 v125, v125
    v_exp_f32 v126, v126
    v_exp_f32 v127, v127
    v_exp_f32 v128, v128
    v_mfma_f32_32x32x16_bf16 v[96:111], a[96:99], v[24:27], 0
    buffer_load_dword v93, v92, s[36:39], s21 offen sc1
    v_exp_f32 v129, v129
    v_exp_f32 v130, v130
    v_exp_f32 v131, v131
    v_exp_f32 v132, v132
    v_mfma_f32_32x32x8bf16_1k v[96:111], a[200:201], v[28:29], v[96:111]
    v_exp_f32 v133, v133
    v_exp_f32 v134, v134
    v_exp_f32 v135, v135
    v_exp_f32 v136, v136
    v_smfmac_f32_32x32x32_bf16 v[48:63], a[76:79], v[112:119], v94
    global_load_dwordx4 a[0:3], v2, s[26:27] offset:0 sc1
    v_exp_f32 v137, v137
    v_exp_f32 v138, v138
    v_exp_f32 v139, v139
    v_exp_f32 v140, v140
    v_smfmac_f32_32x32x32_bf16 v[48:63], a[80:83], v[120:127], v94
    global_load_dwordx4 a[4:7], v2, s[26:27] offset:1024 sc1
    v_exp_f32 v141, v141
    v_exp_f32 v142, v142
    v_exp_f32 v143, v143
    v_exp_f32 v96, v96
    v_mfma_f32_32x32x16_bf16 v[112:127], a[108:111], v[24:27], 0
    s_waitcnt vmcnt(25)
    v_add_u32 v250, 160768, v250
    v_exp_f32 v97, v97
    v_exp_f32 v98, v98
    v_exp_f32 v99, v99
    v_exp_f32 v100, v100
    v_mfma_f32_32x32x8bf16_1k v[112:127], a[200:201], v[30:31], v[112:127]
    v_exp_f32 v101, v101
    v_exp_f32 v102, v102
    v_exp_f32 v103, v103
    v_exp_f32 v104, v104
    v_smfmac_f32_32x32x32_bf16 v[48:63], a[88:91], v[128:135], v94
    ds_write_b128 v251, v[228:231]
    v_exp_f32 v105, v105
    v_exp_f32 v106, v106
    v_exp_f32 v107, v107
    v_exp_f32 v108, v108
    v_smfmac_f32_32x32x32_bf16 v[48:63], a[92:95], v[136:143], v94
    ds_write_b128 v250, v[232:235]
    v_exp_f32 v109, v109
    v_exp_f32 v110, v110
    v_exp_f32 v111, v111
    v_exp_f32 v112, v112
    v_mfma_f32_32x32x16_bf16 v[128:143], a[120:123], v[24:27], 0
    global_load_dwordx4 a[8:11], v2, s[100:101] offset:-2048 sc1
    v_exp_f32 v113, v113
    v_exp_f32 v114, v114
    v_exp_f32 v115, v115
    v_exp_f32 v116, v116
    v_mfma_f32_32x32x8bf16_1k v[128:143], a[202:203], v[28:29], v[128:143]
    v_exp_f32 v117, v117
    v_exp_f32 v118, v118
    v_exp_f32 v119, v119
    v_exp_f32 v120, v120
    v_smfmac_f32_32x32x32_bf16 v[48:63], a[100:103], v[96:103], v94
    global_load_dwordx4 a[12:15], v2, s[100:101] offset:-1024 sc1
    v_exp_f32 v121, v121
    v_exp_f32 v122, v122
    v_exp_f32 v123, v123
    v_exp_f32 v124, v124
    v_smfmac_f32_32x32x32_bf16 v[48:63], a[104:107], v[104:111], v94
    v_exp_f32 v125, v125
    v_exp_f32 v126, v126
    v_exp_f32 v127, v127
    v_exp_f32 v128, v128
    v_mfma_f32_32x32x16_bf16 v[96:111], a[132:135], v[24:27], 0
    global_load_dwordx4 a[16:19], v2, s[26:27] offset:2048 sc1
    v_exp_f32 v129, v129
    v_exp_f32 v130, v130
    v_exp_f32 v131, v131
    v_exp_f32 v132, v132
    v_mfma_f32_32x32x8bf16_1k v[96:111], a[202:203], v[30:31], v[96:111]
    v_exp_f32 v133, v133
    v_exp_f32 v134, v134
    v_exp_f32 v135, v135
    v_exp_f32 v136, v136
    v_smfmac_f32_32x32x32_bf16 v[48:63], a[112:115], v[112:119], v94
    global_load_dwordx4 a[20:23], v2, s[26:27] offset:3072 sc1
    v_exp_f32 v137, v137
    v_exp_f32 v138, v138
    v_exp_f32 v139, v139
    v_exp_f32 v140, v140
    v_smfmac_f32_32x32x32_bf16 v[48:63], a[116:119], v[120:127], v94
    v_exp_f32 v141, v141
    v_exp_f32 v142, v142
    v_exp_f32 v143, v143
    v_exp_f32 v96, v96
    v_mfma_f32_32x32x16_bf16 v[112:127], a[144:147], v[24:27], 0
    buffer_load_dwordx4 v[64:67], v2, s[36:39], s87 offen offset:0 sc1
    v_exp_f32 v97, v97
    v_exp_f32 v98, v98
    v_exp_f32 v99, v99
    v_exp_f32 v100, v100
    v_mfma_f32_32x32x8bf16_1k v[112:127], a[204:205], v[28:29], v[112:127]
    v_exp_f32 v101, v101
    v_exp_f32 v102, v102
    v_exp_f32 v103, v103
    v_exp_f32 v104, v104
    v_smfmac_f32_32x32x32_bf16 v[48:63], a[124:127], v[128:135], v94
    buffer_load_dwordx4 v[68:71], v2, s[36:39], s87 offen offset:2048 sc1
    v_exp_f32 v105, v105
    v_exp_f32 v106, v106
    v_exp_f32 v107, v107
    v_exp_f32 v108, v108
    v_smfmac_f32_32x32x32_bf16 v[48:63], a[128:131], v[136:143], v94
    global_load_dwordx4 a[24:27], v2, s[100:101] offset:0 sc1
    v_exp_f32 v109, v109
    v_exp_f32 v110, v110
    v_exp_f32 v111, v111
    s_waitcnt lgkmcnt(0)
    s_barrier
    s_mov_b64 exec, 1
    buffer_store_dword v236, off, s[36:39], s20 offset:32 sc1
    s_mov_b64 exec, -1
    v_exp_f32 v112, v112
    v_mfma_f32_32x32x16_bf16 v[128:143], a[156:159], v[24:27], 0
    buffer_load_dwordx4 v[72:75], v2, s[36:39], s88 offen offset:0 sc1
    v_exp_f32 v113, v113
    v_exp_f32 v114, v114
    v_exp_f32 v115, v115
    v_exp_f32 v116, v116
    v_mfma_f32_32x32x8bf16_1k v[128:143], a[204:205], v[30:31], v[128:143]
    v_exp_f32 v117, v117
    v_exp_f32 v118, v118
    v_exp_f32 v119, v119
    v_exp_f32 v120, v120
    v_smfmac_f32_32x32x32_bf16 v[48:63], a[136:139], v[96:103], v94
    buffer_load_dwordx4 v[76:79], v2, s[36:39], s88 offen offset:2048 sc1
    v_exp_f32 v121, v121
    v_exp_f32 v122, v122
    v_exp_f32 v123, v123
    v_exp_f32 v124, v124
    v_smfmac_f32_32x32x32_bf16 v[48:63], a[140:143], v[104:111], v94
    global_load_dwordx4 a[28:31], v2, s[100:101] offset:1024 sc1
    v_exp_f32 v125, v125
    v_exp_f32 v126, v126
    v_exp_f32 v127, v127
    v_exp_f32 v128, v128
    v_mfma_f32_32x32x16_bf16 v[96:111], a[168:171], v[24:27], 0
    buffer_load_dwordx4 v[80:83], v13, s[36:39], s87 offen offset:0 sc1
    v_exp_f32 v129, v129
    v_exp_f32 v130, v130
    v_exp_f32 v131, v131
    v_exp_f32 v132, v132
    v_mfma_f32_32x32x8bf16_1k v[96:111], a[206:207], v[28:29], v[96:111]
    v_exp_f32 v133, v133
    v_exp_f32 v134, v134
    v_exp_f32 v135, v135
    v_exp_f32 v136, v136
    v_smfmac_f32_32x32x32_bf16 v[48:63], a[148:151], v[112:119], v94
    buffer_load_dwordx4 v[84:87], v13, s[36:39], s87 offen offset:2048 sc1
    v_exp_f32 v137, v137
    v_exp_f32 v138, v138
    v_exp_f32 v139, v139
    v_exp_f32 v140, v140
    v_smfmac_f32_32x32x32_bf16 v[48:63], a[152:155], v[120:127], v94
    global_load_dwordx4 a[32:35], v13, s[26:27] offset:-4096 sc1
    v_exp_f32 v141, v141
    v_exp_f32 v142, v142
    v_exp_f32 v143, v143
    v_exp_f32 v96, v96
    v_mfma_f32_32x32x16_bf16 v[112:127], a[180:183], v[24:27], 0
    buffer_load_dwordx4 v[16:19], v13, s[36:39], s88 offen offset:0 sc1
    v_exp_f32 v97, v97
    v_exp_f32 v98, v98
    v_exp_f32 v99, v99
    v_exp_f32 v100, v100
    v_mfma_f32_32x32x8bf16_1k v[112:127], a[206:207], v[30:31], v[112:127]
    v_exp_f32 v101, v101
    v_exp_f32 v102, v102
    v_exp_f32 v103, v103
    v_exp_f32 v104, v104
    v_smfmac_f32_32x32x32_bf16 v[48:63], a[160:163], v[128:135], v94
    buffer_load_dwordx4 v[20:23], v13, s[36:39], s88 offen offset:2048 sc1
    v_exp_f32 v105, v105
    v_exp_f32 v106, v106
    v_exp_f32 v107, v107
    v_exp_f32 v108, v108
    v_smfmac_f32_32x32x32_bf16 v[48:63], a[164:167], v[136:143], v94
    global_load_dwordx4 a[36:39], v13, s[26:27] offset:-3072 sc1
    v_exp_f32 v109, v109
    v_exp_f32 v110, v110
    v_exp_f32 v111, v111
    v_exp_f32 v112, v112
    v_smfmac_f32_32x32x32_bf16 v[48:63], a[172:175], v[96:103], v94
    global_load_dwordx4 a[40:43], v2, s[100:101] offset:2048 sc1
    v_exp_f32 v113, v113
    v_exp_f32 v114, v114
    v_exp_f32 v115, v115
    v_exp_f32 v116, v116
    v_exp_f32 v117, v117
    v_exp_f32 v118, v118
    v_exp_f32 v119, v119
    v_exp_f32 v120, v120
    v_smfmac_f32_32x32x32_bf16 v[48:63], a[176:179], v[104:111], v94
    global_load_dwordx4 a[44:47], v2, s[100:101] offset:3072 sc1
    v_exp_f32 v121, v121
    v_exp_f32 v122, v122
    v_exp_f32 v123, v123
    v_exp_f32 v124, v124
    v_smfmac_f32_32x32x32_bf16 v[48:63], a[184:187], v[112:119], v94
    v_exp_f32 v125, v125
    v_exp_f32 v126, v126
    v_exp_f32 v127, v127
    s_nop 1
    v_smfmac_f32_32x32x32_bf16 v[48:63], a[188:191], v[120:127], v94
    v_accvgpr_read_b32 v232, a252
    v_accvgpr_read_b32 v236, a253
    v_xor_b32 v233, 64, v232
    v_add_u32 v234, s90, v232
    v_add_u32 v235, s90, v233
    ds_read_b64_tr_b16 a[184:185], v233 offset:0
    ds_read_b64_tr_b16 a[186:187], v233 offset:512
    ds_read_b64_tr_b16 a[188:189], v233 offset:4096
    ds_read_b64_tr_b16 a[190:191], v233 offset:4608
    ds_read_b64_tr_b16 a[192:193], v233 offset:8192
    ds_read_b64_tr_b16 a[194:195], v233 offset:8704
    ds_read_b64_tr_b16 a[196:197], v233 offset:12288
    ds_read_b64_tr_b16 a[198:199], v233 offset:12800
    v_rcp_f32 v58, v58
    s_nop 0
    v_mul_f32 v48, v48, v58
    v_mul_f32 v49, v49, v58
    v_mul_f32 v50, v50, v58
    v_mul_f32 v51, v51, v58
    v_mul_f32 v52, v52, v58
    v_mul_f32 v53, v53, v58
    v_mul_f32 v54, v54, v58
    v_mul_f32 v55, v55, v58
    v_mul_f32 v56, v56, v58
    v_mul_f32 v57, v57, v58
    v_cvt_pk_bf16_f32 v128, v48, v49
    v_cvt_pk_bf16_f32 v129, v50, v51
    v_cvt_pk_bf16_f32 v130, v52, v53
    v_cvt_pk_bf16_f32 v131, v54, v55
    v_cvt_pk_bf16_f32 v11, v56, v57
    v_min_u32 v128, -2, v128
    v_min_u32 v129, -2, v129
    v_min_u32 v130, -2, v130
    v_min_u32 v131, -2, v131
    global_store_dwordx4 v2, v[128:131], s[64:65] offset:1024 sc1
    v_min_u32 v11, -2, v11
    s_mov_b32 exec_hi, 0
    global_store_dwordx2 v2, v[10:11], s[66:67] sc1
    s_mov_b32 exec_hi, -1
    s_memrealtime s[70:71]
    ds_read_b64_tr_b16 a[200:201], v233 offset:16384
    ds_read_b64_tr_b16 a[202:203], v233 offset:16896
    ds_read_b64_tr_b16 a[204:205], v233 offset:20480
    ds_read_b64_tr_b16 a[206:207], v233 offset:20992
    ds_read_b64_tr_b16 a[208:209], v233 offset:24576
    ds_read_b64_tr_b16 a[210:211], v233 offset:25088
    ds_read_b64_tr_b16 a[212:213], v233 offset:28672
    ds_read_b64_tr_b16 a[214:215], v233 offset:29184
    s_waitcnt vmcnt(11)
    v_max3_u32 v238, v64, v65, v66
    v_max3_u32 v238, v238, v67, v68
    v_max3_u32 v238, v238, v69, v70
    v_max3_u32 v238, v238, v71, v72
    v_max3_u32 v238, v238, v73, v74
    v_max3_u32 v238, v238, v75, v76
    v_max3_u32 v238, v238, v77, v78
    v_max_u32 v238, v238, v79
    v_cmp_eq_u32 vcc, -1, v238
    s_cbranch_vccnz oe_slow0
oe_back0:
    s_waitcnt lgkmcnt(14)
    v_mfma_f32_32x32x16_bf16 v[112:127], a[184:187], v[64:67], 0
    ds_read_b64_tr_b16 a[216:217], v232 offset:0
    ds_read_b64_tr_b16 a[218:219], v232 offset:512
    ds_read_b64_tr_b16 a[220:221], v232 offset:4096
    s_waitcnt vmcnt(5)
    v_max3_u32 v238, v80, v81, v82
    v_max3_u32 v238, v238, v83, v84
    v_max3_u32 v238, v238, v85, v86
    v_max3_u32 v238, v238, v87, v16
    v_max3_u32 v238, v238, v17, v18
    s_waitcnt lgkmcnt(15)
    v_mfma_f32_32x32x16_bf16 v[112:127], a[188:191], v[68:71], v[112:127]
    ds_read_b64_tr_b16 a[222:223], v232 offset:4608
    ds_read_b64_tr_b16 a[224:225], v232 offset:8192
    ds_read_b64_tr_b16 a[226:227], v232 offset:8704
    v_max3_u32 v238, v238, v19, v20
    v_max3_u32 v238, v238, v21, v22
    v_max_u32 v238, v238, v23
    v_cmp_eq_u32 vcc, -1, v238
    s_cbranch_vccnz oe_slow1
oe_back1:
    v_cmp_eq_u32 vcc, -1, v93
    s_waitcnt lgkmcnt(15)
    v_mfma_f32_32x32x16_bf16 v[112:127], a[192:195], v[72:75], v[112:127]
    ds_read_b64_tr_b16 a[228:229], v232 offset:12288
    ds_read_b64_tr_b16 a[230:231], v232 offset:12800
    ds_read_b64_tr_b16 a[232:233], v232 offset:16384
    v_subrev_u32 v93, s68, v93
    v_mov_b32 v92, 200
    v_med3_i32 v93, v93, 0, v92
    v_cndmask_b32 v93, v93, v92, vcc
    v_lshlrev_b32 v96, 16, v216
    s_waitcnt lgkmcnt(15)
    v_mfma_f32_32x32x16_bf16 v[112:127], a[196:199], v[76:79], v[112:127]
    global_load_dwordx4 a[48:51], v13, s[26:27] offset:-2048 sc1
    ds_read_b64_tr_b16 a[234:235], v232 offset:16896
    ds_read_b64_tr_b16 a[236:237], v232 offset:20480
    ds_read_b64_tr_b16 a[238:239], v232 offset:20992
    v_and_b32 v97, 0xffff0000, v216
    v_max_u32_dpp v93, v93, v93 quad_perm:[1,0,3,2] row_mask:0xf bank_mask:0xf
    v_lshlrev_b32 v98, 16, v217
    v_and_b32 v99, 0xffff0000, v217
    v_max_u32_dpp v93, v93, v93 quad_perm:[2,3,0,1] row_mask:0xf bank_mask:0xf
    s_waitcnt lgkmcnt(15)
    v_mfma_f32_32x32x16_bf16 v[112:127], a[200:203], v[80:83], v[112:127]
    ds_read_b64_tr_b16 a[240:241], v232 offset:24576
    ds_read_b64_tr_b16 a[242:243], v232 offset:25088
    ds_read_b64_tr_b16 a[244:245], v232 offset:28672
    v_lshlrev_b32 v100, 16, v218
    v_and_b32 v101, 0xffff0000, v218
    v_max_u32_dpp v93, v93, v93 row_half_mirror row_mask:0xf bank_mask:0xf
    v_lshlrev_b32 v102, 16, v219
    v_and_b32 v103, 0xffff0000, v219
    s_waitcnt lgkmcnt(15)
    v_mfma_f32_32x32x16_bf16 v[112:127], a[204:207], v[84:87], v[112:127]
    v_readfirstlane_b32 s68, v93
    s_add_i32 s68, s68, 24
    v_lshlrev_b32 v104, 16, v220
    v_and_b32 v105, 0xffff0000, v220
    v_lshlrev_b32 v106, 16, v221
    s_waitcnt lgkmcnt(15)
    v_mfma_f32_32x32x16_bf16 v[112:127], a[208:211], v[16:19], v[112:127]
    s_waitcnt lgkmcnt(0)
    s_add_u32 s68, s68, s70
    s_memrealtime s[70:71]
    ds_read_b64_tr_b16 a[246:247], v232 offset:29184
    ds_read_b64_tr_b16 a[248:249], v236
    ds_read_b64_tr_b16 a[250:251], v236 offset:64
    v_lshl_add_u32 v236, v237, 1, v236
    v_and_b32 v107, 0xffff0000, v221
    v_lshlrev_b32 v108, 16, v222
    v_and_b32 v109, 0xffff0000, v222
    v_lshlrev_b32 v110, 16, v223
    v_and_b32 v111, 0xffff0000, v223
    v_mfma_f32_32x32x16_bf16 v[112:127], a[212:215], v[20:23], v[112:127]
    global_load_dwordx4 a[52:55], v13, s[26:27] offset:-1024 sc1
    s_lshr_b32 s17, s16, 1
    s_xor_b32 s17, s17, s15
    s_and_b32 s17, s17, 1
    s_lshl_b32 s17, s17, 9
    s_add_u32 s17, s17, 162816
    v_mfma_f32_32x32x16_bf16 v[96:111], a[216:219], v[64:67], v[96:111]
ap_loop:
    s_waitcnt lgkmcnt(0)
    s_sub_u32 s69, s70, s68
    s_cmp_lt_i32 s69, 0
    s_cbranch_scc0 ap_done
    s_memrealtime s[70:71]
    s_branch ap_loop
ap_done:
    buffer_load_dwordx4 v[24:27], v2, s[36:39], s87 offen offset:1024 sc1
    buffer_load_dwordx4 v[28:31], v2, s[36:39], s87 offen offset:3072 sc1
    ds_read_b64_tr_b16 a[252:253], v236
    ds_read_b64_tr_b16 a[254:255], v236 offset:64
    v_lshl_add_u32 v236, v237, 1, v236
    ds_read_b64_tr_b16 a[184:185], v236
    v_and_b32 v239, 31, v1
    v_lshl_add_u32 v240, v239, 3, s17
    ds_read_b32 v241, v240
    ds_read_b32 v242, v240 offset:256
    v_mfma_f32_32x32x16_bf16 v[96:111], a[220:223], v[68:71], v[96:111]
    buffer_load_dwordx4 v[32:35], v2, s[36:39], s88 offen offset:1024 sc1
    ds_read_b64_tr_b16 a[186:187], v236 offset:64
    v_lshl_add_u32 v236, v237, 1, v236
    ds_read_b64_tr_b16 a[188:189], v236
    ds_read_b64_tr_b16 a[190:191], v236 offset:64
    v_lshl_add_u32 v236, v237, 1, v236
    s_sub_u32 s17, s86, 1
    s_and_b32 s18, s17, 0xffff0000
    v_lshlrev_b32 v128, 16, v224
    v_and_b32 v129, s18, v224
    v_mfma_f32_32x32x16_bf16 v[96:111], a[224:227], v[72:75], v[96:111]
    buffer_load_dwordx4 v[36:39], v2, s[36:39], s88 offen offset:3072 sc1
    ds_read_b64_tr_b16 a[192:193], v236
    ds_read_b64_tr_b16 a[194:195], v236 offset:64
    v_lshl_add_u32 v236, v237, 1, v236
    ds_read_b64_tr_b16 a[196:197], v236
    v_and_b32 v128, s17, v128
    v_lshlrev_b32 v130, 16, v225
    v_and_b32 v131, s18, v225
    v_and_b32 v130, s17, v130
    v_mfma_f32_32x32x16_bf16 v[96:111], a[228:231], v[76:79], v[96:111]
    buffer_load_dwordx4 v[40:43], v13, s[36:39], s87 offen offset:1024 sc1
    ds_read_b64_tr_b16 a[198:199], v236 offset:64
    v_lshl_add_u32 v236, v237, 1, v236
    ds_read_b64_tr_b16 a[200:201], v236
    ds_read_b64_tr_b16 a[202:203], v236 offset:64
    v_lshl_add_u32 v236, v237, 1, v236
    v_lshlrev_b32 v132, 16, v226
    v_and_b32 v133, s18, v226
    v_and_b32 v132, s17, v132
    v_lshlrev_b32 v134, 16, v227
    v_mfma_f32_32x32x16_bf16 v[96:111], a[232:235], v[80:83], v[96:111]
    buffer_load_dwordx4 v[44:47], v13, s[36:39], s87 offen offset:3072 sc1
    ds_read_b64_tr_b16 a[204:205], v236
    ds_read_b64_tr_b16 a[206:207], v236 offset:64
    ds_read_b64_tr_b16 a[208:209], v233 offset:2048
    v_and_b32 v135, s18, v227
    v_and_b32 v134, s17, v134
    s_waitcnt lgkmcnt(12)
    v_add_f32 v136, v241, v242
    v_mul_f32 v136, 0x3a638e39, v136
    v_mfma_f32_32x32x16_bf16 v[96:111], a[236:239], v[84:87], v[96:111]
    buffer_load_dwordx4 v[48:51], v13, s[36:39], s88 offen offset:1024 sc1
    ds_read_b64_tr_b16 a[210:211], v233 offset:2560
    v_mad_i32_i24 v236, v237, -13, v236
    ds_read_b64_tr_b16 a[212:213], v236
    ds_read_b64_tr_b16 a[214:215], v236 offset:64
    v_mov_b32 v137, 0
    v_mov_b32 v138, 0
    v_mov_b32 v139, 0
    v_mov_b32 v140, 0
    v_mfma_f32_32x32x16_bf16 v[96:111], a[240:243], v[16:19], v[96:111]
    buffer_load_dwordx4 v[52:55], v13, s[36:39], s88 offen offset:3072 sc1
    ds_read_b64_tr_b16 a[216:217], v233 offset:6144
    ds_read_b64_tr_b16 a[218:219], v233 offset:6656
    v_lshl_add_u32 v236, v237, 1, v236
    ds_read_b64_tr_b16 a[220:221], v236
    v_mov_b32 v141, 0
    v_mov_b32 v142, 0
    v_mov_b32 v143, 0
    s_mul_i32 s17, s15, 4608
    v_mfma_f32_32x32x16_bf16 v[96:111], a[244:247], v[20:23], v[96:111]
    buffer_load_dwordx4 v[56:59], v2, s[36:39], s89 offen offset:0 sc1
    ds_read_b64_tr_b16 a[222:223], v236 offset:64
    ds_read_b64_tr_b16 a[224:225], v233 offset:10240
    ds_read_b64_tr_b16 a[226:227], v233 offset:10752
    v_lshl_add_u32 v236, v237, 1, v236
    s_add_u32 s17, s17, s19
    s_add_u32 s95, s17, 20189184
    s_lshl_b32 s18, s86, 11
    s_add_u32 s94, s17, s18
    v_mfma_f32_32x32x16_bf16 v[128:143], a[248:251], v[64:67], v[128:143]
    buffer_load_dwordx4 v[60:63], v2, s[36:39], s89 offen offset:1024 sc1
    ds_read_b64_tr_b16 a[228:229], v236
    ds_read_b64_tr_b16 a[230:231], v236 offset:64
    ds_read_b64_tr_b16 a[232:233], v233 offset:14336
    s_add_u32 s94, s94, 20185088
    s_lshl_b32 s17, s14, 12
    s_lshl_b32 s18, s16, 10
    s_add_u32 s17, s17, s18
    v_mfma_f32_32x32x16_bf16 v[128:143], a[252:255], v[68:71], v[128:143]
    ds_read_b64_tr_b16 a[234:235], v233 offset:14848
    v_lshl_add_u32 v236, v237, 1, v236
    ds_read_b64_tr_b16 a[236:237], v236
    ds_read_b64_tr_b16 a[238:239], v236 offset:64
    s_lshl_b32 s18, s15, 2
    s_add_u32 s17, s17, s18
    s_add_u32 s96, s17, 22544384
    s_lshr_b32 s17, s16, 1
    s_waitcnt lgkmcnt(15)
    v_mfma_f32_32x32x16_bf16 v[128:143], a[184:187], v[72:75], v[128:143]
    ds_read_b64_tr_b16 a[240:241], v233 offset:18432
    ds_read_b64_tr_b16 a[242:243], v233 offset:18944
    v_lshl_add_u32 v236, v237, 1, v236
    ds_read_b64_tr_b16 a[244:245], v236
    s_mul_i32 s18, s17, 36864
    s_add_u32 s18, s18, 18432
    s_lshl_b32 s91, s86, 13
    s_add_u32 s92, s18, s91
    s_waitcnt lgkmcnt(15)
    v_mfma_f32_32x32x16_bf16 v[128:143], a[188:191], v[76:79], v[128:143]
    global_load_dwordx4 a[56:59], v2, s[24:25] offset:-4096 sc1
    ds_read_b64_tr_b16 a[246:247], v236 offset:64
    ds_read_b64_tr_b16 a[248:249], v233 offset:22528
    ds_read_b64_tr_b16 a[250:251], v233 offset:23040
    v_lshl_add_u32 v236, v237, 1, v236
    s_sub_u32 s18, s18, s91
    v_add_u32 v249, s92, v2
    v_add_u32 v240, s18, v13
    s_lshl_b32 s17, s17, 7
    s_waitcnt lgkmcnt(15)
    v_mfma_f32_32x32x16_bf16 v[128:143], a[192:195], v[80:83], v[128:143]
    ds_read_b64_tr_b16 a[252:253], v236
    ds_read_b64_tr_b16 a[254:255], v236 offset:64
    ds_read_b64_tr_b16 a[184:185], v233 offset:26624
    s_add_u32 s17, s17, 145408
    v_lshl_add_u32 v243, v239, 2, s17
    v_lshlrev_b32 v9, 5, v1
    s_waitcnt lgkmcnt(15)
    v_mfma_f32_32x32x16_bf16 v[128:143], a[196:199], v[84:87], v[128:143]
    ds_read_b64_tr_b16 a[186:187], v233 offset:27136
    v_lshl_add_u32 v236, v237, 1, v236
    ds_read_b64_tr_b16 a[188:189], v236
    ds_read_b64_tr_b16 a[190:191], v236 offset:64
    s_waitcnt lgkmcnt(15)
    v_mfma_f32_32x32x16_bf16 v[128:143], a[200:203], v[16:19], v[128:143]
    ds_read_b64_tr_b16 a[192:193], v233 offset:30720
    ds_read_b64_tr_b16 a[194:195], v233 offset:31232
    v_lshl_add_u32 v236, v237, 1, v236
    ds_read_b64_tr_b16 a[196:197], v236
    s_waitcnt lgkmcnt(15)
    v_mfma_f32_32x32x16_bf16 v[128:143], a[204:207], v[20:23], v[128:143]
    global_load_dwordx4 a[60:63], v2, s[24:25] offset:-3072 sc1
    ds_read_b64_tr_b16 a[198:199], v236 offset:64
    ds_read_b64_tr_b16 a[200:201], v235 offset:0
    ds_read_b64_tr_b16 a[202:203], v235 offset:512
    v_mad_u32_u24 v236, v237, s97, v236
    s_waitcnt vmcnt(8)
    v_max3_u32 v238, v24, v25, v26
    v_max3_u32 v238, v238, v27, v28
    v_max3_u32 v238, v238, v29, v30
    v_max3_u32 v238, v238, v31, v32
    v_max3_u32 v238, v238, v33, v34
    v_max3_u32 v238, v238, v35, v36
    v_max3_u32 v238, v238, v37, v38
    v_max_u32 v238, v238, v39
    v_cmp_eq_u32 vcc, -1, v238
    s_cbranch_vccnz og_slow0
og_back0:
    s_waitcnt lgkmcnt(15)
    v_mfma_f32_32x32x16_bf16 v[112:127], a[208:211], v[24:27], v[112:127]
    ds_read_b64_tr_b16 a[204:205], v236
    ds_read_b64_tr_b16 a[206:207], v236 offset:64
    s_waitcnt lgkmcnt(15)
    v_mfma_f32_32x32x16_bf16 v[128:143], a[212:215], v[24:27], v[128:143]
    ds_read_b64_tr_b16 a[208:209], v235 offset:2048
    ds_read_b64_tr_b16 a[210:211], v235 offset:2560
    v_add_u32 v236, v236, v237
    global_load_dwordx4 a[64:67], v2, s[28:29] offset:0 sc1
    s_waitcnt lgkmcnt(15)
    v_mfma_f32_32x32x16_bf16 v[112:127], a[216:219], v[28:31], v[112:127]
    ds_read_b64_tr_b16 a[212:213], v236
    ds_read_b64_tr_b16 a[214:215], v236 offset:64
    global_load_dwordx4 a[68:71], v2, s[28:29] offset:1024 sc1
    s_waitcnt lgkmcnt(15)
    v_mfma_f32_32x32x16_bf16 v[128:143], a[220:223], v[28:31], v[128:143]
    ds_read_b64_tr_b16 a[216:217], v232 offset:2048
    ds_read_b64_tr_b16 a[218:219], v232 offset:2560
    global_load_dwordx4 a[72:75], v13, s[24:25] offset:0 sc1
    s_waitcnt lgkmcnt(15)
    v_mfma_f32_32x32x16_bf16 v[112:127], a[224:227], v[32:35], v[112:127]
    ds_read_b64_tr_b16 a[220:221], v232 offset:6144
    ds_read_b64_tr_b16 a[222:223], v232 offset:6656
    s_waitcnt lgkmcnt(15)
    v_mfma_f32_32x32x16_bf16 v[128:143], a[228:231], v[32:35], v[128:143]
    ds_read_b64_tr_b16 a[224:225], v232 offset:10240
    ds_read_b64_tr_b16 a[226:227], v232 offset:10752
    global_load_dwordx4 a[76:79], v13, s[24:25] offset:1024 sc1
    s_waitcnt lgkmcnt(15)
    v_mfma_f32_32x32x16_bf16 v[112:127], a[232:235], v[36:39], v[112:127]
    ds_read_b64_tr_b16 a[228:229], v232 offset:14336
    ds_read_b64_tr_b16 a[230:231], v232 offset:14848
    global_load_dwordx4 a[80:83], v2, s[30:31] offset:-4096 sc1
    s_waitcnt lgkmcnt(15)
    v_mfma_f32_32x32x16_bf16 v[128:143], a[236:239], v[36:39], v[128:143]
    ds_read_b64_tr_b16 a[232:233], v232 offset:18432
    ds_read_b64_tr_b16 a[234:235], v232 offset:18944
    global_load_dwordx4 a[84:87], v2, s[30:31] offset:-3072 sc1
    s_waitcnt vmcnt(10)
    v_max3_u32 v238, v40, v41, v42
    v_max3_u32 v238, v238, v43, v44
    v_max3_u32 v238, v238, v45, v46
    v_max3_u32 v238, v238, v47, v48
    v_max3_u32 v238, v238, v49, v50
    v_max3_u32 v238, v238, v51, v52
    v_max3_u32 v238, v238, v53, v54
    v_max_u32 v238, v238, v55
    v_cmp_eq_u32 vcc, -1, v238
    s_cbranch_vccnz og_slow1
og_back1:
    s_waitcnt lgkmcnt(15)
    v_mfma_f32_32x32x16_bf16 v[112:127], a[240:243], v[40:43], v[112:127]
    ds_read_b64_tr_b16 a[236:237], v232 offset:22528
    ds_read_b64_tr_b16 a[238:239], v232 offset:23040
    s_waitcnt lgkmcnt(15)
    v_mfma_f32_32x32x16_bf16 v[128:143], a[244:247], v[40:43], v[128:143]
    ds_read_b64_tr_b16 a[240:241], v232 offset:26624
    ds_read_b64_tr_b16 a[242:243], v232 offset:27136
    global_load_dwordx4 a[88:91], v13, s[24:25] offset:2048 sc1
    s_waitcnt lgkmcnt(15)
    v_mfma_f32_32x32x16_bf16 v[112:127], a[248:251], v[44:47], v[112:127]
    ds_read_b64_tr_b16 a[244:245], v232 offset:30720
    ds_read_b64_tr_b16 a[246:247], v232 offset:31232
    global_load_dwordx4 a[92:95], v13, s[24:25] offset:3072 sc1
    s_waitcnt lgkmcnt(15)
    v_mfma_f32_32x32x16_bf16 v[128:143], a[252:255], v[44:47], v[128:143]
    ds_read_b64_tr_b16 a[248:249], v234 offset:0
    ds_read_b64_tr_b16 a[250:251], v234 offset:512
    global_load_dwordx4 a[96:99], v2, s[30:31] offset:-2048 sc1
    s_waitcnt lgkmcnt(15)
    v_mfma_f32_32x32x16_bf16 v[112:127], a[184:187], v[48:51], v[112:127]
    ds_read_b64_tr_b16 a[252:253], v234 offset:2048
    ds_read_b64_tr_b16 a[254:255], v234 offset:2560
    s_waitcnt lgkmcnt(15)
    v_mfma_f32_32x32x16_bf16 v[128:143], a[188:191], v[48:51], v[128:143]
    global_load_dwordx4 a[100:103], v2, s[30:31] offset:-1024 sc1
    s_waitcnt lgkmcnt(15)
    v_mfma_f32_32x32x16_bf16 v[112:127], a[192:195], v[52:55], v[112:127]
    global_load_dwordx4 a[104:107], v2, s[26:27] offset:-4096 sc1
    s_waitcnt lgkmcnt(15)
    v_mfma_f32_32x32x16_bf16 v[128:143], a[196:199], v[52:55], v[128:143]
    global_load_dwordx4 a[108:111], v2, s[26:27] offset:-3072 sc1
    s_waitcnt vmcnt(14)
    v_max3_u32 v238, v56, v57, v58
    v_max3_u32 v238, v238, v59, v60
    v_max3_u32 v238, v238, v61, v62
    v_max_u32 v238, v238, v63
    v_cmp_eq_u32 vcc, -1, v238
    s_cbranch_vccnz og_slow2
og_back2:
    s_waitcnt lgkmcnt(15)
    v_mfma_f32_32x32x16_bf16 v[112:127], a[200:203], v[56:59], v[112:127]
    s_waitcnt lgkmcnt(15)
    v_mfma_f32_32x32x16_bf16 v[128:143], a[204:207], v[56:59], v[128:143]
    global_load_dwordx4 a[112:115], v2, s[30:31] offset:0 sc1
    s_waitcnt lgkmcnt(15)
    v_mfma_f32_32x32x16_bf16 v[112:127], a[208:211], v[60:63], v[112:127]
    global_load_dwordx4 a[116:119], v2, s[30:31] offset:1024 sc1
    s_waitcnt lgkmcnt(15)
    v_mfma_f32_32x32x16_bf16 v[128:143], a[212:215], v[60:63], v[128:143]
    global_load_dwordx4 a[120:123], v2, s[26:27] offset:-2048 sc1
    s_waitcnt lgkmcnt(15)
    v_mfma_f32_32x32x16_bf16 v[96:111], a[216:219], v[24:27], v[96:111]
wb_pad4:
    s_cbranch_execz wb_ret
    ds_write_b128 v240, v[112:115] offset:0
    ds_write_b128 v240, v[116:119] offset:1024
    s_waitcnt lgkmcnt(15)
    v_mfma_f32_32x32x16_bf16 v[96:111], a[220:223], v[28:31], v[96:111]
    ds_write_b128 v240, v[120:123] offset:2048
    ds_write_b128 v240, v[124:127] offset:3072
    s_waitcnt lgkmcnt(15)
    v_mfma_f32_32x32x16_bf16 v[96:111], a[224:227], v[32:35], v[96:111]
    ds_write_b128 v240, v[128:131] offset:4096
    ds_write_b128 v240, v[132:135] offset:5120
    s_waitcnt lgkmcnt(15)
    v_mfma_f32_32x32x16_bf16 v[96:111], a[228:231], v[36:39], v[96:111]
    ds_write_b128 v240, v[136:139] offset:6144
    v_add_f32 v136, v136, v137
    v_add_f32 v138, v138, v139
    v_add_f32 v136, v136, v138
    s_waitcnt lgkmcnt(15)
    v_mfma_f32_32x32x16_bf16 v[96:111], a[232:235], v[40:43], v[96:111]
    global_load_dwordx4 a[124:127], v2, s[26:27] offset:-1024 sc1
    s_waitcnt lgkmcnt(15)
    v_mfma_f32_32x32x16_bf16 v[96:111], a[236:239], v[44:47], v[96:111]
    s_waitcnt lgkmcnt(0)
    s_barrier
    ds_read_b128 v[72:75], v249 offset:6144
    ds_read_b128 v[112:115], v249 offset:0
    ds_read_b128 v[116:119], v249 offset:1024
    ds_read_b128 v[120:123], v249 offset:2048
    ds_read_b128 v[124:127], v249 offset:3072
    ds_read_b128 v[64:67], v249 offset:4096
    ds_read_b128 v[68:71], v249 offset:5120
    v_mfma_f32_32x32x16_bf16 v[96:111], a[240:243], v[48:51], v[96:111]
    global_load_dwordx4 a[128:131], v2, s[30:31] offset:2048 sc1
    v_mfma_f32_32x32x16_bf16 v[96:111], a[244:247], v[52:55], v[96:111]
    global_load_dwordx4 a[132:135], v2, s[30:31] offset:3072 sc1
    s_waitcnt lgkmcnt(6)
    v_add_f32 v72, v72, v73
    v_add_f32 v74, v74, v75
    v_add_f32 v136, v136, v72
    v_add_f32 v136, v136, v74
    v_mov_b32 v137, 0
    s_waitcnt lgkmcnt(4)
    v_sub_f32 v112, v112, v136
    v_mfma_f32_32x32x16_bf16 v[96:111], a[248:251], v[56:59], v[96:111]
    global_load_dwordx4 a[136:139], v13, s[26:27] offset:0 sc1
    v_sub_f32 v113, v113, v136
    v_sub_f32 v114, v114, v136
    v_sub_f32 v115, v115, v136
    v_sub_f32 v116, v116, v136
    v_sub_f32 v117, v117, v136
    v_sub_f32 v118, v118, v136
    v_mfma_f32_32x32x16_bf16 v[96:111], a[252:255], v[60:63], v[96:111]
    global_load_dwordx4 a[140:143], v13, s[26:27] offset:1024 sc1
    v_sub_f32 v119, v119, v136
    s_waitcnt lgkmcnt(2)
    v_sub_f32 v120, v120, v136
    v_sub_f32 v121, v121, v136
    v_sub_f32 v122, v122, v136
    v_sub_f32 v123, v123, v136
    v_sub_f32 v124, v124, v136
    v_sub_f32 v125, v125, v136
    v_sub_f32 v126, v126, v136
    v_sub_f32 v127, v127, v136
    s_nop 0
    v_add_f32 v96, v96, v112
    v_add_f32 v97, v97, v113
    v_add_f32 v98, v98, v114
    v_add_f32 v99, v99, v115
    v_add_f32 v100, v100, v116
    v_add_f32 v101, v101, v117
    v_add_f32 v102, v102, v118
    v_add_f32 v103, v103, v119
    v_cvt_pk_bf16_f32 v76, v96, v97
    v_cvt_pk_bf16_f32 v77, v98, v99
    v_cvt_pk_bf16_f32 v78, v100, v101
    v_cvt_pk_bf16_f32 v79, v102, v103
    v_min_u32 v76, -2, v76
    v_min_u32 v77, -2, v77
    v_min_u32 v78, -2, v78
    v_min_u32 v79, -2, v79
    buffer_store_dwordx4 v[76:79], v2, s[36:39], s94 offen offset:0 sc1
    v_add_f32 v104, v104, v120
    v_add_f32 v105, v105, v121
    v_add_f32 v106, v106, v122
    v_add_f32 v107, v107, v123
    v_add_f32 v108, v108, v124
    v_add_f32 v109, v109, v125
    v_add_f32 v110, v110, v126
    v_add_f32 v111, v111, v127
    v_cvt_pk_bf16_f32 v80, v104, v105
    v_cvt_pk_bf16_f32 v81, v106, v107
    v_cvt_pk_bf16_f32 v82, v108, v109
    v_cvt_pk_bf16_f32 v83, v110, v111
    v_min_u32 v80, -2, v80
    v_min_u32 v81, -2, v81
    v_min_u32 v82, -2, v82
    v_min_u32 v83, -2, v83
    buffer_store_dwordx4 v[80:83], v2, s[36:39], s94 offen offset:1024 sc1
    s_cmp_eq_u32 s86, 0
    s_cbranch_scc0 kb_no8
    s_mov_b32 exec_hi, 0
    s_waitcnt lgkmcnt(0)
    v_add_f32 v128, v128, v64
    v_add_f32 v129, v129, v65
    v_add_f32 v130, v130, v66
    v_add_f32 v131, v131, v67
    v_add_f32 v132, v132, v68
    v_add_f32 v133, v133, v69
    v_add_f32 v134, v134, v70
    v_add_f32 v135, v135, v71
    v_sub_f32 v128, v128, v136
    v_sub_f32 v129, v129, v136
    v_sub_f32 v130, v130, v136
    v_sub_f32 v131, v131, v136
    v_sub_f32 v132, v132, v136
    v_sub_f32 v133, v133, v136
    v_sub_f32 v134, v134, v136
    v_sub_f32 v135, v135, v136
    v_cvt_pk_bf16_f32 v84, v128, v129
    v_cvt_pk_bf16_f32 v85, v130, v131
    v_cvt_pk_bf16_f32 v86, v132, v133
    v_cvt_pk_bf16_f32 v87, v134, v135
    v_min_u32 v84, -2, v84
    v_min_u32 v85, -2, v85
    v_min_u32 v86, -2, v86
    v_min_u32 v87, -2, v87
    buffer_store_dwordx4 v[84:87], v2, s[36:39], s95 offen sc1
    ds_write_b32 v243, v136
    v_fmac_f32 v137, v128, v128
    v_fmac_f32 v137, v129, v129
    v_fmac_f32 v137, v130, v130
    v_fmac_f32 v137, v131, v131
    v_fmac_f32 v137, v132, v132
    v_fmac_f32 v137, v133, v133
    v_fmac_f32 v137, v134, v134
    v_fmac_f32 v137, v135, v135
    s_mov_b32 exec_hi, -1
kb_no8:
wb_pad5:
    s_cbranch_execz wb_ret
    v_mul_f32 v138, v96, v96
    v_fmac_f32 v138, v97, v97
    v_fmac_f32 v137, v98, v98
    v_fmac_f32 v138, v99, v99
    v_fmac_f32 v137, v100, v100
    v_fmac_f32 v138, v101, v101
    v_fmac_f32 v137, v102, v102
    v_fmac_f32 v138, v103, v103
    v_fmac_f32 v137, v104, v104
    v_fmac_f32 v138, v105, v105
    v_fmac_f32 v137, v106, v106
    v_fmac_f32 v138, v107, v107
    v_fmac_f32 v137, v108, v108
    v_fmac_f32 v138, v109, v109
    v_fmac_f32 v137, v110, v110
    v_fmac_f32 v138, v111, v111
    v_add_f32 v137, v137, v138
    v_mov_b32 v138, v137
    s_nop 1
    v_permlane32_swap_b32 v137, v138
    v_add_f32 v137, v137, v138
    v_min_u32 v137, -2, v137
    s_mov_b32 exec_hi, 0
    buffer_store_dword v137, v9, s[36:39], s96 offen sc1
    s_mov_b32 exec_hi, -1
    s_waitcnt lgkmcnt(0)
    global_load_dwordx4 a[144:147], v2, s[50:51] offset:-4096 sc1
    global_load_dwordx4 a[148:151], v2, s[50:51] offset:-3072 sc1
    global_load_dwordx4 a[152:155], v13, s[26:27] offset:2048 sc1
    global_load_dwordx4 a[156:159], v13, s[26:27] offset:3072 sc1
    global_load_dwordx4 a[160:163], v2, s[50:51] offset:-2048 sc1
    global_load_dwordx4 a[164:167], v2, s[50:51] offset:-1024 sc1
    global_load_dwordx4 a[168:171], v2, s[28:29] offset:-4096 sc1
    global_load_dwordx4 a[172:175], v2, s[28:29] offset:-3072 sc1
    global_load_dwordx4 a[176:179], v2, s[50:51] offset:0 sc1
    global_load_dwordx4 a[180:183], v2, s[50:51] offset:1024 sc1
    s_mov_b64 exec, 0
    s_cmp_eq_u32 s16, 0
    s_cbranch_scc1 wc_pad0
    s_cmp_eq_u32 s16, 1
    s_cbranch_scc1 wc_pad1
    s_cmp_eq_u32 s16, 2
    s_cbranch_scc1 wc_pad2
    s_branch wc_pad3
wc_ret:
    s_mov_b64 exec, -1
    s_mul_i32 s94, s14, 73728
    s_mul_i32 s19, s16, 9216
    s_add_u32 s4, s94, s19
    s_add_u32 s4, s4, 20185088
    s_add_u32 s5, s4, 4096
    s_add_u32 s6, s4, 8192
    s_add_u32 s62, s4, 45056
    v_and_b32 v12, 0xf0, v2
    v_bfe_u32 v11, v2, 8, 1
    v_lshl_add_u32 v12, v11, 9, v12
    v_lshrrev_b32 v11, 9, v2
    v_lshl_add_u32 v10, v11, 10, v12
    v_lshl_add_u32 v12, v11, 8, v12
    v_add_u32 v11, 36864, v10
    s_lshl_b32 s7, s14, 12
    s_add_u32 s7, s7, 22544384
    s_add_u32 s18, s16, 0
    s_and_b32 s18, s18, 3
    s_mul_i32 s18, s18, 36864
    v_add_u32 v3, s18, v10
    s_add_u32 s18, s16, 1
    s_and_b32 s18, s18, 3
    s_mul_i32 s18, s18, 36864
    v_add_u32 v4, s18, v10
    s_add_u32 s18, s16, 2
    s_and_b32 s18, s18, 3
    s_mul_i32 s18, s18, 36864
    v_add_u32 v5, s18, v10
    s_add_u32 s18, s16, 3
    s_and_b32 s18, s18, 3
    s_mul_i32 s18, s18, 36864
    v_add_u32 v6, s18, v10
    v_cmp_gt_u32 vcc, 512, v2
    v_subrev_u32 v7, 1024, v5
    v_subrev_u32 v8, 1024, v6
    v_cndmask_b32 v7, v7, v3, vcc
    v_cndmask_b32 v8, v8, v4, vcc
    s_mul_i32 s19, s16, 36864
    s_lshl2_add_u32 s97, s15, s16
    s_mul_i32 s75, s97, 57
    buffer_load_dwordx4 v[128:131], v10, s[36:39], s4 offen offset:0 sc1
    buffer_load_dwordx4 v[132:135], v10, s[36:39], s4 offen offset:256 sc1
    buffer_load_dwordx4 v[136:139], v11, s[36:39], s4 offen offset:0 sc1
    buffer_load_dwordx4 v[140:143], v11, s[36:39], s4 offen offset:256 sc1
    s_lshr_b32 s75, s75, 9
    s_mul_i32 s75, s75, 27648
    buffer_load_dwordx4 v[112:115], v10, s[36:39], s4 offen offset:2048 sc1
    s_lshl_b32 s96, s97, 10
    s_add_u32 s75, s75, s96
    buffer_load_dwordx4 v[116:119], v10, s[36:39], s4 offen offset:2304 sc1
    s_and_b32 s90, s15, 1
    s_lshr_b32 s91, s15, 1
    buffer_load_dwordx4 v[120:123], v11, s[36:39], s4 offen offset:2048 sc1
    s_lshl_b32 s93, s16, 7
    s_mul_i32 s76, s90, 9
    buffer_load_dwordx4 v[124:127], v11, s[36:39], s4 offen offset:2304 sc1
    s_add_u32 s76, s76, s91
    s_lshl_b32 s76, s76, 10
    buffer_load_dwordx4 v[216:219], v10, s[36:39], s5 offen offset:0 sc1
    s_add_u32 s76, s76, s93
    s_add_u32 s76, s76, 115712
    buffer_load_dwordx4 v[220:223], v10, s[36:39], s5 offen offset:256 sc1
    s_lshl2_add_u32 s92, s90, s16
    s_lshl_b32 s84, s92, 5
    buffer_load_dwordx4 v[224:227], v11, s[36:39], s5 offen offset:0 sc1
    buffer_load_dwordx4 v[228:231], v11, s[36:39], s5 offen offset:256 sc1
    s_waitcnt vmcnt(8)
    v_max3_u32 v15, v128, v129, v130
    v_max3_u32 v15, v15, v131, v132
    v_max3_u32 v15, v15, v133, v134
    v_max3_u32 v15, v15, v135, v136
    v_max3_u32 v15, v15, v137, v138
    v_max3_u32 v15, v15, v139, v140
    v_max3_u32 v15, v15, v141, v142
    v_max_u32 v15, v15, v143
    v_cmp_eq_u32 vcc, -1, v15
    s_cbranch_vccnz hg_slow0
hg_back0:
    v_mfma_f32_16x16x32_bf16 v[80:83], v[208:211], v[128:131], 0
    buffer_load_dwordx4 v[232:235], v10, s[36:39], s5 offen offset:2048 sc1
    ds_write_b128 v3, v[128:131] offset:0
    v_mfma_f32_16x16x32_bf16 v[84:87], v[212:215], v[128:131], 0
    buffer_load_dwordx4 v[236:239], v10, s[36:39], s5 offen offset:2304 sc1
    ds_write_b128 v3, v[132:135] offset:256
    v_mfma_f32_16x16x32_bf16 v[16:19], v[144:147], v[128:131], 0
    buffer_load_dwordx4 v[240:243], v11, s[36:39], s5 offen offset:2048 sc1
    ds_write_b128 v3, v[136:139] offset:9216
    v_mfma_f32_16x16x32_bf16 v[20:23], v[148:151], v[128:131], 0
    buffer_load_dwordx4 v[244:247], v11, s[36:39], s5 offen offset:2304 sc1
    ds_write_b128 v3, v[140:143] offset:9472
    v_mfma_f32_16x16x32_bf16 v[28:31], v[148:151], v[132:135], 0
    buffer_load_dwordx4 v[248:251], v12, s[36:39], s6 offen sc1
    v_mfma_f32_16x16x32_bf16 v[24:27], v[144:147], v[132:135], 0
    buffer_load_dwordx4 v[252:255], v12, s[36:39], s62 offen sc1
    v_mfma_f32_16x16x32_bf16 v[92:95], v[212:215], v[132:135], 0
    global_load_dwordx4 a[184:187], v2, s[28:29] offset:-2048 sc1
    v_mfma_f32_16x16x32_bf16 v[88:91], v[208:211], v[132:135], 0
    v_mfma_f32_16x16x32_bf16 v[96:99], v[208:211], v[136:139], 0
    v_mfma_f32_16x16x32_bf16 v[100:103], v[212:215], v[136:139], 0
    s_waitcnt vmcnt(11)
    v_max3_u32 v15, v112, v113, v114
    v_max3_u32 v15, v15, v115, v116
    v_max3_u32 v15, v15, v117, v118
    v_max3_u32 v15, v15, v119, v120
    v_mfma_f32_16x16x32_bf16 v[32:35], v[144:147], v[136:139], 0
    global_load_dwordx4 a[188:191], v2, s[28:29] offset:-1024 sc1
    v_max3_u32 v15, v15, v121, v122
    v_max3_u32 v15, v15, v123, v124
    v_max3_u32 v15, v15, v125, v126
    v_mfma_f32_16x16x32_bf16 v[36:39], v[148:151], v[136:139], 0
    v_max_u32 v15, v15, v127
    v_cmp_eq_u32 vcc, -1, v15
    s_cbranch_vccnz hg_slow1
hg_back1:
    v_mfma_f32_16x16x32_bf16 v[44:47], v[148:151], v[140:143], 0
    ds_write_b128 v3, v[112:115] offset:2048
    v_mfma_f32_16x16x32_bf16 v[40:43], v[144:147], v[140:143], 0
    ds_write_b128 v3, v[116:119] offset:2304
    v_mfma_f32_16x16x32_bf16 v[108:111], v[212:215], v[140:143], 0
    global_load_dwordx4 a[192:195], v2, s[50:51] offset:2048 sc1
    v_mfma_f32_16x16x32_bf16 v[104:107], v[208:211], v[140:143], 0
    ds_write_b128 v3, v[120:123] offset:11264
    v_mfma_f32_16x16x32_bf16 v[80:83], v[152:155], v[112:115], v[80:83]
    ds_write_b128 v3, v[124:127] offset:11520
    v_mfma_f32_16x16x32_bf16 v[84:87], v[156:159], v[112:115], v[84:87]
    buffer_load_dwordx4 v[128:131], v9, s[36:39], s7 offen offset:0 sc1
    v_mfma_f32_16x16x32_bf16 v[16:19], v[160:163], v[112:115], v[16:19]
    buffer_load_dwordx4 v[132:135], v9, s[36:39], s7 offen offset:16 sc1
    v_mfma_f32_16x16x32_bf16 v[20:23], v[164:167], v[112:115], v[20:23]
    global_load_dwordx4 a[196:199], v2, s[50:51] offset:3072 sc1
    buffer_load_dwordx4 v[136:139], v9, s[36:39], s7 offen offset:2048 sc1
    v_mfma_f32_16x16x32_bf16 v[28:31], v[164:167], v[116:119], v[28:31]
    buffer_load_dwordx4 v[140:143], v9, s[36:39], s7 offen offset:2064 sc1
    v_mfma_f32_16x16x32_bf16 v[24:27], v[160:163], v[116:119], v[24:27]
    v_mfma_f32_16x16x32_bf16 v[92:95], v[156:159], v[116:119], v[92:95]
    s_waitcnt vmcnt(14)
    v_max3_u32 v15, v216, v217, v218
    v_max3_u32 v15, v15, v219, v220
    v_mfma_f32_16x16x32_bf16 v[88:91], v[152:155], v[116:119], v[88:91]
    global_load_dwordx4 a[200:203], v2, s[28:29] offset:2048 sc1
    v_max3_u32 v15, v15, v221, v222
    v_max3_u32 v15, v15, v223, v224
    v_mfma_f32_16x16x32_bf16 v[96:99], v[152:155], v[120:123], v[96:99]
    v_max3_u32 v15, v15, v225, v226
    v_max3_u32 v15, v15, v227, v228
    v_mfma_f32_16x16x32_bf16 v[100:103], v[156:159], v[120:123], v[100:103]
    v_max3_u32 v15, v15, v229, v230
    v_max_u32 v15, v15, v231
    v_mfma_f32_16x16x32_bf16 v[32:35], v[160:163], v[120:123], v[32:35]
    v_cmp_eq_u32 vcc, -1, v15
    s_cbranch_vccnz hg_slow2
hg_back2:
    v_mfma_f32_16x16x32_bf16 v[36:39], v[164:167], v[120:123], v[36:39]
    global_load_dwordx4 a[204:207], v2, s[28:29] offset:3072 sc1
    ds_write_b128 v3, v[216:219] offset:4096
    v_mfma_f32_16x16x32_bf16 v[44:47], v[164:167], v[124:127], v[44:47]
    ds_write_b128 v3, v[220:223] offset:4352
    v_mfma_f32_16x16x32_bf16 v[40:43], v[160:163], v[124:127], v[40:43]
    ds_write_b128 v3, v[224:227] offset:13312
    v_mfma_f32_16x16x32_bf16 v[108:111], v[156:159], v[124:127], v[108:111]
    ds_write_b128 v3, v[228:231] offset:13568
    v_mfma_f32_16x16x32_bf16 v[104:107], v[152:155], v[124:127], v[104:107]
    v_mfma_f32_16x16x32_bf16 v[80:83], v[168:171], v[216:219], v[80:83]
    global_load_dwordx4 a[208:211], v13, s[50:51] offset:-2048 sc1
    v_mfma_f32_16x16x32_bf16 v[84:87], v[172:175], v[216:219], v[84:87]
    v_mfma_f32_16x16x32_bf16 v[16:19], v[176:179], v[216:219], v[16:19]
    s_waitcnt vmcnt(11)
    v_max3_u32 v15, v232, v233, v234
    v_max3_u32 v15, v15, v235, v236
    v_mfma_f32_16x16x32_bf16 v[20:23], v[180:183], v[216:219], v[20:23]
    v_max3_u32 v15, v15, v237, v238
    v_max3_u32 v15, v15, v239, v240
    v_max3_u32 v15, v15, v241, v242
    v_mfma_f32_16x16x32_bf16 v[28:31], v[180:183], v[220:223], v[28:31]
    global_load_dwordx4 a[212:215], v13, s[50:51] offset:-1024 sc1
    v_max3_u32 v15, v15, v243, v244
    v_mfma_f32_16x16x32_bf16 v[24:27], v[176:179], v[220:223], v[24:27]
    v_max3_u32 v15, v15, v245, v246
    v_max3_u32 v15, v15, v247, v248
    v_max3_u32 v15, v15, v249, v250
    v_mfma_f32_16x16x32_bf16 v[92:95], v[172:175], v[220:223], v[92:95]
    v_max3_u32 v15, v15, v251, v252
    v_max3_u32 v15, v15, v253, v254
    v_mfma_f32_16x16x32_bf16 v[88:91], v[168:171], v[220:223], v[88:91]
    v_max_u32 v15, v15, v255
    v_cmp_eq_u32 vcc, -1, v15
    s_cbranch_vccnz hg_slow3
hg_back3:
    v_mfma_f32_16x16x32_bf16 v[96:99], v[168:171], v[224:227], v[96:99]
    ds_write_b128 v3, v[232:235] offset:6144
    v_mfma_f32_16x16x32_bf16 v[100:103], v[172:175], v[224:227], v[100:103]
    ds_write_b128 v3, v[236:239] offset:6400
    v_mfma_f32_16x16x32_bf16 v[32:35], v[176:179], v[224:227], v[32:35]
    ds_write_b128 v3, v[240:243] offset:15360
    v_mfma_f32_16x16x32_bf16 v[36:39], v[180:183], v[224:227], v[36:39]
    ds_write_b128 v3, v[244:247] offset:15616
    v_mfma_f32_16x16x32_bf16 v[44:47], v[180:183], v[228:231], v[44:47]
    v_add_u32 v214, s19, v12
    v_add_u32 v215, 36864, v12
    v_mfma_f32_16x16x32_bf16 v[40:43], v[176:179], v[228:231], v[40:43]
    global_load_dwordx4 v[176:179], v13, s[28:29] offset:-4096 sc1
    ds_write_b128 v214, v[248:251] offset:8192
    v_mfma_f32_16x16x32_bf16 v[108:111], v[172:175], v[228:231], v[108:111]
    global_load_dwordx4 v[180:183], v13, s[28:29] offset:-3072 sc1
    v_mfma_f32_16x16x32_bf16 v[104:107], v[168:171], v[228:231], v[104:107]
    ds_write_b128 v214, v[252:255] offset:17408
    v_mfma_f32_16x16x32_bf16 v[80:83], v[184:187], v[232:235], v[80:83]
    v_mfma_f32_16x16x32_bf16 v[84:87], v[188:191], v[232:235], v[84:87]
    v_mfma_f32_16x16x32_bf16 v[16:19], v[192:195], v[232:235], v[16:19]
    v_mfma_f32_16x16x32_bf16 v[20:23], v[196:199], v[232:235], v[20:23]
    v_mfma_f32_16x16x32_bf16 v[28:31], v[196:199], v[236:239], v[28:31]
    s_waitcnt lgkmcnt(0)
    s_barrier
    v_mfma_f32_16x16x32_bf16 v[24:27], v[192:195], v[236:239], v[24:27]
    ds_read_b128 a[216:219], v5 offset:0
    v_mfma_f32_16x16x32_bf16 v[92:95], v[188:191], v[236:239], v[92:95]
    ds_read_b128 a[220:223], v5 offset:256
    v_mfma_f32_16x16x32_bf16 v[88:91], v[184:187], v[236:239], v[88:91]
    ds_read_b128 a[224:227], v5 offset:9216
    v_mfma_f32_16x16x32_bf16 v[96:99], v[184:187], v[240:243], v[96:99]
    s_add_u32 s20, s98, 114688
    s_addc_u32 s21, s99, 0
    ds_read_b128 a[228:231], v5 offset:9472
    v_mfma_f32_16x16x32_bf16 v[100:103], v[188:191], v[240:243], v[100:103]
    s_lshl_b32 s18, s16, 12
    ds_read_b128 a[232:235], v5 offset:2048
    v_mfma_f32_16x16x32_bf16 v[32:35], v[192:195], v[240:243], v[32:35]
    s_add_u32 s18, s18, 147456
    ds_read_b128 a[236:239], v5 offset:2304
    v_mfma_f32_16x16x32_bf16 v[36:39], v[196:199], v[240:243], v[36:39]
    s_add_u32 s22, s98, 131072
    s_addc_u32 s23, s99, 0
    ds_read_b128 a[240:243], v5 offset:11264
    v_mfma_f32_16x16x32_bf16 v[44:47], v[196:199], v[244:247], v[44:47]
    s_add_u32 s32, s98, 147456
    s_addc_u32 s33, s99, 0
    ds_read_b128 a[244:247], v5 offset:11520
    v_mfma_f32_16x16x32_bf16 v[40:43], v[192:195], v[244:247], v[40:43]
    s_add_u32 s34, s98, 163840
    s_addc_u32 s35, s99, 0
    ds_read_b128 a[248:251], v5 offset:4096
    v_mfma_f32_16x16x32_bf16 v[108:111], v[188:191], v[244:247], v[108:111]
    s_add_u32 s40, s98, 180224
    s_addc_u32 s41, s99, 0
    ds_read_b128 a[252:255], v5 offset:4352
    v_mfma_f32_16x16x32_bf16 v[104:107], v[184:187], v[244:247], v[104:107]
    s_waitcnt lgkmcnt(9)
    global_load_dwordx4 v[184:187], v13, s[50:51] offset:0 sc1
    v_mfma_f32_16x16x32_bf16 v[80:83], v[200:203], a[216:219], v[80:83]
    s_add_u32 s42, s98, 196608
    s_addc_u32 s43, s99, 0
    global_load_dwordx4 v[188:191], v13, s[50:51] offset:1024 sc1
    v_mfma_f32_16x16x32_bf16 v[84:87], v[204:207], a[216:219], v[84:87]
    s_add_u32 s44, s98, 212992
    s_addc_u32 s45, s99, 0
    global_load_dwordx4 v[192:195], v13, s[28:29] offset:-2048 sc1
    v_mfma_f32_16x16x32_bf16 v[16:19], a[0:3], a[216:219], v[16:19]
    s_add_u32 s46, s98, 229376
    s_addc_u32 s47, s99, 0
    v_add_u32 v252, s75, v12
    v_mfma_f32_16x16x32_bf16 v[20:23], a[4:7], a[216:219], v[20:23]
    s_waitcnt lgkmcnt(8)
    ds_read_b128 a[216:219], v5 offset:13312
    v_and_b32 v253, 0x70, v2
    v_mfma_f32_16x16x32_bf16 v[28:31], a[4:7], a[220:223], v[28:31]
    s_add_u32 s48, s98, 245760
    s_addc_u32 s49, s99, 0
    global_load_dwordx4 v[196:199], v13, s[28:29] offset:-1024 sc1
    v_mfma_f32_16x16x32_bf16 v[24:27], a[0:3], a[220:223], v[24:27]
    s_add_u32 s52, s98, 262144
    s_addc_u32 s53, s99, 0
    v_bfe_u32 v254, v2, 7, 1
    v_mfma_f32_16x16x32_bf16 v[92:95], v[204:207], a[220:223], v[92:95]
    s_add_u32 s54, s98, 278528
    s_addc_u32 s55, s99, 0
    v_lshrrev_b32 v255, 8, v2
    v_mfma_f32_16x16x32_bf16 v[88:91], v[200:203], a[220:223], v[88:91]
    s_waitcnt lgkmcnt(8)
    ds_read_b128 a[220:223], v5 offset:13568
    v_lshl_add_u32 v253, v254, 9, v253
    v_mfma_f32_16x16x32_bf16 v[96:99], v[200:203], a[224:227], v[96:99]
    s_add_u32 s56, s98, 294912
    s_addc_u32 s57, s99, 0
    v_lshl_add_u32 v253, v255, 2, v253
    v_mfma_f32_16x16x32_bf16 v[100:103], v[204:207], a[224:227], v[100:103]
    s_add_u32 s58, s98, 311296
    s_addc_u32 s59, s99, 0
    v_add_u32 v253, s76, v253
    v_mfma_f32_16x16x32_bf16 v[32:35], a[0:3], a[224:227], v[32:35]
    s_add_u32 s60, s98, 327680
    s_addc_u32 s61, s99, 0
    ds_read_b128 v[240:243], v252
    v_mfma_f32_16x16x32_bf16 v[36:39], a[4:7], a[224:227], v[36:39]
    s_waitcnt lgkmcnt(9)
    ds_read_b128 a[224:227], v5 offset:6144
    ds_read_b128 v[244:247], v252 offset:9216
    v_mfma_f32_16x16x32_bf16 v[44:47], a[4:7], a[228:231], v[44:47]
    s_mul_i32 s80, s92, 9216
    ds_read_b32 v250, v253
    v_bfe_u32 v254, v12, 4, 5
    v_mfma_f32_16x16x32_bf16 v[40:43], a[0:3], a[228:231], v[40:43]
    s_add_u32 s80, s80, s94
    v_bfe_u32 v255, v2, 4, 3
    v_lshlrev_b32 v254, 2, v254
    v_mfma_f32_16x16x32_bf16 v[108:111], v[204:207], a[228:231], v[108:111]
    s_lshl_b32 s92, s91, 5
    v_lshl_add_u32 v255, v255, 2, s84
    v_add_u32 v254, 145408, v254
    v_mfma_f32_16x16x32_bf16 v[104:107], v[200:203], a[228:231], v[104:107]
    s_waitcnt lgkmcnt(11)
    global_load_dwordx4 v[200:203], v13, s[50:51] offset:2048 sc1
    ds_read_b128 a[228:231], v5 offset:6400
    v_mfma_f32_16x16x32_bf16 v[80:83], a[8:11], a[232:235], v[80:83]
    s_add_u32 s80, s80, s92
    global_load_dwordx4 v[204:207], v13, s[50:51] offset:3072 sc1
    v_add_u32 v255, 145408, v255
    v_mfma_f32_16x16x32_bf16 v[84:87], a[12:15], a[232:235], v[84:87]
    s_add_u32 s80, s80, 1024
    global_load_dwordx4 a[0:3], v13, s[28:29] offset:0 sc1
    ds_read_b32 v248, v254
    v_mfma_f32_16x16x32_bf16 v[16:19], a[16:19], a[232:235], v[16:19]
    s_lshl_b32 s79, s97, 5
    ds_read_b32 v249, v254 offset:128
    ds_read_b32 v251, v255
    v_mfma_f32_16x16x32_bf16 v[20:23], a[20:23], a[232:235], v[20:23]
    s_waitcnt lgkmcnt(14)
    ds_read_b128 a[232:235], v5 offset:15360
    v_mfma_f32_16x16x32_bf16 v[28:31], a[20:23], a[236:239], v[28:31]
    s_add_u32 s79, s79, s94
    v_mfma_f32_16x16x32_bf16 v[24:27], a[16:19], a[236:239], v[24:27]
    s_add_u32 s85, s79, 36864
    global_load_dwordx4 a[4:7], v13, s[28:29] offset:1024 sc1
    v_mfma_f32_16x16x32_bf16 v[92:95], a[12:15], a[236:239], v[92:95]
    s_add_u32 s95, s94, 23068672
    v_mfma_f32_16x16x32_bf16 v[88:91], a[8:11], a[236:239], v[88:91]
    s_waitcnt lgkmcnt(14)
    ds_read_b128 a[236:239], v5 offset:15616
    v_mfma_f32_16x16x32_bf16 v[96:99], a[8:11], a[240:243], v[96:99]
    s_mul_i32 s92, s90, 36
    v_mfma_f32_16x16x32_bf16 v[100:103], a[12:15], a[240:243], v[100:103]
    s_add_u32 s92, s92, s91
    v_mfma_f32_16x16x32_bf16 v[32:35], a[16:19], a[240:243], v[32:35]
    s_add_u32 s92, s92, 32
    s_waitcnt vmcnt(14)
    v_max3_u32 v15, v128, v129, v130
    v_mfma_f32_16x16x32_bf16 v[36:39], a[20:23], a[240:243], v[36:39]
    s_waitcnt lgkmcnt(14)
    ds_read_b128 a[240:243], v7 offset:8192
    v_max3_u32 v15, v15, v131, v132
    v_mfma_f32_16x16x32_bf16 v[44:47], a[20:23], a[244:247], v[44:47]
    s_lshl_b32 s92, s92, 10
    v_max3_u32 v15, v15, v133, v134
    v_max3_u32 v15, v15, v135, v136
    v_mfma_f32_16x16x32_bf16 v[40:43], a[16:19], a[244:247], v[40:43]
    s_add_u32 s92, s92, s93
    v_max3_u32 v15, v15, v137, v138
    v_max3_u32 v15, v15, v139, v140
    v_mfma_f32_16x16x32_bf16 v[108:111], a[12:15], a[244:247], v[108:111]
    s_add_u32 s73, s95, s92
    v_max3_u32 v15, v15, v141, v142
    v_max_u32 v15, v15, v143
    v_mfma_f32_16x16x32_bf16 v[104:107], a[8:11], a[244:247], v[104:107]
    s_waitcnt lgkmcnt(14)
    global_load_dwordx4 a[8:11], v2, s[20:21] offset:-4096 sc1
    ds_read_b128 a[244:247], v7 offset:8448
    v_mfma_f32_16x16x32_bf16 v[80:83], a[24:27], a[248:251], v[80:83]
    s_add_u32 s74, s73, 9437184
    global_load_dwordx4 a[12:15], v2, s[20:21] offset:-3072 sc1
    v_mfma_f32_16x16x32_bf16 v[84:87], a[28:31], a[248:251], v[84:87]
    s_mov_b32 s81, 0x00003f80
    v_cmp_eq_u32 vcc, -1, v15
    s_cbranch_vccnz k4_slowS
k4_backS:
    v_mfma_f32_16x16x32_bf16 v[16:19], a[32:35], a[248:251], v[16:19]
    s_mov_b32 s82, 0x3f800000
    global_load_dwordx4 a[16:19], v13, s[28:29] offset:2048 sc1
    s_mov_b32 s7, 0xffff0000
    v_mfma_f32_16x16x32_bf16 v[20:23], a[36:39], a[248:251], v[20:23]
    s_waitcnt lgkmcnt(14)
    ds_read_b128 a[248:251], v7 offset:17408
    v_add_f32 v128, v128, v132
    v_mfma_f32_16x16x32_bf16 v[28:31], a[36:39], a[252:255], v[28:31]
    s_add_u32 s96, s95, s96
    v_add_f32 v129, v129, v133
    v_add_f32 v130, v130, v134
    v_mfma_f32_16x16x32_bf16 v[24:27], a[32:35], a[252:255], v[24:27]
    s_sub_u32 s92, s15, 1
    v_add_f32 v131, v131, v135
    v_add_f32 v128, v128, v129
    v_mfma_f32_16x16x32_bf16 v[92:95], a[28:31], a[252:255], v[92:95]
    s_and_b32 s92, s92, 7
    v_add_f32 v130, v130, v131
    v_add_f32 v136, v136, v140
    v_mfma_f32_16x16x32_bf16 v[88:91], a[24:27], a[252:255], v[88:91]
    s_waitcnt lgkmcnt(14)
    global_load_dwordx4 a[20:23], v13, s[28:29] offset:3072 sc1
    ds_read_b128 a[252:255], v7 offset:17664
    v_mfma_f32_16x16x32_bf16 v[96:99], a[24:27], a[216:219], v[96:99]
    s_mul_i32 s92, s92, 2359296
    v_add_f32 v137, v137, v141
    v_add_f32 v138, v138, v142
    v_mfma_f32_16x16x32_bf16 v[100:103], a[28:31], a[216:219], v[100:103]
    s_add_u32 s66, s96, s92
    v_add_f32 v139, v139, v143
    v_add_f32 v136, v136, v137
    v_mfma_f32_16x16x32_bf16 v[32:35], a[32:35], a[216:219], v[32:35]
    s_sub_u32 s92, s15, 2
    v_add_f32 v138, v138, v139
    v_add_f32 v212, v128, v130
    v_mfma_f32_16x16x32_bf16 v[36:39], a[36:39], a[216:219], v[36:39]
    s_waitcnt lgkmcnt(14)
    ds_read_b128 a[216:219], v4 offset:0
    v_add_f32 v213, v136, v138
    v_mfma_f32_16x16x32_bf16 v[44:47], a[36:39], a[220:223], v[44:47]
    s_and_b32 s92, s92, 7
    v_mov_b32 v14, 0x3727c5ac
    v_mfma_f32_16x16x32_bf16 v[40:43], a[32:35], a[220:223], v[40:43]
    s_mul_i32 s92, s92, 2359296
    v_permlane32_swap_b32 v212, v213
    v_mfma_f32_16x16x32_bf16 v[108:111], a[28:31], a[220:223], v[108:111]
    s_add_u32 s67, s96, s92
    v_add_f32 v212, v212, v213
    v_fmac_f32 v14, 0x3ae38e39, v212
    v_mfma_f32_16x16x32_bf16 v[104:107], a[24:27], a[220:223], v[104:107]
    s_waitcnt lgkmcnt(13)
    global_load_dwordx4 a[24:27], v2, s[20:21] offset:-2048 sc1
    ds_read_b128 a[220:223], v4 offset:256
    v_mfma_f32_16x16x32_bf16 v[80:83], a[40:43], a[224:227], v[80:83]
    s_sub_u32 s92, s15, 3
    global_load_dwordx4 a[28:31], v2, s[20:21] offset:-1024 sc1
    v_mfma_f32_16x16x32_bf16 v[84:87], a[44:47], a[224:227], v[84:87]
    s_and_b32 s92, s92, 7
    v_rsq_f32 v14, v14
    v_mfma_f32_16x16x32_bf16 v[16:19], a[48:51], a[224:227], v[16:19]
    s_mul_i32 s92, s92, 2359296
    v_mul_f32 v208, 0xbfb8aa3b, v14
    v_mul_f32 v210, 0xbfb8aa3b, v14
    v_mfma_f32_16x16x32_bf16 v[20:23], a[52:55], a[224:227], v[20:23]
    s_waitcnt lgkmcnt(11)
    ds_read_b128 a[224:227], v4 offset:9216
    v_mfma_f32_16x16x32_bf16 v[28:31], a[52:55], a[228:231], v[28:31]
    s_add_u32 s68, s96, s92
    global_load_dwordx4 a[32:35], v13, s[30:31] offset:-4096 sc1
    v_mfma_f32_16x16x32_bf16 v[24:27], a[48:51], a[228:231], v[24:27]
    s_sub_u32 s92, s15, 4
    v_permlane32_swap_b32 v208, v210
    v_mfma_f32_16x16x32_bf16 v[92:95], a[44:47], a[228:231], v[92:95]
    s_and_b32 s92, s92, 7
    v_mov_b32 v209, v208
    v_mov_b32 v211, v210
    v_mfma_f32_16x16x32_bf16 v[88:91], a[40:43], a[228:231], v[88:91]
    s_waitcnt lgkmcnt(8)
    ds_read_b128 a[228:231], v4 offset:9472
    v_mfma_f32_16x16x32_bf16 v[96:99], a[40:43], a[232:235], v[96:99]
    s_mul_i32 s92, s92, 2359296
    global_load_dwordx4 a[36:39], v13, s[30:31] offset:-3072 sc1
    v_mfma_f32_16x16x32_bf16 v[100:103], a[44:47], a[232:235], v[100:103]
    s_add_u32 s69, s96, s92
    v_permlane16_swap_b32 v208, v209
    v_mfma_f32_16x16x32_bf16 v[32:35], a[48:51], a[232:235], v[32:35]
    s_sub_u32 s92, s15, 5
    v_permlane16_swap_b32 v210, v211
    v_mfma_f32_16x16x32_bf16 v[36:39], a[52:55], a[232:235], v[36:39]
    s_waitcnt lgkmcnt(8)
    ds_read_b128 a[232:235], v4 offset:2048
    v_mov_b32 v212, v208
    v_mfma_f32_16x16x32_bf16 v[44:47], a[52:55], a[236:239], v[44:47]
wc_pad0:
    s_cbranch_execz wc_pad4
    s_and_b32 s92, s92, 7
    v_mov_b32 v128, v209
    v_mov_b32 v213, v210
    v_mfma_f32_16x16x32_bf16 v[40:43], a[48:51], a[236:239], v[40:43]
    s_mul_i32 s92, s92, 2359296
    v_mov_b32 v129, v211
    v_mfma_f32_16x16x32_bf16 v[108:111], a[44:47], a[236:239], v[108:111]
    s_add_u32 s70, s96, s92
    v_permlane32_swap_b32 v212, v128
    v_mfma_f32_16x16x32_bf16 v[104:107], a[40:43], a[236:239], v[104:107]
    s_waitcnt lgkmcnt(8)
    global_load_dwordx4 a[40:43], v13, s[20:21] offset:0 sc1
    ds_read_b128 a[236:239], v4 offset:2304
    v_mfma_f32_16x16x32_bf16 v[80:83], a[56:59], a[240:243], v[80:83]
    s_sub_u32 s92, s15, 6
    v_permlane32_swap_b32 v213, v129
    v_mfma_f32_16x16x32_bf16 v[84:87], a[60:63], a[240:243], v[84:87]
    s_and_b32 s92, s92, 7
    global_load_dwordx4 a[44:47], v13, s[20:21] offset:1024 sc1
    v_lshlrev_b32 v9, 16, v240
    v_mfma_f32_16x16x32_bf16 v[16:19], a[64:67], a[240:243], v[16:19]
    s_mul_i32 s92, s92, 2359296
    v_and_b32 v240, s7, v240
    v_add_f32 v136, v248, v9
    v_mfma_f32_16x16x32_bf16 v[20:23], a[68:71], a[240:243], v[20:23]
    s_waitcnt lgkmcnt(8)
    ds_read_b128 a[240:243], v4 offset:11264
    v_add_f32 v137, v248, v240
    v_mfma_f32_16x16x32_bf16 v[28:31], a[68:71], a[244:247], v[28:31]
    s_add_u32 s71, s96, s92
    v_lshlrev_b32 v15, 16, v241
    v_and_b32 v241, s7, v241
    v_mfma_f32_16x16x32_bf16 v[24:27], a[64:67], a[244:247], v[24:27]
    s_sub_u32 s92, s15, 7
    global_load_dwordx4 a[48:51], v13, s[30:31] offset:-2048 sc1
    v_add_f32 v138, v248, v15
    v_mfma_f32_16x16x32_bf16 v[92:95], a[60:63], a[244:247], v[92:95]
    s_and_b32 s92, s92, 7
    v_add_f32 v139, v248, v241
    v_lshlrev_b32 v9, 16, v242
    v_mfma_f32_16x16x32_bf16 v[88:91], a[56:59], a[244:247], v[88:91]
    s_waitcnt lgkmcnt(8)
    ds_read_b128 a[244:247], v4 offset:11520
    v_and_b32 v242, s7, v242
    v_mfma_f32_16x16x32_bf16 v[96:99], a[56:59], a[248:251], v[96:99]
    s_mul_i32 s92, s92, 2359296
    v_add_f32 v140, v248, v9
    v_add_f32 v141, v248, v242
    v_mfma_f32_16x16x32_bf16 v[100:103], a[60:63], a[248:251], v[100:103]
    s_add_u32 s72, s96, s92
    global_load_dwordx4 a[52:55], v13, s[30:31] offset:-1024 sc1
    v_lshlrev_b32 v15, 16, v243
    v_mfma_f32_16x16x32_bf16 v[32:35], a[64:67], a[248:251], v[32:35]
    s_mul_i32 s96, s15, 2359296
    v_and_b32 v243, s7, v243
    v_add_f32 v142, v248, v15
    v_mfma_f32_16x16x32_bf16 v[36:39], a[68:71], a[248:251], v[36:39]
    s_waitcnt lgkmcnt(8)
    ds_read_b128 a[248:251], v4 offset:4096
    v_add_f32 v143, v248, v243
    v_mfma_f32_16x16x32_bf16 v[44:47], a[68:71], a[252:255], v[44:47]
    s_add_u32 s96, s96, s95
    v_lshlrev_b32 v9, 16, v244
    v_and_b32 v244, s7, v244
    v_mfma_f32_16x16x32_bf16 v[40:43], a[64:67], a[252:255], v[40:43]
    s_and_b32 s90, s16, 1
    v_add_f32 v216, v249, v9
    v_add_f32 v217, v249, v244
    v_mfma_f32_16x16x32_bf16 v[108:111], a[60:63], a[252:255], v[108:111]
    s_lshl_b32 s90, s90, 11
    v_lshlrev_b32 v15, 16, v245
    v_and_b32 v245, s7, v245
    v_mfma_f32_16x16x32_bf16 v[104:107], a[56:59], a[252:255], v[104:107]
    s_waitcnt lgkmcnt(8)
    global_load_dwordx4 a[56:59], v13, s[20:21] offset:2048 sc1
    ds_read_b128 a[252:255], v4 offset:4352
    v_mfma_f32_16x16x32_bf16 v[16:19], a[72:75], a[216:219], v[16:19]
    s_add_u32 s96, s96, s90
    v_add_f32 v218, v249, v15
    v_add_f32 v219, v249, v245
    v_mfma_f32_16x16x32_bf16 v[20:23], a[76:79], a[216:219], v[20:23]
    s_lshr_b32 s90, s16, 1
    v_lshlrev_b32 v9, 16, v246
    v_and_b32 v246, s7, v246
    v_mfma_f32_16x16x32_bf16 v[48:51], a[80:83], a[216:219], 0
    s_add_u32 s91, s90, s15
    global_load_dwordx4 a[60:63], v13, s[20:21] offset:3072 sc1
    v_add_f32 v220, v249, v9
    v_mfma_f32_16x16x32_bf16 v[52:55], a[84:87], a[216:219], 0
    s_waitcnt lgkmcnt(8)
    ds_read_b128 a[216:219], v4 offset:13312
    v_add_f32 v221, v249, v246
    v_mfma_f32_16x16x32_bf16 v[60:63], a[84:87], a[220:223], 0
    s_add_u32 s92, s91, 0
    v_lshlrev_b32 v15, 16, v247
    v_and_b32 v247, s7, v247
    v_mfma_f32_16x16x32_bf16 v[56:59], a[80:83], a[220:223], 0
    s_and_b32 s92, s92, 7
    v_add_f32 v222, v249, v15
    v_add_f32 v223, v249, v247
    v_mfma_f32_16x16x32_bf16 v[28:31], a[76:79], a[220:223], v[28:31]
    s_cmp_eq_u32 s90, 0
    s_cselect_b32 s92, 8, s92
    global_load_dwordx4 a[64:67], v13, s[30:31] offset:0 sc1
    v_mfma_f32_16x16x32_bf16 v[24:27], a[72:75], a[220:223], v[24:27]
    s_waitcnt lgkmcnt(8)
    ds_read_b128 a[220:223], v4 offset:13568
    v_lshlrev_b32 v224, 2, v2
    v_mfma_f32_16x16x32_bf16 v[32:35], a[72:75], a[224:227], v[32:35]
    s_lshl_b32 s92, s92, 12
    s_mov_b32 s17, 3375136
    v_add_u32 v9, s18, v12
    v_mfma_f32_16x16x32_bf16 v[36:39], a[76:79], a[224:227], v[36:39]
    s_add_u32 s64, s96, s92
    buffer_load_dwordx4 v[224:227], v224, s[36:39], s17 offen sc1
    v_mfma_f32_16x16x32_bf16 v[64:67], a[80:83], a[224:227], 0
    s_add_u32 s92, s91, 2
    v_xor_b32 v9, 4096, v9
    v_mfma_f32_16x16x32_bf16 v[68:71], a[84:87], a[224:227], 0
    s_waitcnt lgkmcnt(8)
    global_load_dwordx4 a[68:71], v13, s[30:31] offset:1024 sc1
    ds_read_b128 a[224:227], v4 offset:6144
    v_mfma_f32_16x16x32_bf16 v[76:79], a[84:87], a[228:231], 0
    s_and_b32 s92, s92, 7
    v_permlane32_swap_b32 v80, v88
    v_mfma_f32_16x16x32_bf16 v[72:75], a[80:83], a[228:231], 0
    s_lshl_b32 s92, s92, 12
    v_permlane32_swap_b32 v81, v89
    v_mfma_f32_16x16x32_bf16 v[44:47], a[76:79], a[228:231], v[44:47]
    s_add_u32 s65, s96, s92
    v_permlane32_swap_b32 v82, v90
    v_mfma_f32_16x16x32_bf16 v[40:43], a[72:75], a[228:231], v[40:43]
    s_waitcnt lgkmcnt(8)
    global_load_dwordx4 a[72:75], v2, s[22:23] offset:-4096 sc1
    ds_read_b128 a[228:231], v4 offset:6400
    v_mfma_f32_16x16x32_bf16 v[16:19], a[88:91], a[232:235], v[16:19]
    s_add_u32 s92, s91, 4
    v_permlane32_swap_b32 v83, v91
    v_mfma_f32_16x16x32_bf16 v[20:23], a[92:95], a[232:235], v[20:23]
    s_and_b32 s92, s92, 7
    v_permlane32_swap_b32 v84, v92
    v_mfma_f32_16x16x32_bf16 v[48:51], a[96:99], a[232:235], v[48:51]
    s_lshl_b32 s92, s92, 12
    v_permlane32_swap_b32 v85, v93
    v_mfma_f32_16x16x32_bf16 v[52:55], a[100:103], a[232:235], v[52:55]
    s_waitcnt lgkmcnt(8)
    global_load_dwordx4 a[76:79], v2, s[22:23] offset:-3072 sc1
    ds_read_b128 a[232:235], v4 offset:15360
    v_mfma_f32_16x16x32_bf16 v[60:63], a[100:103], a[236:239], v[60:63]
    s_add_u32 s77, s96, s92
    v_permlane32_swap_b32 v86, v94
    v_mfma_f32_16x16x32_bf16 v[56:59], a[96:99], a[236:239], v[56:59]
    s_add_u32 s92, s91, 6
    v_permlane32_swap_b32 v87, v95
    v_mfma_f32_16x16x32_bf16 v[28:31], a[92:95], a[236:239], v[28:31]
    s_and_b32 s92, s92, 7
    ds_write_b128 v9, v[88:91] offset:0
    v_mfma_f32_16x16x32_bf16 v[24:27], a[88:91], a[236:239], v[24:27]
    s_waitcnt lgkmcnt(9)
    ds_read_b128 a[236:239], v4 offset:15616
    v_mfma_f32_16x16x32_bf16 v[32:35], a[88:91], a[240:243], v[32:35]
    s_lshl_b32 s92, s92, 12
    global_load_dwordx4 a[80:83], v13, s[30:31] offset:2048 sc1
    v_mfma_f32_16x16x32_bf16 v[36:39], a[92:95], a[240:243], v[36:39]
    s_add_u32 s78, s96, s92
    ds_write_b128 v9, v[92:95] offset:1024
    v_mfma_f32_16x16x32_bf16 v[64:67], a[96:99], a[240:243], v[64:67]
    v_permlane32_swap_b32 v96, v104
    v_mfma_f32_16x16x32_bf16 v[68:71], a[100:103], a[240:243], v[68:71]
    s_waitcnt lgkmcnt(10)
    ds_read_b128 a[240:243], v6 offset:0
    v_mfma_f32_16x16x32_bf16 v[76:79], a[100:103], a[244:247], v[76:79]
    global_load_dwordx4 a[84:87], v13, s[30:31] offset:3072 sc1
    v_mfma_f32_16x16x32_bf16 v[72:75], a[96:99], a[244:247], v[72:75]
    v_permlane32_swap_b32 v97, v105
    v_mfma_f32_16x16x32_bf16 v[44:47], a[92:95], a[244:247], v[44:47]
    v_permlane32_swap_b32 v98, v106
    v_mfma_f32_16x16x32_bf16 v[40:43], a[88:91], a[244:247], v[40:43]
    s_waitcnt lgkmcnt(10)
    ds_read_b128 a[244:247], v6 offset:256
    v_mfma_f32_16x16x32_bf16 v[16:19], a[104:107], a[248:251], v[16:19]
    v_permlane32_swap_b32 v99, v107
    v_mfma_f32_16x16x32_bf16 v[20:23], a[108:111], a[248:251], v[20:23]
    global_load_dwordx4 a[88:91], v2, s[22:23] offset:-2048 sc1
    v_mfma_f32_16x16x32_bf16 v[48:51], a[112:115], a[248:251], v[48:51]
    v_permlane32_swap_b32 v100, v108
    v_mfma_f32_16x16x32_bf16 v[52:55], a[116:119], a[248:251], v[52:55]
    s_waitcnt lgkmcnt(10)
    ds_read_b128 a[248:251], v6 offset:9216
    v_mfma_f32_16x16x32_bf16 v[60:63], a[116:119], a[252:255], v[60:63]
    v_permlane32_swap_b32 v101, v109
    v_mfma_f32_16x16x32_bf16 v[56:59], a[112:115], a[252:255], v[56:59]
    global_load_dwordx4 a[92:95], v2, s[22:23] offset:-1024 sc1
    v_mfma_f32_16x16x32_bf16 v[28:31], a[108:111], a[252:255], v[28:31]
    v_permlane32_swap_b32 v102, v110
    v_mfma_f32_16x16x32_bf16 v[24:27], a[104:107], a[252:255], v[24:27]
    s_waitcnt lgkmcnt(10)
    ds_read_b128 a[252:255], v6 offset:9472
    v_mfma_f32_16x16x32_bf16 v[32:35], a[104:107], a[216:219], v[32:35]
    v_permlane32_swap_b32 v103, v111
    v_mfma_f32_16x16x32_bf16 v[36:39], a[108:111], a[216:219], v[36:39]
    global_load_dwordx4 a[96:99], v13, s[50:51] offset:-4096 sc1
    v_mfma_f32_16x16x32_bf16 v[64:67], a[112:115], a[216:219], v[64:67]
    ds_write_b128 v9, v[104:107] offset:2048
    v_mfma_f32_16x16x32_bf16 v[68:71], a[116:119], a[216:219], v[68:71]
    s_waitcnt lgkmcnt(11)
    ds_read_b128 a[216:219], v6 offset:2048
    v_mfma_f32_16x16x32_bf16 v[76:79], a[116:119], a[220:223], v[76:79]
    ds_write_b128 v9, v[108:111] offset:3072
    v_mfma_f32_16x16x32_bf16 v[72:75], a[112:115], a[220:223], v[72:75]
    v_xor_b32 v9, 4096, v9
    v_mfma_f32_16x16x32_bf16 v[44:47], a[108:111], a[220:223], v[44:47]
    global_load_dwordx4 a[100:103], v13, s[50:51] offset:-3072 sc1
    v_mfma_f32_16x16x32_bf16 v[40:43], a[104:107], a[220:223], v[40:43]
    s_waitcnt lgkmcnt(12)
    ds_read_b128 a[220:223], v6 offset:2304
    v_mfma_f32_16x16x32_bf16 v[16:19], a[120:123], a[224:227], v[16:19]
    v_mfma_f32_16x16x32_bf16 v[20:23], a[124:127], a[224:227], v[20:23]
    s_waitcnt lgkmcnt(1)
    s_barrier
    v_mfma_f32_16x16x32_bf16 v[48:51], a[128:131], a[224:227], v[48:51]
    global_load_dwordx4 a[104:107], v13, s[22:23] offset:0 sc1
    ds_read_b128 v[112:115], v9 offset:0
    v_mfma_f32_16x16x32_bf16 v[52:55], a[132:135], a[224:227], v[52:55]
    ds_read_b128 a[224:227], v6 offset:11264
    ds_read_b128 v[116:119], v9 offset:1024
    v_mfma_f32_16x16x32_bf16 v[60:63], a[132:135], a[228:231], v[60:63]
    ds_read_b128 v[120:123], v9 offset:2048
    ds_read_b128 v[124:127], v9 offset:3072
    v_mfma_f32_16x16x32_bf16 v[56:59], a[128:131], a[228:231], v[56:59]
    v_mfma_f32_16x16x32_bf16 v[28:31], a[124:127], a[228:231], v[28:31]
    global_load_dwordx4 a[108:111], v13, s[22:23] offset:1024 sc1
    v_mfma_f32_16x16x32_bf16 v[24:27], a[120:123], a[228:231], v[24:27]
    ds_read_b128 a[228:231], v6 offset:11520
    v_mfma_f32_16x16x32_bf16 v[32:35], a[120:123], a[232:235], v[32:35]
    v_mfma_f32_16x16x32_bf16 v[36:39], a[124:127], a[232:235], v[36:39]
    v_mfma_f32_16x16x32_bf16 v[64:67], a[128:131], a[232:235], v[64:67]
    v_mfma_f32_16x16x32_bf16 v[68:71], a[132:135], a[232:235], v[68:71]
    global_load_dwordx4 a[112:115], v2, s[20:21] offset:0 sc1
    ds_read_b128 a[232:235], v6 offset:4096
    v_mfma_f32_16x16x32_bf16 v[76:79], a[132:135], a[236:239], v[76:79]
    v_mfma_f32_16x16x32_bf16 v[72:75], a[128:131], a[236:239], v[72:75]
    v_mfma_f32_16x16x32_bf16 v[44:47], a[124:127], a[236:239], v[44:47]
    s_waitcnt lgkmcnt(2)
    v_add_f32 v112, v112, v80
    v_add_f32 v113, v113, v81
    v_mfma_f32_16x16x32_bf16 v[40:43], a[120:123], a[236:239], v[40:43]
    global_load_dwordx4 a[116:119], v2, s[20:21] offset:1024 sc1
    ds_read_b128 a[236:239], v6 offset:4352
    v_mfma_f32_16x16x32_bf16 v[16:19], a[136:139], a[240:243], v[16:19]
    v_add_f32 v114, v114, v82
    v_add_f32 v115, v115, v83
    v_mfma_f32_16x16x32_bf16 v[20:23], a[140:143], a[240:243], v[20:23]
    v_add_f32 v116, v116, v84
    v_add_f32 v117, v117, v85
    v_mfma_f32_16x16x32_bf16 v[48:51], a[144:147], a[240:243], v[48:51]
    v_add_f32 v118, v118, v86
    v_add_f32 v119, v119, v87
    v_mfma_f32_16x16x32_bf16 v[52:55], a[148:151], a[240:243], v[52:55]
    global_load_dwordx4 a[120:123], v13, s[32:33] offset:-4096 sc1
    ds_read_b128 a[240:243], v6 offset:13312
    v_mfma_f32_16x16x32_bf16 v[60:63], a[148:151], a[244:247], v[60:63]
    v_add_f32 v120, v120, v96
    v_add_f32 v121, v121, v97
    v_mfma_f32_16x16x32_bf16 v[56:59], a[144:147], a[244:247], v[56:59]
    v_add_f32 v122, v122, v98
    v_add_f32 v123, v123, v99
    v_mfma_f32_16x16x32_bf16 v[28:31], a[140:143], a[244:247], v[28:31]
    v_add_f32 v124, v124, v100
    v_add_f32 v125, v125, v101
    v_mfma_f32_16x16x32_bf16 v[24:27], a[136:139], a[244:247], v[24:27]
    ds_read_b128 a[244:247], v6 offset:13568
    v_add_f32 v126, v126, v102
    v_mfma_f32_16x16x32_bf16 v[32:35], a[136:139], a[248:251], v[32:35]
    global_load_dwordx4 a[124:127], v13, s[32:33] offset:-3072 sc1
    v_add_f32 v127, v127, v103
    v_mfma_f32_16x16x32_bf16 v[36:39], a[140:143], a[248:251], v[36:39]
    v_mul_f32 v128, v112, v212
    v_mul_f32 v129, v113, v212
    v_mfma_f32_16x16x32_bf16 v[64:67], a[144:147], a[248:251], v[64:67]
    v_mul_f32 v130, v114, v212
    v_mul_f32 v131, v115, v212
    v_mfma_f32_16x16x32_bf16 v[68:71], a[148:151], a[248:251], v[68:71]
    ds_read_b128 a[248:251], v6 offset:6144
    v_mul_f32 v132, v116, v212
    v_mfma_f32_16x16x32_bf16 v[76:79], a[148:151], a[252:255], v[76:79]
    global_load_dwordx4 a[128:131], v2, s[20:21] offset:2048 sc1
    v_mul_f32 v133, v117, v212
    v_mfma_f32_16x16x32_bf16 v[72:75], a[144:147], a[252:255], v[72:75]
    v_exp_f32 v128, v128
    v_mfma_f32_16x16x32_bf16 v[44:47], a[140:143], a[252:255], v[44:47]
    v_exp_f32 v129, v129
    v_mfma_f32_16x16x32_bf16 v[40:43], a[136:139], a[252:255], v[40:43]
    ds_read_b128 a[252:255], v6 offset:6400
    v_add_f32 v128, 1.0, v128
    v_mfma_f32_16x16x32_bf16 v[16:19], a[152:155], a[216:219], v[16:19]
    global_load_dwordx4 a[132:135], v2, s[20:21] offset:3072 sc1
    v_add_f32 v129, 1.0, v129
    v_mfma_f32_16x16x32_bf16 v[20:23], a[156:159], a[216:219], v[20:23]
    v_exp_f32 v130, v130
    v_mfma_f32_16x16x32_bf16 v[48:51], a[160:163], a[216:219], v[48:51]
    v_exp_f32 v131, v131
    v_mfma_f32_16x16x32_bf16 v[52:55], a[164:167], a[216:219], v[52:55]
    ds_read_b128 a[216:219], v6 offset:15360
    v_add_f32 v130, 1.0, v130
    v_mfma_f32_16x16x32_bf16 v[60:63], a[164:167], a[220:223], v[60:63]
    v_add_f32 v131, 1.0, v131
    v_mul_f32 v134, v118, v212
    v_mfma_f32_16x16x32_bf16 v[56:59], a[160:163], a[220:223], v[56:59]
    global_load_dwordx4 a[136:139], v13, s[32:33] offset:-2048 sc1
    v_mul_f32 v135, v119, v212
    v_mfma_f32_16x16x32_bf16 v[28:31], a[156:159], a[220:223], v[28:31]
    v_rcp_f32 v128, v128
    v_mfma_f32_16x16x32_bf16 v[24:27], a[152:155], a[220:223], v[24:27]
    ds_read_b128 a[220:223], v6 offset:15616
    v_mul_f32 v112, v112, v128
    v_mfma_f32_16x16x32_bf16 v[32:35], a[152:155], a[224:227], v[32:35]
    v_rcp_f32 v129, v129
    v_mfma_f32_16x16x32_bf16 v[36:39], a[156:159], a[224:227], v[36:39]
    global_load_dwordx4 a[140:143], v13, s[32:33] offset:-1024 sc1
    v_mul_f32 v113, v113, v129
    v_mfma_f32_16x16x32_bf16 v[64:67], a[160:163], a[224:227], v[64:67]
    v_rcp_f32 v130, v130
    v_mfma_f32_16x16x32_bf16 v[68:71], a[164:167], a[224:227], v[68:71]
    s_waitcnt lgkmcnt(8)
    ds_read_b128 a[224:227], v8 offset:8192
    v_mul_f32 v114, v114, v130
    v_mfma_f32_16x16x32_bf16 v[76:79], a[164:167], a[228:231], v[76:79]
    v_rcp_f32 v131, v131
    v_mfma_f32_16x16x32_bf16 v[72:75], a[160:163], a[228:231], v[72:75]
    global_load_dwordx4 a[144:147], v13, s[20:21] offset:-4096 sc1
    v_mul_f32 v115, v115, v131
    v_mfma_f32_16x16x32_bf16 v[44:47], a[156:159], a[228:231], v[44:47]
    v_exp_f32 v132, v132
    v_mfma_f32_16x16x32_bf16 v[40:43], a[152:155], a[228:231], v[40:43]
    s_waitcnt lgkmcnt(8)
    ds_read_b128 a[228:231], v8 offset:8448
    v_add_f32 v132, 1.0, v132
    v_mfma_f32_16x16x32_bf16 v[16:19], a[168:171], a[232:235], v[16:19]
    v_exp_f32 v133, v133
    v_mfma_f32_16x16x32_bf16 v[20:23], a[172:175], a[232:235], v[20:23]
    v_exp_f32 v134, v134
    v_mfma_f32_16x16x32_bf16 v[48:51], a[176:179], a[232:235], v[48:51]
    global_load_dwordx4 a[148:151], v13, s[20:21] offset:-3072 sc1
    v_add_f32 v133, 1.0, v133
    v_mfma_f32_16x16x32_bf16 v[52:55], a[180:183], a[232:235], v[52:55]
    s_waitcnt lgkmcnt(8)
    ds_read_b128 a[232:235], v8 offset:17408
    v_add_f32 v134, 1.0, v134
    v_mfma_f32_16x16x32_bf16 v[60:63], a[180:183], a[236:239], v[60:63]
    v_exp_f32 v135, v135
    v_mfma_f32_16x16x32_bf16 v[56:59], a[176:179], a[236:239], v[56:59]
    v_add_f32 v135, 1.0, v135
    v_cvt_pk_bf16_f32 v112, v112, v113
    v_mfma_f32_16x16x32_bf16 v[28:31], a[172:175], a[236:239], v[28:31]
    global_load_dwordx4 a[152:155], v13, s[32:33] offset:0 sc1
    v_cvt_pk_bf16_f32 v113, v114, v115
    v_mfma_f32_16x16x32_bf16 v[24:27], a[168:171], a[236:239], v[24:27]
    s_waitcnt lgkmcnt(8)
    ds_read_b128 a[236:239], v8 offset:17664
    v_mul_f32 v128, v120, v213
    v_mfma_f32_16x16x32_bf16 v[32:35], a[168:171], a[240:243], v[32:35]
    v_rcp_f32 v132, v132
    v_mfma_f32_16x16x32_bf16 v[36:39], a[172:175], a[240:243], v[36:39]
    v_rcp_f32 v133, v133
    v_mfma_f32_16x16x32_bf16 v[64:67], a[176:179], a[240:243], v[64:67]
    v_rcp_f32 v134, v134
    v_mfma_f32_16x16x32_bf16 v[68:71], a[180:183], a[240:243], v[68:71]
    s_waitcnt lgkmcnt(8)
    global_load_dwordx4 a[156:159], v13, s[32:33] offset:1024 sc1
    ds_read_b128 a[240:243], v3 offset:0
    v_mfma_f32_16x16x32_bf16 v[76:79], a[180:183], a[244:247], v[76:79]
    v_rcp_f32 v135, v135
    v_mfma_f32_16x16x32_bf16 v[72:75], a[176:179], a[244:247], v[72:75]
    v_mul_f32 v116, v116, v132
    v_mul_f32 v117, v117, v133
    v_mfma_f32_16x16x32_bf16 v[44:47], a[172:175], a[244:247], v[44:47]
    v_mul_f32 v118, v118, v134
    v_mul_f32 v119, v119, v135
    v_mfma_f32_16x16x32_bf16 v[40:43], a[168:171], a[244:247], v[40:43]
    s_waitcnt vmcnt(50) lgkmcnt(8)
    global_load_dwordx4 a[160:163], v13, s[20:21] offset:-2048 sc1
    ds_read_b128 a[244:247], v3 offset:256
    v_mfma_f32_16x16x32_bf16 v[16:19], a[184:187], a[248:251], v[16:19]
    v_cvt_pk_bf16_f32 v114, v116, v117
    v_cvt_pk_bf16_f32 v115, v118, v119
    v_mfma_f32_16x16x32_bf16 v[20:23], a[188:191], a[248:251], v[20:23]
    ds_write_b128 v214, v[112:115] offset:26624
    v_mfma_f32_16x16x32_bf16 v[48:51], a[192:195], a[248:251], v[48:51]
    v_mul_f32 v129, v121, v213
    v_mul_f32 v130, v122, v213
    v_mfma_f32_16x16x32_bf16 v[52:55], a[196:199], a[248:251], v[52:55]
    s_waitcnt lgkmcnt(9)
    global_load_dwordx4 a[164:167], v13, s[20:21] offset:-1024 sc1
    ds_read_b128 a[248:251], v3 offset:9216
    v_mfma_f32_16x16x32_bf16 v[60:63], a[196:199], a[252:255], v[60:63]
    v_mul_f32 v131, v123, v213
    v_mul_f32 v132, v124, v213
    v_mfma_f32_16x16x32_bf16 v[56:59], a[192:195], a[252:255], v[56:59]
    v_exp_f32 v128, v128
    v_mfma_f32_16x16x32_bf16 v[28:31], a[188:191], a[252:255], v[28:31]
    v_exp_f32 v129, v129
    v_mfma_f32_16x16x32_bf16 v[24:27], a[184:187], a[252:255], v[24:27]
    s_waitcnt lgkmcnt(9)
    ds_read_b128 a[252:255], v3 offset:9472
    v_add_f32 v128, 1.0, v128
    v_mfma_f32_16x16x32_bf16 v[32:35], a[184:187], a[216:219], v[32:35]
    global_load_dwordx4 a[168:171], v13, s[32:33] offset:2048 sc1
    v_add_f32 v129, 1.0, v129
    v_mfma_f32_16x16x32_bf16 v[36:39], a[188:191], a[216:219], v[36:39]
    v_exp_f32 v130, v130
    v_mfma_f32_16x16x32_bf16 v[64:67], a[192:195], a[216:219], v[64:67]
    v_exp_f32 v131, v131
    v_mfma_f32_16x16x32_bf16 v[68:71], a[196:199], a[216:219], v[68:71]
    s_waitcnt vmcnt(50) lgkmcnt(9)
    ds_read_b128 a[216:219], v3 offset:2048
    v_add_f32 v130, 1.0, v130
    v_mfma_f32_16x16x32_bf16 v[76:79], a[196:199], a[220:223], v[76:79]
    global_load_dwordx4 a[172:175], v13, s[32:33] offset:3072 sc1
    v_add_f32 v131, 1.0, v131
    v_mfma_f32_16x16x32_bf16 v[72:75], a[192:195], a[220:223], v[72:75]
    v_rcp_f32 v128, v128
    v_mfma_f32_16x16x32_bf16 v[44:47], a[188:191], a[220:223], v[44:47]
    v_rcp_f32 v129, v129
    v_mfma_f32_16x16x32_bf16 v[40:43], a[184:187], a[220:223], v[40:43]
    s_waitcnt lgkmcnt(9)
    ds_read_b128 a[220:223], v3 offset:2304
    v_mul_f32 v120, v120, v128
    v_mfma_f32_16x16x32_bf16 v[16:19], a[200:203], a[224:227], v[16:19]
    global_load_dwordx4 a[176:179], v2, s[22:23] offset:0 sc1
    v_mul_f32 v121, v121, v129
    v_mfma_f32_16x16x32_bf16 v[20:23], a[204:207], a[224:227], v[20:23]
    v_rcp_f32 v130, v130
    v_mfma_f32_16x16x32_bf16 v[48:51], a[208:211], a[224:227], v[48:51]
    v_rcp_f32 v131, v131
    v_mfma_f32_16x16x32_bf16 v[52:55], a[212:215], a[224:227], v[52:55]
    s_waitcnt lgkmcnt(9)
    ds_read_b128 a[224:227], v3 offset:11264
    v_mul_f32 v122, v122, v130
    v_mfma_f32_16x16x32_bf16 v[60:63], a[212:215], a[228:231], v[60:63]
    v_mul_f32 v123, v123, v131
    v_mul_f32 v133, v125, v213
    v_mfma_f32_16x16x32_bf16 v[56:59], a[208:211], a[228:231], v[56:59]
    global_load_dwordx4 a[180:183], v2, s[22:23] offset:1024 sc1
    v_mul_f32 v134, v126, v213
    v_mfma_f32_16x16x32_bf16 v[28:31], a[204:207], a[228:231], v[28:31]
    v_mul_f32 v135, v127, v213
    v_cvt_pk_bf16_f32 v120, v120, v121
    v_mfma_f32_16x16x32_bf16 v[24:27], a[200:203], a[228:231], v[24:27]
    s_waitcnt vmcnt(50) lgkmcnt(9)
    ds_read_b128 a[228:231], v3 offset:11520
    v_cvt_pk_bf16_f32 v121, v122, v123
    v_mfma_f32_16x16x32_bf16 v[32:35], a[200:203], a[232:235], v[32:35]
    v_exp_f32 v132, v132
    v_mfma_f32_16x16x32_bf16 v[36:39], a[204:207], a[232:235], v[36:39]
    global_load_dwordx4 a[184:187], v13, s[34:35] offset:-4096 sc1
    v_add_f32 v132, 1.0, v132
    v_mfma_f32_16x16x32_bf16 v[64:67], a[208:211], a[232:235], v[64:67]
    v_exp_f32 v133, v133
    v_mfma_f32_16x16x32_bf16 v[68:71], a[212:215], a[232:235], v[68:71]
    s_waitcnt lgkmcnt(9)
    ds_read_b128 a[232:235], v3 offset:4096
    v_add_f32 v133, 1.0, v133
    v_mfma_f32_16x16x32_bf16 v[76:79], a[212:215], a[236:239], v[76:79]
    v_exp_f32 v134, v134
    v_mfma_f32_16x16x32_bf16 v[72:75], a[208:211], a[236:239], v[72:75]
    global_load_dwordx4 a[188:191], v13, s[34:35] offset:-3072 sc1
    v_add_f32 v134, 1.0, v134
    v_mfma_f32_16x16x32_bf16 v[44:47], a[204:207], a[236:239], v[44:47]
    v_exp_f32 v135, v135
    v_mfma_f32_16x16x32_bf16 v[40:43], a[200:203], a[236:239], v[40:43]
    s_waitcnt lgkmcnt(9)
    ds_read_b128 a[236:239], v3 offset:4352
    v_add_f32 v135, 1.0, v135
    v_mfma_f32_16x16x32_bf16 v[48:51], v[176:179], a[240:243], v[48:51]
    v_rcp_f32 v132, v132
    v_mfma_f32_16x16x32_bf16 v[52:55], v[180:183], a[240:243], v[52:55]
    v_rcp_f32 v133, v133
    v_mfma_f32_16x16x32_bf16 v[144:147], v[184:187], a[240:243], 0
    global_load_dwordx4 a[192:195], v2, s[22:23] offset:2048 sc1
    v_rcp_f32 v134, v134
    v_mfma_f32_16x16x32_bf16 v[148:151], v[188:191], a[240:243], 0
    s_waitcnt vmcnt(50) lgkmcnt(9)
    ds_read_b128 a[240:243], v3 offset:13312
    v_mul_f32 v124, v124, v132
    v_mfma_f32_16x16x32_bf16 v[156:159], v[188:191], a[244:247], 0
    v_rcp_f32 v135, v135
    v_mfma_f32_16x16x32_bf16 v[152:155], v[184:187], a[244:247], 0
    v_mul_f32 v125, v125, v133
    v_mul_f32 v126, v126, v134
    v_mul_f32 v127, v127, v135
    v_mfma_f32_16x16x32_bf16 v[60:63], v[180:183], a[244:247], v[60:63]
    global_load_dwordx4 a[196:199], v2, s[22:23] offset:3072 sc1
    v_cvt_pk_bf16_f32 v122, v124, v125
    v_mfma_f32_16x16x32_bf16 v[56:59], v[176:179], a[244:247], v[56:59]
    s_waitcnt lgkmcnt(8)
    ds_read_b128 a[244:247], v3 offset:13568
    v_cvt_pk_bf16_f32 v123, v126, v127
    v_mfma_f32_16x16x32_bf16 v[64:67], v[176:179], a[248:251], v[64:67]
    ds_write_b128 v214, v[120:123] offset:35840
    v_mfma_f32_16x16x32_bf16 v[68:71], v[180:183], a[248:251], v[68:71]
    s_waitcnt vmcnt(33)
    v_min3_u32 v224, v224, v225, v226
    v_min_u32 v224, v224, v227
    v_mfma_f32_16x16x32_bf16 v[160:163], v[184:187], a[248:251], 0
    global_load_dwordx4 a[200:203], v13, s[34:35] offset:-2048 sc1
    v_cmp_eq_u32 vcc, 0, v224
    s_cbranch_vccnz kc_fslow
kc_fback:
    v_mfma_f32_16x16x32_bf16 v[164:167], v[188:191], a[248:251], 0
    s_waitcnt lgkmcnt(9)
    ds_read_b128 a[248:251], v3 offset:6144
    v_mul_f32 v212, 0xbf317218, v212
    v_mfma_f32_16x16x32_bf16 v[172:175], v[188:191], a[252:255], 0
    v_mul_f32 v213, 0xbf317218, v213
    v_mul_f32 v128, v16, v208
    v_mfma_f32_16x16x32_bf16 v[168:171], v[184:187], a[252:255], 0
    v_mul_f32 v129, v17, v208
    v_mul_f32 v130, v18, v208
    v_mul_f32 v131, v19, v208
    v_mfma_f32_16x16x32_bf16 v[76:79], v[180:183], a[252:255], v[76:79]
    v_exp_f32 v128, v128
    v_mfma_f32_16x16x32_bf16 v[72:75], v[176:179], a[252:255], v[72:75]
    s_waitcnt lgkmcnt(9)
    global_load_dwordx4 a[204:207], v13, s[34:35] offset:-1024 sc1
    ds_read_b128 a[252:255], v3 offset:6400
    v_add_f32 v128, 1.0, v128
    v_mfma_f32_16x16x32_bf16 v[48:51], v[192:195], a[216:219], v[48:51]
    v_exp_f32 v129, v129
    v_mfma_f32_16x16x32_bf16 v[52:55], v[196:199], a[216:219], v[52:55]
    v_exp_f32 v130, v130
    v_mfma_f32_16x16x32_bf16 v[144:147], v[200:203], a[216:219], v[144:147]
    v_exp_f32 v131, v131
    v_add_f32 v129, 1.0, v129
    v_mfma_f32_16x16x32_bf16 v[148:151], v[204:207], a[216:219], v[148:151]
    s_waitcnt lgkmcnt(9)
    global_load_dwordx4 a[208:211], v13, s[22:23] offset:-4096 sc1
    ds_read_b128 a[216:219], v3 offset:15360
    v_mfma_f32_16x16x32_bf16 v[156:159], v[204:207], a[220:223], v[156:159]
    v_add_f32 v130, 1.0, v130
    v_add_f32 v131, 1.0, v131
    v_mfma_f32_16x16x32_bf16 v[152:155], v[200:203], a[220:223], v[152:155]
    v_rcp_f32 v128, v128
    v_mul_f32 v132, v20, v208
    v_mfma_f32_16x16x32_bf16 v[60:63], v[196:199], a[220:223], v[60:63]
    v_rcp_f32 v129, v129
    v_mfma_f32_16x16x32_bf16 v[56:59], v[192:195], a[220:223], v[56:59]
    s_waitcnt lgkmcnt(9)
    global_load_dwordx4 a[212:215], v13, s[22:23] offset:-3072 sc1
    ds_read_b128 a[220:223], v3 offset:15616
    v_mul_f32 v16, v16, v128
    v_mfma_f32_16x16x32_bf16 v[64:67], v[192:195], a[224:227], v[64:67]
    v_rcp_f32 v130, v130
    v_mfma_f32_16x16x32_bf16 v[68:71], v[196:199], a[224:227], v[68:71]
    v_rcp_f32 v131, v131
    v_mfma_f32_16x16x32_bf16 v[160:163], v[200:203], a[224:227], v[160:163]
    v_mul_f32 v17, v17, v129
    v_mul_f32 v18, v18, v130
    v_mul_f32 v19, v19, v131
    v_mfma_f32_16x16x32_bf16 v[164:167], v[204:207], a[224:227], v[164:167]
    s_waitcnt lgkmcnt(9)
    ds_read_b128 a[224:227], v5 offset:0
    v_mul_f32 v133, v21, v208
    v_mfma_f32_16x16x32_bf16 v[172:175], v[204:207], a[228:231], v[172:175]
    global_load_dwordx4 v[176:179], v13, s[34:35] offset:0 sc1
    v_mul_f32 v134, v22, v208
    v_mfma_f32_16x16x32_bf16 v[168:171], v[200:203], a[228:231], v[168:171]
    v_mul_f32 v135, v23, v208
    v_exp_f32 v132, v132
    v_mfma_f32_16x16x32_bf16 v[76:79], v[196:199], a[228:231], v[76:79]
    v_exp_f32 v133, v133
    v_mfma_f32_16x16x32_bf16 v[72:75], v[192:195], a[228:231], v[72:75]
    s_waitcnt lgkmcnt(9)
    ds_read_b128 a[228:231], v5 offset:256
    v_exp_f32 v134, v134
    v_mfma_f32_16x16x32_bf16 v[48:51], a[0:3], a[232:235], v[48:51]
    global_load_dwordx4 v[180:183], v13, s[34:35] offset:1024 sc1
    v_add_f32 v132, 1.0, v132
    v_mfma_f32_16x16x32_bf16 v[52:55], a[4:7], a[232:235], v[52:55]
    v_exp_f32 v135, v135
    v_mfma_f32_16x16x32_bf16 v[144:147], a[8:11], a[232:235], v[144:147]
    v_add_f32 v133, 1.0, v133
    v_add_f32 v134, 1.0, v134
    v_add_f32 v135, 1.0, v135
    v_mfma_f32_16x16x32_bf16 v[148:151], a[12:15], a[232:235], v[148:151]
    s_waitcnt lgkmcnt(9)
    ds_read_b128 a[232:235], v5 offset:9216
    v_cvt_pk_bf16_f32 v16, v16, v17
    v_mfma_f32_16x16x32_bf16 v[156:159], a[12:15], a[236:239], v[156:159]
    v_rcp_f32 v132, v132
    v_mfma_f32_16x16x32_bf16 v[152:155], a[8:11], a[236:239], v[152:155]
    global_load_dwordx4 v[184:187], v13, s[22:23] offset:-2048 sc1
    v_rcp_f32 v133, v133
    v_mfma_f32_16x16x32_bf16 v[60:63], a[4:7], a[236:239], v[60:63]
    v_rcp_f32 v134, v134
    v_mfma_f32_16x16x32_bf16 v[56:59], a[0:3], a[236:239], v[56:59]
    s_waitcnt lgkmcnt(9)
    ds_read_b128 a[236:239], v5 offset:9472
    v_rcp_f32 v135, v135
    v_mfma_f32_16x16x32_bf16 v[64:67], a[0:3], a[240:243], v[64:67]
    v_mul_f32 v20, v20, v132
    v_mul_f32 v21, v21, v133
    v_mfma_f32_16x16x32_bf16 v[68:71], a[4:7], a[240:243], v[68:71]
    global_load_dwordx4 v[188:191], v13, s[22:23] offset:-1024 sc1
    v_mul_f32 v22, v22, v134
    v_mfma_f32_16x16x32_bf16 v[160:163], a[8:11], a[240:243], v[160:163]
    v_mul_f32 v23, v23, v135
    v_cvt_pk_bf16_f32 v17, v18, v19
    v_cvt_pk_bf16_f32 v18, v20, v21
    v_mfma_f32_16x16x32_bf16 v[164:167], a[12:15], a[240:243], v[164:167]
    s_waitcnt lgkmcnt(9)
    ds_read_b128 a[240:243], v5 offset:2048
    v_cvt_pk_bf16_f32 v19, v22, v23
    v_mfma_f32_16x16x32_bf16 v[172:175], a[12:15], a[244:247], v[172:175]
    ds_write_b128 v3, v[16:19] offset:18432
    v_mfma_f32_16x16x32_bf16 v[168:171], a[8:11], a[244:247], v[168:171]
    global_load_dwordx4 v[192:195], v13, s[34:35] offset:2048 sc1
    v_mul_f32 v128, v24, v209
    v_mul_f32 v129, v25, v209
    v_mfma_f32_16x16x32_bf16 v[76:79], a[4:7], a[244:247], v[76:79]
    v_mul_f32 v130, v26, v209
    v_mul_f32 v131, v27, v209
    v_mfma_f32_16x16x32_bf16 v[72:75], a[0:3], a[244:247], v[72:75]
    s_waitcnt lgkmcnt(9)
    ds_read_b128 a[244:247], v5 offset:2304
    v_exp_f32 v128, v128
    v_mfma_f32_16x16x32_bf16 v[48:51], a[16:19], a[248:251], v[48:51]
    v_exp_f32 v129, v129
    v_mfma_f32_16x16x32_bf16 v[52:55], a[20:23], a[248:251], v[52:55]
    v_exp_f32 v130, v130
    v_mfma_f32_16x16x32_bf16 v[144:147], a[24:27], a[248:251], v[144:147]
    global_load_dwordx4 v[196:199], v13, s[34:35] offset:3072 sc1
    v_exp_f32 v131, v131
    v_mfma_f32_16x16x32_bf16 v[148:151], a[28:31], a[248:251], v[148:151]
    s_waitcnt lgkmcnt(9)
    ds_read_b128 a[248:251], v5 offset:11264
    v_add_f32 v128, 1.0, v128
    v_mfma_f32_16x16x32_bf16 v[156:159], a[28:31], a[252:255], v[156:159]
    v_add_f32 v129, 1.0, v129
    v_add_f32 v130, 1.0, v130
    v_mfma_f32_16x16x32_bf16 v[152:155], a[24:27], a[252:255], v[152:155]
    v_add_f32 v131, 1.0, v131
    v_rcp_f32 v128, v128
    v_mfma_f32_16x16x32_bf16 v[60:63], a[20:23], a[252:255], v[60:63]
    global_load_dwordx4 v[200:203], v13, s[22:23] offset:2048 sc1
    v_mul_f32 v24, v24, v128
    v_mfma_f32_16x16x32_bf16 v[56:59], a[16:19], a[252:255], v[56:59]
    s_waitcnt lgkmcnt(9)
    ds_read_b128 a[252:255], v5 offset:11520
    v_rcp_f32 v129, v129
    v_mfma_f32_16x16x32_bf16 v[64:67], a[16:19], a[216:219], v[64:67]
    v_rcp_f32 v130, v130
    v_mfma_f32_16x16x32_bf16 v[68:71], a[20:23], a[216:219], v[68:71]
    v_rcp_f32 v131, v131
    v_mfma_f32_16x16x32_bf16 v[160:163], a[24:27], a[216:219], v[160:163]
    global_load_dwordx4 v[204:207], v13, s[22:23] offset:3072 sc1
    v_mul_f32 v25, v25, v129
    v_mul_f32 v26, v26, v130
    v_mfma_f32_16x16x32_bf16 v[164:167], a[28:31], a[216:219], v[164:167]
wc_pad1:
    s_cbranch_execz wc_pad5
    s_waitcnt lgkmcnt(9)
    ds_read_b128 a[216:219], v5 offset:4096
    v_mul_f32 v27, v27, v131
    v_mfma_f32_16x16x32_bf16 v[172:175], a[28:31], a[220:223], v[172:175]
    v_mul_f32 v132, v28, v209
    v_mul_f32 v133, v29, v209
    v_mfma_f32_16x16x32_bf16 v[168:171], a[24:27], a[220:223], v[168:171]
    v_mul_f32 v134, v30, v209
    v_mul_f32 v135, v31, v209
    v_cvt_pk_bf16_f32 v24, v24, v25
    v_mfma_f32_16x16x32_bf16 v[76:79], a[20:23], a[220:223], v[76:79]
    v_exp_f32 v132, v132
    v_mfma_f32_16x16x32_bf16 v[72:75], a[16:19], a[220:223], v[72:75]
    s_waitcnt lgkmcnt(9)
    global_load_dwordx4 a[0:3], v2, s[40:41] offset:-2048 sc1
    ds_read_b128 a[220:223], v5 offset:4352
    v_add_f32 v132, 1.0, v132
    v_mfma_f32_16x16x32_bf16 v[48:51], a[32:35], a[224:227], v[48:51]
    v_exp_f32 v133, v133
    v_mfma_f32_16x16x32_bf16 v[52:55], a[36:39], a[224:227], v[52:55]
    v_exp_f32 v134, v134
    v_mfma_f32_16x16x32_bf16 v[144:147], a[40:43], a[224:227], v[144:147]
    v_exp_f32 v135, v135
    v_add_f32 v133, 1.0, v133
    v_mfma_f32_16x16x32_bf16 v[148:151], a[44:47], a[224:227], v[148:151]
    s_waitcnt lgkmcnt(9)
    global_load_dwordx4 a[4:7], v2, s[40:41] offset:-1024 sc1
    ds_read_b128 a[224:227], v5 offset:13312
    v_mfma_f32_16x16x32_bf16 v[156:159], a[44:47], a[228:231], v[156:159]
    v_add_f32 v134, 1.0, v134
    v_add_f32 v135, 1.0, v135
    v_mfma_f32_16x16x32_bf16 v[152:155], a[40:43], a[228:231], v[152:155]
    v_rcp_f32 v132, v132
    v_cvt_pk_bf16_f32 v25, v26, v27
    v_mfma_f32_16x16x32_bf16 v[60:63], a[36:39], a[228:231], v[60:63]
    v_rcp_f32 v133, v133
    v_mfma_f32_16x16x32_bf16 v[56:59], a[32:35], a[228:231], v[56:59]
    s_waitcnt lgkmcnt(9)
    global_load_dwordx4 a[8:11], v2, s[32:33] offset:-4096 sc1
    ds_read_b128 a[228:231], v5 offset:13568
    v_mul_f32 v28, v28, v132
    v_mfma_f32_16x16x32_bf16 v[64:67], a[32:35], a[232:235], v[64:67]
    v_rcp_f32 v134, v134
    v_mfma_f32_16x16x32_bf16 v[68:71], a[36:39], a[232:235], v[68:71]
    v_rcp_f32 v135, v135
    v_mfma_f32_16x16x32_bf16 v[160:163], a[40:43], a[232:235], v[160:163]
    v_mul_f32 v29, v29, v133
    v_mul_f32 v30, v30, v134
    v_mul_f32 v31, v31, v135
    v_mfma_f32_16x16x32_bf16 v[164:167], a[44:47], a[232:235], v[164:167]
    s_waitcnt lgkmcnt(9)
    ds_read_b128 a[232:235], v5 offset:6144
    v_cvt_pk_bf16_f32 v26, v28, v29
    v_mfma_f32_16x16x32_bf16 v[172:175], a[44:47], a[236:239], v[172:175]
    global_load_dwordx4 a[12:15], v2, s[32:33] offset:-3072 sc1
    v_cvt_pk_bf16_f32 v27, v30, v31
    v_mfma_f32_16x16x32_bf16 v[168:171], a[40:43], a[236:239], v[168:171]
    ds_write_b128 v3, v[24:27] offset:18688
    v_mfma_f32_16x16x32_bf16 v[76:79], a[36:39], a[236:239], v[76:79]
    v_mul_f32 v128, v32, v210
    v_mul_f32 v129, v33, v210
    v_mfma_f32_16x16x32_bf16 v[72:75], a[32:35], a[236:239], v[72:75]
    s_waitcnt lgkmcnt(10)
    ds_read_b128 a[236:239], v5 offset:6400
    v_mul_f32 v130, v34, v210
    v_mul_f32 v131, v35, v210
    v_mfma_f32_16x16x32_bf16 v[48:51], a[48:51], a[240:243], v[48:51]
    global_load_dwordx4 a[16:19], v2, s[32:33] offset:-2048 sc1
    v_mul_f32 v132, v36, v210
    v_mfma_f32_16x16x32_bf16 v[52:55], a[52:55], a[240:243], v[52:55]
    v_exp_f32 v128, v128
    v_mfma_f32_16x16x32_bf16 v[144:147], a[56:59], a[240:243], v[144:147]
    v_exp_f32 v129, v129
    v_add_f32 v128, 1.0, v128
    v_mfma_f32_16x16x32_bf16 v[148:151], a[60:63], a[240:243], v[148:151]
    s_waitcnt lgkmcnt(9)
    ds_read_b128 a[240:243], v5 offset:15360
    v_add_f32 v129, 1.0, v129
    v_mfma_f32_16x16x32_bf16 v[156:159], a[60:63], a[244:247], v[156:159]
    global_load_dwordx4 a[20:23], v2, s[32:33] offset:-1024 sc1
    v_mul_f32 v133, v37, v210
    v_mfma_f32_16x16x32_bf16 v[152:155], a[56:59], a[244:247], v[152:155]
    v_exp_f32 v130, v130
    v_mul_f32 v134, v38, v210
    v_mfma_f32_16x16x32_bf16 v[60:63], a[52:55], a[244:247], v[60:63]
    v_exp_f32 v131, v131
    v_mfma_f32_16x16x32_bf16 v[56:59], a[48:51], a[244:247], v[56:59]
    s_waitcnt lgkmcnt(9)
    ds_read_b128 a[244:247], v5 offset:15616
    v_add_f32 v130, 1.0, v130
    v_add_f32 v131, 1.0, v131
    v_mfma_f32_16x16x32_bf16 v[64:67], a[48:51], a[248:251], v[64:67]
    v_rcp_f32 v128, v128
    v_mfma_f32_16x16x32_bf16 v[68:71], a[52:55], a[248:251], v[68:71]
    global_load_dwordx4 a[24:27], v2, s[32:33] offset:0 sc1
    v_mul_f32 v32, v32, v128
    v_mfma_f32_16x16x32_bf16 v[160:163], a[56:59], a[248:251], v[160:163]
    v_rcp_f32 v129, v129
    v_mul_f32 v135, v39, v210
    v_mfma_f32_16x16x32_bf16 v[164:167], a[60:63], a[248:251], v[164:167]
    s_waitcnt lgkmcnt(9)
    ds_read_b128 a[248:251], v7 offset:8192
    v_mul_f32 v33, v33, v129
    v_mfma_f32_16x16x32_bf16 v[172:175], a[60:63], a[252:255], v[172:175]
    v_rcp_f32 v130, v130
    v_mfma_f32_16x16x32_bf16 v[168:171], a[56:59], a[252:255], v[168:171]
    global_load_dwordx4 a[28:31], v2, s[32:33] offset:1024 sc1
    v_rcp_f32 v131, v131
    v_mfma_f32_16x16x32_bf16 v[76:79], a[52:55], a[252:255], v[76:79]
    v_mul_f32 v34, v34, v130
    v_mul_f32 v35, v35, v131
    v_mfma_f32_16x16x32_bf16 v[72:75], a[48:51], a[252:255], v[72:75]
    s_waitcnt vmcnt(50) lgkmcnt(9)
    ds_read_b128 a[252:255], v7 offset:8448
    v_exp_f32 v132, v132
    v_mfma_f32_16x16x32_bf16 v[48:51], a[64:67], a[216:219], v[48:51]
    v_exp_f32 v133, v133
    v_mfma_f32_16x16x32_bf16 v[52:55], a[68:71], a[216:219], v[52:55]
    global_load_dwordx4 a[32:35], v2, s[32:33] offset:2048 sc1
    v_add_f32 v132, 1.0, v132
    v_mfma_f32_16x16x32_bf16 v[144:147], a[72:75], a[216:219], v[144:147]
    v_exp_f32 v134, v134
    v_add_f32 v133, 1.0, v133
    v_mfma_f32_16x16x32_bf16 v[148:151], a[76:79], a[216:219], v[148:151]
    s_waitcnt lgkmcnt(9)
    ds_read_b128 a[216:219], v7 offset:17408
    v_add_f32 v134, 1.0, v134
    v_mfma_f32_16x16x32_bf16 v[156:159], a[76:79], a[220:223], v[156:159]
    v_exp_f32 v135, v135
    v_mfma_f32_16x16x32_bf16 v[152:155], a[72:75], a[220:223], v[152:155]
    v_add_f32 v135, 1.0, v135
    v_rcp_f32 v132, v132
    v_mfma_f32_16x16x32_bf16 v[60:63], a[68:71], a[220:223], v[60:63]
    global_load_dwordx4 a[36:39], v2, s[32:33] offset:3072 sc1
    v_mul_f32 v36, v36, v132
    v_mfma_f32_16x16x32_bf16 v[56:59], a[64:67], a[220:223], v[56:59]
    s_waitcnt lgkmcnt(9)
    ds_read_b128 a[220:223], v7 offset:17664
    v_rcp_f32 v133, v133
    v_mfma_f32_16x16x32_bf16 v[64:67], a[64:67], a[224:227], v[64:67]
    v_rcp_f32 v134, v134
    v_mfma_f32_16x16x32_bf16 v[68:71], a[68:71], a[224:227], v[68:71]
    v_rcp_f32 v135, v135
    v_mfma_f32_16x16x32_bf16 v[160:163], a[72:75], a[224:227], v[160:163]
    global_load_dwordx4 a[40:43], v2, s[34:35] offset:-4096 sc1
    v_mul_f32 v37, v37, v133
    v_mul_f32 v38, v38, v134
    v_mfma_f32_16x16x32_bf16 v[164:167], a[76:79], a[224:227], v[164:167]
    s_waitcnt vmcnt(50) lgkmcnt(9)
    ds_read_b128 a[224:227], v4 offset:0
    v_mul_f32 v39, v39, v135
    v_mfma_f32_16x16x32_bf16 v[172:175], a[76:79], a[228:231], v[172:175]
    v_cvt_pk_bf16_f32 v32, v32, v33
    v_cvt_pk_bf16_f32 v33, v34, v35
    v_mfma_f32_16x16x32_bf16 v[168:171], a[72:75], a[228:231], v[168:171]
    v_cvt_pk_bf16_f32 v34, v36, v37
    v_cvt_pk_bf16_f32 v35, v38, v39
    v_mul_f32 v128, v40, v211
    v_mfma_f32_16x16x32_bf16 v[76:79], a[68:71], a[228:231], v[76:79]
    ds_write_b128 v3, v[32:35] offset:27648
    v_mfma_f32_16x16x32_bf16 v[72:75], a[64:67], a[228:231], v[72:75]
    s_waitcnt vmcnt(49) lgkmcnt(10)
    global_load_dwordx4 a[44:47], v2, s[34:35] offset:-3072 sc1
    ds_read_b128 a[228:231], v4 offset:256
    v_mul_f32 v129, v41, v211
    v_mfma_f32_16x16x32_bf16 v[48:51], a[80:83], a[232:235], v[48:51]
    v_mul_f32 v130, v42, v211
    v_mul_f32 v131, v43, v211
    v_mfma_f32_16x16x32_bf16 v[52:55], a[84:87], a[232:235], v[52:55]
    v_exp_f32 v128, v128
    v_mfma_f32_16x16x32_bf16 v[144:147], a[88:91], a[232:235], v[144:147]
    v_exp_f32 v129, v129
    v_add_f32 v128, 1.0, v128
    v_mfma_f32_16x16x32_bf16 v[148:151], a[92:95], a[232:235], v[148:151]
    s_waitcnt lgkmcnt(9)
    global_load_dwordx4 a[48:51], v2, s[34:35] offset:-2048 sc1
    ds_read_b128 a[232:235], v4 offset:9216
    v_mfma_f32_16x16x32_bf16 v[156:159], a[92:95], a[236:239], v[156:159]
    v_exp_f32 v130, v130
    v_mfma_f32_16x16x32_bf16 v[152:155], a[88:91], a[236:239], v[152:155]
    v_exp_f32 v131, v131
    v_add_f32 v129, 1.0, v129
    v_mfma_f32_16x16x32_bf16 v[60:63], a[84:87], a[236:239], v[60:63]
    v_add_f32 v130, 1.0, v130
    v_add_f32 v131, 1.0, v131
    v_mfma_f32_16x16x32_bf16 v[56:59], a[80:83], a[236:239], v[56:59]
    s_waitcnt lgkmcnt(9)
    global_load_dwordx4 a[52:55], v2, s[34:35] offset:-1024 sc1
    ds_read_b128 a[236:239], v4 offset:9472
    v_mul_f32 v132, v44, v211
    v_mfma_f32_16x16x32_bf16 v[64:67], a[80:83], a[240:243], v[64:67]
    v_rcp_f32 v128, v128
    v_mfma_f32_16x16x32_bf16 v[68:71], a[84:87], a[240:243], v[68:71]
    v_rcp_f32 v129, v129
    v_mfma_f32_16x16x32_bf16 v[160:163], a[88:91], a[240:243], v[160:163]
    v_rcp_f32 v130, v130
    v_mul_f32 v40, v40, v128
    v_mfma_f32_16x16x32_bf16 v[164:167], a[92:95], a[240:243], v[164:167]
    s_waitcnt lgkmcnt(9)
    ds_read_b128 a[240:243], v4 offset:2048
    v_mul_f32 v41, v41, v129
    v_mfma_f32_16x16x32_bf16 v[172:175], a[92:95], a[244:247], v[172:175]
    global_load_dwordx4 a[56:59], v2, s[34:35] offset:0 sc1
    v_mul_f32 v42, v42, v130
    v_mfma_f32_16x16x32_bf16 v[168:171], a[88:91], a[244:247], v[168:171]
    v_rcp_f32 v131, v131
    v_mul_f32 v133, v45, v211
    v_mfma_f32_16x16x32_bf16 v[76:79], a[84:87], a[244:247], v[76:79]
    v_mul_f32 v43, v43, v131
    v_mul_f32 v134, v46, v211
    v_mfma_f32_16x16x32_bf16 v[72:75], a[80:83], a[244:247], v[72:75]
    s_waitcnt vmcnt(49) lgkmcnt(9)
    ds_read_b128 a[244:247], v4 offset:2304
    v_mul_f32 v135, v47, v211
    v_cvt_pk_bf16_f32 v40, v40, v41
    v_mfma_f32_16x16x32_bf16 v[48:51], a[96:99], a[248:251], v[48:51]
    global_load_dwordx4 a[60:63], v2, s[34:35] offset:1024 sc1
    v_cvt_pk_bf16_f32 v41, v42, v43
    v_mfma_f32_16x16x32_bf16 v[52:55], a[100:103], a[248:251], v[52:55]
    v_exp_f32 v132, v132
    v_mfma_f32_16x16x32_bf16 v[144:147], a[104:107], a[248:251], v[144:147]
    v_exp_f32 v133, v133
    v_add_f32 v132, 1.0, v132
    v_mfma_f32_16x16x32_bf16 v[148:151], a[108:111], a[248:251], v[148:151]
    s_waitcnt lgkmcnt(9)
    ds_read_b128 a[248:251], v4 offset:11264
    v_add_f32 v133, 1.0, v133
    v_mfma_f32_16x16x32_bf16 v[156:159], a[108:111], a[252:255], v[156:159]
    global_load_dwordx4 a[64:67], v2, s[34:35] offset:2048 sc1
    v_mfma_f32_16x16x32_bf16 v[152:155], a[104:107], a[252:255], v[152:155]
    v_exp_f32 v134, v134
    v_mfma_f32_16x16x32_bf16 v[60:63], a[100:103], a[252:255], v[60:63]
    v_exp_f32 v135, v135
    v_mfma_f32_16x16x32_bf16 v[56:59], a[96:99], a[252:255], v[56:59]
    s_waitcnt lgkmcnt(9)
    ds_read_b128 a[252:255], v4 offset:11520
    v_add_f32 v134, 1.0, v134
    v_add_f32 v135, 1.0, v135
    v_mfma_f32_16x16x32_bf16 v[64:67], a[96:99], a[216:219], v[64:67]
    v_rcp_f32 v132, v132
    v_mfma_f32_16x16x32_bf16 v[68:71], a[100:103], a[216:219], v[68:71]
    global_load_dwordx4 a[68:71], v2, s[34:35] offset:3072 sc1
    v_mul_f32 v44, v44, v132
    v_mfma_f32_16x16x32_bf16 v[160:163], a[104:107], a[216:219], v[160:163]
    v_rcp_f32 v133, v133
    v_mfma_f32_16x16x32_bf16 v[164:167], a[108:111], a[216:219], v[164:167]
    s_waitcnt lgkmcnt(9)
    ds_read_b128 a[216:219], v4 offset:4096
    v_mul_f32 v45, v45, v133
    v_mfma_f32_16x16x32_bf16 v[172:175], a[108:111], a[220:223], v[172:175]
    v_rcp_f32 v134, v134
    v_mfma_f32_16x16x32_bf16 v[168:171], a[104:107], a[220:223], v[168:171]
    global_load_dwordx4 a[72:75], v2, s[40:41] offset:-4096 sc1
    v_rcp_f32 v135, v135
    v_mfma_f32_16x16x32_bf16 v[76:79], a[100:103], a[220:223], v[76:79]
    v_mul_f32 v46, v46, v134
    v_mul_f32 v47, v47, v135
    v_mfma_f32_16x16x32_bf16 v[72:75], a[96:99], a[220:223], v[72:75]
    s_waitcnt vmcnt(49) lgkmcnt(9)
    ds_read_b128 a[220:223], v4 offset:4352
    v_cvt_pk_bf16_f32 v42, v44, v45
    v_cvt_pk_bf16_f32 v43, v46, v47
    v_mfma_f32_16x16x32_bf16 v[144:147], a[112:115], a[224:227], v[144:147]
    ds_write_b128 v3, v[40:43] offset:27904
    v_mfma_f32_16x16x32_bf16 v[148:151], a[116:119], a[224:227], v[148:151]
    global_load_dwordx4 a[76:79], v2, s[40:41] offset:-3072 sc1
    v_mfma_f32_16x16x32_bf16 v[80:83], a[120:123], a[224:227], 0
    v_mul_f32 v128, v48, v208
    v_mul_f32 v129, v49, v208
    v_mul_f32 v130, v50, v208
    v_mfma_f32_16x16x32_bf16 v[84:87], a[124:127], a[224:227], 0
    s_waitcnt lgkmcnt(9)
    ds_read_b128 a[224:227], v4 offset:13312
    v_mul_f32 v131, v51, v208
    v_mfma_f32_16x16x32_bf16 v[92:95], a[124:127], a[228:231], 0
    v_exp_f32 v128, v128
    v_mfma_f32_16x16x32_bf16 v[88:91], a[120:123], a[228:231], 0
    v_exp_f32 v129, v129
    v_add_f32 v128, 1.0, v128
    v_mfma_f32_16x16x32_bf16 v[156:159], a[116:119], a[228:231], v[156:159]
    global_load_dwordx4 a[80:83], v2, s[40:41] offset:0 sc1
    v_add_f32 v129, 1.0, v129
    v_mfma_f32_16x16x32_bf16 v[152:155], a[112:115], a[228:231], v[152:155]
    s_waitcnt lgkmcnt(9)
    ds_read_b128 a[228:231], v4 offset:13568
    v_exp_f32 v130, v130
    v_mfma_f32_16x16x32_bf16 v[160:163], a[112:115], a[232:235], v[160:163]
    v_exp_f32 v131, v131
    v_mfma_f32_16x16x32_bf16 v[164:167], a[116:119], a[232:235], v[164:167]
    v_add_f32 v130, 1.0, v130
    v_add_f32 v131, 1.0, v131
    v_mfma_f32_16x16x32_bf16 v[96:99], a[120:123], a[232:235], 0
    global_load_dwordx4 a[84:87], v2, s[40:41] offset:1024 sc1
    v_rcp_f32 v128, v128
    v_mfma_f32_16x16x32_bf16 v[100:103], a[124:127], a[232:235], 0
    s_waitcnt lgkmcnt(9)
    ds_read_b128 a[232:235], v4 offset:6144
    v_mul_f32 v48, v48, v128
    v_mfma_f32_16x16x32_bf16 v[108:111], a[124:127], a[236:239], 0
    v_rcp_f32 v129, v129
    v_mfma_f32_16x16x32_bf16 v[104:107], a[120:123], a[236:239], 0
    v_rcp_f32 v130, v130
    v_mul_f32 v49, v49, v129
    v_mfma_f32_16x16x32_bf16 v[172:175], a[116:119], a[236:239], v[172:175]
    global_load_dwordx4 a[88:91], v13, s[44:45] offset:-4096 sc1
    v_mul_f32 v50, v50, v130
    v_mfma_f32_16x16x32_bf16 v[168:171], a[112:115], a[236:239], v[168:171]
    s_waitcnt vmcnt(49) lgkmcnt(9)
    ds_read_b128 a[236:239], v4 offset:6400
    v_rcp_f32 v131, v131
    v_mfma_f32_16x16x32_bf16 v[144:147], a[128:131], a[240:243], v[144:147]
    v_mul_f32 v51, v51, v131
    v_mul_f32 v132, v52, v208
    v_mfma_f32_16x16x32_bf16 v[148:151], a[132:135], a[240:243], v[148:151]
    v_mul_f32 v133, v53, v208
    v_mul_f32 v134, v54, v208
    v_mfma_f32_16x16x32_bf16 v[80:83], a[136:139], a[240:243], v[80:83]
    v_mul_f32 v135, v55, v208
    v_exp_f32 v132, v132
    v_mfma_f32_16x16x32_bf16 v[84:87], a[140:143], a[240:243], v[84:87]
    s_waitcnt lgkmcnt(9)
    global_load_dwordx4 a[92:95], v13, s[44:45] offset:-3072 sc1
    ds_read_b128 a[240:243], v4 offset:15360
    v_mfma_f32_16x16x32_bf16 v[92:95], a[140:143], a[244:247], v[92:95]
    v_exp_f32 v133, v133
    v_mfma_f32_16x16x32_bf16 v[88:91], a[136:139], a[244:247], v[88:91]
    v_exp_f32 v134, v134
    v_add_f32 v132, 1.0, v132
    v_mfma_f32_16x16x32_bf16 v[156:159], a[132:135], a[244:247], v[156:159]
    v_exp_f32 v135, v135
    v_mfma_f32_16x16x32_bf16 v[152:155], a[128:131], a[244:247], v[152:155]
    s_waitcnt lgkmcnt(9)
    global_load_dwordx4 a[96:99], v13, s[40:41] offset:0 sc1
    ds_read_b128 a[244:247], v4 offset:15616
    v_add_f32 v133, 1.0, v133
    v_mfma_f32_16x16x32_bf16 v[160:163], a[128:131], a[248:251], v[160:163]
    v_add_f32 v134, 1.0, v134
    v_add_f32 v135, 1.0, v135
    v_mfma_f32_16x16x32_bf16 v[164:167], a[132:135], a[248:251], v[164:167]
    v_rcp_f32 v132, v132
    v_mfma_f32_16x16x32_bf16 v[96:99], a[136:139], a[248:251], v[96:99]
    v_rcp_f32 v133, v133
    v_mul_f32 v52, v52, v132
    v_mfma_f32_16x16x32_bf16 v[100:103], a[140:143], a[248:251], v[100:103]
    s_waitcnt lgkmcnt(9)
    global_load_dwordx4 a[100:103], v13, s[40:41] offset:1024 sc1
    ds_read_b128 a[248:251], v6 offset:0
    v_mfma_f32_16x16x32_bf16 v[108:111], a[140:143], a[252:255], v[108:111]
    v_rcp_f32 v134, v134
    v_mfma_f32_16x16x32_bf16 v[104:107], a[136:139], a[252:255], v[104:107]
    v_rcp_f32 v135, v135
    v_mul_f32 v53, v53, v133
    v_mfma_f32_16x16x32_bf16 v[172:175], a[132:135], a[252:255], v[172:175]
    v_mul_f32 v54, v54, v134
    v_mul_f32 v55, v55, v135
    v_mfma_f32_16x16x32_bf16 v[168:171], a[128:131], a[252:255], v[168:171]
    s_waitcnt vmcnt(48) lgkmcnt(9)
    ds_read_b128 a[252:255], v6 offset:256
    v_cvt_pk_bf16_f32 v48, v48, v49
    v_cvt_pk_bf16_f32 v49, v50, v51
    v_mfma_f32_16x16x32_bf16 v[144:147], a[144:147], a[216:219], v[144:147]
    global_load_dwordx4 a[104:107], v2, s[46:47] offset:-4096 sc1
    v_cvt_pk_bf16_f32 v50, v52, v53
    v_mfma_f32_16x16x32_bf16 v[148:151], a[148:151], a[216:219], v[148:151]
    v_cvt_pk_bf16_f32 v51, v54, v55
    v_mul_f32 v128, v56, v209
    v_mfma_f32_16x16x32_bf16 v[80:83], a[152:155], a[216:219], v[80:83]
    ds_write_b128 v3, v[48:51] offset:20480
    v_mfma_f32_16x16x32_bf16 v[84:87], a[156:159], a[216:219], v[84:87]
    s_waitcnt lgkmcnt(10)
    ds_read_b128 a[216:219], v6 offset:9216
    v_mul_f32 v129, v57, v209
    v_mfma_f32_16x16x32_bf16 v[92:95], a[156:159], a[220:223], v[92:95]
    global_load_dwordx4 a[108:111], v2, s[46:47] offset:-3072 sc1
    v_mul_f32 v130, v58, v209
    v_mfma_f32_16x16x32_bf16 v[88:91], a[152:155], a[220:223], v[88:91]
    v_mul_f32 v131, v59, v209
    v_exp_f32 v128, v128
    v_mfma_f32_16x16x32_bf16 v[156:159], a[148:151], a[220:223], v[156:159]
    v_exp_f32 v129, v129
    v_mfma_f32_16x16x32_bf16 v[152:155], a[144:147], a[220:223], v[152:155]
    s_waitcnt lgkmcnt(9)
    ds_read_b128 a[220:223], v6 offset:9472
    v_exp_f32 v130, v130
    v_mfma_f32_16x16x32_bf16 v[160:163], a[144:147], a[224:227], v[160:163]
    v_exp_f32 v131, v131
    v_mfma_f32_16x16x32_bf16 v[164:167], a[148:151], a[224:227], v[164:167]
    global_load_dwordx4 a[112:115], v2, s[42:43] offset:0 sc1
    v_add_f32 v128, 1.0, v128
    v_mfma_f32_16x16x32_bf16 v[96:99], a[152:155], a[224:227], v[96:99]
    v_add_f32 v129, 1.0, v129
    v_add_f32 v130, 1.0, v130
    v_add_f32 v131, 1.0, v131
    v_mfma_f32_16x16x32_bf16 v[100:103], a[156:159], a[224:227], v[100:103]
    s_waitcnt lgkmcnt(9)
    ds_read_b128 a[224:227], v6 offset:2048
    v_mul_f32 v132, v60, v209
    v_mfma_f32_16x16x32_bf16 v[108:111], a[156:159], a[228:231], v[108:111]
    v_rcp_f32 v128, v128
    v_mfma_f32_16x16x32_bf16 v[104:107], a[152:155], a[228:231], v[104:107]
    global_load_dwordx4 a[116:119], v2, s[42:43] offset:1024 sc1
    v_rcp_f32 v129, v129
    v_mfma_f32_16x16x32_bf16 v[172:175], a[148:151], a[228:231], v[172:175]
    v_rcp_f32 v130, v130
    v_mfma_f32_16x16x32_bf16 v[168:171], a[144:147], a[228:231], v[168:171]
    s_waitcnt vmcnt(48) lgkmcnt(9)
    ds_read_b128 a[228:231], v6 offset:2304
    v_rcp_f32 v131, v131
    v_mfma_f32_16x16x32_bf16 v[144:147], a[160:163], a[232:235], v[144:147]
    v_mul_f32 v56, v56, v128
    v_mul_f32 v57, v57, v129
    v_mfma_f32_16x16x32_bf16 v[148:151], a[164:167], a[232:235], v[148:151]
    global_load_dwordx4 a[120:123], v13, s[46:47] offset:-4096 sc1
    v_mul_f32 v58, v58, v130
    v_mfma_f32_16x16x32_bf16 v[80:83], a[168:171], a[232:235], v[80:83]
    v_mul_f32 v59, v59, v131
    v_mul_f32 v133, v61, v209
    v_mul_f32 v134, v62, v209
    v_mfma_f32_16x16x32_bf16 v[84:87], a[172:175], a[232:235], v[84:87]
    s_waitcnt lgkmcnt(9)
    ds_read_b128 a[232:235], v6 offset:11264
    v_mul_f32 v135, v63, v209
    v_mfma_f32_16x16x32_bf16 v[92:95], a[172:175], a[236:239], v[92:95]
    v_exp_f32 v132, v132
    v_mfma_f32_16x16x32_bf16 v[88:91], a[168:171], a[236:239], v[88:91]
    v_exp_f32 v133, v133
    v_add_f32 v132, 1.0, v132
    v_mfma_f32_16x16x32_bf16 v[156:159], a[164:167], a[236:239], v[156:159]
    global_load_dwordx4 a[124:127], v13, s[46:47] offset:-3072 sc1
    v_add_f32 v133, 1.0, v133
    v_mfma_f32_16x16x32_bf16 v[152:155], a[160:163], a[236:239], v[152:155]
    s_waitcnt lgkmcnt(9)
    ds_read_b128 a[236:239], v6 offset:11520
    v_exp_f32 v134, v134
    v_mfma_f32_16x16x32_bf16 v[160:163], a[160:163], a[240:243], v[160:163]
    v_exp_f32 v135, v135
    v_mfma_f32_16x16x32_bf16 v[164:167], a[164:167], a[240:243], v[164:167]
    v_add_f32 v134, 1.0, v134
    v_add_f32 v135, 1.0, v135
    v_mfma_f32_16x16x32_bf16 v[96:99], a[168:171], a[240:243], v[96:99]
    global_load_dwordx4 a[128:131], v13, s[42:43] offset:0 sc1
    v_rcp_f32 v132, v132
    v_mfma_f32_16x16x32_bf16 v[100:103], a[172:175], a[240:243], v[100:103]
    s_waitcnt lgkmcnt(9)
    ds_read_b128 a[240:243], v6 offset:4096
    v_mul_f32 v60, v60, v132
    v_mfma_f32_16x16x32_bf16 v[108:111], a[172:175], a[244:247], v[108:111]
    v_rcp_f32 v133, v133
    v_mfma_f32_16x16x32_bf16 v[104:107], a[168:171], a[244:247], v[104:107]
    v_rcp_f32 v134, v134
    v_mul_f32 v61, v61, v133
    v_mfma_f32_16x16x32_bf16 v[172:175], a[164:167], a[244:247], v[172:175]
    global_load_dwordx4 a[132:135], v13, s[42:43] offset:1024 sc1
    v_mul_f32 v62, v62, v134
    v_mfma_f32_16x16x32_bf16 v[168:171], a[160:163], a[244:247], v[168:171]
    s_waitcnt vmcnt(48) lgkmcnt(9)
    ds_read_b128 a[244:247], v6 offset:4352
    v_rcp_f32 v135, v135
    v_mfma_f32_16x16x32_bf16 v[144:147], a[176:179], a[248:251], v[144:147]
    v_mul_f32 v63, v63, v135
    v_cvt_pk_bf16_f32 v56, v56, v57
    v_mfma_f32_16x16x32_bf16 v[148:151], a[180:183], a[248:251], v[148:151]
    v_cvt_pk_bf16_f32 v57, v58, v59
    v_cvt_pk_bf16_f32 v58, v60, v61
    v_mfma_f32_16x16x32_bf16 v[80:83], a[184:187], a[248:251], v[80:83]
    v_cvt_pk_bf16_f32 v59, v62, v63
    v_mul_f32 v128, v64, v210
    v_mul_f32 v129, v65, v210
    v_mfma_f32_16x16x32_bf16 v[84:87], a[188:191], a[248:251], v[84:87]
    s_waitcnt lgkmcnt(9)
    global_load_dwordx4 a[136:139], v2, s[48:49] offset:-4096 sc1
    ds_read_b128 a[248:251], v6 offset:13312
    v_mfma_f32_16x16x32_bf16 v[92:95], a[188:191], a[252:255], v[92:95]
    ds_write_b128 v3, v[56:59] offset:20736
    v_mfma_f32_16x16x32_bf16 v[88:91], a[184:187], a[252:255], v[88:91]
    v_mul_f32 v130, v66, v210
    v_mul_f32 v131, v67, v210
    v_mul_f32 v132, v68, v210
    v_mfma_f32_16x16x32_bf16 v[156:159], a[180:183], a[252:255], v[156:159]
    v_exp_f32 v128, v128
    v_mfma_f32_16x16x32_bf16 v[152:155], a[176:179], a[252:255], v[152:155]
    s_waitcnt lgkmcnt(9)
    global_load_dwordx4 a[140:143], v2, s[48:49] offset:-3072 sc1
    ds_read_b128 a[252:255], v6 offset:13568
    v_add_f32 v128, 1.0, v128
    v_mfma_f32_16x16x32_bf16 v[160:163], a[176:179], a[216:219], v[160:163]
    v_exp_f32 v129, v129
    v_mfma_f32_16x16x32_bf16 v[164:167], a[180:183], a[216:219], v[164:167]
    v_exp_f32 v130, v130
    v_mfma_f32_16x16x32_bf16 v[96:99], a[184:187], a[216:219], v[96:99]
    v_exp_f32 v131, v131
    v_add_f32 v129, 1.0, v129
    v_mfma_f32_16x16x32_bf16 v[100:103], a[188:191], a[216:219], v[100:103]
    s_waitcnt lgkmcnt(9)
    global_load_dwordx4 a[144:147], v2, s[44:45] offset:0 sc1
    ds_read_b128 a[216:219], v6 offset:6144
    v_mfma_f32_16x16x32_bf16 v[108:111], a[188:191], a[220:223], v[108:111]
    v_add_f32 v130, 1.0, v130
    v_add_f32 v131, 1.0, v131
    v_mfma_f32_16x16x32_bf16 v[104:107], a[184:187], a[220:223], v[104:107]
    v_rcp_f32 v128, v128
    v_mul_f32 v133, v69, v210
    v_mfma_f32_16x16x32_bf16 v[172:175], a[180:183], a[220:223], v[172:175]
    v_rcp_f32 v129, v129
    v_mfma_f32_16x16x32_bf16 v[168:171], a[176:179], a[220:223], v[168:171]
    s_waitcnt vmcnt(47) lgkmcnt(9)
    ds_read_b128 a[220:223], v6 offset:6400
    v_rcp_f32 v130, v130
    v_mfma_f32_16x16x32_bf16 v[144:147], a[192:195], a[224:227], v[144:147]
    global_load_dwordx4 a[148:151], v2, s[44:45] offset:1024 sc1
    v_mul_f32 v64, v64, v128
    v_mfma_f32_16x16x32_bf16 v[148:151], a[196:199], a[224:227], v[148:151]
    v_rcp_f32 v131, v131
    v_mfma_f32_16x16x32_bf16 v[80:83], a[200:203], a[224:227], v[80:83]
    v_mul_f32 v65, v65, v129
    v_mul_f32 v66, v66, v130
    v_mul_f32 v67, v67, v131
    v_mfma_f32_16x16x32_bf16 v[84:87], a[204:207], a[224:227], v[84:87]
    s_waitcnt lgkmcnt(9)
    ds_read_b128 a[224:227], v6 offset:15360
    v_mul_f32 v134, v70, v210
    v_mfma_f32_16x16x32_bf16 v[92:95], a[204:207], a[228:231], v[92:95]
    global_load_dwordx4 a[152:155], v13, s[48:49] offset:-4096 sc1
    v_mul_f32 v135, v71, v210
    v_mfma_f32_16x16x32_bf16 v[88:91], a[200:203], a[228:231], v[88:91]
    v_exp_f32 v132, v132
    v_cvt_pk_bf16_f32 v64, v64, v65
    v_mfma_f32_16x16x32_bf16 v[156:159], a[196:199], a[228:231], v[156:159]
    v_exp_f32 v133, v133
    v_mfma_f32_16x16x32_bf16 v[152:155], a[192:195], a[228:231], v[152:155]
    s_waitcnt lgkmcnt(9)
    ds_read_b128 a[228:231], v6 offset:15616
    v_exp_f32 v134, v134
    v_mfma_f32_16x16x32_bf16 v[160:163], a[192:195], a[232:235], v[160:163]
    global_load_dwordx4 a[156:159], v13, s[48:49] offset:-3072 sc1
    v_add_f32 v132, 1.0, v132
    v_mfma_f32_16x16x32_bf16 v[164:167], a[196:199], a[232:235], v[164:167]
    v_exp_f32 v135, v135
    v_mfma_f32_16x16x32_bf16 v[96:99], a[200:203], a[232:235], v[96:99]
    v_add_f32 v133, 1.0, v133
    v_add_f32 v134, 1.0, v134
    v_add_f32 v135, 1.0, v135
    v_mfma_f32_16x16x32_bf16 v[100:103], a[204:207], a[232:235], v[100:103]
    s_waitcnt lgkmcnt(9)
    ds_read_b128 a[232:235], v8 offset:8192
    v_cvt_pk_bf16_f32 v65, v66, v67
    v_mfma_f32_16x16x32_bf16 v[108:111], a[204:207], a[236:239], v[108:111]
    v_rcp_f32 v132, v132
    v_mfma_f32_16x16x32_bf16 v[104:107], a[200:203], a[236:239], v[104:107]
    global_load_dwordx4 a[160:163], v2, s[44:45] offset:2048 sc1
    v_rcp_f32 v133, v133
    v_mfma_f32_16x16x32_bf16 v[172:175], a[196:199], a[236:239], v[172:175]
    v_rcp_f32 v134, v134
    v_mfma_f32_16x16x32_bf16 v[168:171], a[192:195], a[236:239], v[168:171]
    s_waitcnt vmcnt(47) lgkmcnt(9)
    ds_read_b128 a[236:239], v8 offset:8448
    v_rcp_f32 v135, v135
    v_mfma_f32_16x16x32_bf16 v[144:147], a[208:211], a[240:243], v[144:147]
    v_mul_f32 v68, v68, v132
    v_mul_f32 v69, v69, v133
    v_mfma_f32_16x16x32_bf16 v[148:151], a[212:215], a[240:243], v[148:151]
    global_load_dwordx4 a[164:167], v2, s[44:45] offset:3072 sc1
    v_mul_f32 v70, v70, v134
    v_mfma_f32_16x16x32_bf16 v[80:83], v[176:179], a[240:243], v[80:83]
    v_mul_f32 v71, v71, v135
    v_cvt_pk_bf16_f32 v66, v68, v69
    v_cvt_pk_bf16_f32 v67, v70, v71
    v_mfma_f32_16x16x32_bf16 v[84:87], v[180:183], a[240:243], v[84:87]
    s_waitcnt lgkmcnt(9)
    ds_read_b128 a[240:243], v8 offset:17408
    v_mul_f32 v128, v72, v211
    v_mfma_f32_16x16x32_bf16 v[92:95], v[180:183], a[244:247], v[92:95]
    ds_write_b128 v3, v[64:67] offset:29696
    v_mfma_f32_16x16x32_bf16 v[88:91], v[176:179], a[244:247], v[88:91]
    global_load_dwordx4 a[168:171], v13, s[48:49] offset:-2048 sc1
    v_mul_f32 v129, v73, v211
    v_mul_f32 v130, v74, v211
    v_mfma_f32_16x16x32_bf16 v[156:159], a[212:215], a[244:247], v[156:159]
    v_mul_f32 v131, v75, v211
    v_mul_f32 v132, v76, v211
    v_mfma_f32_16x16x32_bf16 v[152:155], a[208:211], a[244:247], v[152:155]
    s_waitcnt lgkmcnt(10)
    ds_read_b128 a[244:247], v8 offset:17664
    v_exp_f32 v128, v128
    v_mfma_f32_16x16x32_bf16 v[160:163], a[208:211], a[248:251], v[160:163]
    v_exp_f32 v129, v129
    v_mfma_f32_16x16x32_bf16 v[164:167], a[212:215], a[248:251], v[164:167]
    v_exp_f32 v130, v130
    v_mfma_f32_16x16x32_bf16 v[96:99], v[176:179], a[248:251], v[96:99]
    global_load_dwordx4 a[172:175], v13, s[48:49] offset:-1024 sc1
    v_exp_f32 v131, v131
    v_mfma_f32_16x16x32_bf16 v[100:103], v[180:183], a[248:251], v[100:103]
    s_waitcnt lgkmcnt(9)
    ds_read_b128 a[248:251], v3 offset:0
    v_add_f32 v128, 1.0, v128
    v_mfma_f32_16x16x32_bf16 v[108:111], v[180:183], a[252:255], v[108:111]
    v_add_f32 v129, 1.0, v129
    v_add_f32 v130, 1.0, v130
    v_mfma_f32_16x16x32_bf16 v[104:107], v[176:179], a[252:255], v[104:107]
    v_add_f32 v131, 1.0, v131
    v_rcp_f32 v128, v128
    v_mfma_f32_16x16x32_bf16 v[172:175], a[212:215], a[252:255], v[172:175]
    global_load_dwordx4 a[176:179], v2, s[40:41] offset:2048 sc1
    v_mul_f32 v72, v72, v128
    v_mfma_f32_16x16x32_bf16 v[168:171], a[208:211], a[252:255], v[168:171]
    s_waitcnt vmcnt(47) lgkmcnt(9)
    ds_read_b128 a[252:255], v3 offset:256
    v_rcp_f32 v129, v129
    v_mfma_f32_16x16x32_bf16 v[144:147], v[184:187], a[216:219], v[144:147]
    v_rcp_f32 v130, v130
    v_mfma_f32_16x16x32_bf16 v[148:151], v[188:191], a[216:219], v[148:151]
    v_rcp_f32 v131, v131
    v_mfma_f32_16x16x32_bf16 v[80:83], v[192:195], a[216:219], v[80:83]
    v_mul_f32 v73, v73, v129
    v_mul_f32 v74, v74, v130
    v_mul_f32 v75, v75, v131
    v_mfma_f32_16x16x32_bf16 v[84:87], v[196:199], a[216:219], v[84:87]
    s_waitcnt lgkmcnt(9)
    global_load_dwordx4 a[180:183], v2, s[40:41] offset:3072 sc1
    ds_read_b128 a[216:219], v3 offset:9216
    v_mfma_f32_16x16x32_bf16 v[92:95], v[196:199], a[220:223], v[92:95]
    v_mul_f32 v133, v77, v211
    v_mul_f32 v134, v78, v211
    v_mfma_f32_16x16x32_bf16 v[88:91], v[192:195], a[220:223], v[88:91]
    v_mul_f32 v135, v79, v211
    v_exp_f32 v132, v132
    v_mfma_f32_16x16x32_bf16 v[156:159], v[188:191], a[220:223], v[156:159]
    v_exp_f32 v133, v133
    v_mfma_f32_16x16x32_bf16 v[152:155], v[184:187], a[220:223], v[152:155]
    s_waitcnt lgkmcnt(9)
    global_load_dwordx4 a[184:187], v13, s[44:45] offset:-2048 sc1
    ds_read_b128 a[220:223], v3 offset:9472
    v_add_f32 v132, 1.0, v132
    v_mfma_f32_16x16x32_bf16 v[160:163], v[184:187], a[224:227], v[160:163]
    v_exp_f32 v134, v134
    v_mfma_f32_16x16x32_bf16 v[164:167], v[188:191], a[224:227], v[164:167]
    v_exp_f32 v135, v135
    v_mfma_f32_16x16x32_bf16 v[96:99], v[192:195], a[224:227], v[96:99]
    v_add_f32 v133, 1.0, v133
    v_add_f32 v134, 1.0, v134
    v_add_f32 v135, 1.0, v135
    v_mfma_f32_16x16x32_bf16 v[100:103], v[196:199], a[224:227], v[100:103]
    s_waitcnt lgkmcnt(9)
    global_load_dwordx4 a[188:191], v13, s[44:45] offset:-1024 sc1
    ds_read_b128 a[224:227], v3 offset:2048
    v_mfma_f32_16x16x32_bf16 v[108:111], v[196:199], a[228:231], v[108:111]
    v_rcp_f32 v132, v132
    v_mfma_f32_16x16x32_bf16 v[104:107], v[192:195], a[228:231], v[104:107]
    v_rcp_f32 v133, v133
    v_mul_f32 v76, v76, v132
    v_mfma_f32_16x16x32_bf16 v[172:175], v[188:191], a[228:231], v[172:175]
    v_rcp_f32 v134, v134
    v_mfma_f32_16x16x32_bf16 v[168:171], v[184:187], a[228:231], v[168:171]
    s_waitcnt vmcnt(46) lgkmcnt(9)
    ds_read_b128 a[228:231], v3 offset:2304
    v_rcp_f32 v135, v135
    v_mfma_f32_16x16x32_bf16 v[144:147], v[200:203], a[232:235], v[144:147]
    global_load_dwordx4 a[192:195], v13, s[40:41] offset:2048 sc1
    v_mul_f32 v77, v77, v133
    v_mfma_f32_16x16x32_bf16 v[148:151], v[204:207], a[232:235], v[148:151]
    v_mul_f32 v78, v78, v134
    v_mul_f32 v79, v79, v135
    v_mfma_f32_16x16x32_bf16 v[80:83], a[0:3], a[232:235], v[80:83]
    v_cvt_pk_bf16_f32 v72, v72, v73
    v_cvt_pk_bf16_f32 v73, v74, v75
    v_cvt_pk_bf16_f32 v74, v76, v77
    v_mfma_f32_16x16x32_bf16 v[84:87], a[4:7], a[232:235], v[84:87]
    s_waitcnt lgkmcnt(9)
    ds_read_b128 a[232:235], v3 offset:11264
    v_cvt_pk_bf16_f32 v75, v78, v79
    v_mfma_f32_16x16x32_bf16 v[92:95], a[4:7], a[236:239], v[92:95]
wc_pad2:
    s_cbranch_execz wc_pad6
    global_load_dwordx4 a[196:199], v13, s[40:41] offset:3072 sc1
    v_mfma_f32_16x16x32_bf16 v[88:91], a[0:3], a[236:239], v[88:91]
    ds_write_b128 v3, v[72:75] offset:29952
    v_mfma_f32_16x16x32_bf16 v[156:159], v[204:207], a[236:239], v[156:159]
    v_mfma_f32_16x16x32_bf16 v[152:155], v[200:203], a[236:239], v[152:155]
    s_waitcnt lgkmcnt(10)
    ds_read_b128 a[236:239], v3 offset:11520
    v_mfma_f32_16x16x32_bf16 v[160:163], v[200:203], a[240:243], v[160:163]
    global_load_dwordx4 a[200:203], v2, s[46:47] offset:-2048 sc1
    v_mfma_f32_16x16x32_bf16 v[164:167], v[204:207], a[240:243], v[164:167]
    v_mfma_f32_16x16x32_bf16 v[96:99], a[0:3], a[240:243], v[96:99]
    s_waitcnt lgkmcnt(1)
    s_barrier
    v_mfma_f32_16x16x32_bf16 v[100:103], a[4:7], a[240:243], v[100:103]
    ds_read_b128 a[240:243], v3 offset:4096
    v_mfma_f32_16x16x32_bf16 v[108:111], a[4:7], a[244:247], v[108:111]
    v_mfma_f32_16x16x32_bf16 v[104:107], a[0:3], a[244:247], v[104:107]
    global_load_dwordx4 a[204:207], v2, s[46:47] offset:-1024 sc1
    v_mfma_f32_16x16x32_bf16 v[172:175], v[204:207], a[244:247], v[172:175]
    v_mfma_f32_16x16x32_bf16 v[168:171], v[200:203], a[244:247], v[168:171]
    s_waitcnt vmcnt(48)
    ds_read_b128 a[244:247], v3 offset:4352
    v_mfma_f32_16x16x32_bf16 v[80:83], a[8:11], a[248:251], v[80:83]
    v_mfma_f32_16x16x32_bf16 v[84:87], a[12:15], a[248:251], v[84:87]
    global_load_dwordx4 a[208:211], v2, s[42:43] offset:2048 sc1
    ds_read_b128 a[248:251], v3 offset:13312
    v_mfma_f32_16x16x32_bf16 v[92:95], a[12:15], a[252:255], v[92:95]
    v_mul_f32 v128, v144, v208
    v_mul_f32 v129, v145, v208
    v_mul_f32 v130, v146, v208
    v_mfma_f32_16x16x32_bf16 v[88:91], a[8:11], a[252:255], v[88:91]
    ds_read_b128 a[252:255], v3 offset:13568
    v_mul_f32 v131, v147, v208
    v_mfma_f32_16x16x32_bf16 v[96:99], a[8:11], a[216:219], v[96:99]
    v_exp_f32 v128, v128
    v_mfma_f32_16x16x32_bf16 v[100:103], a[12:15], a[216:219], v[100:103]
    global_load_dwordx4 a[212:215], v2, s[42:43] offset:3072 sc1
    ds_read_b128 a[216:219], v3 offset:6144
    v_add_f32 v128, 1.0, v128
    v_mfma_f32_16x16x32_bf16 v[108:111], a[12:15], a[220:223], v[108:111]
    v_exp_f32 v129, v129
    v_mfma_f32_16x16x32_bf16 v[104:107], a[8:11], a[220:223], v[104:107]
    s_waitcnt vmcnt(48)
    ds_read_b128 a[220:223], v3 offset:6400
    v_exp_f32 v130, v130
    v_mfma_f32_16x16x32_bf16 v[80:83], a[16:19], a[224:227], v[80:83]
    v_exp_f32 v131, v131
    v_mfma_f32_16x16x32_bf16 v[84:87], a[20:23], a[224:227], v[84:87]
    ds_read_b128 a[224:227], v3 offset:15360
    v_add_f32 v129, 1.0, v129
    v_mfma_f32_16x16x32_bf16 v[92:95], a[20:23], a[228:231], v[92:95]
    global_load_dwordx4 v[176:179], v13, s[46:47] offset:-2048 sc1
    v_add_f32 v130, 1.0, v130
    v_add_f32 v131, 1.0, v131
    v_mfma_f32_16x16x32_bf16 v[88:91], a[16:19], a[228:231], v[88:91]
    ds_read_b128 a[228:231], v3 offset:15616
    v_mul_f32 v132, v148, v208
    v_mfma_f32_16x16x32_bf16 v[96:99], a[16:19], a[232:235], v[96:99]
    v_rcp_f32 v128, v128
    v_mfma_f32_16x16x32_bf16 v[100:103], a[20:23], a[232:235], v[100:103]
    s_waitcnt lgkmcnt(8)
    ds_read_b128 a[232:235], v5 offset:0
    v_rcp_f32 v129, v129
    v_mfma_f32_16x16x32_bf16 v[108:111], a[20:23], a[236:239], v[108:111]
    global_load_dwordx4 v[180:183], v13, s[46:47] offset:-1024 sc1
    v_mul_f32 v144, v144, v128
    v_mfma_f32_16x16x32_bf16 v[104:107], a[16:19], a[236:239], v[104:107]
    s_waitcnt vmcnt(48) lgkmcnt(8)
    ds_read_b128 a[236:239], v5 offset:256
    v_rcp_f32 v130, v130
    v_mfma_f32_16x16x32_bf16 v[80:83], a[24:27], a[240:243], v[80:83]
    v_rcp_f32 v131, v131
    v_mfma_f32_16x16x32_bf16 v[84:87], a[28:31], a[240:243], v[84:87]
    s_waitcnt lgkmcnt(8)
    ds_read_b128 a[240:243], v5 offset:9216
    v_mul_f32 v145, v145, v129
    v_mfma_f32_16x16x32_bf16 v[92:95], a[28:31], a[244:247], v[92:95]
    global_load_dwordx4 v[184:187], v13, s[42:43] offset:2048 sc1
    v_mul_f32 v146, v146, v130
    v_mul_f32 v147, v147, v131
    v_mfma_f32_16x16x32_bf16 v[88:91], a[24:27], a[244:247], v[88:91]
    s_waitcnt lgkmcnt(8)
    ds_read_b128 a[244:247], v5 offset:9472
    v_mul_f32 v133, v149, v208
    v_mfma_f32_16x16x32_bf16 v[96:99], a[24:27], a[248:251], v[96:99]
    v_mul_f32 v134, v150, v208
    v_mul_f32 v135, v151, v208
    v_mfma_f32_16x16x32_bf16 v[100:103], a[28:31], a[248:251], v[100:103]
    s_waitcnt lgkmcnt(8)
    ds_read_b128 a[248:251], v5 offset:2048
    v_exp_f32 v132, v132
    v_mfma_f32_16x16x32_bf16 v[108:111], a[28:31], a[252:255], v[108:111]
    v_exp_f32 v133, v133
    v_mfma_f32_16x16x32_bf16 v[104:107], a[24:27], a[252:255], v[104:107]
    s_waitcnt vmcnt(47) lgkmcnt(8)
    global_load_dwordx4 v[188:191], v13, s[42:43] offset:3072 sc1
    ds_read_b128 a[252:255], v5 offset:2304
    v_add_f32 v132, 1.0, v132
    v_mfma_f32_16x16x32_bf16 v[80:83], a[32:35], a[216:219], v[80:83]
    v_exp_f32 v134, v134
    v_mfma_f32_16x16x32_bf16 v[84:87], a[36:39], a[216:219], v[84:87]
    s_waitcnt lgkmcnt(8)
    ds_read_b128 a[216:219], v5 offset:11264
    v_add_f32 v133, 1.0, v133
    v_mfma_f32_16x16x32_bf16 v[92:95], a[36:39], a[220:223], v[92:95]
    v_exp_f32 v135, v135
    v_add_f32 v134, 1.0, v134
    v_mfma_f32_16x16x32_bf16 v[88:91], a[32:35], a[220:223], v[88:91]
    s_waitcnt lgkmcnt(8)
    global_load_dwordx4 v[192:195], v2, s[48:49] offset:-2048 sc1
    ds_read_b128 a[220:223], v5 offset:11520
    v_mfma_f32_16x16x32_bf16 v[96:99], a[32:35], a[224:227], v[96:99]
    v_add_f32 v135, 1.0, v135
    v_cvt_pk_bf16_f32 v144, v144, v145
    v_mfma_f32_16x16x32_bf16 v[100:103], a[36:39], a[224:227], v[100:103]
    s_waitcnt lgkmcnt(8)
    ds_read_b128 a[224:227], v5 offset:4096
    v_rcp_f32 v132, v132
    v_mfma_f32_16x16x32_bf16 v[108:111], a[36:39], a[228:231], v[108:111]
    v_rcp_f32 v133, v133
    v_mfma_f32_16x16x32_bf16 v[104:107], a[32:35], a[228:231], v[104:107]
    s_waitcnt vmcnt(47) lgkmcnt(8)
    global_load_dwordx4 v[196:199], v2, s[48:49] offset:-1024 sc1
    ds_read_b128 a[228:231], v5 offset:4352
    v_mul_f32 v148, v148, v132
    v_mfma_f32_16x16x32_bf16 v[80:83], a[40:43], a[232:235], v[80:83]
    v_rcp_f32 v134, v134
    v_mfma_f32_16x16x32_bf16 v[84:87], a[44:47], a[232:235], v[84:87]
    s_waitcnt lgkmcnt(8)
    ds_read_b128 a[232:235], v5 offset:13312
    v_mul_f32 v149, v149, v133
    v_mfma_f32_16x16x32_bf16 v[92:95], a[44:47], a[236:239], v[92:95]
    v_rcp_f32 v135, v135
    v_mul_f32 v150, v150, v134
    v_mfma_f32_16x16x32_bf16 v[88:91], a[40:43], a[236:239], v[88:91]
    s_waitcnt lgkmcnt(8)
    ds_read_b128 a[236:239], v5 offset:13568
    v_mul_f32 v151, v151, v135
    v_mfma_f32_16x16x32_bf16 v[96:99], a[40:43], a[240:243], v[96:99]
    global_load_dwordx4 v[200:203], v13, s[40:41] offset:-4096 sc1
    v_cvt_pk_bf16_f32 v145, v146, v147
    v_mfma_f32_16x16x32_bf16 v[100:103], a[44:47], a[240:243], v[100:103]
    s_waitcnt lgkmcnt(8)
    ds_read_b128 a[240:243], v5 offset:6144
    v_cvt_pk_bf16_f32 v146, v148, v149
    v_cvt_pk_bf16_f32 v147, v150, v151
    v_mfma_f32_16x16x32_bf16 v[108:111], a[44:47], a[244:247], v[108:111]
    ds_write_b128 v3, v[144:147] offset:22528
    v_mfma_f32_16x16x32_bf16 v[104:107], a[40:43], a[244:247], v[104:107]
    s_waitcnt vmcnt(47) lgkmcnt(9)
    ds_read_b128 a[244:247], v5 offset:6400
    v_mul_f32 v128, v152, v209
    v_mul_f32 v129, v153, v209
    v_mfma_f32_16x16x32_bf16 v[80:83], a[48:51], a[248:251], v[80:83]
    global_load_dwordx4 v[204:207], v13, s[40:41] offset:-3072 sc1
    v_mul_f32 v130, v154, v209
    v_mfma_f32_16x16x32_bf16 v[84:87], a[52:55], a[248:251], v[84:87]
    s_waitcnt lgkmcnt(9)
    ds_read_b128 a[248:251], v5 offset:15360
    v_mul_f32 v131, v155, v209
    v_mfma_f32_16x16x32_bf16 v[92:95], a[52:55], a[252:255], v[92:95]
    v_exp_f32 v128, v128
    v_mul_f32 v132, v156, v209
    v_mfma_f32_16x16x32_bf16 v[88:91], a[48:51], a[252:255], v[88:91]
    s_waitcnt lgkmcnt(9)
    ds_read_b128 a[252:255], v5 offset:15616
    v_add_f32 v128, 1.0, v128
    v_mfma_f32_16x16x32_bf16 v[96:99], a[48:51], a[216:219], v[96:99]
    v_exp_f32 v129, v129
    v_mfma_f32_16x16x32_bf16 v[100:103], a[52:55], a[216:219], v[100:103]
    s_waitcnt lgkmcnt(9)
    global_load_dwordx4 a[0:3], v13, s[44:45] offset:0 sc1
    ds_read_b128 a[216:219], v7 offset:8192
    v_add_f32 v129, 1.0, v129
    v_mfma_f32_16x16x32_bf16 v[108:111], a[52:55], a[220:223], v[108:111]
    v_exp_f32 v130, v130
    v_mfma_f32_16x16x32_bf16 v[104:107], a[48:51], a[220:223], v[104:107]
    s_waitcnt vmcnt(47) lgkmcnt(9)
    ds_read_b128 a[220:223], v7 offset:8448
    v_exp_f32 v131, v131
    v_mfma_f32_16x16x32_bf16 v[80:83], a[56:59], a[224:227], v[80:83]
    v_add_f32 v130, 1.0, v130
    v_add_f32 v131, 1.0, v131
    v_mfma_f32_16x16x32_bf16 v[84:87], a[60:63], a[224:227], v[84:87]
    s_waitcnt lgkmcnt(9)
    global_load_dwordx4 a[4:7], v13, s[44:45] offset:1024 sc1
    ds_read_b128 a[224:227], v7 offset:17408
    v_mfma_f32_16x16x32_bf16 v[92:95], a[60:63], a[228:231], v[92:95]
    v_rcp_f32 v128, v128
    v_mul_f32 v133, v157, v209
    v_mfma_f32_16x16x32_bf16 v[88:91], a[56:59], a[228:231], v[88:91]
    s_waitcnt lgkmcnt(9)
    ds_read_b128 a[228:231], v7 offset:17664
    v_mul_f32 v152, v152, v128
    v_mfma_f32_16x16x32_bf16 v[96:99], a[56:59], a[232:235], v[96:99]
    v_rcp_f32 v129, v129
    v_mfma_f32_16x16x32_bf16 v[100:103], a[60:63], a[232:235], v[100:103]
    s_waitcnt lgkmcnt(9)
    global_load_dwordx4 a[8:11], v2, s[42:43] offset:-4096 sc1
    ds_read_b128 a[232:235], v3 offset:18432
    v_mul_f32 v153, v153, v129
    v_mfma_f32_16x16x32_bf16 v[108:111], a[60:63], a[236:239], v[108:111]
    v_rcp_f32 v130, v130
    v_mfma_f32_16x16x32_bf16 v[104:107], a[56:59], a[236:239], v[104:107]
    s_waitcnt vmcnt(47) lgkmcnt(9)
    ds_read_b128 a[236:239], v3 offset:18688
    v_rcp_f32 v131, v131
    v_mfma_f32_16x16x32_bf16 v[80:83], a[64:67], a[240:243], v[80:83]
    v_mul_f32 v154, v154, v130
    v_mul_f32 v155, v155, v131
    v_mfma_f32_16x16x32_bf16 v[84:87], a[68:71], a[240:243], v[84:87]
    s_waitcnt lgkmcnt(8)
    ds_read_b128 a[240:243], v3 offset:27648
    v_mul_f32 v134, v158, v209
    v_mfma_f32_16x16x32_bf16 v[92:95], a[68:71], a[244:247], v[92:95]
    global_load_dwordx4 a[12:15], v2, s[42:43] offset:-3072 sc1
    v_mul_f32 v135, v159, v209
    v_cvt_pk_bf16_f32 v152, v152, v153
    v_mfma_f32_16x16x32_bf16 v[88:91], a[64:67], a[244:247], v[88:91]
    s_waitcnt lgkmcnt(8)
    ds_read_b128 a[244:247], v3 offset:27904
    v_cvt_pk_bf16_f32 v153, v154, v155
    v_mfma_f32_16x16x32_bf16 v[96:99], a[64:67], a[248:251], v[96:99]
    v_exp_f32 v132, v132
    v_mfma_f32_16x16x32_bf16 v[100:103], a[68:71], a[248:251], v[100:103]
    s_waitcnt lgkmcnt(8)
    ds_read_b128 a[248:251], v4 offset:18432
    v_exp_f32 v133, v133
    v_mfma_f32_16x16x32_bf16 v[108:111], a[68:71], a[252:255], v[108:111]
    global_load_dwordx4 a[16:19], v2, s[46:47] offset:0 sc1
    v_add_f32 v132, 1.0, v132
    v_mfma_f32_16x16x32_bf16 v[104:107], a[64:67], a[252:255], v[104:107]
    s_waitcnt vmcnt(47) lgkmcnt(8)
    ds_read_b128 a[252:255], v4 offset:18688
    v_exp_f32 v134, v134
    v_mfma_f32_16x16x32_bf16 v[80:83], a[72:75], a[216:219], v[80:83]
    v_exp_f32 v135, v135
    v_mfma_f32_16x16x32_bf16 v[84:87], a[76:79], a[216:219], v[84:87]
    s_waitcnt lgkmcnt(8)
    ds_read_b128 a[216:219], v4 offset:27648
    v_add_f32 v133, 1.0, v133
    v_mfma_f32_16x16x32_bf16 v[92:95], a[76:79], a[220:223], v[92:95]
    global_load_dwordx4 a[20:23], v2, s[46:47] offset:1024 sc1
    v_add_f32 v134, 1.0, v134
    v_add_f32 v135, 1.0, v135
    v_mfma_f32_16x16x32_bf16 v[88:91], a[72:75], a[220:223], v[88:91]
    s_waitcnt lgkmcnt(8)
    ds_read_b128 a[220:223], v4 offset:27904
    v_mul_f32 v128, v160, v210
    v_mfma_f32_16x16x32_bf16 v[96:99], a[72:75], a[224:227], v[96:99]
    v_rcp_f32 v132, v132
    v_mfma_f32_16x16x32_bf16 v[100:103], a[76:79], a[224:227], v[100:103]
    s_waitcnt lgkmcnt(8)
    ds_read_b128 a[224:227], v5 offset:18432
    v_rcp_f32 v133, v133
    v_mfma_f32_16x16x32_bf16 v[108:111], a[76:79], a[228:231], v[108:111]
    v_rcp_f32 v134, v134
    v_mfma_f32_16x16x32_bf16 v[104:107], a[72:75], a[228:231], v[104:107]
    s_waitcnt vmcnt(44) lgkmcnt(8)
    global_load_dwordx4 a[24:27], v13, s[42:43] offset:-4096 sc1
    ds_read_b128 a[228:231], v5 offset:18688
    v_mul_f32 v156, v156, v132
    v_mfma_f32_16x16x32_bf16 v[16:19], a[80:83], a[232:235], 0
    v_rcp_f32 v135, v135
    v_mfma_f32_16x16x32_bf16 v[20:23], a[84:87], a[232:235], 0
    v_mul_f32 v157, v157, v133
    v_mul_f32 v158, v158, v134
    v_mfma_f32_16x16x32_bf16 v[48:51], a[88:91], a[232:235], 0
    v_mul_f32 v159, v159, v135
    v_cvt_pk_bf16_f32 v154, v156, v157
    v_cvt_pk_bf16_f32 v155, v158, v159
    v_mfma_f32_16x16x32_bf16 v[52:55], a[92:95], a[232:235], 0
    s_waitcnt lgkmcnt(8)
    global_load_dwordx4 a[28:31], v13, s[42:43] offset:-3072 sc1
    ds_read_b128 a[232:235], v5 offset:27648
    v_mfma_f32_16x16x32_bf16 v[60:63], a[92:95], a[236:239], 0
    ds_write_b128 v3, v[152:155] offset:22784
    v_mfma_f32_16x16x32_bf16 v[56:59], a[88:91], a[236:239], 0
    v_mul_f32 v129, v161, v210
    v_mul_f32 v130, v162, v210
    v_mul_f32 v131, v163, v210
    v_mfma_f32_16x16x32_bf16 v[28:31], a[84:87], a[236:239], 0
    v_exp_f32 v128, v128
    v_mfma_f32_16x16x32_bf16 v[24:27], a[80:83], a[236:239], 0
    s_waitcnt lgkmcnt(9)
    global_load_dwordx4 a[32:35], v13, s[46:47] offset:0 sc1
    ds_read_b128 a[236:239], v5 offset:27904
    v_add_f32 v128, 1.0, v128
    v_mfma_f32_16x16x32_bf16 v[32:35], a[80:83], a[240:243], 0
    v_exp_f32 v129, v129
    v_mfma_f32_16x16x32_bf16 v[36:39], a[84:87], a[240:243], 0
    v_exp_f32 v130, v130
    v_mfma_f32_16x16x32_bf16 v[64:67], a[88:91], a[240:243], 0
    v_exp_f32 v131, v131
    v_add_f32 v129, 1.0, v129
    v_mfma_f32_16x16x32_bf16 v[68:71], a[92:95], a[240:243], 0
    s_waitcnt lgkmcnt(9)
    ds_read_b128 a[240:243], v6 offset:18432
    v_add_f32 v130, 1.0, v130
    v_mfma_f32_16x16x32_bf16 v[76:79], a[92:95], a[244:247], 0
    global_load_dwordx4 a[36:39], v13, s[46:47] offset:1024 sc1
    v_add_f32 v131, 1.0, v131
    v_mfma_f32_16x16x32_bf16 v[72:75], a[88:91], a[244:247], 0
    v_rcp_f32 v128, v128
    v_mul_f32 v132, v164, v210
    v_mfma_f32_16x16x32_bf16 v[44:47], a[84:87], a[244:247], 0
    v_rcp_f32 v129, v129
    v_mfma_f32_16x16x32_bf16 v[40:43], a[80:83], a[244:247], 0
    s_waitcnt vmcnt(44) lgkmcnt(9)
    ds_read_b128 a[244:247], v6 offset:18688
    v_rcp_f32 v130, v130
    v_mfma_f32_16x16x32_bf16 v[16:19], a[96:99], a[248:251], v[16:19]
    global_load_dwordx4 a[40:43], v2, s[44:45] offset:-4096 sc1
    v_mul_f32 v160, v160, v128
    v_mfma_f32_16x16x32_bf16 v[20:23], a[100:103], a[248:251], v[20:23]
    v_rcp_f32 v131, v131
    v_mfma_f32_16x16x32_bf16 v[48:51], a[104:107], a[248:251], v[48:51]
    v_mul_f32 v161, v161, v129
    v_mul_f32 v162, v162, v130
    v_mul_f32 v163, v163, v131
    v_mfma_f32_16x16x32_bf16 v[52:55], a[108:111], a[248:251], v[52:55]
    s_waitcnt lgkmcnt(9)
    ds_read_b128 a[248:251], v6 offset:27648
    v_mul_f32 v133, v165, v210
    v_mfma_f32_16x16x32_bf16 v[60:63], a[108:111], a[252:255], v[60:63]
    global_load_dwordx4 a[44:47], v2, s[44:45] offset:-3072 sc1
    v_mul_f32 v134, v166, v210
    v_mfma_f32_16x16x32_bf16 v[56:59], a[104:107], a[252:255], v[56:59]
    v_mul_f32 v135, v167, v210
    v_exp_f32 v132, v132
    v_mfma_f32_16x16x32_bf16 v[28:31], a[100:103], a[252:255], v[28:31]
    v_exp_f32 v133, v133
    v_mfma_f32_16x16x32_bf16 v[24:27], a[96:99], a[252:255], v[24:27]
    s_waitcnt lgkmcnt(9)
    ds_read_b128 a[252:255], v6 offset:27904
    v_exp_f32 v134, v134
    v_mfma_f32_16x16x32_bf16 v[32:35], a[96:99], a[216:219], v[32:35]
    v_exp_f32 v135, v135
    v_mfma_f32_16x16x32_bf16 v[36:39], a[100:103], a[216:219], v[36:39]
    global_load_dwordx4 a[48:51], v2, s[48:49] offset:0 sc1
    v_add_f32 v132, 1.0, v132
    v_mfma_f32_16x16x32_bf16 v[64:67], a[104:107], a[216:219], v[64:67]
    v_add_f32 v133, 1.0, v133
    v_add_f32 v134, 1.0, v134
    v_add_f32 v135, 1.0, v135
    v_mfma_f32_16x16x32_bf16 v[68:71], a[108:111], a[216:219], v[68:71]
    s_waitcnt lgkmcnt(9)
    ds_read_b128 a[216:219], v7 offset:26624
    v_cvt_pk_bf16_f32 v160, v160, v161
    v_mfma_f32_16x16x32_bf16 v[76:79], a[108:111], a[220:223], v[76:79]
    v_rcp_f32 v132, v132
    v_mfma_f32_16x16x32_bf16 v[72:75], a[104:107], a[220:223], v[72:75]
    global_load_dwordx4 a[52:55], v2, s[48:49] offset:1024 sc1
    v_rcp_f32 v133, v133
    v_mfma_f32_16x16x32_bf16 v[44:47], a[100:103], a[220:223], v[44:47]
    v_rcp_f32 v134, v134
    v_mfma_f32_16x16x32_bf16 v[40:43], a[96:99], a[220:223], v[40:43]
    s_waitcnt vmcnt(44) lgkmcnt(9)
    ds_read_b128 a[220:223], v7 offset:26880
    v_rcp_f32 v135, v135
    v_mfma_f32_16x16x32_bf16 v[16:19], a[112:115], a[224:227], v[16:19]
    v_mul_f32 v164, v164, v132
    v_mul_f32 v165, v165, v133
    v_mfma_f32_16x16x32_bf16 v[20:23], a[116:119], a[224:227], v[20:23]
    global_load_dwordx4 a[56:59], v13, s[40:41] offset:-2048 sc1
    v_mul_f32 v166, v166, v134
    v_mfma_f32_16x16x32_bf16 v[48:51], a[120:123], a[224:227], v[48:51]
    v_mul_f32 v167, v167, v135
    v_cvt_pk_bf16_f32 v161, v162, v163
    v_cvt_pk_bf16_f32 v162, v164, v165
    v_mfma_f32_16x16x32_bf16 v[52:55], a[124:127], a[224:227], v[52:55]
    s_waitcnt lgkmcnt(9)
    ds_read_b128 a[224:227], v7 offset:35840
    v_cvt_pk_bf16_f32 v163, v166, v167
    v_mfma_f32_16x16x32_bf16 v[60:63], a[124:127], a[228:231], v[60:63]
    ds_write_b128 v3, v[160:163] offset:31744
    v_mfma_f32_16x16x32_bf16 v[56:59], a[120:123], a[228:231], v[56:59]
    v_mul_f32 v128, v168, v211
    v_mul_f32 v129, v169, v211
    v_mul_f32 v130, v170, v211
    v_mfma_f32_16x16x32_bf16 v[28:31], a[116:119], a[228:231], v[28:31]
    global_load_dwordx4 a[60:63], v13, s[40:41] offset:-1024 sc1
    v_mul_f32 v131, v171, v211
    v_mfma_f32_16x16x32_bf16 v[24:27], a[112:115], a[228:231], v[24:27]
    s_waitcnt lgkmcnt(10)
    ds_read_b128 a[228:231], v7 offset:36096
    v_exp_f32 v128, v128
    v_mfma_f32_16x16x32_bf16 v[32:35], a[112:115], a[232:235], v[32:35]
    v_exp_f32 v129, v129
    v_mfma_f32_16x16x32_bf16 v[36:39], a[116:119], a[232:235], v[36:39]
    v_exp_f32 v130, v130
    v_mfma_f32_16x16x32_bf16 v[64:67], a[120:123], a[232:235], v[64:67]
    global_load_dwordx4 a[64:67], v13, s[44:45] offset:2048 sc1
    v_exp_f32 v131, v131
    v_mfma_f32_16x16x32_bf16 v[68:71], a[124:127], a[232:235], v[68:71]
    s_waitcnt lgkmcnt(9)
    ds_read_b128 a[232:235], v8 offset:26624
    v_add_f32 v128, 1.0, v128
    v_mfma_f32_16x16x32_bf16 v[76:79], a[124:127], a[236:239], v[76:79]
    v_add_f32 v129, 1.0, v129
    v_add_f32 v130, 1.0, v130
    v_mfma_f32_16x16x32_bf16 v[72:75], a[120:123], a[236:239], v[72:75]
    v_add_f32 v131, 1.0, v131
    v_rcp_f32 v128, v128
    v_mfma_f32_16x16x32_bf16 v[44:47], a[116:119], a[236:239], v[44:47]
    v_rcp_f32 v129, v129
    v_mfma_f32_16x16x32_bf16 v[40:43], a[112:115], a[236:239], v[40:43]
    s_waitcnt vmcnt(43) lgkmcnt(9)
    global_load_dwordx4 a[68:71], v13, s[44:45] offset:3072 sc1
    ds_read_b128 a[236:239], v8 offset:26880
    v_mul_f32 v168, v168, v128
    v_mfma_f32_16x16x32_bf16 v[16:19], a[128:131], a[240:243], v[16:19]
    v_rcp_f32 v130, v130
    v_mfma_f32_16x16x32_bf16 v[20:23], a[132:135], a[240:243], v[20:23]
    v_rcp_f32 v131, v131
    v_mfma_f32_16x16x32_bf16 v[48:51], a[136:139], a[240:243], v[48:51]
    v_mul_f32 v169, v169, v129
    v_mul_f32 v170, v170, v130
    v_mul_f32 v171, v171, v131
    v_mfma_f32_16x16x32_bf16 v[52:55], a[140:143], a[240:243], v[52:55]
    s_waitcnt lgkmcnt(9)
    global_load_dwordx4 a[72:75], v2, s[42:43] offset:-2048 sc1
    ds_read_b128 a[240:243], v8 offset:35840
    v_mfma_f32_16x16x32_bf16 v[60:63], a[140:143], a[244:247], v[60:63]
    v_mul_f32 v132, v172, v211
    v_mul_f32 v133, v173, v211
    v_mfma_f32_16x16x32_bf16 v[56:59], a[136:139], a[244:247], v[56:59]
    v_mul_f32 v134, v174, v211
    v_mul_f32 v135, v175, v211
    v_cvt_pk_bf16_f32 v168, v168, v169
    v_mfma_f32_16x16x32_bf16 v[28:31], a[132:135], a[244:247], v[28:31]
    v_exp_f32 v132, v132
    v_mfma_f32_16x16x32_bf16 v[24:27], a[128:131], a[244:247], v[24:27]
    s_waitcnt lgkmcnt(9)
    global_load_dwordx4 a[76:79], v2, s[42:43] offset:-1024 sc1
    ds_read_b128 a[244:247], v8 offset:36096
    v_add_f32 v132, 1.0, v132
    v_mfma_f32_16x16x32_bf16 v[32:35], a[128:131], a[248:251], v[32:35]
    v_exp_f32 v133, v133
    v_mfma_f32_16x16x32_bf16 v[36:39], a[132:135], a[248:251], v[36:39]
    v_exp_f32 v134, v134
    v_mfma_f32_16x16x32_bf16 v[64:67], a[136:139], a[248:251], v[64:67]
    v_exp_f32 v135, v135
    v_add_f32 v133, 1.0, v133
    v_mfma_f32_16x16x32_bf16 v[68:71], a[140:143], a[248:251], v[68:71]
    s_waitcnt lgkmcnt(9)
    ds_read_b128 a[248:251], v3 offset:20480
    v_add_f32 v134, 1.0, v134
    v_mfma_f32_16x16x32_bf16 v[76:79], a[140:143], a[252:255], v[76:79]
    global_load_dwordx4 a[80:83], v2, s[46:47] offset:2048 sc1
    v_add_f32 v135, 1.0, v135
    v_mfma_f32_16x16x32_bf16 v[72:75], a[136:139], a[252:255], v[72:75]
    v_rcp_f32 v132, v132
    v_cvt_pk_bf16_f32 v169, v170, v171
    v_mfma_f32_16x16x32_bf16 v[44:47], a[132:135], a[252:255], v[44:47]
    v_rcp_f32 v133, v133
    v_mfma_f32_16x16x32_bf16 v[40:43], a[128:131], a[252:255], v[40:43]
    s_waitcnt vmcnt(43) lgkmcnt(9)
    ds_read_b128 a[252:255], v3 offset:20736
    v_rcp_f32 v134, v134
    v_mfma_f32_16x16x32_bf16 v[16:19], a[144:147], a[216:219], v[16:19]
    global_load_dwordx4 a[84:87], v2, s[46:47] offset:3072 sc1
    v_mul_f32 v172, v172, v132
    v_mfma_f32_16x16x32_bf16 v[20:23], a[148:151], a[216:219], v[20:23]
    v_rcp_f32 v135, v135
    v_mfma_f32_16x16x32_bf16 v[48:51], a[152:155], a[216:219], v[48:51]
    v_mul_f32 v173, v173, v133
    v_mul_f32 v174, v174, v134
    v_mul_f32 v175, v175, v135
    v_mfma_f32_16x16x32_bf16 v[52:55], a[156:159], a[216:219], v[52:55]
    s_waitcnt lgkmcnt(9)
    ds_read_b128 a[216:219], v3 offset:29696
    v_cvt_pk_bf16_f32 v170, v172, v173
    v_mfma_f32_16x16x32_bf16 v[60:63], a[156:159], a[220:223], v[60:63]
    global_load_dwordx4 a[88:91], v13, s[42:43] offset:-2048 sc1
    v_cvt_pk_bf16_f32 v171, v174, v175
    v_mfma_f32_16x16x32_bf16 v[56:59], a[152:155], a[220:223], v[56:59]
    ds_write_b128 v3, v[168:171] offset:32000
    v_mfma_f32_16x16x32_bf16 v[28:31], a[148:151], a[220:223], v[28:31]
    v_mfma_f32_16x16x32_bf16 v[24:27], a[144:147], a[220:223], v[24:27]
    s_waitcnt lgkmcnt(10)
    ds_read_b128 a[220:223], v3 offset:29952
    v_mfma_f32_16x16x32_bf16 v[32:35], a[144:147], a[224:227], v[32:35]
    v_mfma_f32_16x16x32_bf16 v[36:39], a[148:151], a[224:227], v[36:39]
    global_load_dwordx4 a[92:95], v13, s[42:43] offset:-1024 sc1
    v_mfma_f32_16x16x32_bf16 v[64:67], a[152:155], a[224:227], v[64:67]
    s_waitcnt lgkmcnt(1)
    s_barrier
    v_mfma_f32_16x16x32_bf16 v[68:71], a[156:159], a[224:227], v[68:71]
    ds_read_b128 a[224:227], v4 offset:20480
    v_mul_f32 v128, v80, v208
    v_mfma_f32_16x16x32_bf16 v[76:79], a[156:159], a[228:231], v[76:79]
    v_mul_f32 v129, v81, v208
    v_mul_f32 v130, v82, v208
    v_mfma_f32_16x16x32_bf16 v[72:75], a[152:155], a[228:231], v[72:75]
    global_load_dwordx4 a[96:99], v13, s[46:47] offset:2048 sc1
    v_mul_f32 v131, v83, v208
    v_mul_f32 v132, v84, v208
    v_mfma_f32_16x16x32_bf16 v[44:47], a[148:151], a[228:231], v[44:47]
    v_exp_f32 v128, v128
    v_mfma_f32_16x16x32_bf16 v[40:43], a[144:147], a[228:231], v[40:43]
    s_waitcnt vmcnt(43)
    ds_read_b128 a[228:231], v4 offset:20736
    v_exp_f32 v129, v129
    v_mfma_f32_16x16x32_bf16 v[16:19], a[160:163], a[232:235], v[16:19]
    v_exp_f32 v130, v130
    v_mfma_f32_16x16x32_bf16 v[20:23], a[164:167], a[232:235], v[20:23]
    global_load_dwordx4 a[100:103], v13, s[46:47] offset:3072 sc1
    v_add_f32 v128, 1.0, v128
    v_mfma_f32_16x16x32_bf16 v[48:51], a[168:171], a[232:235], v[48:51]
    v_exp_f32 v131, v131
    v_add_f32 v129, 1.0, v129
    v_mfma_f32_16x16x32_bf16 v[52:55], a[172:175], a[232:235], v[52:55]
    ds_read_b128 a[232:235], v4 offset:29696
    v_add_f32 v130, 1.0, v130
    v_mfma_f32_16x16x32_bf16 v[60:63], a[172:175], a[236:239], v[60:63]
    v_add_f32 v131, 1.0, v131
    v_mul_f32 v133, v85, v208
    v_mfma_f32_16x16x32_bf16 v[56:59], a[168:171], a[236:239], v[56:59]
    v_rcp_f32 v128, v128
    v_mul_f32 v134, v86, v208
    v_mfma_f32_16x16x32_bf16 v[28:31], a[164:167], a[236:239], v[28:31]
    global_load_dwordx4 a[104:107], v2, s[44:45] offset:-2048 sc1
    v_mul_f32 v80, v80, v128
    v_mfma_f32_16x16x32_bf16 v[24:27], a[160:163], a[236:239], v[24:27]
    ds_read_b128 a[236:239], v4 offset:29952
    v_rcp_f32 v129, v129
    v_mfma_f32_16x16x32_bf16 v[32:35], a[160:163], a[240:243], v[32:35]
    v_rcp_f32 v130, v130
    v_mfma_f32_16x16x32_bf16 v[36:39], a[164:167], a[240:243], v[36:39]
    v_rcp_f32 v131, v131
    v_mfma_f32_16x16x32_bf16 v[64:67], a[168:171], a[240:243], v[64:67]
    global_load_dwordx4 a[108:111], v2, s[44:45] offset:-1024 sc1
    v_mul_f32 v81, v81, v129
    v_mul_f32 v82, v82, v130
    v_mfma_f32_16x16x32_bf16 v[68:71], a[172:175], a[240:243], v[68:71]
    ds_read_b128 a[240:243], v5 offset:20480
    v_mul_f32 v83, v83, v131
    v_mfma_f32_16x16x32_bf16 v[76:79], a[172:175], a[244:247], v[76:79]
    v_mul_f32 v135, v87, v208
    v_cvt_pk_bf16_f32 v80, v80, v81
    v_mfma_f32_16x16x32_bf16 v[72:75], a[168:171], a[244:247], v[72:75]
    v_exp_f32 v132, v132
    v_cvt_pk_bf16_f32 v81, v82, v83
    v_mfma_f32_16x16x32_bf16 v[44:47], a[164:167], a[244:247], v[44:47]
    global_load_dwordx4 a[112:115], v2, s[48:49] offset:2048 sc1
    v_add_f32 v132, 1.0, v132
    v_mfma_f32_16x16x32_bf16 v[40:43], a[160:163], a[244:247], v[40:43]
    s_waitcnt vmcnt(43)
    ds_read_b128 a[244:247], v5 offset:20736
    v_exp_f32 v133, v133
    v_mfma_f32_16x16x32_bf16 v[16:19], a[176:179], a[248:251], v[16:19]
    v_exp_f32 v134, v134
    v_mfma_f32_16x16x32_bf16 v[20:23], a[180:183], a[248:251], v[20:23]
    v_exp_f32 v135, v135
    v_mfma_f32_16x16x32_bf16 v[48:51], a[184:187], a[248:251], v[48:51]
    v_add_f32 v133, 1.0, v133
    v_add_f32 v134, 1.0, v134
    v_add_f32 v135, 1.0, v135
    v_mfma_f32_16x16x32_bf16 v[52:55], a[188:191], a[248:251], v[52:55]
    global_load_dwordx4 a[116:119], v2, s[48:49] offset:3072 sc1
    ds_read_b128 a[248:251], v5 offset:29696
    v_mfma_f32_16x16x32_bf16 v[60:63], a[188:191], a[252:255], v[60:63]
    v_rcp_f32 v132, v132
    v_mfma_f32_16x16x32_bf16 v[56:59], a[184:187], a[252:255], v[56:59]
    v_rcp_f32 v133, v133
    v_mul_f32 v84, v84, v132
    v_mfma_f32_16x16x32_bf16 v[28:31], a[180:183], a[252:255], v[28:31]
    v_rcp_f32 v134, v134
    v_mfma_f32_16x16x32_bf16 v[24:27], a[176:179], a[252:255], v[24:27]
    global_load_dwordx4 a[120:123], v13, s[48:49] offset:0 sc1
    ds_read_b128 a[252:255], v5 offset:29952
    v_mul_f32 v85, v85, v133
    v_mfma_f32_16x16x32_bf16 v[32:35], a[176:179], a[216:219], v[32:35]
    v_rcp_f32 v135, v135
    v_mfma_f32_16x16x32_bf16 v[36:39], a[180:183], a[216:219], v[36:39]
    v_mul_f32 v86, v86, v134
    v_mul_f32 v87, v87, v135
    v_mfma_f32_16x16x32_bf16 v[64:67], a[184:187], a[216:219], v[64:67]
    v_cvt_pk_bf16_f32 v82, v84, v85
    v_cvt_pk_bf16_f32 v83, v86, v87
    v_mul_f32 v128, v88, v209
    v_mfma_f32_16x16x32_bf16 v[68:71], a[188:191], a[216:219], v[68:71]
    s_waitcnt lgkmcnt(8)
    global_load_dwordx4 a[124:127], v13, s[48:49] offset:1024 sc1
    ds_read_b128 a[216:219], v6 offset:20480
    v_mfma_f32_16x16x32_bf16 v[76:79], a[188:191], a[220:223], v[76:79]
    ds_write_b128 v3, v[80:83] offset:24576
    v_mfma_f32_16x16x32_bf16 v[72:75], a[184:187], a[220:223], v[72:75]
    v_mul_f32 v129, v89, v209
    v_mul_f32 v130, v90, v209
    v_mul_f32 v131, v91, v209
    v_mfma_f32_16x16x32_bf16 v[44:47], a[180:183], a[220:223], v[44:47]
    v_exp_f32 v128, v128
    v_mfma_f32_16x16x32_bf16 v[40:43], a[176:179], a[220:223], v[40:43]
    s_waitcnt vmcnt(42) lgkmcnt(9)
    ds_read_b128 a[220:223], v6 offset:20736
    v_exp_f32 v129, v129
    v_mfma_f32_16x16x32_bf16 v[16:19], a[192:195], a[224:227], v[16:19]
    global_load_dwordx4 a[128:131], v13, s[48:49] offset:2048 sc1
    v_add_f32 v128, 1.0, v128
    v_mfma_f32_16x16x32_bf16 v[20:23], a[196:199], a[224:227], v[20:23]
    v_exp_f32 v130, v130
    v_mfma_f32_16x16x32_bf16 v[48:51], a[200:203], a[224:227], v[48:51]
    v_exp_f32 v131, v131
    v_add_f32 v129, 1.0, v129
    v_mfma_f32_16x16x32_bf16 v[52:55], a[204:207], a[224:227], v[52:55]
    s_waitcnt lgkmcnt(9)
    ds_read_b128 a[224:227], v6 offset:29696
    v_add_f32 v130, 1.0, v130
    v_mfma_f32_16x16x32_bf16 v[60:63], a[204:207], a[228:231], v[60:63]
    global_load_dwordx4 a[132:135], v13, s[48:49] offset:3072 sc1
    v_add_f32 v131, 1.0, v131
    v_mfma_f32_16x16x32_bf16 v[56:59], a[200:203], a[228:231], v[56:59]
    v_rcp_f32 v128, v128
    v_mul_f32 v132, v92, v209
    v_mfma_f32_16x16x32_bf16 v[28:31], a[196:199], a[228:231], v[28:31]
    v_rcp_f32 v129, v129
    v_mfma_f32_16x16x32_bf16 v[24:27], a[192:195], a[228:231], v[24:27]
    s_waitcnt lgkmcnt(9)
    ds_read_b128 a[228:231], v6 offset:29952
    v_rcp_f32 v130, v130
    v_mfma_f32_16x16x32_bf16 v[32:35], a[192:195], a[232:235], v[32:35]
    v_rcp_f32 v131, v131
    v_mfma_f32_16x16x32_bf16 v[36:39], a[196:199], a[232:235], v[36:39]
    global_load_dwordx4 a[136:139], v2, s[52:53] offset:-4096 sc1
    v_mul_f32 v88, v88, v128
    v_mfma_f32_16x16x32_bf16 v[64:67], a[200:203], a[232:235], v[64:67]
    v_mul_f32 v89, v89, v129
    v_mul_f32 v90, v90, v130
    v_mul_f32 v91, v91, v131
    v_mfma_f32_16x16x32_bf16 v[68:71], a[204:207], a[232:235], v[68:71]
    s_waitcnt lgkmcnt(9)
    ds_read_b128 a[232:235], v3 offset:22528
    v_mul_f32 v133, v93, v209
    v_mfma_f32_16x16x32_bf16 v[76:79], a[204:207], a[236:239], v[76:79]
    v_mul_f32 v134, v94, v209
    v_mul_f32 v135, v95, v209
    v_mfma_f32_16x16x32_bf16 v[72:75], a[200:203], a[236:239], v[72:75]
    global_load_dwordx4 a[140:143], v2, s[52:53] offset:-3072 sc1
    v_exp_f32 v132, v132
    v_mfma_f32_16x16x32_bf16 v[44:47], a[196:199], a[236:239], v[44:47]
    v_exp_f32 v133, v133
    v_mfma_f32_16x16x32_bf16 v[40:43], a[192:195], a[236:239], v[40:43]
    s_waitcnt vmcnt(42) lgkmcnt(9)
    ds_read_b128 a[236:239], v3 offset:22784
    v_exp_f32 v134, v134
    v_mfma_f32_16x16x32_bf16 v[16:19], a[208:211], a[240:243], v[16:19]
    v_exp_f32 v135, v135
    v_mfma_f32_16x16x32_bf16 v[20:23], a[212:215], a[240:243], v[20:23]
    global_load_dwordx4 a[144:147], v2, s[52:53] offset:-2048 sc1
    v_add_f32 v132, 1.0, v132
    v_mfma_f32_16x16x32_bf16 v[48:51], v[176:179], a[240:243], v[48:51]
    v_add_f32 v133, 1.0, v133
    v_add_f32 v134, 1.0, v134
    v_add_f32 v135, 1.0, v135
    v_mfma_f32_16x16x32_bf16 v[52:55], v[180:183], a[240:243], v[52:55]
    s_waitcnt lgkmcnt(9)
    ds_read_b128 a[240:243], v3 offset:31744
    v_cvt_pk_bf16_f32 v88, v88, v89
    v_mfma_f32_16x16x32_bf16 v[60:63], v[180:183], a[244:247], v[60:63]
wc_pad3:
    s_cbranch_execz wc_pad7
    v_rcp_f32 v132, v132
    v_mfma_f32_16x16x32_bf16 v[56:59], v[176:179], a[244:247], v[56:59]
    v_rcp_f32 v133, v133
    v_mul_f32 v92, v92, v132
    v_mfma_f32_16x16x32_bf16 v[28:31], a[212:215], a[244:247], v[28:31]
    global_load_dwordx4 a[148:151], v2, s[52:53] offset:-1024 sc1
    v_mul_f32 v93, v93, v133
    v_mfma_f32_16x16x32_bf16 v[24:27], a[208:211], a[244:247], v[24:27]
    s_waitcnt lgkmcnt(9)
    ds_read_b128 a[244:247], v3 offset:32000
    v_rcp_f32 v134, v134
    v_mfma_f32_16x16x32_bf16 v[32:35], a[208:211], a[248:251], v[32:35]
    v_rcp_f32 v135, v135
    v_mfma_f32_16x16x32_bf16 v[36:39], a[212:215], a[248:251], v[36:39]
    v_mul_f32 v94, v94, v134
    v_mul_f32 v95, v95, v135
    v_mfma_f32_16x16x32_bf16 v[64:67], v[176:179], a[248:251], v[64:67]
    global_load_dwordx4 a[152:155], v2, s[52:53] offset:0 sc1
    v_cvt_pk_bf16_f32 v89, v90, v91
    v_cvt_pk_bf16_f32 v90, v92, v93
    v_mfma_f32_16x16x32_bf16 v[68:71], v[180:183], a[248:251], v[68:71]
    s_waitcnt lgkmcnt(9)
    ds_read_b128 a[248:251], v4 offset:22528
    v_cvt_pk_bf16_f32 v91, v94, v95
    v_mfma_f32_16x16x32_bf16 v[76:79], v[180:183], a[252:255], v[76:79]
    ds_write_b128 v3, v[88:91] offset:24832
    v_mfma_f32_16x16x32_bf16 v[72:75], v[176:179], a[252:255], v[72:75]
    v_mul_f32 v128, v96, v210
    v_mul_f32 v129, v97, v210
    v_mul_f32 v130, v98, v210
    v_mfma_f32_16x16x32_bf16 v[44:47], a[212:215], a[252:255], v[44:47]
    global_load_dwordx4 a[156:159], v2, s[52:53] offset:1024 sc1
    v_mul_f32 v131, v99, v210
    v_mfma_f32_16x16x32_bf16 v[40:43], a[208:211], a[252:255], v[40:43]
    s_waitcnt vmcnt(42) lgkmcnt(10)
    ds_read_b128 a[252:255], v4 offset:22784
    v_exp_f32 v128, v128
    v_mfma_f32_16x16x32_bf16 v[16:19], v[184:187], a[216:219], v[16:19]
    v_exp_f32 v129, v129
    v_mfma_f32_16x16x32_bf16 v[20:23], v[188:191], a[216:219], v[20:23]
    v_exp_f32 v130, v130
    v_mfma_f32_16x16x32_bf16 v[48:51], v[192:195], a[216:219], v[48:51]
    v_exp_f32 v131, v131
    v_add_f32 v128, 1.0, v128
    v_mfma_f32_16x16x32_bf16 v[52:55], v[196:199], a[216:219], v[52:55]
    s_waitcnt lgkmcnt(9)
    global_load_dwordx4 a[160:163], v2, s[52:53] offset:2048 sc1
    ds_read_b128 a[216:219], v4 offset:31744
    v_mfma_f32_16x16x32_bf16 v[60:63], v[196:199], a[220:223], v[60:63]
    v_add_f32 v129, 1.0, v129
    v_add_f32 v130, 1.0, v130
    v_mfma_f32_16x16x32_bf16 v[56:59], v[192:195], a[220:223], v[56:59]
    v_add_f32 v131, 1.0, v131
    v_rcp_f32 v128, v128
    v_mfma_f32_16x16x32_bf16 v[28:31], v[188:191], a[220:223], v[28:31]
    v_rcp_f32 v129, v129
    v_mfma_f32_16x16x32_bf16 v[24:27], v[184:187], a[220:223], v[24:27]
    s_waitcnt lgkmcnt(9)
    global_load_dwordx4 a[164:167], v2, s[52:53] offset:3072 sc1
    ds_read_b128 a[220:223], v4 offset:32000
    v_mul_f32 v96, v96, v128
    v_mfma_f32_16x16x32_bf16 v[32:35], v[184:187], a[224:227], v[32:35]
    v_rcp_f32 v130, v130
    v_mfma_f32_16x16x32_bf16 v[36:39], v[188:191], a[224:227], v[36:39]
    v_rcp_f32 v131, v131
    v_mfma_f32_16x16x32_bf16 v[64:67], v[192:195], a[224:227], v[64:67]
    v_mul_f32 v97, v97, v129
    v_mul_f32 v98, v98, v130
    v_mul_f32 v99, v99, v131
    v_mfma_f32_16x16x32_bf16 v[68:71], v[196:199], a[224:227], v[68:71]
    s_waitcnt lgkmcnt(9)
    global_load_dwordx4 a[168:171], v13, s[52:53] offset:-4096 sc1
    ds_read_b128 a[224:227], v5 offset:22528
    v_mfma_f32_16x16x32_bf16 v[76:79], v[196:199], a[228:231], v[76:79]
    v_mul_f32 v132, v100, v210
    v_mul_f32 v133, v101, v210
    v_mfma_f32_16x16x32_bf16 v[72:75], v[192:195], a[228:231], v[72:75]
    v_mul_f32 v134, v102, v210
    v_mul_f32 v135, v103, v210
    v_cvt_pk_bf16_f32 v96, v96, v97
    v_mfma_f32_16x16x32_bf16 v[44:47], v[188:191], a[228:231], v[44:47]
    v_exp_f32 v132, v132
    v_mfma_f32_16x16x32_bf16 v[40:43], v[184:187], a[228:231], v[40:43]
    s_waitcnt vmcnt(41) lgkmcnt(9)
    ds_read_b128 a[228:231], v5 offset:22784
    v_exp_f32 v133, v133
    v_mfma_f32_16x16x32_bf16 v[16:19], v[200:203], a[232:235], v[16:19]
    global_load_dwordx4 a[172:175], v13, s[52:53] offset:-3072 sc1
    v_add_f32 v132, 1.0, v132
    v_mfma_f32_16x16x32_bf16 v[20:23], v[204:207], a[232:235], v[20:23]
    v_exp_f32 v134, v134
    v_mfma_f32_16x16x32_bf16 v[48:51], a[0:3], a[232:235], v[48:51]
    v_exp_f32 v135, v135
    v_add_f32 v133, 1.0, v133
    v_mfma_f32_16x16x32_bf16 v[52:55], a[4:7], a[232:235], v[52:55]
    s_waitcnt lgkmcnt(9)
    ds_read_b128 a[232:235], v5 offset:31744
    v_add_f32 v134, 1.0, v134
    v_mfma_f32_16x16x32_bf16 v[60:63], a[4:7], a[236:239], v[60:63]
    global_load_dwordx4 a[176:179], v13, s[52:53] offset:-2048 sc1
    v_add_f32 v135, 1.0, v135
    v_mfma_f32_16x16x32_bf16 v[56:59], a[0:3], a[236:239], v[56:59]
    v_rcp_f32 v132, v132
    v_cvt_pk_bf16_f32 v97, v98, v99
    v_mfma_f32_16x16x32_bf16 v[28:31], v[204:207], a[236:239], v[28:31]
    v_rcp_f32 v133, v133
    v_mfma_f32_16x16x32_bf16 v[24:27], v[200:203], a[236:239], v[24:27]
    s_waitcnt lgkmcnt(9)
    ds_read_b128 a[236:239], v5 offset:32000
    v_rcp_f32 v134, v134
    v_mfma_f32_16x16x32_bf16 v[32:35], v[200:203], a[240:243], v[32:35]
    global_load_dwordx4 a[180:183], v13, s[52:53] offset:-1024 sc1
    v_mul_f32 v100, v100, v132
    v_mfma_f32_16x16x32_bf16 v[36:39], v[204:207], a[240:243], v[36:39]
    v_rcp_f32 v135, v135
    v_mfma_f32_16x16x32_bf16 v[64:67], a[0:3], a[240:243], v[64:67]
    v_mul_f32 v101, v101, v133
    v_mul_f32 v102, v102, v134
    v_mul_f32 v103, v103, v135
    v_mfma_f32_16x16x32_bf16 v[68:71], a[4:7], a[240:243], v[68:71]
    s_waitcnt lgkmcnt(9)
    ds_read_b128 a[240:243], v6 offset:22528
    v_cvt_pk_bf16_f32 v98, v100, v101
    v_mfma_f32_16x16x32_bf16 v[76:79], a[4:7], a[244:247], v[76:79]
    v_cvt_pk_bf16_f32 v99, v102, v103
    v_mul_f32 v128, v104, v211
    v_mfma_f32_16x16x32_bf16 v[72:75], a[0:3], a[244:247], v[72:75]
    global_load_dwordx4 a[184:187], v13, s[52:53] offset:0 sc1
    ds_write_b128 v3, v[96:99] offset:33792
    v_mfma_f32_16x16x32_bf16 v[44:47], v[204:207], a[244:247], v[44:47]
    v_mul_f32 v129, v105, v211
    v_mul_f32 v130, v106, v211
    v_mfma_f32_16x16x32_bf16 v[40:43], v[200:203], a[244:247], v[40:43]
    s_waitcnt vmcnt(41) lgkmcnt(10)
    ds_read_b128 a[244:247], v6 offset:22784
    v_mul_f32 v131, v107, v211
    v_mul_f32 v132, v108, v211
    v_mfma_f32_16x16x32_bf16 v[16:19], a[8:11], a[248:251], v[16:19]
    v_exp_f32 v128, v128
    v_mfma_f32_16x16x32_bf16 v[20:23], a[12:15], a[248:251], v[20:23]
    global_load_dwordx4 a[188:191], v13, s[52:53] offset:1024 sc1
    v_add_f32 v128, 1.0, v128
    v_mfma_f32_16x16x32_bf16 v[48:51], a[16:19], a[248:251], v[48:51]
    v_exp_f32 v129, v129
    v_mul_f32 v133, v109, v211
    v_mfma_f32_16x16x32_bf16 v[52:55], a[20:23], a[248:251], v[52:55]
    s_waitcnt lgkmcnt(9)
    ds_read_b128 a[248:251], v6 offset:31744
    v_add_f32 v129, 1.0, v129
    v_mfma_f32_16x16x32_bf16 v[60:63], a[20:23], a[252:255], v[60:63]
    v_exp_f32 v130, v130
    v_mfma_f32_16x16x32_bf16 v[56:59], a[16:19], a[252:255], v[56:59]
    global_load_dwordx4 a[192:195], v13, s[52:53] offset:2048 sc1
    v_exp_f32 v131, v131
    v_mfma_f32_16x16x32_bf16 v[28:31], a[12:15], a[252:255], v[28:31]
    v_add_f32 v130, 1.0, v130
    v_add_f32 v131, 1.0, v131
    v_mfma_f32_16x16x32_bf16 v[24:27], a[8:11], a[252:255], v[24:27]
    s_waitcnt lgkmcnt(9)
    ds_read_b128 a[252:255], v6 offset:32000
    v_rcp_f32 v128, v128
    v_mfma_f32_16x16x32_bf16 v[32:35], a[8:11], a[216:219], v[32:35]
    v_rcp_f32 v129, v129
    v_mfma_f32_16x16x32_bf16 v[36:39], a[12:15], a[216:219], v[36:39]
    v_rcp_f32 v130, v130
    v_mfma_f32_16x16x32_bf16 v[64:67], a[16:19], a[216:219], v[64:67]
    global_load_dwordx4 a[196:199], v13, s[52:53] offset:3072 sc1
    v_rcp_f32 v131, v131
    v_mfma_f32_16x16x32_bf16 v[68:71], a[20:23], a[216:219], v[68:71]
    s_waitcnt lgkmcnt(9)
    v_mul_f32 v104, v104, v128
    v_mul_f32 v105, v105, v129
    v_mfma_f32_16x16x32_bf16 v[76:79], a[20:23], a[220:223], v[76:79]
    v_mul_f32 v106, v106, v130
    v_mul_f32 v107, v107, v131
    v_mfma_f32_16x16x32_bf16 v[72:75], a[16:19], a[220:223], v[72:75]
    v_mul_f32 v134, v110, v211
    v_mul_f32 v135, v111, v211
    v_cvt_pk_bf16_f32 v104, v104, v105
    v_mfma_f32_16x16x32_bf16 v[44:47], a[12:15], a[220:223], v[44:47]
    global_load_dwordx4 a[200:203], v2, s[54:55] offset:-4096 sc1
    v_cvt_pk_bf16_f32 v105, v106, v107
    v_mfma_f32_16x16x32_bf16 v[40:43], a[8:11], a[220:223], v[40:43]
    s_waitcnt vmcnt(41) lgkmcnt(8)
    v_exp_f32 v132, v132
    v_mfma_f32_16x16x32_bf16 v[16:19], a[24:27], a[224:227], v[16:19]
    v_exp_f32 v133, v133
    v_mfma_f32_16x16x32_bf16 v[20:23], a[28:31], a[224:227], v[20:23]
    v_exp_f32 v134, v134
    v_mfma_f32_16x16x32_bf16 v[48:51], a[32:35], a[224:227], v[48:51]
    v_exp_f32 v135, v135
    v_add_f32 v132, 1.0, v132
    v_mfma_f32_16x16x32_bf16 v[52:55], a[36:39], a[224:227], v[52:55]
    s_waitcnt lgkmcnt(7)
    global_load_dwordx4 a[204:207], v2, s[54:55] offset:-3072 sc1
    v_add_f32 v133, 1.0, v133
    v_mfma_f32_16x16x32_bf16 v[60:63], a[36:39], a[228:231], v[60:63]
    v_add_f32 v134, 1.0, v134
    v_add_f32 v135, 1.0, v135
    v_mfma_f32_16x16x32_bf16 v[56:59], a[32:35], a[228:231], v[56:59]
    v_rcp_f32 v132, v132
    v_mfma_f32_16x16x32_bf16 v[28:31], a[28:31], a[228:231], v[28:31]
    v_rcp_f32 v133, v133
    v_mfma_f32_16x16x32_bf16 v[24:27], a[24:27], a[228:231], v[24:27]
    s_waitcnt lgkmcnt(6)
    global_load_dwordx4 a[208:211], v2, s[54:55] offset:-2048 sc1
    v_rcp_f32 v134, v134
    v_mfma_f32_16x16x32_bf16 v[32:35], a[24:27], a[232:235], v[32:35]
    v_rcp_f32 v135, v135
    v_mfma_f32_16x16x32_bf16 v[36:39], a[28:31], a[232:235], v[36:39]
    v_mul_f32 v108, v108, v132
    v_mul_f32 v109, v109, v133
    v_mfma_f32_16x16x32_bf16 v[64:67], a[32:35], a[232:235], v[64:67]
    v_mul_f32 v110, v110, v134
    v_mul_f32 v111, v111, v135
    v_cvt_pk_bf16_f32 v106, v108, v109
    v_mfma_f32_16x16x32_bf16 v[68:71], a[36:39], a[232:235], v[68:71]
    s_waitcnt lgkmcnt(5)
    global_load_dwordx4 a[212:215], v2, s[54:55] offset:-1024 sc1
    v_cvt_pk_bf16_f32 v107, v110, v111
    v_mfma_f32_16x16x32_bf16 v[76:79], a[36:39], a[236:239], v[76:79]
    ds_write_b128 v3, v[104:107] offset:34048
    v_mfma_f32_16x16x32_bf16 v[72:75], a[32:35], a[236:239], v[72:75]
    v_mfma_f32_16x16x32_bf16 v[44:47], a[28:31], a[236:239], v[44:47]
    v_mfma_f32_16x16x32_bf16 v[40:43], a[24:27], a[236:239], v[40:43]
    s_waitcnt vmcnt(40) lgkmcnt(5)
    v_mfma_f32_16x16x32_bf16 v[16:19], a[40:43], a[240:243], v[16:19]
    global_load_dwordx4 v[176:179], v2, s[54:55] offset:0 sc1
    v_mfma_f32_16x16x32_bf16 v[20:23], a[44:47], a[240:243], v[20:23]
    s_waitcnt lgkmcnt(0)
    s_barrier
    v_mfma_f32_16x16x32_bf16 v[48:51], a[48:51], a[240:243], v[48:51]
    ds_read_b128 a[216:219], v3 offset:24576
    v_bfe_u32 v132, v12, 4, 5
    v_mul_u32_u24 v128, 1152, v132
    v_mfma_f32_16x16x32_bf16 v[52:55], a[52:55], a[240:243], v[52:55]
    ds_read_b128 a[220:223], v4 offset:24576
    v_lshrrev_b32 v132, 9, v12
    v_mfma_f32_16x16x32_bf16 v[60:63], a[52:55], a[244:247], v[60:63]
    global_load_dwordx4 v[180:183], v2, s[54:55] offset:1024 sc1
    ds_read_b128 a[224:227], v5 offset:24576
    v_mfma_f32_16x16x32_bf16 v[56:59], a[48:51], a[244:247], v[56:59]
    ds_read_b128 a[228:231], v6 offset:24576
    v_lshl_add_u32 v128, v132, 4, v128
    v_and_b32 v134, 0x70, v2
    v_mfma_f32_16x16x32_bf16 v[28:31], a[44:47], a[244:247], v[28:31]
    ds_read_b128 a[232:235], v3 offset:24832
    v_bfe_u32 v135, v2, 7, 1
    v_mfma_f32_16x16x32_bf16 v[24:27], a[40:43], a[244:247], v[24:27]
    ds_read_b128 a[236:239], v4 offset:24832
    v_lshrrev_b32 v132, 8, v2
    v_lshl_add_u32 v130, v135, 9, v134
    v_mfma_f32_16x16x32_bf16 v[32:35], a[40:43], a[248:251], v[32:35]
    global_load_dwordx4 v[184:187], v2, s[54:55] offset:2048 sc1
    ds_read_b128 a[240:243], v5 offset:24832
    v_mfma_f32_16x16x32_bf16 v[36:39], a[44:47], a[248:251], v[36:39]
    ds_read_b128 a[244:247], v6 offset:24832
    v_mul_u32_u24 v129, 2359296, v132
    v_mfma_f32_16x16x32_bf16 v[64:67], a[48:51], a[248:251], v[64:67]
    v_add_u32 v129, v129, v130
    v_mul_u32_u24 v131, 72, v134
    v_lshl_add_u32 v131, v135, 4, v131
    v_mfma_f32_16x16x32_bf16 v[68:71], a[52:55], a[248:251], v[68:71]
    ds_read_b128 a[248:251], v3 offset:33792
    v_lshl_add_u32 v131, v132, 2, v131
    v_mfma_f32_16x16x32_bf16 v[76:79], a[52:55], a[252:255], v[76:79]
    v_lshrrev_b32 v134, 2, v134
    v_add_u32 v134, s84, v134
    v_mfma_f32_16x16x32_bf16 v[72:75], a[48:51], a[252:255], v[72:75]
    global_load_dwordx4 v[188:191], v2, s[54:55] offset:3072 sc1
    ds_bpermute_b32 v14, v134, v14
    v_lshlrev_b32 v9, 16, v250
    v_mfma_f32_16x16x32_bf16 v[44:47], a[44:47], a[252:255], v[44:47]
    v_and_b32 v250, s7, v250
    v_add_f32 v132, v251, v9
    v_mfma_f32_16x16x32_bf16 v[40:43], a[40:43], a[252:255], v[40:43]
    s_waitcnt vmcnt(40) lgkmcnt(9)
    ds_read_b128 a[252:255], v4 offset:33792
    v_add_f32 v133, v251, v250
    v_mfma_f32_16x16x32_bf16 v[16:19], a[56:59], a[216:219], v[16:19]
    v_mfma_f32_16x16x32_bf16 v[20:23], a[60:63], a[216:219], v[20:23]
    global_load_dwordx4 v[192:195], v13, s[54:55] offset:-4096 sc1
    v_mfma_f32_16x16x32_bf16 v[48:51], a[64:67], a[216:219], v[48:51]
    v_mfma_f32_16x16x32_bf16 v[52:55], a[68:71], a[216:219], v[52:55]
    s_waitcnt vmcnt(37) lgkmcnt(9)
    ds_read_b128 a[216:219], v5 offset:33792
    v_mfma_f32_16x16x32_bf16 v[16:19], a[72:75], a[220:223], v[16:19]
    v_mfma_f32_16x16x32_bf16 v[20:23], a[76:79], a[220:223], v[20:23]
    global_load_dwordx4 v[196:199], v13, s[54:55] offset:-3072 sc1
    v_mfma_f32_16x16x32_bf16 v[48:51], a[80:83], a[220:223], v[48:51]
    v_mfma_f32_16x16x32_bf16 v[52:55], a[84:87], a[220:223], v[52:55]
    s_waitcnt vmcnt(34) lgkmcnt(9)
    ds_read_b128 a[220:223], v6 offset:33792
    s_waitcnt lgkmcnt(3)
    s_add_u32 s62, s36, s64
    v_mfma_f32_16x16x32_bf16 v[16:19], a[88:91], a[224:227], v[16:19]
    s_addc_u32 s63, s37, 0
    v_mfma_f32_16x16x32_bf16 v[20:23], a[92:95], a[224:227], v[20:23]
    v_mfma_f32_16x16x32_bf16 v[48:51], a[96:99], a[224:227], v[48:51]
    global_load_dwordx4 v[200:203], v13, s[54:55] offset:-2048 sc1
    v_mfma_f32_16x16x32_bf16 v[52:55], a[100:103], a[224:227], v[52:55]
    s_waitcnt vmcnt(31)
    ds_read_b128 a[224:227], v3 offset:34048
    v_mfma_f32_16x16x32_bf16 v[16:19], a[104:107], a[228:231], v[16:19]
    v_mfma_f32_16x16x32_bf16 v[20:23], a[108:111], a[228:231], v[20:23]
    v_mfma_f32_16x16x32_bf16 v[48:51], a[112:115], a[228:231], v[48:51]
    global_load_dwordx4 v[204:207], v13, s[54:55] offset:-1024 sc1
    v_mfma_f32_16x16x32_bf16 v[52:55], a[116:119], a[228:231], v[52:55]
    ds_read_b128 a[228:231], v4 offset:34048
    v_mfma_f32_16x16x32_bf16 v[24:27], a[56:59], a[232:235], v[24:27]
    v_mfma_f32_16x16x32_bf16 v[28:31], a[60:63], a[232:235], v[28:31]
    v_mfma_f32_16x16x32_bf16 v[56:59], a[64:67], a[232:235], v[56:59]
    global_load_dwordx4 a[0:3], v13, s[54:55] offset:0 sc1
    v_cvt_pk_bf16_f32 v16, v16, v17
    v_mfma_f32_16x16x32_bf16 v[60:63], a[68:71], a[232:235], v[60:63]
    ds_read_b128 a[232:235], v5 offset:34048
    v_cvt_pk_bf16_f32 v17, v18, v19
    v_mfma_f32_16x16x32_bf16 v[24:27], a[72:75], a[236:239], v[24:27]
    v_cvt_pk_bf16_f32 v18, v20, v21
    v_cvt_pk_bf16_f32 v19, v22, v23
    v_mfma_f32_16x16x32_bf16 v[28:31], a[76:79], a[236:239], v[28:31]
    v_min_u32 v16, -2, v16
    v_min_u32 v17, -2, v17
    v_mfma_f32_16x16x32_bf16 v[56:59], a[80:83], a[236:239], v[56:59]
    v_min_u32 v18, -2, v18
    v_min_u32 v19, -2, v19
    v_mfma_f32_16x16x32_bf16 v[60:63], a[84:87], a[236:239], v[60:63]
    global_load_dwordx4 a[4:7], v13, s[54:55] offset:1024 sc1
    ds_read_b128 a[236:239], v6 offset:34048
    v_mfma_f32_16x16x32_bf16 v[24:27], a[88:91], a[240:243], v[24:27]
    global_store_dwordx4 v10, v[16:19], s[62:63] offset:0 sc1
    v_mfma_f32_16x16x32_bf16 v[28:31], a[92:95], a[240:243], v[28:31]
    s_add_u32 s62, s36, s65
    s_addc_u32 s63, s37, 0
    v_mfma_f32_16x16x32_bf16 v[56:59], a[96:99], a[240:243], v[56:59]
    v_mfma_f32_16x16x32_bf16 v[60:63], a[100:103], a[240:243], v[60:63]
    global_load_dwordx4 a[8:11], v13, s[54:55] offset:2048 sc1
    ds_read_b128 a[240:243], v3 offset:18432
    v_mfma_f32_16x16x32_bf16 v[24:27], a[104:107], a[244:247], v[24:27]
    v_mfma_f32_16x16x32_bf16 v[28:31], a[108:111], a[244:247], v[28:31]
    v_mfma_f32_16x16x32_bf16 v[56:59], a[112:115], a[244:247], v[56:59]
    v_mfma_f32_16x16x32_bf16 v[60:63], a[116:119], a[244:247], v[60:63]
    global_load_dwordx4 a[12:15], v13, s[54:55] offset:3072 sc1
    ds_read_b128 a[244:247], v3 offset:18688
    v_mfma_f32_16x16x32_bf16 v[32:35], a[56:59], a[248:251], v[32:35]
    v_cvt_pk_bf16_f32 v48, v48, v49
    v_cvt_pk_bf16_f32 v49, v50, v51
    v_mfma_f32_16x16x32_bf16 v[36:39], a[60:63], a[248:251], v[36:39]
    v_cvt_pk_bf16_f32 v50, v52, v53
    v_cvt_pk_bf16_f32 v51, v54, v55
    v_mfma_f32_16x16x32_bf16 v[64:67], a[64:67], a[248:251], v[64:67]
    v_min_u32 v48, -2, v48
    v_min_u32 v49, -2, v49
    v_mfma_f32_16x16x32_bf16 v[68:71], a[68:71], a[248:251], v[68:71]
    s_waitcnt lgkmcnt(8)
    ds_read_b128 a[248:251], v3 offset:27648
    v_min_u32 v50, -2, v50
    v_mfma_f32_16x16x32_bf16 v[32:35], a[72:75], a[252:255], v[32:35]
    global_load_dwordx4 a[16:19], v2, s[56:57] offset:-4096 sc1
    v_min_u32 v51, -2, v51
    v_mfma_f32_16x16x32_bf16 v[36:39], a[76:79], a[252:255], v[36:39]
    global_store_dwordx4 v10, v[48:51], s[62:63] offset:0 sc1
    v_mfma_f32_16x16x32_bf16 v[64:67], a[80:83], a[252:255], v[64:67]
    s_add_u32 s62, s36, s64
    s_addc_u32 s63, s37, 0
    v_mfma_f32_16x16x32_bf16 v[68:71], a[84:87], a[252:255], v[68:71]
    s_waitcnt lgkmcnt(8)
    ds_read_b128 a[252:255], v3 offset:27904
    v_mfma_f32_16x16x32_bf16 v[32:35], a[88:91], a[216:219], v[32:35]
    global_load_dwordx4 a[20:23], v2, s[56:57] offset:-3072 sc1
    v_mfma_f32_16x16x32_bf16 v[36:39], a[92:95], a[216:219], v[36:39]
    v_mfma_f32_16x16x32_bf16 v[64:67], a[96:99], a[216:219], v[64:67]
    v_mfma_f32_16x16x32_bf16 v[68:71], a[100:103], a[216:219], v[68:71]
    s_waitcnt lgkmcnt(8)
    ds_read_b128 a[216:219], v3 offset:20480
    v_mfma_f32_16x16x32_bf16 v[32:35], a[104:107], a[220:223], v[32:35]
    v_mfma_f32_16x16x32_bf16 v[36:39], a[108:111], a[220:223], v[36:39]
    global_load_dwordx4 a[24:27], v2, s[56:57] offset:-2048 sc1
    v_mfma_f32_16x16x32_bf16 v[64:67], a[112:115], a[220:223], v[64:67]
    v_mfma_f32_16x16x32_bf16 v[68:71], a[116:119], a[220:223], v[68:71]
    s_waitcnt lgkmcnt(8)
    ds_read_b128 a[220:223], v3 offset:20736
    v_mfma_f32_16x16x32_bf16 v[40:43], a[56:59], a[224:227], v[40:43]
    v_cvt_pk_bf16_f32 v24, v24, v25
    v_cvt_pk_bf16_f32 v25, v26, v27
    v_mfma_f32_16x16x32_bf16 v[44:47], a[60:63], a[224:227], v[44:47]
    global_load_dwordx4 a[28:31], v2, s[56:57] offset:-1024 sc1
    v_cvt_pk_bf16_f32 v26, v28, v29
    v_mfma_f32_16x16x32_bf16 v[72:75], a[64:67], a[224:227], v[72:75]
    v_cvt_pk_bf16_f32 v27, v30, v31
    v_min_u32 v24, -2, v24
    v_mfma_f32_16x16x32_bf16 v[76:79], a[68:71], a[224:227], v[76:79]
    s_waitcnt lgkmcnt(8)
    ds_read_b128 a[224:227], v3 offset:29696
    v_min_u32 v25, -2, v25
    v_mfma_f32_16x16x32_bf16 v[40:43], a[72:75], a[228:231], v[40:43]
    v_min_u32 v26, -2, v26
    v_min_u32 v27, -2, v27
    v_mfma_f32_16x16x32_bf16 v[44:47], a[76:79], a[228:231], v[44:47]
    global_load_dwordx4 a[32:35], v2, s[56:57] offset:0 sc1
    v_mfma_f32_16x16x32_bf16 v[72:75], a[80:83], a[228:231], v[72:75]
    global_store_dwordx4 v10, v[24:27], s[62:63] offset:256 sc1
    v_mfma_f32_16x16x32_bf16 v[76:79], a[84:87], a[228:231], v[76:79]
    s_waitcnt lgkmcnt(8)
    ds_read_b128 a[228:231], v3 offset:29952
    s_add_u32 s62, s36, s65
    v_mfma_f32_16x16x32_bf16 v[40:43], a[88:91], a[232:235], v[40:43]
    s_addc_u32 s63, s37, 0
    v_mfma_f32_16x16x32_bf16 v[44:47], a[92:95], a[232:235], v[44:47]
    v_mfma_f32_16x16x32_bf16 v[72:75], a[96:99], a[232:235], v[72:75]
    global_load_dwordx4 a[36:39], v2, s[56:57] offset:1024 sc1
    v_mfma_f32_16x16x32_bf16 v[76:79], a[100:103], a[232:235], v[76:79]
    s_waitcnt lgkmcnt(8)
    ds_read_b128 a[232:235], v3 offset:22528
    v_mfma_f32_16x16x32_bf16 v[40:43], a[104:107], a[236:239], v[40:43]
    v_mfma_f32_16x16x32_bf16 v[44:47], a[108:111], a[236:239], v[44:47]
    v_mfma_f32_16x16x32_bf16 v[72:75], a[112:115], a[236:239], v[72:75]
    global_load_dwordx4 a[40:43], v2, s[56:57] offset:2048 sc1
    v_mfma_f32_16x16x32_bf16 v[76:79], a[116:119], a[236:239], v[76:79]
    s_waitcnt vmcnt(44) lgkmcnt(8)
    ds_read_b128 a[236:239], v3 offset:22784
    v_mfma_f32_16x16x32_bf16 v[144:147], a[120:123], a[240:243], 0
    v_cvt_pk_bf16_f32 v56, v56, v57
    v_cvt_pk_bf16_f32 v57, v58, v59
    v_mfma_f32_16x16x32_bf16 v[148:151], a[124:127], a[240:243], 0
    s_waitcnt lgkmcnt(8)
    ds_read_b128 a[240:243], v3 offset:31744
    v_cvt_pk_bf16_f32 v58, v60, v61
    v_mfma_f32_16x16x32_bf16 v[156:159], a[124:127], a[244:247], 0
    global_load_dwordx4 a[44:47], v2, s[56:57] offset:3072 sc1
    v_cvt_pk_bf16_f32 v59, v62, v63
    v_mfma_f32_16x16x32_bf16 v[152:155], a[120:123], a[244:247], 0
    s_waitcnt lgkmcnt(8)
    ds_read_b128 a[244:247], v3 offset:32000
    v_min_u32 v56, -2, v56
    v_mfma_f32_16x16x32_bf16 v[160:163], a[120:123], a[248:251], 0
    v_min_u32 v57, -2, v57
    v_min_u32 v58, -2, v58
    v_mfma_f32_16x16x32_bf16 v[164:167], a[124:127], a[248:251], 0
    s_waitcnt lgkmcnt(8)
    ds_read_b128 a[248:251], v3 offset:24576
    v_min_u32 v59, -2, v59
    v_mfma_f32_16x16x32_bf16 v[172:175], a[124:127], a[252:255], 0
    global_store_dwordx4 v10, v[56:59], s[62:63] offset:256 sc1
    v_mfma_f32_16x16x32_bf16 v[168:171], a[120:123], a[252:255], 0
    s_waitcnt vmcnt(44) lgkmcnt(8)
    global_load_dwordx4 a[48:51], v13, s[56:57] offset:-4096 sc1
    ds_read_b128 a[252:255], v3 offset:24832
    v_mfma_f32_16x16x32_bf16 v[144:147], a[128:131], a[216:219], v[144:147]
    s_add_u32 s62, s36, s64
    s_addc_u32 s63, s37, 0
    v_mfma_f32_16x16x32_bf16 v[148:151], a[132:135], a[216:219], v[148:151]
    s_waitcnt lgkmcnt(8)
    ds_read_b128 a[216:219], v3 offset:33792
    v_mfma_f32_16x16x32_bf16 v[156:159], a[132:135], a[220:223], v[156:159]
    v_mfma_f32_16x16x32_bf16 v[152:155], a[128:131], a[220:223], v[152:155]
    s_waitcnt lgkmcnt(8)
    global_load_dwordx4 a[52:55], v13, s[56:57] offset:-3072 sc1
    ds_read_b128 a[220:223], v3 offset:34048
    v_mfma_f32_16x16x32_bf16 v[160:163], a[128:131], a[224:227], v[160:163]
    v_mfma_f32_16x16x32_bf16 v[164:167], a[132:135], a[224:227], v[164:167]
    s_waitcnt lgkmcnt(8)
    ds_read_b128 a[224:227], v4 offset:18432
    v_mfma_f32_16x16x32_bf16 v[172:175], a[132:135], a[228:231], v[172:175]
    v_mfma_f32_16x16x32_bf16 v[168:171], a[128:131], a[228:231], v[168:171]
    s_waitcnt vmcnt(44) lgkmcnt(8)
    global_load_dwordx4 a[56:59], v13, s[56:57] offset:-2048 sc1
    ds_read_b128 a[228:231], v4 offset:18688
    v_mfma_f32_16x16x32_bf16 v[144:147], a[136:139], a[232:235], v[144:147]
    v_cvt_pk_bf16_f32 v32, v32, v33
    v_cvt_pk_bf16_f32 v33, v34, v35
    v_mfma_f32_16x16x32_bf16 v[148:151], a[140:143], a[232:235], v[148:151]
    s_waitcnt lgkmcnt(8)
    ds_read_b128 a[232:235], v4 offset:27648
    v_cvt_pk_bf16_f32 v34, v36, v37
    v_mfma_f32_16x16x32_bf16 v[156:159], a[140:143], a[236:239], v[156:159]
    v_cvt_pk_bf16_f32 v35, v38, v39
    v_min_u32 v32, -2, v32
    v_mfma_f32_16x16x32_bf16 v[152:155], a[136:139], a[236:239], v[152:155]
    s_waitcnt lgkmcnt(8)
    ds_read_b128 a[236:239], v4 offset:27904
    v_min_u32 v33, -2, v33
    v_mfma_f32_16x16x32_bf16 v[160:163], a[136:139], a[240:243], v[160:163]
    global_load_dwordx4 a[60:63], v13, s[56:57] offset:-1024 sc1
    v_min_u32 v34, -2, v34
    v_mfma_f32_16x16x32_bf16 v[164:167], a[140:143], a[240:243], v[164:167]
    s_waitcnt lgkmcnt(8)
    ds_read_b128 a[240:243], v4 offset:20480
    v_min_u32 v35, -2, v35
    v_mfma_f32_16x16x32_bf16 v[172:175], a[140:143], a[244:247], v[172:175]
    global_store_dwordx4 v11, v[32:35], s[62:63] offset:0 sc1
    v_mfma_f32_16x16x32_bf16 v[168:171], a[136:139], a[244:247], v[168:171]
    s_waitcnt vmcnt(45) lgkmcnt(8)
    ds_read_b128 a[244:247], v4 offset:20736
    s_add_u32 s62, s36, s65
    v_mfma_f32_16x16x32_bf16 v[144:147], a[144:147], a[248:251], v[144:147]
    global_load_dwordx4 a[64:67], v13, s[56:57] offset:0 sc1
    s_addc_u32 s63, s37, 0
    v_mfma_f32_16x16x32_bf16 v[148:151], a[148:151], a[248:251], v[148:151]
    s_waitcnt lgkmcnt(8)
    ds_read_b128 a[248:251], v4 offset:29696
    v_mfma_f32_16x16x32_bf16 v[156:159], a[148:151], a[252:255], v[156:159]
    v_mfma_f32_16x16x32_bf16 v[152:155], a[144:147], a[252:255], v[152:155]
    s_waitcnt lgkmcnt(8)
    ds_read_b128 a[252:255], v4 offset:29952
    v_mfma_f32_16x16x32_bf16 v[160:163], a[144:147], a[216:219], v[160:163]
    global_load_dwordx4 a[68:71], v13, s[56:57] offset:1024 sc1
    v_mfma_f32_16x16x32_bf16 v[164:167], a[148:151], a[216:219], v[164:167]
    s_waitcnt lgkmcnt(8)
    ds_read_b128 a[216:219], v4 offset:22528
    v_mfma_f32_16x16x32_bf16 v[172:175], a[148:151], a[220:223], v[172:175]
    v_mfma_f32_16x16x32_bf16 v[168:171], a[144:147], a[220:223], v[168:171]
    s_waitcnt vmcnt(45) lgkmcnt(8)
    ds_read_b128 a[220:223], v4 offset:22784
    v_mfma_f32_16x16x32_bf16 v[144:147], a[152:155], a[224:227], v[144:147]
    v_cvt_pk_bf16_f32 v64, v64, v65
    v_cvt_pk_bf16_f32 v65, v66, v67
    v_mfma_f32_16x16x32_bf16 v[148:151], a[156:159], a[224:227], v[148:151]
    s_waitcnt lgkmcnt(8)
    global_load_dwordx4 a[72:75], v13, s[56:57] offset:2048 sc1
    ds_read_b128 a[224:227], v4 offset:31744
    v_mfma_f32_16x16x32_bf16 v[156:159], a[156:159], a[228:231], v[156:159]
    v_cvt_pk_bf16_f32 v66, v68, v69
    v_cvt_pk_bf16_f32 v67, v70, v71
    v_mfma_f32_16x16x32_bf16 v[152:155], a[152:155], a[228:231], v[152:155]
    s_waitcnt lgkmcnt(8)
    ds_read_b128 a[228:231], v4 offset:32000
    v_min_u32 v64, -2, v64
    v_mfma_f32_16x16x32_bf16 v[160:163], a[152:155], a[232:235], v[160:163]
    v_min_u32 v65, -2, v65
    v_min_u32 v66, -2, v66
    v_mfma_f32_16x16x32_bf16 v[164:167], a[156:159], a[232:235], v[164:167]
    s_waitcnt lgkmcnt(8)
    global_load_dwordx4 a[76:79], v13, s[56:57] offset:3072 sc1
    ds_read_b128 a[232:235], v4 offset:24576
    v_mfma_f32_16x16x32_bf16 v[172:175], a[156:159], a[236:239], v[172:175]
    v_min_u32 v67, -2, v67
    v_mfma_f32_16x16x32_bf16 v[168:171], a[152:155], a[236:239], v[168:171]
    s_waitcnt vmcnt(45) lgkmcnt(8)
    ds_read_b128 a[236:239], v4 offset:24832
    v_mfma_f32_16x16x32_bf16 v[144:147], a[160:163], a[240:243], v[144:147]
    global_store_dwordx4 v11, v[64:67], s[62:63] offset:0 sc1
    v_mfma_f32_16x16x32_bf16 v[148:151], a[164:167], a[240:243], v[148:151]
    s_waitcnt lgkmcnt(8)
    global_load_dwordx4 a[80:83], v2, s[58:59] offset:-4096 sc1
    ds_read_b128 a[240:243], v4 offset:33792
    v_mfma_f32_16x16x32_bf16 v[156:159], a[164:167], a[244:247], v[156:159]
    s_add_u32 s62, s36, s64
    s_addc_u32 s63, s37, 0
    v_mfma_f32_16x16x32_bf16 v[152:155], a[160:163], a[244:247], v[152:155]
    s_waitcnt lgkmcnt(8)
    ds_read_b128 a[244:247], v4 offset:34048
    v_mfma_f32_16x16x32_bf16 v[160:163], a[160:163], a[248:251], v[160:163]
    v_mfma_f32_16x16x32_bf16 v[164:167], a[164:167], a[248:251], v[164:167]
    s_waitcnt lgkmcnt(8)
    ds_read_b128 a[248:251], v5 offset:18432
    v_mfma_f32_16x16x32_bf16 v[172:175], a[164:167], a[252:255], v[172:175]
    global_load_dwordx4 a[84:87], v2, s[58:59] offset:-3072 sc1
    v_mfma_f32_16x16x32_bf16 v[168:171], a[160:163], a[252:255], v[168:171]
    s_waitcnt vmcnt(46) lgkmcnt(8)
    ds_read_b128 a[252:255], v5 offset:18688
    v_mfma_f32_16x16x32_bf16 v[144:147], a[168:171], a[216:219], v[144:147]
    v_cvt_pk_bf16_f32 v40, v40, v41
    v_cvt_pk_bf16_f32 v41, v42, v43
    v_mfma_f32_16x16x32_bf16 v[148:151], a[172:175], a[216:219], v[148:151]
    s_waitcnt lgkmcnt(8)
    ds_read_b128 a[216:219], v5 offset:27648
    v_cvt_pk_bf16_f32 v42, v44, v45
    v_mfma_f32_16x16x32_bf16 v[156:159], a[172:175], a[220:223], v[156:159]
    global_load_dwordx4 a[88:91], v2, s[58:59] offset:-2048 sc1
    v_cvt_pk_bf16_f32 v43, v46, v47
    v_mfma_f32_16x16x32_bf16 v[152:155], a[168:171], a[220:223], v[152:155]
    s_waitcnt lgkmcnt(8)
    ds_read_b128 a[220:223], v5 offset:27904
    v_min_u32 v40, -2, v40
    v_mfma_f32_16x16x32_bf16 v[160:163], a[168:171], a[224:227], v[160:163]
    v_min_u32 v41, -2, v41
    v_min_u32 v42, -2, v42
    v_mfma_f32_16x16x32_bf16 v[164:167], a[172:175], a[224:227], v[164:167]
    s_waitcnt lgkmcnt(8)
    ds_read_b128 a[224:227], v5 offset:20480
    v_min_u32 v43, -2, v43
    v_mfma_f32_16x16x32_bf16 v[172:175], a[172:175], a[228:231], v[172:175]
    global_store_dwordx4 v11, v[40:43], s[62:63] offset:256 sc1
    v_mfma_f32_16x16x32_bf16 v[168:171], a[168:171], a[228:231], v[168:171]
    s_waitcnt vmcnt(46) lgkmcnt(8)
    global_load_dwordx4 a[92:95], v2, s[58:59] offset:-1024 sc1
    ds_read_b128 a[228:231], v5 offset:22528
    v_mfma_f32_16x16x32_bf16 v[144:147], a[176:179], a[232:235], v[144:147]
    s_add_u32 s62, s36, s65
    s_addc_u32 s63, s37, 0
    v_mfma_f32_16x16x32_bf16 v[148:151], a[180:183], a[232:235], v[148:151]
    s_waitcnt lgkmcnt(8)
    ds_read_b128 a[232:235], v5 offset:24576
    v_mfma_f32_16x16x32_bf16 v[156:159], a[180:183], a[236:239], v[156:159]
    v_mfma_f32_16x16x32_bf16 v[152:155], a[176:179], a[236:239], v[152:155]
    s_waitcnt lgkmcnt(8)
    global_load_dwordx4 a[96:99], v2, s[58:59] offset:0 sc1
    ds_read_b128 a[236:239], v6 offset:18432
    v_mfma_f32_16x16x32_bf16 v[160:163], a[176:179], a[240:243], v[160:163]
    v_mfma_f32_16x16x32_bf16 v[164:167], a[180:183], a[240:243], v[164:167]
    s_waitcnt lgkmcnt(8)
    ds_read_b128 a[240:243], v6 offset:20480
    v_mfma_f32_16x16x32_bf16 v[172:175], a[180:183], a[244:247], v[172:175]
    v_mfma_f32_16x16x32_bf16 v[168:171], a[176:179], a[244:247], v[168:171]
    s_waitcnt vmcnt(46) lgkmcnt(8)
    global_load_dwordx4 a[100:103], v2, s[58:59] offset:1024 sc1
    ds_read_b128 a[244:247], v6 offset:22528
    v_mfma_f32_16x16x32_bf16 v[144:147], a[184:187], a[248:251], v[144:147]
    v_cvt_pk_bf16_f32 v72, v72, v73
    v_cvt_pk_bf16_f32 v73, v74, v75
    v_mfma_f32_16x16x32_bf16 v[148:151], a[188:191], a[248:251], v[148:151]
wc_pad4:
    s_cbranch_execz wc_ret
    s_waitcnt lgkmcnt(8)
    ds_read_b128 a[248:251], v6 offset:24576
    v_cvt_pk_bf16_f32 v74, v76, v77
    v_mfma_f32_16x16x32_bf16 v[156:159], a[188:191], a[252:255], v[156:159]
    v_cvt_pk_bf16_f32 v75, v78, v79
    v_min_u32 v72, -2, v72
    v_mfma_f32_16x16x32_bf16 v[152:155], a[184:187], a[252:255], v[152:155]
    s_waitcnt lgkmcnt(8)
    ds_read_b128 a[252:255], v7 offset:26624
    v_min_u32 v73, -2, v73
    v_mfma_f32_16x16x32_bf16 v[160:163], a[184:187], a[216:219], v[160:163]
    global_load_dwordx4 a[104:107], v2, s[58:59] offset:2048 sc1
    v_min_u32 v74, -2, v74
    v_mfma_f32_16x16x32_bf16 v[164:167], a[188:191], a[216:219], v[164:167]
    s_waitcnt lgkmcnt(8)
    ds_read_b128 a[216:219], v8 offset:26624
    v_min_u32 v75, -2, v75
    v_mfma_f32_16x16x32_bf16 v[172:175], a[188:191], a[220:223], v[172:175]
    global_store_dwordx4 v11, v[72:75], s[62:63] offset:256 sc1
    v_mfma_f32_16x16x32_bf16 v[168:171], a[184:187], a[220:223], v[168:171]
    s_waitcnt vmcnt(47) lgkmcnt(8)
    ds_read_b128 a[220:223], v5 offset:20736
    s_add_u32 s62, s36, s77
    v_mfma_f32_16x16x32_bf16 v[144:147], a[192:195], a[224:227], v[144:147]
    global_load_dwordx4 a[108:111], v2, s[58:59] offset:3072 sc1
    s_addc_u32 s63, s37, 0
    v_mfma_f32_16x16x32_bf16 v[148:151], a[196:199], a[224:227], v[148:151]
    s_waitcnt vmcnt(46) lgkmcnt(8)
    ds_read_b128 a[224:227], v5 offset:22784
    v_mfma_f32_16x16x32_bf16 v[144:147], a[200:203], a[228:231], v[144:147]
    v_mfma_f32_16x16x32_bf16 v[148:151], a[204:207], a[228:231], v[148:151]
    s_waitcnt vmcnt(44) lgkmcnt(8)
    ds_read_b128 a[228:231], v5 offset:24832
    v_mfma_f32_16x16x32_bf16 v[144:147], a[208:211], a[232:235], v[144:147]
    global_load_dwordx4 a[112:115], v13, s[58:59] offset:-4096 sc1
    v_mfma_f32_16x16x32_bf16 v[148:151], a[212:215], a[232:235], v[148:151]
    s_waitcnt vmcnt(43) lgkmcnt(8)
    ds_read_b128 a[232:235], v6 offset:18688
    v_mfma_f32_16x16x32_bf16 v[144:147], v[176:179], a[236:239], v[144:147]
    v_mfma_f32_16x16x32_bf16 v[148:151], v[180:183], a[236:239], v[148:151]
    s_waitcnt vmcnt(41) lgkmcnt(8)
    ds_read_b128 a[236:239], v6 offset:20736
    v_mfma_f32_16x16x32_bf16 v[144:147], v[184:187], a[240:243], v[144:147]
    v_mfma_f32_16x16x32_bf16 v[148:151], v[188:191], a[240:243], v[148:151]
    s_waitcnt vmcnt(39) lgkmcnt(8)
    global_load_dwordx4 a[116:119], v13, s[58:59] offset:-3072 sc1
    ds_read_b128 a[240:243], v6 offset:22784
    v_mfma_f32_16x16x32_bf16 v[144:147], v[192:195], a[244:247], v[144:147]
    v_mfma_f32_16x16x32_bf16 v[148:151], v[196:199], a[244:247], v[148:151]
    s_waitcnt vmcnt(38) lgkmcnt(8)
    ds_read_b128 a[244:247], v6 offset:24832
    v_mfma_f32_16x16x32_bf16 v[144:147], v[200:203], a[248:251], v[144:147]
    v_mfma_f32_16x16x32_bf16 v[148:151], v[204:207], a[248:251], v[148:151]
    s_waitcnt vmcnt(36) lgkmcnt(8)
    global_load_dwordx4 a[120:123], v13, s[58:59] offset:-2048 sc1
    ds_read_b128 a[248:251], v7 offset:26880
    v_mfma_f32_16x16x32_bf16 v[144:147], a[0:3], a[252:255], v[144:147]
    v_mfma_f32_16x16x32_bf16 v[148:151], a[4:7], a[252:255], v[148:151]
    s_waitcnt vmcnt(34) lgkmcnt(8)
    ds_read_b128 a[252:255], v8 offset:26880
    v_mfma_f32_16x16x32_bf16 v[144:147], a[8:11], a[216:219], v[144:147]
    v_mfma_f32_16x16x32_bf16 v[148:151], a[12:15], a[216:219], v[148:151]
    s_waitcnt lgkmcnt(8)
    global_load_dwordx4 a[124:127], v13, s[58:59] offset:-1024 sc1
    ds_read_b128 a[216:219], v5 offset:29696
    v_mfma_f32_16x16x32_bf16 v[152:155], a[192:195], a[220:223], v[152:155]
    v_mfma_f32_16x16x32_bf16 v[156:159], a[196:199], a[220:223], v[156:159]
    s_waitcnt lgkmcnt(8)
    ds_read_b128 a[220:223], v5 offset:31744
    v_mfma_f32_16x16x32_bf16 v[152:155], a[200:203], a[224:227], v[152:155]
    v_cvt_pk_bf16_f32 v144, v144, v145
    v_cvt_pk_bf16_f32 v145, v146, v147
    v_mfma_f32_16x16x32_bf16 v[156:159], a[204:207], a[224:227], v[156:159]
    s_waitcnt lgkmcnt(8)
    ds_read_b128 a[224:227], v5 offset:33792
    v_cvt_pk_bf16_f32 v146, v148, v149
    v_mfma_f32_16x16x32_bf16 v[152:155], a[208:211], a[228:231], v[152:155]
    global_load_dwordx4 a[128:131], v13, s[58:59] offset:0 sc1
    v_cvt_pk_bf16_f32 v147, v150, v151
    v_mfma_f32_16x16x32_bf16 v[156:159], a[212:215], a[228:231], v[156:159]
    s_waitcnt lgkmcnt(8)
    ds_read_b128 a[228:231], v6 offset:27648
    v_min_u32 v144, -2, v144
    v_mfma_f32_16x16x32_bf16 v[152:155], v[176:179], a[232:235], v[152:155]
    v_min_u32 v145, -2, v145
    v_min_u32 v146, -2, v146
    v_mfma_f32_16x16x32_bf16 v[156:159], v[180:183], a[232:235], v[156:159]
    s_waitcnt lgkmcnt(8)
    ds_read_b128 a[232:235], v6 offset:29696
    v_min_u32 v147, -2, v147
    v_mfma_f32_16x16x32_bf16 v[152:155], v[184:187], a[236:239], v[152:155]
    global_load_dwordx4 a[132:135], v13, s[58:59] offset:1024 sc1
    v_mfma_f32_16x16x32_bf16 v[156:159], v[188:191], a[236:239], v[156:159]
    s_waitcnt lgkmcnt(8)
    ds_read_b128 a[236:239], v6 offset:31744
    v_mfma_f32_16x16x32_bf16 v[152:155], v[192:195], a[240:243], v[152:155]
    global_store_dwordx4 v10, v[144:147], s[62:63] offset:0 sc1
    v_mfma_f32_16x16x32_bf16 v[156:159], v[196:199], a[240:243], v[156:159]
    s_waitcnt lgkmcnt(8)
    ds_read_b128 a[240:243], v6 offset:33792
    s_add_u32 s62, s36, s77
    v_mfma_f32_16x16x32_bf16 v[152:155], v[200:203], a[244:247], v[152:155]
    global_load_dwordx4 a[136:139], v13, s[58:59] offset:2048 sc1
    s_addc_u32 s63, s37, 0
    v_mfma_f32_16x16x32_bf16 v[156:159], v[204:207], a[244:247], v[156:159]
    s_waitcnt lgkmcnt(8)
    ds_read_b128 a[244:247], v7 offset:35840
    v_mfma_f32_16x16x32_bf16 v[152:155], a[0:3], a[248:251], v[152:155]
    v_mfma_f32_16x16x32_bf16 v[156:159], a[4:7], a[248:251], v[156:159]
    s_waitcnt lgkmcnt(8)
    ds_read_b128 a[248:251], v8 offset:35840
    v_mfma_f32_16x16x32_bf16 v[152:155], a[8:11], a[252:255], v[152:155]
    v_mfma_f32_16x16x32_bf16 v[156:159], a[12:15], a[252:255], v[156:159]
    s_waitcnt lgkmcnt(8)
    global_load_dwordx4 a[140:143], v13, s[58:59] offset:3072 sc1
    ds_read_b128 a[252:255], v5 offset:29952
    v_mfma_f32_16x16x32_bf16 v[160:163], a[192:195], a[216:219], v[160:163]
    v_mfma_f32_16x16x32_bf16 v[164:167], a[196:199], a[216:219], v[164:167]
    s_waitcnt lgkmcnt(8)
    ds_read_b128 a[216:219], v5 offset:32000
    v_mfma_f32_16x16x32_bf16 v[160:163], a[200:203], a[220:223], v[160:163]
    v_cvt_pk_bf16_f32 v152, v152, v153
    v_cvt_pk_bf16_f32 v153, v154, v155
    v_mfma_f32_16x16x32_bf16 v[164:167], a[204:207], a[220:223], v[164:167]
    s_waitcnt lgkmcnt(8)
    global_load_dwordx4 a[144:147], v2, s[60:61] offset:-4096 sc1
    ds_read_b128 a[220:223], v5 offset:34048
    v_mfma_f32_16x16x32_bf16 v[160:163], a[208:211], a[224:227], v[160:163]
    v_cvt_pk_bf16_f32 v154, v156, v157
    v_cvt_pk_bf16_f32 v155, v158, v159
    v_mfma_f32_16x16x32_bf16 v[164:167], a[212:215], a[224:227], v[164:167]
    s_waitcnt lgkmcnt(8)
    ds_read_b128 a[224:227], v6 offset:27904
    v_min_u32 v152, -2, v152
    v_mfma_f32_16x16x32_bf16 v[160:163], v[176:179], a[228:231], v[160:163]
    v_min_u32 v153, -2, v153
    v_min_u32 v154, -2, v154
    v_mfma_f32_16x16x32_bf16 v[164:167], v[180:183], a[228:231], v[164:167]
    s_waitcnt lgkmcnt(8)
    global_load_dwordx4 a[148:151], v2, s[60:61] offset:-3072 sc1
    ds_read_b128 a[228:231], v6 offset:29952
    v_mfma_f32_16x16x32_bf16 v[160:163], v[184:187], a[232:235], v[160:163]
    v_min_u32 v155, -2, v155
    v_mfma_f32_16x16x32_bf16 v[164:167], v[188:191], a[232:235], v[164:167]
    s_waitcnt lgkmcnt(8)
    ds_read_b128 a[232:235], v6 offset:32000
    v_mfma_f32_16x16x32_bf16 v[160:163], v[192:195], a[236:239], v[160:163]
    global_store_dwordx4 v10, v[152:155], s[62:63] offset:256 sc1
    v_mfma_f32_16x16x32_bf16 v[164:167], v[196:199], a[236:239], v[164:167]
    s_waitcnt lgkmcnt(8)
    ds_read_b128 a[236:239], v6 offset:34048
    s_add_u32 s62, s36, s77
    v_mfma_f32_16x16x32_bf16 v[160:163], v[200:203], a[240:243], v[160:163]
    global_load_dwordx4 a[152:155], v2, s[60:61] offset:-2048 sc1
    s_addc_u32 s63, s37, 0
    v_mfma_f32_16x16x32_bf16 v[164:167], v[204:207], a[240:243], v[164:167]
    s_waitcnt lgkmcnt(8)
    ds_read_b128 a[240:243], v7 offset:36096
    v_mfma_f32_16x16x32_bf16 v[160:163], a[0:3], a[244:247], v[160:163]
    v_mfma_f32_16x16x32_bf16 v[164:167], a[4:7], a[244:247], v[164:167]
    s_waitcnt lgkmcnt(8)
    ds_read_b128 a[244:247], v8 offset:36096
    v_mfma_f32_16x16x32_bf16 v[160:163], a[8:11], a[248:251], v[160:163]
    global_load_dwordx4 a[156:159], v2, s[60:61] offset:-1024 sc1
    v_mfma_f32_16x16x32_bf16 v[164:167], a[12:15], a[248:251], v[164:167]
    s_waitcnt lgkmcnt(8)
    ds_read_b128 a[248:251], v3 offset:18432
    v_mfma_f32_16x16x32_bf16 v[168:171], a[192:195], a[252:255], v[168:171]
    v_mfma_f32_16x16x32_bf16 v[172:175], a[196:199], a[252:255], v[172:175]
    s_waitcnt lgkmcnt(8)
    ds_read_b128 a[252:255], v3 offset:20480
    v_mfma_f32_16x16x32_bf16 v[168:171], a[200:203], a[216:219], v[168:171]
    v_cvt_pk_bf16_f32 v160, v160, v161
    v_cvt_pk_bf16_f32 v161, v162, v163
    v_mfma_f32_16x16x32_bf16 v[172:175], a[204:207], a[216:219], v[172:175]
    s_waitcnt lgkmcnt(8)
    global_load_dwordx4 a[160:163], v13, s[98:99] offset:-4096 sc1
    ds_read_b128 a[216:219], v3 offset:22528
    v_mfma_f32_16x16x32_bf16 v[168:171], a[208:211], a[220:223], v[168:171]
    v_cvt_pk_bf16_f32 v162, v164, v165
    v_cvt_pk_bf16_f32 v163, v166, v167
    v_mfma_f32_16x16x32_bf16 v[172:175], a[212:215], a[220:223], v[172:175]
    s_waitcnt lgkmcnt(8)
    ds_read_b128 a[220:223], v3 offset:24576
    v_min_u32 v160, -2, v160
    v_mfma_f32_16x16x32_bf16 v[168:171], v[176:179], a[224:227], v[168:171]
    v_min_u32 v161, -2, v161
    v_min_u32 v162, -2, v162
    v_mfma_f32_16x16x32_bf16 v[172:175], v[180:183], a[224:227], v[172:175]
    s_waitcnt lgkmcnt(8)
    global_load_dwordx4 a[164:167], v13, s[98:99] offset:-3072 sc1
    ds_read_b128 a[224:227], v4 offset:18432
    v_mfma_f32_16x16x32_bf16 v[168:171], v[184:187], a[228:231], v[168:171]
    v_min_u32 v163, -2, v163
    v_mfma_f32_16x16x32_bf16 v[172:175], v[188:191], a[228:231], v[172:175]
    s_waitcnt lgkmcnt(8)
    ds_read_b128 a[228:231], v4 offset:20480
    v_mfma_f32_16x16x32_bf16 v[168:171], v[192:195], a[232:235], v[168:171]
    global_store_dwordx4 v11, v[160:163], s[62:63] offset:0 sc1
    v_mfma_f32_16x16x32_bf16 v[172:175], v[196:199], a[232:235], v[172:175]
    s_waitcnt lgkmcnt(8)
    global_load_dwordx4 a[168:171], v13, s[98:99] offset:-2048 sc1
    ds_read_b128 a[232:235], v4 offset:22528
    v_mfma_f32_16x16x32_bf16 v[168:171], v[200:203], a[236:239], v[168:171]
    s_add_u32 s62, s36, s77
    s_addc_u32 s63, s37, 0
    v_mfma_f32_16x16x32_bf16 v[172:175], v[204:207], a[236:239], v[172:175]
    s_waitcnt lgkmcnt(8)
    ds_read_b128 a[236:239], v4 offset:24576
    v_mfma_f32_16x16x32_bf16 v[168:171], a[0:3], a[240:243], v[168:171]
    v_mfma_f32_16x16x32_bf16 v[172:175], a[4:7], a[240:243], v[172:175]
    s_waitcnt lgkmcnt(8)
    ds_read_b128 a[240:243], v5 offset:18432
    v_mfma_f32_16x16x32_bf16 v[168:171], a[8:11], a[244:247], v[168:171]
    global_load_dwordx4 a[172:175], v13, s[98:99] offset:-1024 sc1
    v_mfma_f32_16x16x32_bf16 v[172:175], a[12:15], a[244:247], v[172:175]
    s_waitcnt vmcnt(47) lgkmcnt(8)
    ds_read_b128 a[244:247], v5 offset:20480
    v_mfma_f32_16x16x32_bf16 v[80:83], a[16:19], a[248:251], 0
    v_mfma_f32_16x16x32_bf16 v[84:87], a[20:23], a[248:251], 0
    s_waitcnt vmcnt(45) lgkmcnt(8)
    ds_read_b128 a[248:251], v5 offset:22528
    v_mfma_f32_16x16x32_bf16 v[80:83], a[24:27], a[252:255], v[80:83]
    global_load_dwordx4 a[176:179], v13, s[98:99] offset:0 sc1
    v_cvt_pk_bf16_f32 v168, v168, v169
    v_mfma_f32_16x16x32_bf16 v[84:87], a[28:31], a[252:255], v[84:87]
    s_waitcnt vmcnt(43) lgkmcnt(8)
    ds_read_b128 a[252:255], v5 offset:24576
    v_cvt_pk_bf16_f32 v169, v170, v171
    v_mfma_f32_16x16x32_bf16 v[80:83], a[32:35], a[216:219], v[80:83]
    v_cvt_pk_bf16_f32 v170, v172, v173
    v_cvt_pk_bf16_f32 v171, v174, v175
    v_mfma_f32_16x16x32_bf16 v[84:87], a[36:39], a[216:219], v[84:87]
    s_waitcnt vmcnt(41) lgkmcnt(8)
    ds_read_b128 a[216:219], v6 offset:18432
    v_min_u32 v168, -2, v168
    v_mfma_f32_16x16x32_bf16 v[80:83], a[40:43], a[220:223], v[80:83]
    global_load_dwordx4 a[180:183], v13, s[98:99] offset:1024 sc1
    v_min_u32 v169, -2, v169
    v_mfma_f32_16x16x32_bf16 v[84:87], a[44:47], a[220:223], v[84:87]
    s_waitcnt vmcnt(39) lgkmcnt(8)
    ds_read_b128 a[220:223], v6 offset:20480
    v_min_u32 v170, -2, v170
    v_mfma_f32_16x16x32_bf16 v[80:83], a[48:51], a[224:227], v[80:83]
    v_min_u32 v171, -2, v171
    v_mfma_f32_16x16x32_bf16 v[84:87], a[52:55], a[224:227], v[84:87]
    s_waitcnt vmcnt(37) lgkmcnt(8)
    ds_read_b128 a[224:227], v6 offset:22528
    v_mfma_f32_16x16x32_bf16 v[80:83], a[56:59], a[228:231], v[80:83]
    global_store_dwordx4 v11, v[168:171], s[62:63] offset:256 sc1
    v_mfma_f32_16x16x32_bf16 v[84:87], a[60:63], a[228:231], v[84:87]
    s_waitcnt vmcnt(35) lgkmcnt(8)
    global_load_dwordx4 a[184:187], v13, s[98:99] offset:2048 sc1
    ds_read_b128 a[228:231], v6 offset:24576
    v_mfma_f32_16x16x32_bf16 v[80:83], a[64:67], a[232:235], v[80:83]
    buffer_load_dwordx4 v[240:243], v12, s[36:39], s66 offen sc1
    v_mfma_f32_16x16x32_bf16 v[84:87], a[68:71], a[232:235], v[84:87]
    s_waitcnt vmcnt(35) lgkmcnt(8)
    ds_read_b128 a[232:235], v7 offset:26624
    v_mfma_f32_16x16x32_bf16 v[80:83], a[72:75], a[236:239], v[80:83]
    buffer_load_dwordx4 v[244:247], v215, s[36:39], s66 offen sc1
    v_mfma_f32_16x16x32_bf16 v[84:87], a[76:79], a[236:239], v[84:87]
    s_waitcnt vmcnt(33) lgkmcnt(8)
    global_load_dwordx4 a[188:191], v13, s[98:99] offset:3072 sc1
    ds_read_b128 a[236:239], v8 offset:26624
    v_mfma_f32_16x16x32_bf16 v[80:83], a[80:83], a[240:243], v[80:83]
    buffer_load_dwordx4 v[248:251], v129, s[36:39], s73 offen sc1
    v_mfma_f32_16x16x32_bf16 v[84:87], a[84:87], a[240:243], v[84:87]
    s_waitcnt vmcnt(32) lgkmcnt(8)
    ds_read_b128 a[240:243], v3 offset:18688
    v_mfma_f32_16x16x32_bf16 v[80:83], a[88:91], a[244:247], v[80:83]
    buffer_load_dwordx4 v[252:255], v129, s[36:39], s74 offen sc1
    v_mfma_f32_16x16x32_bf16 v[84:87], a[92:95], a[244:247], v[84:87]
    s_waitcnt vmcnt(31) lgkmcnt(8)
    global_load_dwordx4 a[192:195], v13, s[100:101] offset:-4096 sc1
    ds_read_b128 a[244:247], v3 offset:20736
    v_mfma_f32_16x16x32_bf16 v[80:83], a[96:99], a[248:251], v[80:83]
    s_add_u32 s62, s36, s78
    s_addc_u32 s63, s37, 0
    v_mfma_f32_16x16x32_bf16 v[84:87], a[100:103], a[248:251], v[84:87]
    s_waitcnt vmcnt(29) lgkmcnt(8)
    ds_read_b128 a[248:251], v3 offset:22784
    v_mfma_f32_16x16x32_bf16 v[80:83], a[104:107], a[252:255], v[80:83]
    v_mfma_f32_16x16x32_bf16 v[84:87], a[108:111], a[252:255], v[84:87]
    s_waitcnt vmcnt(27) lgkmcnt(8)
    ds_read_b128 a[252:255], v3 offset:24832
    v_mfma_f32_16x16x32_bf16 v[80:83], a[112:115], a[216:219], v[80:83]
    global_load_dwordx4 a[196:199], v13, s[100:101] offset:-3072 sc1
    v_mfma_f32_16x16x32_bf16 v[84:87], a[116:119], a[216:219], v[84:87]
    s_waitcnt vmcnt(26) lgkmcnt(8)
    ds_read_b128 a[216:219], v4 offset:18688
    v_mfma_f32_16x16x32_bf16 v[80:83], a[120:123], a[220:223], v[80:83]
    v_mfma_f32_16x16x32_bf16 v[84:87], a[124:127], a[220:223], v[84:87]
    s_waitcnt vmcnt(24) lgkmcnt(8)
    ds_read_b128 a[220:223], v4 offset:20736
    v_mfma_f32_16x16x32_bf16 v[80:83], a[128:131], a[224:227], v[80:83]
    global_load_dwordx4 a[200:203], v13, s[100:101] offset:-2048 sc1
    v_mfma_f32_16x16x32_bf16 v[84:87], a[132:135], a[224:227], v[84:87]
    s_waitcnt vmcnt(22) lgkmcnt(8)
    ds_read_b128 a[224:227], v4 offset:22784
    v_mfma_f32_16x16x32_bf16 v[80:83], a[136:139], a[228:231], v[80:83]
    v_mfma_f32_16x16x32_bf16 v[84:87], a[140:143], a[228:231], v[84:87]
    s_waitcnt vmcnt(20) lgkmcnt(8)
    ds_read_b128 a[228:231], v4 offset:24832
    v_mfma_f32_16x16x32_bf16 v[80:83], a[144:147], a[232:235], v[80:83]
    global_load_dwordx4 a[204:207], v13, s[100:101] offset:-1024 sc1
    v_mfma_f32_16x16x32_bf16 v[84:87], a[148:151], a[232:235], v[84:87]
    s_waitcnt vmcnt(18) lgkmcnt(8)
    ds_read_b128 a[232:235], v5 offset:18688
    v_mfma_f32_16x16x32_bf16 v[80:83], a[152:155], a[236:239], v[80:83]
    v_mfma_f32_16x16x32_bf16 v[84:87], a[156:159], a[236:239], v[84:87]
    s_waitcnt lgkmcnt(8)
    ds_read_b128 a[236:239], v5 offset:20736
    v_mfma_f32_16x16x32_bf16 v[88:91], a[16:19], a[240:243], 0
    v_mfma_f32_16x16x32_bf16 v[92:95], a[20:23], a[240:243], 0
    s_waitcnt lgkmcnt(8)
    global_load_dwordx4 a[208:211], v13, s[100:101] offset:0 sc1
    ds_read_b128 a[240:243], v5 offset:22784
    v_mfma_f32_16x16x32_bf16 v[88:91], a[24:27], a[244:247], v[88:91]
    v_cvt_pk_bf16_f32 v80, v80, v81
    v_cvt_pk_bf16_f32 v81, v82, v83
    v_mfma_f32_16x16x32_bf16 v[92:95], a[28:31], a[244:247], v[92:95]
    s_waitcnt lgkmcnt(8)
    ds_read_b128 a[244:247], v5 offset:24832
    v_cvt_pk_bf16_f32 v82, v84, v85
    v_mfma_f32_16x16x32_bf16 v[88:91], a[32:35], a[248:251], v[88:91]
    v_cvt_pk_bf16_f32 v83, v86, v87
    v_min_u32 v80, -2, v80
    v_mfma_f32_16x16x32_bf16 v[92:95], a[36:39], a[248:251], v[92:95]
    s_waitcnt lgkmcnt(8)
    global_load_dwordx4 a[212:215], v13, s[100:101] offset:1024 sc1
    ds_read_b128 a[248:251], v6 offset:18688
    v_mfma_f32_16x16x32_bf16 v[88:91], a[40:43], a[252:255], v[88:91]
    v_min_u32 v81, -2, v81
    v_min_u32 v82, -2, v82
    v_mfma_f32_16x16x32_bf16 v[92:95], a[44:47], a[252:255], v[92:95]
    s_waitcnt lgkmcnt(8)
    ds_read_b128 a[252:255], v6 offset:20736
    v_min_u32 v83, -2, v83
    v_mfma_f32_16x16x32_bf16 v[88:91], a[48:51], a[216:219], v[88:91]
    global_store_dwordx4 v10, v[80:83], s[62:63] offset:0 sc1
    v_mfma_f32_16x16x32_bf16 v[92:95], a[52:55], a[216:219], v[92:95]
    s_waitcnt lgkmcnt(8)
    global_load_dwordx4 v[176:179], v13, s[100:101] offset:2048 sc1
    ds_read_b128 a[216:219], v6 offset:22784
    v_mfma_f32_16x16x32_bf16 v[88:91], a[56:59], a[220:223], v[88:91]
    s_add_u32 s62, s36, s78
    s_addc_u32 s63, s37, 0
    v_mfma_f32_16x16x32_bf16 v[92:95], a[60:63], a[220:223], v[92:95]
    s_waitcnt lgkmcnt(8)
    ds_read_b128 a[220:223], v6 offset:24832
    v_mfma_f32_16x16x32_bf16 v[88:91], a[64:67], a[224:227], v[88:91]
    v_mfma_f32_16x16x32_bf16 v[92:95], a[68:71], a[224:227], v[92:95]
    s_waitcnt lgkmcnt(8)
    ds_read_b128 a[224:227], v7 offset:26880
    v_mfma_f32_16x16x32_bf16 v[88:91], a[72:75], a[228:231], v[88:91]
    global_load_dwordx4 v[180:183], v13, s[100:101] offset:3072 sc1
    v_mfma_f32_16x16x32_bf16 v[92:95], a[76:79], a[228:231], v[92:95]
    s_waitcnt lgkmcnt(8)
    ds_read_b128 a[228:231], v8 offset:26880
    v_mfma_f32_16x16x32_bf16 v[88:91], a[80:83], a[232:235], v[88:91]
    v_mfma_f32_16x16x32_bf16 v[92:95], a[84:87], a[232:235], v[92:95]
    s_waitcnt lgkmcnt(8)
    ds_read_b128 a[232:235], v3 offset:27648
    v_mfma_f32_16x16x32_bf16 v[88:91], a[88:91], a[236:239], v[88:91]
    global_load_dwordx4 v[184:187], v2, s[24:25] offset:-2048 sc1
    v_mfma_f32_16x16x32_bf16 v[92:95], a[92:95], a[236:239], v[92:95]
    s_waitcnt lgkmcnt(8)
    ds_read_b128 a[236:239], v3 offset:29696
    v_mfma_f32_16x16x32_bf16 v[88:91], a[96:99], a[240:243], v[88:91]
    v_mfma_f32_16x16x32_bf16 v[92:95], a[100:103], a[240:243], v[92:95]
    s_waitcnt lgkmcnt(8)
    ds_read_b128 a[240:243], v3 offset:31744
    v_mfma_f32_16x16x32_bf16 v[88:91], a[104:107], a[244:247], v[88:91]
    v_mfma_f32_16x16x32_bf16 v[92:95], a[108:111], a[244:247], v[92:95]
    s_waitcnt lgkmcnt(8)
    global_load_dwordx4 v[188:191], v2, s[24:25] offset:-1024 sc1
    ds_read_b128 a[244:247], v3 offset:33792
    v_mfma_f32_16x16x32_bf16 v[88:91], a[112:115], a[248:251], v[88:91]
    v_mfma_f32_16x16x32_bf16 v[92:95], a[116:119], a[248:251], v[92:95]
    s_waitcnt lgkmcnt(8)
    ds_read_b128 a[248:251], v4 offset:27648
    v_mfma_f32_16x16x32_bf16 v[88:91], a[120:123], a[252:255], v[88:91]
    v_mfma_f32_16x16x32_bf16 v[92:95], a[124:127], a[252:255], v[92:95]
    s_waitcnt lgkmcnt(8)
    ds_read_b128 a[252:255], v4 offset:29696
    v_mfma_f32_16x16x32_bf16 v[88:91], a[128:131], a[216:219], v[88:91]
    v_mfma_f32_16x16x32_bf16 v[92:95], a[132:135], a[216:219], v[92:95]
    s_waitcnt lgkmcnt(8)
    ds_read_b128 a[216:219], v4 offset:31744
    v_mfma_f32_16x16x32_bf16 v[88:91], a[136:139], a[220:223], v[88:91]
    v_mfma_f32_16x16x32_bf16 v[92:95], a[140:143], a[220:223], v[92:95]
    s_waitcnt lgkmcnt(8)
    ds_read_b128 a[220:223], v4 offset:33792
    v_mfma_f32_16x16x32_bf16 v[88:91], a[144:147], a[224:227], v[88:91]
    v_mfma_f32_16x16x32_bf16 v[92:95], a[148:151], a[224:227], v[92:95]
    s_waitcnt lgkmcnt(8)
    ds_read_b128 a[224:227], v5 offset:27648
    v_mfma_f32_16x16x32_bf16 v[88:91], a[152:155], a[228:231], v[88:91]
    v_mfma_f32_16x16x32_bf16 v[92:95], a[156:159], a[228:231], v[92:95]
    s_waitcnt lgkmcnt(8)
    ds_read_b128 a[228:231], v5 offset:29696
    v_mfma_f32_16x16x32_bf16 v[96:99], a[16:19], a[232:235], 0
    v_mfma_f32_16x16x32_bf16 v[100:103], a[20:23], a[232:235], 0
    s_waitcnt lgkmcnt(8)
    ds_read_b128 a[232:235], v5 offset:31744
    v_mfma_f32_16x16x32_bf16 v[96:99], a[24:27], a[236:239], v[96:99]
    v_cvt_pk_bf16_f32 v88, v88, v89
    v_cvt_pk_bf16_f32 v89, v90, v91
    v_mfma_f32_16x16x32_bf16 v[100:103], a[28:31], a[236:239], v[100:103]
    s_waitcnt lgkmcnt(8)
    ds_read_b128 a[236:239], v5 offset:33792
    v_cvt_pk_bf16_f32 v90, v92, v93
    v_mfma_f32_16x16x32_bf16 v[96:99], a[32:35], a[240:243], v[96:99]
    v_cvt_pk_bf16_f32 v91, v94, v95
    v_min_u32 v88, -2, v88
    v_mfma_f32_16x16x32_bf16 v[100:103], a[36:39], a[240:243], v[100:103]
    s_waitcnt lgkmcnt(8)
    ds_read_b128 a[240:243], v6 offset:27648
    v_min_u32 v89, -2, v89
    v_mfma_f32_16x16x32_bf16 v[96:99], a[40:43], a[244:247], v[96:99]
    v_min_u32 v90, -2, v90
    v_min_u32 v91, -2, v91
    v_mfma_f32_16x16x32_bf16 v[100:103], a[44:47], a[244:247], v[100:103]
    s_waitcnt lgkmcnt(8)
    ds_read_b128 a[244:247], v6 offset:29696
    v_mfma_f32_16x16x32_bf16 v[96:99], a[48:51], a[248:251], v[96:99]
    global_store_dwordx4 v10, v[88:91], s[62:63] offset:256 sc1
    v_mfma_f32_16x16x32_bf16 v[100:103], a[52:55], a[248:251], v[100:103]
    s_waitcnt lgkmcnt(8)
    ds_read_b128 a[248:251], v6 offset:31744
    s_add_u32 s62, s36, s78
    v_mfma_f32_16x16x32_bf16 v[96:99], a[56:59], a[252:255], v[96:99]
    s_addc_u32 s63, s37, 0
    v_mfma_f32_16x16x32_bf16 v[100:103], a[60:63], a[252:255], v[100:103]
    s_waitcnt lgkmcnt(8)
    ds_read_b128 a[252:255], v6 offset:33792
    v_mfma_f32_16x16x32_bf16 v[96:99], a[64:67], a[216:219], v[96:99]
    v_mfma_f32_16x16x32_bf16 v[100:103], a[68:71], a[216:219], v[100:103]
    s_waitcnt lgkmcnt(8)
    ds_read_b128 a[216:219], v7 offset:35840
    v_mfma_f32_16x16x32_bf16 v[96:99], a[72:75], a[220:223], v[96:99]
    v_mfma_f32_16x16x32_bf16 v[100:103], a[76:79], a[220:223], v[100:103]
    s_waitcnt lgkmcnt(8)
    ds_read_b128 a[220:223], v8 offset:35840
    v_mfma_f32_16x16x32_bf16 v[96:99], a[80:83], a[224:227], v[96:99]
    v_mfma_f32_16x16x32_bf16 v[100:103], a[84:87], a[224:227], v[100:103]
    s_waitcnt lgkmcnt(8)
    ds_read_b128 a[224:227], v3 offset:27904
    v_mfma_f32_16x16x32_bf16 v[96:99], a[88:91], a[228:231], v[96:99]
    v_mfma_f32_16x16x32_bf16 v[100:103], a[92:95], a[228:231], v[100:103]
    s_waitcnt lgkmcnt(8)
    ds_read_b128 a[228:231], v3 offset:29952
    v_mfma_f32_16x16x32_bf16 v[96:99], a[96:99], a[232:235], v[96:99]
    v_mfma_f32_16x16x32_bf16 v[100:103], a[100:103], a[232:235], v[100:103]
    s_waitcnt lgkmcnt(8)
    ds_read_b128 a[232:235], v3 offset:32000
    v_mfma_f32_16x16x32_bf16 v[96:99], a[104:107], a[236:239], v[96:99]
    v_mfma_f32_16x16x32_bf16 v[100:103], a[108:111], a[236:239], v[100:103]
    s_waitcnt lgkmcnt(8)
    ds_read_b128 a[236:239], v3 offset:34048
    v_mfma_f32_16x16x32_bf16 v[96:99], a[112:115], a[240:243], v[96:99]
    v_mfma_f32_16x16x32_bf16 v[100:103], a[116:119], a[240:243], v[100:103]
    s_waitcnt lgkmcnt(8)
    ds_read_b128 a[240:243], v4 offset:27904
    v_mfma_f32_16x16x32_bf16 v[96:99], a[120:123], a[244:247], v[96:99]
    v_mfma_f32_16x16x32_bf16 v[100:103], a[124:127], a[244:247], v[100:103]
    s_waitcnt lgkmcnt(8)
    ds_read_b128 a[244:247], v4 offset:29952
    v_mfma_f32_16x16x32_bf16 v[96:99], a[128:131], a[248:251], v[96:99]
    v_mfma_f32_16x16x32_bf16 v[100:103], a[132:135], a[248:251], v[100:103]
    s_waitcnt lgkmcnt(8)
    ds_read_b128 a[248:251], v4 offset:32000
    v_mfma_f32_16x16x32_bf16 v[96:99], a[136:139], a[252:255], v[96:99]
    v_mfma_f32_16x16x32_bf16 v[100:103], a[140:143], a[252:255], v[100:103]
    s_waitcnt lgkmcnt(8)
    ds_read_b128 a[252:255], v4 offset:34048
    v_mfma_f32_16x16x32_bf16 v[96:99], a[144:147], a[216:219], v[96:99]
    v_mfma_f32_16x16x32_bf16 v[100:103], a[148:151], a[216:219], v[100:103]
    s_waitcnt lgkmcnt(8)
    ds_read_b128 a[216:219], v5 offset:27904
    v_mfma_f32_16x16x32_bf16 v[96:99], a[152:155], a[220:223], v[96:99]
    v_mfma_f32_16x16x32_bf16 v[100:103], a[156:159], a[220:223], v[100:103]
    s_waitcnt lgkmcnt(8)
    ds_read_b128 a[220:223], v5 offset:29952
    v_mfma_f32_16x16x32_bf16 v[104:107], a[16:19], a[224:227], 0
    v_mfma_f32_16x16x32_bf16 v[108:111], a[20:23], a[224:227], 0
    s_waitcnt lgkmcnt(8)
    ds_read_b128 a[224:227], v5 offset:32000
    v_mfma_f32_16x16x32_bf16 v[104:107], a[24:27], a[228:231], v[104:107]
    v_cvt_pk_bf16_f32 v96, v96, v97
    v_cvt_pk_bf16_f32 v97, v98, v99
    v_mfma_f32_16x16x32_bf16 v[108:111], a[28:31], a[228:231], v[108:111]
    s_waitcnt lgkmcnt(8)
    ds_read_b128 a[228:231], v5 offset:34048
    v_cvt_pk_bf16_f32 v98, v100, v101
    v_mfma_f32_16x16x32_bf16 v[104:107], a[32:35], a[232:235], v[104:107]
    v_cvt_pk_bf16_f32 v99, v102, v103
    v_min_u32 v96, -2, v96
    v_mfma_f32_16x16x32_bf16 v[108:111], a[36:39], a[232:235], v[108:111]
    s_waitcnt lgkmcnt(8)
    ds_read_b128 a[232:235], v6 offset:27904
    v_min_u32 v97, -2, v97
    v_mfma_f32_16x16x32_bf16 v[104:107], a[40:43], a[236:239], v[104:107]
    v_min_u32 v98, -2, v98
    v_min_u32 v99, -2, v99
    v_mfma_f32_16x16x32_bf16 v[108:111], a[44:47], a[236:239], v[108:111]
    s_waitcnt lgkmcnt(8)
    ds_read_b128 a[236:239], v6 offset:29952
    v_mfma_f32_16x16x32_bf16 v[104:107], a[48:51], a[240:243], v[104:107]
    global_store_dwordx4 v11, v[96:99], s[62:63] offset:0 sc1
    v_mfma_f32_16x16x32_bf16 v[108:111], a[52:55], a[240:243], v[108:111]
    s_waitcnt lgkmcnt(8)
    ds_read_b128 a[240:243], v6 offset:32000
    s_add_u32 s62, s36, s78
    v_mfma_f32_16x16x32_bf16 v[104:107], a[56:59], a[244:247], v[104:107]
    s_addc_u32 s63, s37, 0
    v_mfma_f32_16x16x32_bf16 v[108:111], a[60:63], a[244:247], v[108:111]
    s_waitcnt lgkmcnt(8)
    ds_read_b128 a[244:247], v6 offset:34048
    v_mfma_f32_16x16x32_bf16 v[104:107], a[64:67], a[248:251], v[104:107]
    v_mfma_f32_16x16x32_bf16 v[108:111], a[68:71], a[248:251], v[108:111]
    s_waitcnt lgkmcnt(8)
    ds_read_b128 a[248:251], v7 offset:36096
    v_mfma_f32_16x16x32_bf16 v[104:107], a[72:75], a[252:255], v[104:107]
    v_mfma_f32_16x16x32_bf16 v[108:111], a[76:79], a[252:255], v[108:111]
    s_waitcnt lgkmcnt(8)
    ds_read_b128 a[252:255], v8 offset:36096
    v_mfma_f32_16x16x32_bf16 v[104:107], a[80:83], a[216:219], v[104:107]
    v_mfma_f32_16x16x32_bf16 v[108:111], a[84:87], a[216:219], v[108:111]
    s_waitcnt lgkmcnt(8)
    ds_read_b128 a[216:219], v3 offset:18432
    v_mfma_f32_16x16x32_bf16 v[104:107], a[88:91], a[220:223], v[104:107]
    v_mfma_f32_16x16x32_bf16 v[108:111], a[92:95], a[220:223], v[108:111]
    s_waitcnt lgkmcnt(8)
    ds_read_b128 a[220:223], v3 offset:18688
    v_mfma_f32_16x16x32_bf16 v[104:107], a[96:99], a[224:227], v[104:107]
    v_mfma_f32_16x16x32_bf16 v[108:111], a[100:103], a[224:227], v[108:111]
    s_waitcnt lgkmcnt(8)
    ds_read_b128 a[224:227], v3 offset:27648
    v_mfma_f32_16x16x32_bf16 v[104:107], a[104:107], a[228:231], v[104:107]
    v_mfma_f32_16x16x32_bf16 v[108:111], a[108:111], a[228:231], v[108:111]
    s_waitcnt lgkmcnt(8)
    ds_read_b128 a[228:231], v3 offset:27904
    v_mfma_f32_16x16x32_bf16 v[104:107], a[112:115], a[232:235], v[104:107]
    v_mfma_f32_16x16x32_bf16 v[108:111], a[116:119], a[232:235], v[108:111]
    s_waitcnt lgkmcnt(8)
    ds_read_b128 a[232:235], v3 offset:20480
    v_mfma_f32_16x16x32_bf16 v[104:107], a[120:123], a[236:239], v[104:107]
    v_mfma_f32_16x16x32_bf16 v[108:111], a[124:127], a[236:239], v[108:111]
    s_waitcnt lgkmcnt(8)
    ds_read_b128 a[236:239], v3 offset:20736
    v_mfma_f32_16x16x32_bf16 v[104:107], a[128:131], a[240:243], v[104:107]
    v_mfma_f32_16x16x32_bf16 v[108:111], a[132:135], a[240:243], v[108:111]
    s_waitcnt lgkmcnt(8)
    ds_read_b128 a[240:243], v3 offset:29696
    v_mfma_f32_16x16x32_bf16 v[104:107], a[136:139], a[244:247], v[104:107]
    v_mfma_f32_16x16x32_bf16 v[108:111], a[140:143], a[244:247], v[108:111]
    s_waitcnt lgkmcnt(8)
    ds_read_b128 a[244:247], v3 offset:29952
    v_mfma_f32_16x16x32_bf16 v[104:107], a[144:147], a[248:251], v[104:107]
    v_mfma_f32_16x16x32_bf16 v[108:111], a[148:151], a[248:251], v[108:111]
    s_waitcnt lgkmcnt(8)
    ds_read_b128 a[248:251], v3 offset:22528
    v_mfma_f32_16x16x32_bf16 v[104:107], a[152:155], a[252:255], v[104:107]
    v_mfma_f32_16x16x32_bf16 v[108:111], a[156:159], a[252:255], v[108:111]
    s_waitcnt vmcnt(25) lgkmcnt(8)
    ds_read_b128 a[252:255], v3 offset:22784
    v_mfma_f32_16x16x32_bf16 v[16:19], a[160:163], a[216:219], 0
    v_mfma_f32_16x16x32_bf16 v[20:23], a[164:167], a[216:219], 0
    s_waitcnt lgkmcnt(8)
    ds_read_b128 a[216:219], v3 offset:31744
    v_mfma_f32_16x16x32_bf16 v[28:31], a[164:167], a[220:223], 0
    v_cvt_pk_bf16_f32 v104, v104, v105
    v_cvt_pk_bf16_f32 v105, v106, v107
    v_cvt_pk_bf16_f32 v106, v108, v109
    v_cvt_pk_bf16_f32 v107, v110, v111
    v_min_u32 v104, -2, v104
    v_min_u32 v105, -2, v105
    v_min_u32 v106, -2, v106
    v_min_u32 v107, -2, v107
    v_mfma_f32_16x16x32_bf16 v[24:27], a[160:163], a[220:223], 0
    s_waitcnt lgkmcnt(8)
    ds_read_b128 a[220:223], v3 offset:32000
    global_store_dwordx4 v11, v[104:107], s[62:63] offset:256 sc1
    v_mfma_f32_16x16x32_bf16 v[32:35], a[160:163], a[224:227], 0
    v_mfma_f32_16x16x32_bf16 v[36:39], a[164:167], a[224:227], 0
    s_waitcnt lgkmcnt(8)
    ds_read_b128 a[224:227], v3 offset:24576
    v_mfma_f32_16x16x32_bf16 v[44:47], a[164:167], a[228:231], 0
    buffer_load_dwordx4 v[112:115], v12, s[36:39], s67 offen sc1
    v_mfma_f32_16x16x32_bf16 v[40:43], a[160:163], a[228:231], 0
    s_waitcnt vmcnt(24) lgkmcnt(8)
    ds_read_b128 a[228:231], v3 offset:24832
    v_mfma_f32_16x16x32_bf16 v[16:19], a[168:171], a[232:235], v[16:19]
    buffer_load_dwordx4 v[116:119], v215, s[36:39], s67 offen sc1
    v_mfma_f32_16x16x32_bf16 v[20:23], a[172:175], a[232:235], v[20:23]
wc_pad5:
    s_cbranch_execz wc_ret
    s_waitcnt lgkmcnt(8)
    ds_read_b128 a[232:235], v3 offset:33792
    v_mfma_f32_16x16x32_bf16 v[28:31], a[172:175], a[236:239], v[28:31]
    buffer_load_dwordx4 v[120:123], v12, s[36:39], s68 offen sc1
    v_mfma_f32_16x16x32_bf16 v[24:27], a[168:171], a[236:239], v[24:27]
    s_waitcnt lgkmcnt(8)
    ds_read_b128 a[236:239], v3 offset:34048
    v_mfma_f32_16x16x32_bf16 v[32:35], a[168:171], a[240:243], v[32:35]
    buffer_load_dwordx4 v[124:127], v215, s[36:39], s68 offen sc1
    v_mfma_f32_16x16x32_bf16 v[36:39], a[172:175], a[240:243], v[36:39]
    s_waitcnt lgkmcnt(8)
    ds_read_b128 a[240:243], v5 offset:18432
    v_mfma_f32_16x16x32_bf16 v[44:47], a[172:175], a[244:247], v[44:47]
    buffer_load_dwordx4 v[144:147], v12, s[36:39], s69 offen sc1
    v_mfma_f32_16x16x32_bf16 v[40:43], a[168:171], a[244:247], v[40:43]
    s_waitcnt vmcnt(26) lgkmcnt(8)
    ds_read_b128 a[244:247], v5 offset:18688
    v_mfma_f32_16x16x32_bf16 v[16:19], a[176:179], a[248:251], v[16:19]
    buffer_load_dwordx4 v[148:151], v215, s[36:39], s69 offen sc1
    v_mfma_f32_16x16x32_bf16 v[20:23], a[180:183], a[248:251], v[20:23]
    s_waitcnt lgkmcnt(8)
    ds_read_b128 a[248:251], v5 offset:27648
    v_mfma_f32_16x16x32_bf16 v[28:31], a[180:183], a[252:255], v[28:31]
    buffer_load_dwordx4 v[152:155], v12, s[36:39], s70 offen sc1
    v_mfma_f32_16x16x32_bf16 v[24:27], a[176:179], a[252:255], v[24:27]
    s_waitcnt lgkmcnt(8)
    ds_read_b128 a[252:255], v5 offset:27904
    v_mfma_f32_16x16x32_bf16 v[32:35], a[176:179], a[216:219], v[32:35]
    buffer_load_dwordx4 v[156:159], v215, s[36:39], s70 offen sc1
    v_mfma_f32_16x16x32_bf16 v[36:39], a[180:183], a[216:219], v[36:39]
    s_waitcnt lgkmcnt(8)
    ds_read_b128 a[216:219], v5 offset:20480
    v_mfma_f32_16x16x32_bf16 v[44:47], a[180:183], a[220:223], v[44:47]
    buffer_load_dwordx4 v[160:163], v12, s[36:39], s71 offen sc1
    v_mfma_f32_16x16x32_bf16 v[40:43], a[176:179], a[220:223], v[40:43]
    s_waitcnt vmcnt(25) lgkmcnt(8)
    ds_read_b128 a[220:223], v5 offset:20736
    v_mfma_f32_16x16x32_bf16 v[16:19], a[184:187], a[224:227], v[16:19]
    buffer_load_dwordx4 v[164:167], v12, s[36:39], s72 offen sc1
    v_mfma_f32_16x16x32_bf16 v[20:23], a[188:191], a[224:227], v[20:23]
    s_waitcnt lgkmcnt(8)
    ds_read_b128 a[224:227], v5 offset:29696
    v_mfma_f32_16x16x32_bf16 v[28:31], a[188:191], a[228:231], v[28:31]
    s_waitcnt vmcnt(24)
    v_max3_u32 v15, v240, v241, v242
    v_max3_u32 v15, v15, v243, v244
    v_max3_u32 v15, v15, v245, v246
    v_mfma_f32_16x16x32_bf16 v[24:27], a[184:187], a[228:231], v[24:27]
    s_waitcnt lgkmcnt(8)
    ds_read_b128 a[228:231], v5 offset:29952
    v_max3_u32 v15, v15, v247, v248
    v_mfma_f32_16x16x32_bf16 v[32:35], a[184:187], a[232:235], v[32:35]
    v_max3_u32 v15, v15, v249, v250
    v_max3_u32 v15, v15, v251, v252
    v_max3_u32 v15, v15, v253, v254
    v_mfma_f32_16x16x32_bf16 v[36:39], a[188:191], a[232:235], v[36:39]
    s_waitcnt lgkmcnt(8)
    ds_read_b128 a[232:235], v5 offset:22528
    v_max_u32 v15, v15, v255
    v_mfma_f32_16x16x32_bf16 v[44:47], a[188:191], a[236:239], v[44:47]
    v_cmp_eq_u32 vcc, -1, v15
    s_cbranch_vccnz k4_slowA
k4_backA:
    v_lshlrev_b32 v224, 16, v240
    v_mfma_f32_16x16x32_bf16 v[40:43], a[184:187], a[236:239], v[40:43]
    s_waitcnt vmcnt(22) lgkmcnt(8)
    ds_read_b128 a[236:239], v5 offset:22784
    v_and_b32 v225, s7, v240
    v_mfma_f32_16x16x32_bf16 v[16:19], a[192:195], a[240:243], v[16:19]
    v_lshlrev_b32 v226, 16, v241
    v_and_b32 v227, s7, v241
    v_lshlrev_b32 v228, 16, v242
    v_mfma_f32_16x16x32_bf16 v[20:23], a[196:199], a[240:243], v[20:23]
    s_waitcnt lgkmcnt(8)
    ds_read_b128 a[240:243], v5 offset:31744
    v_and_b32 v229, s7, v242
    v_mfma_f32_16x16x32_bf16 v[28:31], a[196:199], a[244:247], v[28:31]
    v_lshlrev_b32 v230, 16, v243
    v_and_b32 v231, s7, v243
    v_lshlrev_b32 v232, 16, v244
    v_mfma_f32_16x16x32_bf16 v[24:27], a[192:195], a[244:247], v[24:27]
    s_waitcnt lgkmcnt(8)
    ds_read_b128 a[244:247], v5 offset:32000
    v_and_b32 v233, s7, v244
    v_mfma_f32_16x16x32_bf16 v[32:35], a[192:195], a[248:251], v[32:35]
    v_lshlrev_b32 v234, 16, v245
    v_and_b32 v235, s7, v245
    v_lshlrev_b32 v236, 16, v246
    v_mfma_f32_16x16x32_bf16 v[36:39], a[196:199], a[248:251], v[36:39]
    s_waitcnt lgkmcnt(8)
    ds_read_b128 a[248:251], v5 offset:24576
    v_and_b32 v237, s7, v246
    v_mfma_f32_16x16x32_bf16 v[44:47], a[196:199], a[252:255], v[44:47]
    v_lshlrev_b32 v238, 16, v247
    v_and_b32 v239, s7, v247
    v_lshlrev_b32 v240, 16, v248
    v_mfma_f32_16x16x32_bf16 v[40:43], a[192:195], a[252:255], v[40:43]
    s_waitcnt vmcnt(20) lgkmcnt(8)
    ds_read_b128 a[252:255], v5 offset:24832
    v_and_b32 v241, s7, v248
    v_mfma_f32_16x16x32_bf16 v[16:19], a[200:203], a[216:219], v[16:19]
    v_lshlrev_b32 v242, 16, v249
    v_and_b32 v243, s7, v249
    v_lshlrev_b32 v244, 16, v250
    v_mfma_f32_16x16x32_bf16 v[20:23], a[204:207], a[216:219], v[20:23]
    s_waitcnt lgkmcnt(8)
    ds_read_b128 a[216:219], v5 offset:33792
    v_and_b32 v245, s7, v250
    v_mfma_f32_16x16x32_bf16 v[28:31], a[204:207], a[220:223], v[28:31]
    v_lshlrev_b32 v246, 16, v251
    v_and_b32 v247, s7, v251
    v_lshlrev_b32 v9, 16, v252
    v_mfma_f32_16x16x32_bf16 v[24:27], a[200:203], a[220:223], v[24:27]
    s_waitcnt lgkmcnt(8)
    ds_read_b128 a[220:223], v5 offset:34048
    v_and_b32 v252, s7, v252
    v_mfma_f32_16x16x32_bf16 v[32:35], a[200:203], a[224:227], v[32:35]
    v_add_f32 v240, v240, v9
    v_add_f32 v241, v241, v252
    v_lshlrev_b32 v15, 16, v253
    v_mfma_f32_16x16x32_bf16 v[36:39], a[204:207], a[224:227], v[36:39]
    s_waitcnt lgkmcnt(8)
    ds_read_b128 a[224:227], v7 offset:26624
    v_and_b32 v253, s7, v253
    v_mfma_f32_16x16x32_bf16 v[44:47], a[204:207], a[228:231], v[44:47]
    v_add_f32 v242, v242, v15
    v_add_f32 v243, v243, v253
    v_lshlrev_b32 v9, 16, v254
    v_mfma_f32_16x16x32_bf16 v[40:43], a[200:203], a[228:231], v[40:43]
    s_waitcnt vmcnt(18) lgkmcnt(8)
    ds_read_b128 a[228:231], v7 offset:26880
    v_and_b32 v254, s7, v254
    v_mfma_f32_16x16x32_bf16 v[16:19], a[208:211], a[232:235], v[16:19]
    v_add_f32 v244, v244, v9
    v_add_f32 v245, v245, v254
    v_lshlrev_b32 v15, 16, v255
    v_mfma_f32_16x16x32_bf16 v[20:23], a[212:215], a[232:235], v[20:23]
    s_waitcnt lgkmcnt(8)
    ds_read_b128 a[232:235], v7 offset:35840
    v_and_b32 v255, s7, v255
    v_mfma_f32_16x16x32_bf16 v[28:31], a[212:215], a[236:239], v[28:31]
    v_add_f32 v246, v246, v15
    v_add_f32 v247, v247, v255
    v_mfma_f32_16x16x32_bf16 v[24:27], a[208:211], a[236:239], v[24:27]
    s_waitcnt lgkmcnt(8)
    ds_read_b128 a[236:239], v7 offset:36096
    v_mfma_f32_16x16x32_bf16 v[32:35], a[208:211], a[240:243], v[32:35]
    v_permlane32_swap_b32 v240, v244
    v_add_f32 v240, v240, v244
    v_mfma_f32_16x16x32_bf16 v[36:39], a[212:215], a[240:243], v[36:39]
    s_waitcnt lgkmcnt(8)
    v_permlane32_swap_b32 v241, v245
    v_mfma_f32_16x16x32_bf16 v[44:47], a[212:215], a[244:247], v[44:47]
    v_permlane32_swap_b32 v242, v246
    v_add_f32 v241, v241, v245
    v_mfma_f32_16x16x32_bf16 v[40:43], a[208:211], a[244:247], v[40:43]
    s_waitcnt vmcnt(15) lgkmcnt(7)
    v_permlane32_swap_b32 v243, v247
    v_mfma_f32_16x16x32_bf16 v[16:19], v[176:179], a[248:251], v[16:19]
    v_add_f32 v242, v242, v246
    v_add_f32 v243, v243, v247
    v_mfma_f32_16x16x32_bf16 v[20:23], v[180:183], a[248:251], v[20:23]
    s_waitcnt lgkmcnt(6)
    v_permlane16_swap_b32 v240, v242
    v_mfma_f32_16x16x32_bf16 v[28:31], v[180:183], a[252:255], v[28:31]
    v_permlane16_swap_b32 v241, v243
    v_add_f32 v240, v240, v242
    v_mfma_f32_16x16x32_bf16 v[24:27], v[176:179], a[252:255], v[24:27]
    s_waitcnt lgkmcnt(5)
    v_add_f32 v241, v241, v243
    v_fmac_f32 v132, v240, v14
    v_mfma_f32_16x16x32_bf16 v[32:35], v[176:179], a[216:219], v[32:35]
    v_fmac_f32 v133, v241, v14
    v_cvt_pk_bf16_f32 v132, v132, v133
    v_mfma_f32_16x16x32_bf16 v[36:39], v[180:183], a[216:219], v[36:39]
    s_waitcnt lgkmcnt(4)
    buffer_store_dword v132, v131, s[8:11], s80 offen sc1
    v_mfma_f32_16x16x32_bf16 v[44:47], v[180:183], a[220:223], v[44:47]
    v_add_u32 v9, s18, v12
    v_xor_b32 v9, 4096, v9
    v_mfma_f32_16x16x32_bf16 v[40:43], v[176:179], a[220:223], v[40:43]
    s_waitcnt vmcnt(14) lgkmcnt(3)
    v_mfma_f32_16x16x32_bf16 v[16:19], v[184:187], a[224:227], v[16:19]
    v_mfma_f32_16x16x32_bf16 v[20:23], v[188:191], a[224:227], v[20:23]
    s_waitcnt lgkmcnt(2)
    v_mfma_f32_16x16x32_bf16 v[28:31], v[188:191], a[228:231], v[28:31]
    v_mfma_f32_16x16x32_bf16 v[24:27], v[184:187], a[228:231], v[24:27]
    s_waitcnt lgkmcnt(1)
    v_mfma_f32_16x16x32_bf16 v[32:35], v[184:187], a[232:235], v[32:35]
    v_mfma_f32_16x16x32_bf16 v[36:39], v[188:191], a[232:235], v[36:39]
    s_waitcnt lgkmcnt(0)
    v_mfma_f32_16x16x32_bf16 v[44:47], v[188:191], a[236:239], v[44:47]
    v_mfma_f32_16x16x32_bf16 v[40:43], v[184:187], a[236:239], v[40:43]
    s_nop 1
    v_permlane32_swap_b32 v16, v24
    v_permlane32_swap_b32 v17, v25
    v_permlane32_swap_b32 v18, v26
    v_permlane32_swap_b32 v19, v27
    v_permlane32_swap_b32 v20, v28
    v_permlane32_swap_b32 v21, v29
    v_permlane32_swap_b32 v22, v30
    v_permlane32_swap_b32 v23, v31
    ds_write_b128 v9, v[24:27] offset:0
    ds_write_b128 v9, v[28:31] offset:1024
    v_permlane32_swap_b32 v32, v40
    v_permlane32_swap_b32 v33, v41
    v_permlane32_swap_b32 v34, v42
    v_permlane32_swap_b32 v35, v43
    v_permlane32_swap_b32 v36, v44
    v_permlane32_swap_b32 v37, v45
    v_permlane32_swap_b32 v38, v46
    v_permlane32_swap_b32 v39, v47
    ds_write_b128 v9, v[40:43] offset:2048
    ds_write_b128 v9, v[44:47] offset:3072
    v_xor_b32 v9, 4096, v9
    s_waitcnt lgkmcnt(0)
    s_barrier
    ds_read_b128 v[48:51], v9 offset:0
    ds_read_b128 v[52:55], v9 offset:1024
    ds_read_b128 v[56:59], v9 offset:2048
    ds_read_b128 v[60:63], v9 offset:3072
    buffer_load_dwordx4 v[168:171], v215, s[36:39], s71 offen sc1
    buffer_load_dwordx4 v[172:175], v215, s[36:39], s72 offen sc1
    s_waitcnt vmcnt(9)
    v_max3_u32 v15, v112, v113, v114
    v_max3_u32 v15, v15, v115, v116
    v_max3_u32 v15, v15, v117, v118
    v_max3_u32 v15, v15, v119, v120
    v_max3_u32 v15, v15, v121, v122
    v_max3_u32 v15, v15, v123, v124
    v_max3_u32 v15, v15, v125, v126
    v_max_u32 v15, v15, v127
    v_cmp_eq_u32 vcc, -1, v15
    s_cbranch_vccnz k4_slowB
k4_backB:
    v_dot2_f32_bf16 v224, v112, s81, v224
    v_dot2_f32_bf16 v225, v112, s82, v225
    v_dot2_f32_bf16 v226, v113, s81, v226
    v_dot2_f32_bf16 v227, v113, s82, v227
    v_dot2_f32_bf16 v228, v114, s81, v228
    v_dot2_f32_bf16 v229, v114, s82, v229
    v_dot2_f32_bf16 v230, v115, s81, v230
    v_dot2_f32_bf16 v231, v115, s82, v231
    v_dot2_f32_bf16 v232, v116, s81, v232
    v_dot2_f32_bf16 v233, v116, s82, v233
    v_dot2_f32_bf16 v234, v117, s81, v234
    v_dot2_f32_bf16 v235, v117, s82, v235
    v_dot2_f32_bf16 v236, v118, s81, v236
    v_dot2_f32_bf16 v237, v118, s82, v237
    v_dot2_f32_bf16 v238, v119, s81, v238
    v_dot2_f32_bf16 v239, v119, s82, v239
    v_dot2_f32_bf16 v224, v120, s81, v224
    v_dot2_f32_bf16 v225, v120, s82, v225
    v_dot2_f32_bf16 v226, v121, s81, v226
    v_dot2_f32_bf16 v227, v121, s82, v227
    v_dot2_f32_bf16 v228, v122, s81, v228
    v_dot2_f32_bf16 v229, v122, s82, v229
    v_dot2_f32_bf16 v230, v123, s81, v230
    v_dot2_f32_bf16 v231, v123, s82, v231
    v_dot2_f32_bf16 v232, v124, s81, v232
    v_dot2_f32_bf16 v233, v124, s82, v233
    v_dot2_f32_bf16 v234, v125, s81, v234
    v_dot2_f32_bf16 v235, v125, s82, v235
    v_dot2_f32_bf16 v236, v126, s81, v236
    v_dot2_f32_bf16 v237, v126, s82, v237
    v_dot2_f32_bf16 v238, v127, s81, v238
    v_dot2_f32_bf16 v239, v127, s82, v239
    s_waitcnt vmcnt(5)
    v_max3_u32 v15, v144, v145, v146
    v_max3_u32 v15, v15, v147, v148
    v_max3_u32 v15, v15, v149, v150
    v_max3_u32 v15, v15, v151, v152
    v_max3_u32 v15, v15, v153, v154
    v_max3_u32 v15, v15, v155, v156
    v_max3_u32 v15, v15, v157, v158
    v_max_u32 v15, v15, v159
    v_cmp_eq_u32 vcc, -1, v15
    s_cbranch_vccnz k4_slowC
k4_backC:
    v_dot2_f32_bf16 v224, v144, s81, v224
    v_dot2_f32_bf16 v225, v144, s82, v225
    v_dot2_f32_bf16 v226, v145, s81, v226
    v_dot2_f32_bf16 v227, v145, s82, v227
    v_dot2_f32_bf16 v228, v146, s81, v228
    v_dot2_f32_bf16 v229, v146, s82, v229
    v_dot2_f32_bf16 v230, v147, s81, v230
    v_dot2_f32_bf16 v231, v147, s82, v231
    v_dot2_f32_bf16 v232, v148, s81, v232
    v_dot2_f32_bf16 v233, v148, s82, v233
    v_dot2_f32_bf16 v234, v149, s81, v234
    v_dot2_f32_bf16 v235, v149, s82, v235
    v_dot2_f32_bf16 v236, v150, s81, v236
    v_dot2_f32_bf16 v237, v150, s82, v237
    v_dot2_f32_bf16 v238, v151, s81, v238
    v_dot2_f32_bf16 v239, v151, s82, v239
    v_dot2_f32_bf16 v224, v152, s81, v224
    v_dot2_f32_bf16 v225, v152, s82, v225
    v_dot2_f32_bf16 v226, v153, s81, v226
    v_dot2_f32_bf16 v227, v153, s82, v227
    v_dot2_f32_bf16 v228, v154, s81, v228
    v_dot2_f32_bf16 v229, v154, s82, v229
    v_dot2_f32_bf16 v230, v155, s81, v230
    v_dot2_f32_bf16 v231, v155, s82, v231
    v_dot2_f32_bf16 v232, v156, s81, v232
    v_dot2_f32_bf16 v233, v156, s82, v233
    v_dot2_f32_bf16 v234, v157, s81, v234
    v_dot2_f32_bf16 v235, v157, s82, v235
    v_dot2_f32_bf16 v236, v158, s81, v236
    v_dot2_f32_bf16 v237, v158, s82, v237
    v_dot2_f32_bf16 v238, v159, s81, v238
    v_dot2_f32_bf16 v239, v159, s82, v239
    v_pk_add_f32 v[224:225], v[16:17], v[224:225]
    v_pk_add_f32 v[226:227], v[18:19], v[226:227]
    v_pk_add_f32 v[228:229], v[20:21], v[228:229]
    v_pk_add_f32 v[230:231], v[22:23], v[230:231]
    v_pk_add_f32 v[232:233], v[32:33], v[232:233]
    v_pk_add_f32 v[234:235], v[34:35], v[234:235]
    v_pk_add_f32 v[236:237], v[36:37], v[236:237]
    v_pk_add_f32 v[238:239], v[38:39], v[238:239]
    s_waitcnt lgkmcnt(0)
    v_pk_add_f32 v[224:225], v[48:49], v[224:225]
    v_pk_add_f32 v[226:227], v[50:51], v[226:227]
    v_pk_add_f32 v[228:229], v[52:53], v[228:229]
    v_pk_add_f32 v[230:231], v[54:55], v[230:231]
    v_pk_add_f32 v[232:233], v[56:57], v[232:233]
    v_pk_add_f32 v[234:235], v[58:59], v[234:235]
    v_pk_add_f32 v[236:237], v[60:61], v[236:237]
    v_pk_add_f32 v[238:239], v[62:63], v[238:239]
    s_waitcnt vmcnt(3)
    v_max3_u32 v15, v160, v161, v162
    v_max3_u32 v15, v15, v163, v164
    v_max3_u32 v15, v15, v165, v166
    v_max_u32 v15, v15, v167
    v_cmp_eq_u32 vcc, -1, v15
    s_cbranch_vccnz k4_slowE
k4_backE:
    v_dot2_f32_bf16 v224, v160, s81, v224
    v_dot2_f32_bf16 v225, v160, s82, v225
    v_dot2_f32_bf16 v226, v161, s81, v226
    v_dot2_f32_bf16 v227, v161, s82, v227
    v_dot2_f32_bf16 v228, v162, s81, v228
    v_dot2_f32_bf16 v229, v162, s82, v229
    v_dot2_f32_bf16 v230, v163, s81, v230
    v_dot2_f32_bf16 v231, v163, s82, v231
    v_dot2_f32_bf16 v224, v164, s81, v224
    v_dot2_f32_bf16 v225, v164, s82, v225
    v_dot2_f32_bf16 v226, v165, s81, v226
    v_dot2_f32_bf16 v227, v165, s82, v227
    v_dot2_f32_bf16 v228, v166, s81, v228
    v_dot2_f32_bf16 v229, v166, s82, v229
    v_dot2_f32_bf16 v230, v167, s81, v230
    v_dot2_f32_bf16 v231, v167, s82, v231
    v_pk_fma_f32 v[136:137], v[224:225], v[212:213], v[136:137] op_sel:[0,0,0] op_sel_hi:[1,0,1]
    v_pk_fma_f32 v[138:139], v[226:227], v[212:213], v[138:139] op_sel:[0,0,0] op_sel_hi:[1,0,1]
    v_pk_fma_f32 v[140:141], v[228:229], v[212:213], v[140:141] op_sel:[0,0,0] op_sel_hi:[1,0,1]
    v_pk_fma_f32 v[142:143], v[230:231], v[212:213], v[142:143] op_sel:[0,0,0] op_sel_hi:[1,0,1]
    v_cvt_pk_bf16_f32 v136, v136, v137
    v_cvt_pk_bf16_f32 v137, v138, v139
    v_cvt_pk_bf16_f32 v138, v140, v141
    v_cvt_pk_bf16_f32 v139, v142, v143
    buffer_store_dwordx4 v[136:139], v128, s[8:11], s79 offen sc1
    s_waitcnt vmcnt(1)
    v_max3_u32 v15, v168, v169, v170
    v_max3_u32 v15, v15, v171, v172
    v_max3_u32 v15, v15, v173, v174
    v_max_u32 v15, v15, v175
    v_cmp_eq_u32 vcc, -1, v15
    s_cbranch_vccnz k4_slowD
k4_backD:
    v_dot2_f32_bf16 v232, v168, s81, v232
    v_dot2_f32_bf16 v233, v168, s82, v233
    v_dot2_f32_bf16 v234, v169, s81, v234
    v_dot2_f32_bf16 v235, v169, s82, v235
    v_dot2_f32_bf16 v236, v170, s81, v236
    v_dot2_f32_bf16 v237, v170, s82, v237
    v_dot2_f32_bf16 v238, v171, s81, v238
    v_dot2_f32_bf16 v239, v171, s82, v239
    v_dot2_f32_bf16 v232, v172, s81, v232
    v_dot2_f32_bf16 v233, v172, s82, v233
    v_dot2_f32_bf16 v234, v173, s81, v234
    v_dot2_f32_bf16 v235, v173, s82, v235
    v_dot2_f32_bf16 v236, v174, s81, v236
    v_dot2_f32_bf16 v237, v174, s82, v237
    v_dot2_f32_bf16 v238, v175, s81, v238
    v_dot2_f32_bf16 v239, v175, s82, v239
    v_pk_fma_f32 v[216:217], v[232:233], v[212:213], v[216:217] op_sel:[0,1,0] op_sel_hi:[1,1,1]
    v_pk_fma_f32 v[218:219], v[234:235], v[212:213], v[218:219] op_sel:[0,1,0] op_sel_hi:[1,1,1]
    v_pk_fma_f32 v[220:221], v[236:237], v[212:213], v[220:221] op_sel:[0,1,0] op_sel_hi:[1,1,1]
    v_pk_fma_f32 v[222:223], v[238:239], v[212:213], v[222:223] op_sel:[0,1,0] op_sel_hi:[1,1,1]
    v_cvt_pk_bf16_f32 v216, v216, v217
    v_cvt_pk_bf16_f32 v217, v218, v219
    v_cvt_pk_bf16_f32 v218, v220, v221
    v_cvt_pk_bf16_f32 v219, v222, v223
    buffer_store_dwordx4 v[216:219], v128, s[8:11], s85 offen sc1
    s_endpgm
k4_slowS:
    s_cmp_eq_u32 s83, 0
    s_cbranch_scc1 k4_backS
    s_sub_u32 s83, s83, 1
    buffer_load_dwordx4 v[128:131], v9, s[36:39], s7 offen offset:0 sc1
    buffer_load_dwordx4 v[132:135], v9, s[36:39], s7 offen offset:16 sc1
    buffer_load_dwordx4 v[136:139], v9, s[36:39], s7 offen offset:2048 sc1
    buffer_load_dwordx4 v[140:143], v9, s[36:39], s7 offen offset:2064 sc1
    s_waitcnt vmcnt(0)
    v_max3_u32 v15, v128, v129, v130
    v_max3_u32 v15, v15, v131, v132
    v_max3_u32 v15, v15, v133, v134
    v_max3_u32 v15, v15, v135, v136
    v_max3_u32 v15, v15, v137, v138
    v_max3_u32 v15, v15, v139, v140
    v_max3_u32 v15, v15, v141, v142
    v_max_u32 v15, v15, v143
    v_cmp_eq_u32 vcc, -1, v15
    s_cbranch_vccnz k4_slowS
    s_branch k4_backS
k4_slowA:
    s_cmp_eq_u32 s83, 0
    s_cbranch_scc1 k4_backA
    s_sub_u32 s83, s83, 1
    buffer_load_dwordx4 v[240:243], v12, s[36:39], s66 offen sc1
    buffer_load_dwordx4 v[244:247], v215, s[36:39], s66 offen sc1
    buffer_load_dwordx4 v[248:251], v129, s[36:39], s73 offen sc1
    buffer_load_dwordx4 v[252:255], v129, s[36:39], s74 offen sc1
    s_waitcnt vmcnt(0)
    v_max3_u32 v15, v240, v241, v242
    v_max3_u32 v15, v15, v243, v244
    v_max3_u32 v15, v15, v245, v246
    v_max3_u32 v15, v15, v247, v248
    v_max3_u32 v15, v15, v249, v250
    v_max3_u32 v15, v15, v251, v252
    v_max3_u32 v15, v15, v253, v254
    v_max_u32 v15, v15, v255
    v_cmp_eq_u32 vcc, -1, v15
    s_cbranch_vccnz k4_slowA
    s_branch k4_backA
k4_slowB:
    s_cmp_eq_u32 s83, 0
    s_cbranch_scc1 k4_backB
    s_sub_u32 s83, s83, 1
    buffer_load_dwordx4 v[112:115], v12, s[36:39], s67 offen sc1
    buffer_load_dwordx4 v[116:119], v215, s[36:39], s67 offen sc1
    buffer_load_dwordx4 v[120:123], v12, s[36:39], s68 offen sc1
    buffer_load_dwordx4 v[124:127], v215, s[36:39], s68 offen sc1
    s_waitcnt vmcnt(0)
    v_max3_u32 v15, v112, v113, v114
    v_max3_u32 v15, v15, v115, v116
    v_max3_u32 v15, v15, v117, v118
    v_max3_u32 v15, v15, v119, v120
    v_max3_u32 v15, v15, v121, v122
    v_max3_u32 v15, v15, v123, v124
    v_max3_u32 v15, v15, v125, v126
    v_max_u32 v15, v15, v127
    v_cmp_eq_u32 vcc, -1, v15
    s_cbranch_vccnz k4_slowB
    s_branch k4_backB
k4_slowC:
    s_cmp_eq_u32 s83, 0
    s_cbranch_scc1 k4_backC
    s_sub_u32 s83, s83, 1
    buffer_load_dwordx4 v[144:147], v12, s[36:39], s69 offen sc1
    buffer_load_dwordx4 v[148:151], v215, s[36:39], s69 offen sc1
    buffer_load_dwordx4 v[152:155], v12, s[36:39], s70 offen sc1
    buffer_load_dwordx4 v[156:159], v215, s[36:39], s70 offen sc1
    s_waitcnt vmcnt(0)
    v_max3_u32 v15, v144, v145, v146
    v_max3_u32 v15, v15, v147, v148
    v_max3_u32 v15, v15, v149, v150
    v_max3_u32 v15, v15, v151, v152
    v_max3_u32 v15, v15, v153, v154
    v_max3_u32 v15, v15, v155, v156
    v_max3_u32 v15, v15, v157, v158
    v_max_u32 v15, v15, v159
    v_cmp_eq_u32 vcc, -1, v15
    s_cbranch_vccnz k4_slowC
    s_branch k4_backC
k4_slowE:
    s_cmp_eq_u32 s83, 0
    s_cbranch_scc1 k4_backE
    s_sub_u32 s83, s83, 1
    buffer_load_dwordx4 v[160:163], v12, s[36:39], s71 offen sc1
    buffer_load_dwordx4 v[164:167], v12, s[36:39], s72 offen sc1
    s_waitcnt vmcnt(0)
    v_max3_u32 v15, v160, v161, v162
    v_max3_u32 v15, v15, v163, v164
    v_max3_u32 v15, v15, v165, v166
    v_max_u32 v15, v15, v167
    v_cmp_eq_u32 vcc, -1, v15
    s_cbranch_vccnz k4_slowE
    s_branch k4_backE
k4_slowD:
wc_pad6:
    s_cbranch_execz wc_ret
    s_cmp_eq_u32 s83, 0
    s_cbranch_scc1 k4_backD
    s_sub_u32 s83, s83, 1
    buffer_load_dwordx4 v[168:171], v215, s[36:39], s71 offen sc1
    buffer_load_dwordx4 v[172:175], v215, s[36:39], s72 offen sc1
    s_waitcnt vmcnt(0)
    v_max3_u32 v15, v168, v169, v170
    v_max3_u32 v15, v15, v171, v172
    v_max3_u32 v15, v15, v173, v174
    v_max_u32 v15, v15, v175
    v_cmp_eq_u32 vcc, -1, v15
    s_cbranch_vccnz k4_slowD
    s_branch k4_backD
hg_slow0:
wc_pad7:
    s_cbranch_execz wc_ret
    s_cmp_eq_u32 s83, 0
    s_cbranch_scc1 hg_back0
    s_sub_u32 s83, s83, 1
    buffer_load_dwordx4 v[128:131], v10, s[36:39], s4 offen offset:0 sc1
    buffer_load_dwordx4 v[132:135], v10, s[36:39], s4 offen offset:256 sc1
    buffer_load_dwordx4 v[136:139], v11, s[36:39], s4 offen offset:0 sc1
    buffer_load_dwordx4 v[140:143], v11, s[36:39], s4 offen offset:256 sc1
    s_waitcnt vmcnt(4)
    v_max3_u32 v15, v112, v113, v114
    v_max3_u32 v15, v15, v115, v116
    v_max3_u32 v15, v15, v117, v118
    v_max3_u32 v15, v15, v119, v120
    v_max3_u32 v15, v15, v121, v122
    v_max3_u32 v15, v15, v123, v124
    v_max3_u32 v15, v15, v125, v126
    v_max_u32 v15, v15, v127
    v_cmp_eq_u32 vcc, -1, v15
    s_cbranch_vccz hg_s0k1
    buffer_load_dwordx4 v[112:115], v10, s[36:39], s4 offen offset:2048 sc1
    buffer_load_dwordx4 v[116:119], v10, s[36:39], s4 offen offset:2304 sc1
    buffer_load_dwordx4 v[120:123], v11, s[36:39], s4 offen offset:2048 sc1
    buffer_load_dwordx4 v[124:127], v11, s[36:39], s4 offen offset:2304 sc1
hg_s0k1:
    v_max3_u32 v15, v216, v217, v218
    v_max3_u32 v15, v15, v219, v220
    v_max3_u32 v15, v15, v221, v222
    v_max3_u32 v15, v15, v223, v224
    v_max3_u32 v15, v15, v225, v226
    v_max3_u32 v15, v15, v227, v228
    v_max3_u32 v15, v15, v229, v230
    v_max_u32 v15, v15, v231
    v_cmp_eq_u32 vcc, -1, v15
    s_cbranch_vccz hg_s0k2
    buffer_load_dwordx4 v[216:219], v10, s[36:39], s5 offen offset:0 sc1
    buffer_load_dwordx4 v[220:223], v10, s[36:39], s5 offen offset:256 sc1
    buffer_load_dwordx4 v[224:227], v11, s[36:39], s5 offen offset:0 sc1
    buffer_load_dwordx4 v[228:231], v11, s[36:39], s5 offen offset:256 sc1
hg_s0k2:
    v_max3_u32 v15, v232, v233, v234
    v_max3_u32 v15, v15, v235, v236
    v_max3_u32 v15, v15, v237, v238
    v_max3_u32 v15, v15, v239, v240
    v_max3_u32 v15, v15, v241, v242
    v_max3_u32 v15, v15, v243, v244
    v_max3_u32 v15, v15, v245, v246
    v_max3_u32 v15, v15, v247, v248
    v_max3_u32 v15, v15, v249, v250
    v_max3_u32 v15, v15, v251, v252
    v_max3_u32 v15, v15, v253, v254
    v_max_u32 v15, v15, v255
    v_cmp_eq_u32 vcc, -1, v15
    s_cbranch_vccz hg_s0k3
    buffer_load_dwordx4 v[232:235], v10, s[36:39], s5 offen offset:2048 sc1
    buffer_load_dwordx4 v[236:239], v10, s[36:39], s5 offen offset:2304 sc1
    buffer_load_dwordx4 v[240:243], v11, s[36:39], s5 offen offset:2048 sc1
    buffer_load_dwordx4 v[244:247], v11, s[36:39], s5 offen offset:2304 sc1
    buffer_load_dwordx4 v[248:251], v12, s[36:39], s6 offen sc1
    buffer_load_dwordx4 v[252:255], v12, s[36:39], s62 offen sc1
hg_s0k3:
    s_waitcnt vmcnt(0)
    v_max3_u32 v15, v128, v129, v130
    v_max3_u32 v15, v15, v131, v132
    v_max3_u32 v15, v15, v133, v134
    v_max3_u32 v15, v15, v135, v136
    v_max3_u32 v15, v15, v137, v138
    v_max3_u32 v15, v15, v139, v140
    v_max3_u32 v15, v15, v141, v142
    v_max_u32 v15, v15, v143
    v_cmp_eq_u32 vcc, -1, v15
    s_nop 4
    s_cbranch_vccnz hg_slow0
    s_branch hg_back0
hg_slow1:
    s_cmp_eq_u32 s83, 0
    s_cbranch_scc1 hg_back1
    s_sub_u32 s83, s83, 1
    buffer_load_dwordx4 v[112:115], v10, s[36:39], s4 offen offset:2048 sc1
    buffer_load_dwordx4 v[116:119], v10, s[36:39], s4 offen offset:2304 sc1
    buffer_load_dwordx4 v[120:123], v11, s[36:39], s4 offen offset:2048 sc1
    buffer_load_dwordx4 v[124:127], v11, s[36:39], s4 offen offset:2304 sc1
    s_waitcnt vmcnt(4)
    v_max3_u32 v15, v216, v217, v218
    v_max3_u32 v15, v15, v219, v220
    v_max3_u32 v15, v15, v221, v222
    v_max3_u32 v15, v15, v223, v224
    v_max3_u32 v15, v15, v225, v226
    v_max3_u32 v15, v15, v227, v228
    v_max3_u32 v15, v15, v229, v230
    v_max_u32 v15, v15, v231
    v_cmp_eq_u32 vcc, -1, v15
    s_cbranch_vccz hg_s1k2
    buffer_load_dwordx4 v[216:219], v10, s[36:39], s5 offen offset:0 sc1
    buffer_load_dwordx4 v[220:223], v10, s[36:39], s5 offen offset:256 sc1
    buffer_load_dwordx4 v[224:227], v11, s[36:39], s5 offen offset:0 sc1
    buffer_load_dwordx4 v[228:231], v11, s[36:39], s5 offen offset:256 sc1
hg_s1k2:
    v_max3_u32 v15, v232, v233, v234
    v_max3_u32 v15, v15, v235, v236
    v_max3_u32 v15, v15, v237, v238
    v_max3_u32 v15, v15, v239, v240
    v_max3_u32 v15, v15, v241, v242
    v_max3_u32 v15, v15, v243, v244
    v_max3_u32 v15, v15, v245, v246
    v_max3_u32 v15, v15, v247, v248
    v_max3_u32 v15, v15, v249, v250
    v_max3_u32 v15, v15, v251, v252
    v_max3_u32 v15, v15, v253, v254
    v_max_u32 v15, v15, v255
    v_cmp_eq_u32 vcc, -1, v15
    s_cbranch_vccz hg_s1k3
    buffer_load_dwordx4 v[232:235], v10, s[36:39], s5 offen offset:2048 sc1
    buffer_load_dwordx4 v[236:239], v10, s[36:39], s5 offen offset:2304 sc1
    buffer_load_dwordx4 v[240:243], v11, s[36:39], s5 offen offset:2048 sc1
    buffer_load_dwordx4 v[244:247], v11, s[36:39], s5 offen offset:2304 sc1
    buffer_load_dwordx4 v[248:251], v12, s[36:39], s6 offen sc1
    buffer_load_dwordx4 v[252:255], v12, s[36:39], s62 offen sc1
hg_s1k3:
    s_waitcnt vmcnt(0)
    v_max3_u32 v15, v112, v113, v114
    v_max3_u32 v15, v15, v115, v116
    v_max3_u32 v15, v15, v117, v118
    v_max3_u32 v15, v15, v119, v120
    v_max3_u32 v15, v15, v121, v122
    v_max3_u32 v15, v15, v123, v124
    v_max3_u32 v15, v15, v125, v126
    v_max_u32 v15, v15, v127
    v_cmp_eq_u32 vcc, -1, v15
    s_nop 4
    s_cbranch_vccnz hg_slow1
    s_branch hg_back1
hg_slow2:
    s_cmp_eq_u32 s83, 0
    s_cbranch_scc1 hg_back2
    s_sub_u32 s83, s83, 1
    buffer_load_dwordx4 v[216:219], v10, s[36:39], s5 offen offset:0 sc1
    buffer_load_dwordx4 v[220:223], v10, s[36:39], s5 offen offset:256 sc1
    buffer_load_dwordx4 v[224:227], v11, s[36:39], s5 offen offset:0 sc1
    buffer_load_dwordx4 v[228:231], v11, s[36:39], s5 offen offset:256 sc1
    s_waitcnt vmcnt(4)
    v_max3_u32 v15, v232, v233, v234
    v_max3_u32 v15, v15, v235, v236
    v_max3_u32 v15, v15, v237, v238
    v_max3_u32 v15, v15, v239, v240
    v_max3_u32 v15, v15, v241, v242
    v_max3_u32 v15, v15, v243, v244
    v_max3_u32 v15, v15, v245, v246
    v_max3_u32 v15, v15, v247, v248
    v_max3_u32 v15, v15, v249, v250
    v_max3_u32 v15, v15, v251, v252
    v_max3_u32 v15, v15, v253, v254
    v_max_u32 v15, v15, v255
    v_cmp_eq_u32 vcc, -1, v15
    s_cbranch_vccz hg_s2k3
    buffer_load_dwordx4 v[232:235], v10, s[36:39], s5 offen offset:2048 sc1
    buffer_load_dwordx4 v[236:239], v10, s[36:39], s5 offen offset:2304 sc1
    buffer_load_dwordx4 v[240:243], v11, s[36:39], s5 offen offset:2048 sc1
    buffer_load_dwordx4 v[244:247], v11, s[36:39], s5 offen offset:2304 sc1
    buffer_load_dwordx4 v[248:251], v12, s[36:39], s6 offen sc1
    buffer_load_dwordx4 v[252:255], v12, s[36:39], s62 offen sc1
hg_s2k3:
    s_waitcnt vmcnt(0)
    v_max3_u32 v15, v216, v217, v218
    v_max3_u32 v15, v15, v219, v220
    v_max3_u32 v15, v15, v221, v222
    v_max3_u32 v15, v15, v223, v224
    v_max3_u32 v15, v15, v225, v226
    v_max3_u32 v15, v15, v227, v228
    v_max3_u32 v15, v15, v229, v230
    v_max_u32 v15, v15, v231
    v_cmp_eq_u32 vcc, -1, v15
    s_nop 4
    s_cbranch_vccnz hg_slow2
    s_branch hg_back2
hg_slow3:
    s_cmp_eq_u32 s83, 0
    s_cbranch_scc1 hg_back3
    s_sub_u32 s83, s83, 1
    buffer_load_dwordx4 v[232:235], v10, s[36:39], s5 offen offset:2048 sc1
    buffer_load_dwordx4 v[236:239], v10, s[36:39], s5 offen offset:2304 sc1
    buffer_load_dwordx4 v[240:243], v11, s[36:39], s5 offen offset:2048 sc1
    buffer_load_dwordx4 v[244:247], v11, s[36:39], s5 offen offset:2304 sc1
    buffer_load_dwordx4 v[248:251], v12, s[36:39], s6 offen sc1
    buffer_load_dwordx4 v[252:255], v12, s[36:39], s62 offen sc1
    s_waitcnt vmcnt(0)
    v_max3_u32 v15, v232, v233, v234
    v_max3_u32 v15, v15, v235, v236
    v_max3_u32 v15, v15, v237, v238
    v_max3_u32 v15, v15, v239, v240
    v_max3_u32 v15, v15, v241, v242
    v_max3_u32 v15, v15, v243, v244
    v_max3_u32 v15, v15, v245, v246
    v_max3_u32 v15, v15, v247, v248
    v_max3_u32 v15, v15, v249, v250
    v_max3_u32 v15, v15, v251, v252
    v_max3_u32 v15, v15, v253, v254
    v_max_u32 v15, v15, v255
    v_cmp_eq_u32 vcc, -1, v15
    s_nop 4
    s_cbranch_vccnz hg_slow3
    s_branch hg_back3
kc_fslow:
    s_cmp_eq_u32 s83, 0
    s_cbranch_scc1 kc_fback
    s_sub_u32 s83, s83, 1
    v_lshlrev_b32 v224, 2, v2
    s_mov_b32 s17, 3375136
    buffer_load_dwordx4 v[224:227], v224, s[36:39], s17 offen sc1
    s_waitcnt vmcnt(0)
    v_min3_u32 v224, v224, v225, v226
    v_min_u32 v224, v224, v227
    v_cmp_eq_u32 vcc, 0, v224
    s_nop 4
    s_cbranch_vccnz kc_fslow
    s_branch kc_fback
og_slow0:
wb_pad6:
    s_cbranch_execz wb_ret
    s_cmp_eq_u32 s83, 0
    s_cbranch_scc1 og_back0
    s_sub_u32 s83, s83, 1
    buffer_load_dwordx4 v[24:27], v2, s[36:39], s87 offen offset:1024 sc1
    buffer_load_dwordx4 v[28:31], v2, s[36:39], s87 offen offset:3072 sc1
    buffer_load_dwordx4 v[32:35], v2, s[36:39], s88 offen offset:1024 sc1
    buffer_load_dwordx4 v[36:39], v2, s[36:39], s88 offen offset:3072 sc1
    s_waitcnt vmcnt(4)
    v_max3_u32 v238, v40, v41, v42
    v_max3_u32 v238, v238, v43, v44
    v_max3_u32 v238, v238, v45, v46
    v_max3_u32 v238, v238, v47, v48
    v_max3_u32 v238, v238, v49, v50
    v_max3_u32 v238, v238, v51, v52
    v_max3_u32 v238, v238, v53, v54
    v_max_u32 v238, v238, v55
    v_cmp_eq_u32 vcc, -1, v238
    s_cbranch_vccz og_s0k1
    buffer_load_dwordx4 v[40:43], v13, s[36:39], s87 offen offset:1024 sc1
    buffer_load_dwordx4 v[44:47], v13, s[36:39], s87 offen offset:3072 sc1
    buffer_load_dwordx4 v[48:51], v13, s[36:39], s88 offen offset:1024 sc1
    buffer_load_dwordx4 v[52:55], v13, s[36:39], s88 offen offset:3072 sc1
og_s0k1:
    v_max3_u32 v238, v56, v57, v58
    v_max3_u32 v238, v238, v59, v60
    v_max3_u32 v238, v238, v61, v62
    v_max_u32 v238, v238, v63
    v_cmp_eq_u32 vcc, -1, v238
    s_cbranch_vccz og_s0k2
    buffer_load_dwordx4 v[56:59], v2, s[36:39], s89 offen offset:0 sc1
    buffer_load_dwordx4 v[60:63], v2, s[36:39], s89 offen offset:1024 sc1
og_s0k2:
    s_waitcnt vmcnt(0)
    v_max3_u32 v238, v24, v25, v26
    v_max3_u32 v238, v238, v27, v28
    v_max3_u32 v238, v238, v29, v30
    v_max3_u32 v238, v238, v31, v32
    v_max3_u32 v238, v238, v33, v34
    v_max3_u32 v238, v238, v35, v36
    v_max3_u32 v238, v238, v37, v38
    v_max_u32 v238, v238, v39
    v_cmp_eq_u32 vcc, -1, v238
    s_nop 4
    s_cbranch_vccnz og_slow0
    s_branch og_back0
og_slow1:
    s_cmp_eq_u32 s83, 0
    s_cbranch_scc1 og_back1
    s_sub_u32 s83, s83, 1
    buffer_load_dwordx4 v[40:43], v13, s[36:39], s87 offen offset:1024 sc1
    buffer_load_dwordx4 v[44:47], v13, s[36:39], s87 offen offset:3072 sc1
    buffer_load_dwordx4 v[48:51], v13, s[36:39], s88 offen offset:1024 sc1
    buffer_load_dwordx4 v[52:55], v13, s[36:39], s88 offen offset:3072 sc1
    s_waitcnt vmcnt(4)
    v_max3_u32 v238, v56, v57, v58
    v_max3_u32 v238, v238, v59, v60
    v_max3_u32 v238, v238, v61, v62
    v_max_u32 v238, v238, v63
    v_cmp_eq_u32 vcc, -1, v238
    s_cbranch_vccz og_s1k2
    buffer_load_dwordx4 v[56:59], v2, s[36:39], s89 offen offset:0 sc1
    buffer_load_dwordx4 v[60:63], v2, s[36:39], s89 offen offset:1024 sc1
og_s1k2:
    s_waitcnt vmcnt(0)
    v_max3_u32 v238, v40, v41, v42
    v_max3_u32 v238, v238, v43, v44
    v_max3_u32 v238, v238, v45, v46
    v_max3_u32 v238, v238, v47, v48
    v_max3_u32 v238, v238, v49, v50
    v_max3_u32 v238, v238, v51, v52
    v_max3_u32 v238, v238, v53, v54
    v_max_u32 v238, v238, v55
    v_cmp_eq_u32 vcc, -1, v238
    s_nop 4
    s_cbranch_vccnz og_slow1
    s_branch og_back1
og_slow2:
    s_cmp_eq_u32 s83, 0
    s_cbranch_scc1 og_back2
    s_sub_u32 s83, s83, 1
    buffer_load_dwordx4 v[56:59], v2, s[36:39], s89 offen offset:0 sc1
    buffer_load_dwordx4 v[60:63], v2, s[36:39], s89 offen offset:1024 sc1
    s_waitcnt vmcnt(0)
    v_max3_u32 v238, v56, v57, v58
    v_max3_u32 v238, v238, v59, v60
    v_max3_u32 v238, v238, v61, v62
    v_max_u32 v238, v238, v63
    v_cmp_eq_u32 vcc, -1, v238
    s_nop 4
    s_cbranch_vccnz og_slow2
    s_branch og_back2
oe_slow0:
wb_pad7:
    s_cbranch_execz wb_ret
    s_cmp_eq_u32 s83, 0
    s_cbranch_scc1 oe_back0
    s_sub_u32 s83, s83, 1
    buffer_load_dwordx4 v[64:67], v2, s[36:39], s87 offen offset:0 sc1
    buffer_load_dwordx4 v[68:71], v2, s[36:39], s87 offen offset:2048 sc1
    buffer_load_dwordx4 v[72:75], v2, s[36:39], s88 offen offset:0 sc1
    buffer_load_dwordx4 v[76:79], v2, s[36:39], s88 offen offset:2048 sc1
    s_waitcnt vmcnt(4)
    v_max3_u32 v238, v80, v81, v82
    v_max3_u32 v238, v238, v83, v84
    v_max3_u32 v238, v238, v85, v86
    v_max3_u32 v238, v238, v87, v16
    v_max3_u32 v238, v238, v17, v18
    v_max3_u32 v238, v238, v19, v20
    v_max3_u32 v238, v238, v21, v22
    v_max_u32 v238, v238, v23
    v_cmp_eq_u32 vcc, -1, v238
    s_cbranch_vccz oe_s0k1
    buffer_load_dwordx4 v[80:83], v13, s[36:39], s87 offen offset:0 sc1
    buffer_load_dwordx4 v[84:87], v13, s[36:39], s87 offen offset:2048 sc1
    buffer_load_dwordx4 v[16:19], v13, s[36:39], s88 offen offset:0 sc1
    buffer_load_dwordx4 v[20:23], v13, s[36:39], s88 offen offset:2048 sc1
oe_s0k1:
    s_waitcnt vmcnt(0)
    v_max3_u32 v238, v64, v65, v66
    v_max3_u32 v238, v238, v67, v68
    v_max3_u32 v238, v238, v69, v70
    v_max3_u32 v238, v238, v71, v72
    v_max3_u32 v238, v238, v73, v74
    v_max3_u32 v238, v238, v75, v76
    v_max3_u32 v238, v238, v77, v78
    v_max_u32 v238, v238, v79
    v_cmp_eq_u32 vcc, -1, v238
    s_nop 4
    s_cbranch_vccnz oe_slow0
    s_branch oe_back0
oe_slow1:
    s_cmp_eq_u32 s83, 0
    s_cbranch_scc1 oe_back1
    s_sub_u32 s83, s83, 1
    buffer_load_dwordx4 v[80:83], v13, s[36:39], s87 offen offset:0 sc1
    buffer_load_dwordx4 v[84:87], v13, s[36:39], s87 offen offset:2048 sc1
    buffer_load_dwordx4 v[16:19], v13, s[36:39], s88 offen offset:0 sc1
    buffer_load_dwordx4 v[20:23], v13, s[36:39], s88 offen offset:2048 sc1
    s_waitcnt vmcnt(0)
    v_max3_u32 v238, v80, v81, v82
    v_max3_u32 v238, v238, v83, v84
    v_max3_u32 v238, v238, v85, v86
    v_max3_u32 v238, v238, v87, v16
    v_max3_u32 v238, v238, v17, v18
    v_max3_u32 v238, v238, v19, v20
    v_max3_u32 v238, v238, v21, v22
    v_max_u32 v238, v238, v23
    v_cmp_eq_u32 vcc, -1, v238
    s_nop 4
    s_cbranch_vccnz oe_slow1
    s_branch oe_back1
k2_flslow:
    s_cmp_eq_u32 s63, 0
    s_cbranch_scc1 k2_flok
    s_sub_u32 s63, s63, 1
    v_lshlrev_b32 v240, 6, v1
    s_mov_b32 s17, 3375120
    buffer_load_dwordx4 v[240:243], v240, s[36:39], s17 offen sc1
    s_waitcnt vmcnt(0)
    s_branch k2_flchk
p1_pslow:
    s_cmp_eq_u32 s63, 0
    s_cbranch_scc1 p1_ok
    s_sub_u32 s63, s63, 1
    buffer_load_dwordx2 v[254:255], v5, s[36:39], s23 offen sc1
    s_branch p1_poll
p1_mkslow0:
    s_cmp_eq_u32 s63, 0
    s_cbranch_scc1 p1_mkok0
    s_sub_u32 s63, s63, 1
    buffer_load_dword v255, off, s[64:67], 0 sc1
    s_waitcnt vmcnt(0)
    s_branch p1_mk0
p1_mkslow1:
    s_cmp_eq_u32 s63, 0
    s_cbranch_scc1 p1_mkok1
    s_sub_u32 s63, s63, 1
    buffer_load_dword v255, off, s[64:67], 0 sc1
    s_waitcnt vmcnt(0)
    s_branch p1_mk1
p1_mkslow2:
    s_cmp_eq_u32 s63, 0
    s_cbranch_scc1 p1_mkok2
    s_sub_u32 s63, s63, 1
    buffer_load_dword v255, off, s[64:67], 0 sc1
    s_waitcnt vmcnt(0)
    s_branch p1_mk2
k2_fallback:
    s_waitcnt vmcnt(0)
    v_cndmask_b32 v20, 0, v20, s[52:53]
    v_cndmask_b32 v28, 0, v28, s[52:53]
    v_mov_b32 v128, 0xff7fffff
    v_mov_b32 v129, 0xff7fffff
    v_mov_b32 v141, 0
    s_mov_b32 s68, 3145728
    s_mov_b32 s69, 0
k2_fb_loop:
    s_lshr_b32 s17, s69, 2
    s_lshl_b32 s17, s17, 10
    s_and_b32 s18, s69, 3
    s_lshl_b32 s18, s18, 2
    s_add_u32 s17, s17, s18
    s_add_u32 s17, s17, 3342336
    buffer_load_dwordx4 v[136:139], v2, s[36:39], s68 offen sc1
    buffer_load_dword v140, v2, s[36:39], s17 offen sc1
    s_waitcnt vmcnt(0)
    v_mfma_f32_32x32x16_bf16 v[96:111], v[136:139], v[16:19], 0
    v_mfma_f32_32x32x8bf16_1k v[96:111], v[140:141], v[20:21], v[96:111]
    s_nop 11
    v_max3_f32 v128, v96, v97, v128
    v_max3_f32 v128, v98, v99, v128
    v_max3_f32 v128, v100, v101, v128
    v_max3_f32 v128, v102, v103, v128
    v_max3_f32 v128, v104, v105, v128
    v_max3_f32 v128, v106, v107, v128
    v_max3_f32 v128, v108, v109, v128
    v_max3_f32 v128, v110, v111, v128
    v_mfma_f32_32x32x16_bf16 v[96:111], v[136:139], v[24:27], 0
    v_mfma_f32_32x32x8bf16_1k v[96:111], v[140:141], v[28:29], v[96:111]
    s_nop 11
    v_max3_f32 v129, v96, v97, v129
    v_max3_f32 v129, v98, v99, v129
    v_max3_f32 v129, v100, v101, v129
    v_max3_f32 v129, v102, v103, v129
    v_max3_f32 v129, v104, v105, v129
    v_max3_f32 v129, v106, v107, v129
    v_max3_f32 v129, v108, v109, v129
    v_max3_f32 v129, v110, v111, v129
    s_add_u32 s68, s68, 2304
    s_add_u32 s69, s69, 1
    s_cmp_lt_u32 s69, 64
    s_nop 0
    s_cbranch_scc1 k2_fb_loop
    v_mov_b32 v136, v128
    s_nop 1
    v_permlane32_swap_b32 v136, v128
    v_max_f32 v128, v128, v136
    v_cvt_pk_bf16_f32 v105, v128, v128
    v_lshlrev_b32 v105, 16, v105
    v_sub_f32 v106, v128, v105
    v_cvt_pk_bf16_f32 v105, -v105, -v106
    v_cndmask_b32 v20, v105, v20, s[52:53]
    v_mov_b32 v136, v129
    s_nop 1
    v_permlane32_swap_b32 v136, v129
    v_max_f32 v129, v129, v136
    v_cvt_pk_bf16_f32 v105, v129, v129
    v_lshlrev_b32 v105, 16, v105
    v_sub_f32 v106, v129, v105
    v_cvt_pk_bf16_f32 v105, -v105, -v106
    v_cndmask_b32 v28, v105, v28, s[52:53]
    s_nop 1
    s_branch k2_main
sequential_preLN__grouped_kv_mqa__dense_activation_silu__prompt_kernel_end:
    s_endpgm
.section .rodata,"a"
.p2align 6
.amdhsa_kernel sequential_preLN__grouped_kv_mqa__dense_activation_silu__prompt_kernel
  .amdhsa_next_free_vgpr 512
  .amdhsa_next_free_sgpr 102
  .amdhsa_accum_offset 256
  .amdhsa_group_segment_fixed_size 0
  .amdhsa_kernarg_size 88
  .amdhsa_user_sgpr_count 2
  .amdhsa_user_sgpr_kernarg_segment_ptr 1
  .amdhsa_system_sgpr_workgroup_id_x 1
.end_amdhsa_kernel
```
